```python
import torch

def _softmax(x, axis=-1):
    return torch.softmax(x, dim=axis)

def _gelu(x):
    return torch.nn.functional.gelu(x, approximate='tanh')

def _silu(x):
    return torch.nn.functional.silu(x)

def _sigmoid(x):
    return torch.sigmoid(x)

def _layernorm(x, axis=-1, eps=1e-05):
    m = x.mean(dim=axis, keepdim=True)
    v = x.var(dim=axis, keepdim=True, unbiased=False)
    return (x - m) / torch.sqrt(v + eps)

def _scatter_add(tgt, idx, src, axis=0):
    return tgt.clone().index_add_(axis, idx, src)

def _segment_sum(src, seg, n):
    out = torch.zeros((n,) + src.shape[1:], dtype=src.dtype)
    return out.index_add_(0, seg, src)

def _pad(x, pw):
    flat = tuple((v for pair in reversed(pw) for v in pair))
    return torch.nn.functional.pad(x, flat)
kernel_name = 'parallel_sum__memory_aug_recurrent_mem_tr__glu_gated_reglu__prompt'

def setup_inputs():

    _w = lambda a: (lambda t: t.to(torch.bfloat16) if t.is_floating_point() else t)(torch.as_tensor(a))

    def _A_setup():
        B, S, Dm = (1, 2048, 640)
        H, Dh = (32, 192)
        M, seg = (8, 32)
        seg = min(seg, S)
        S = S // seg * seg
        return {'x': _w((lambda *s: torch.randn(*s, dtype=torch.bfloat16) * 0.05)(B, S, Dm)), 'mem0': _w((lambda *s: torch.randn(*s, dtype=torch.bfloat16) * 0.2)(B, M, Dm)), 'Wq': _w((lambda *s: torch.randn(*s, dtype=torch.bfloat16) * 1.6)(Dm, H, Dh) * Dm ** (-0.5)), 'Wk': _w((lambda *s: torch.randn(*s, dtype=torch.bfloat16) * 1.6)(Dm, H, Dh) * Dm ** (-0.5)), 'Wv': _w((lambda *s: torch.randn(*s, dtype=torch.bfloat16) * 0.2)(Dm, H, Dh) * Dm ** (-0.5)), 'Wo': _w((lambda *s: torch.randn(*s, dtype=torch.bfloat16) * 0.2)(H, Dh, Dm) * (H * Dh) ** (-0.5)), 'seg_len': seg}
    _A_in = _A_setup()

    def _B_setup():
        B, S, D, F = (1, 2048, 640, 1536)
        return {'x': _w((lambda *s: torch.randn(*s, dtype=torch.bfloat16) * 0.05)(B, S, D)), 'W_gate': _w((lambda *s: torch.randn(*s, dtype=torch.bfloat16) * 0.2)(D, F) * (2.0 / D) ** 0.5), 'W_up': _w((lambda *s: torch.randn(*s, dtype=torch.bfloat16) * 0.2)(D, F) * (2.0 / D) ** 0.5), 'W_down': _w((lambda *s: torch.randn(*s, dtype=torch.bfloat16) * 0.2)(F, D) * (1.0 / F) ** 0.5)}
    _B_in = _B_setup()
    return {'A_x': _A_in['x'], 'A_mem0': _A_in['mem0'], 'A_Wq': _A_in['Wq'], 'A_Wk': _A_in['Wk'], 'A_Wv': _A_in['Wv'], 'A_Wo': _A_in['Wo'], 'A_seg_len': _A_in['seg_len'], 'B_x': _B_in['x'], 'B_W_gate': _B_in['W_gate'], 'B_W_up': _B_in['W_up'], 'B_W_down': _B_in['W_down']}

def reference(A_x, A_mem0, A_Wq, A_Wk, A_Wv, A_Wo, A_seg_len, B_x, B_W_gate, B_W_up, B_W_down):

    def _A_ref(x, mem0, Wq, Wk, Wv, Wo, seg_len):
        B, S, Dm = x.shape
        H, Dh = (Wq.shape[1], Wq.shape[2])
        M = mem0.shape[1]
        scale = Dh ** (-0.5)
        n_seg = S // seg_len
        L = M + seg_len
        idx = torch.arange(L)
        mask = (idx[:, None] < M) | (idx[:, None] >= idx[None, :])
        mem = mem0
        outs = []
        for s in range(n_seg):
            xs = x[:, s * seg_len:(s + 1) * seg_len, :].clone()
            h = torch.concatenate([mem, xs], axis=1)
            q = torch.einsum('btd,dhe->bhte', h, Wq)
            k = torch.einsum('btd,dhe->bhte', h, Wk)
            v = torch.einsum('btd,dhe->bhte', h, Wv)
            scores = torch.einsum('bhqe,bhke->bhqk', q, k) * scale
            scores = torch.where(mask[None, None], scores, -1000000000.0)
            p = _softmax(scores, axis=-1)
            o = torch.einsum('bhqk,bhke->bhqe', p, v)
            o = torch.einsum('bhte,hed->btd', o, Wo)
            mem = o[:, :M, :].clone()
            outs.append(o[:, M:, :])
        return torch.concatenate(outs, axis=1)

    def _B_ref(x, W_gate, W_up, W_down):
        gate = torch.einsum('bsd,df->bsf', x, W_gate)
        up = torch.einsum('bsd,df->bsf', x, W_up)
        gate = gate * (lambda x, dt: x.to(dt))(gate > 0, gate.dtype)
        h = gate * up
        return torch.einsum('bsf,fd->bsd', h, W_down)
    x = A_x
    xn = _layernorm(x, axis=-1)
    return x + _A_ref(xn, A_mem0, A_Wq, A_Wk, A_Wv, A_Wo, A_seg_len) + _B_ref(xn, B_W_gate, B_W_up, B_W_down)
```

```asm
; @launch kernel=ln_kernel grid=(512,1,1) block=(256,1,1) lds=0
; @launch kernel=chain_kernel grid=(256,1,1) block=(256,1,1) lds=131072
; @launch kernel=fin_kernel grid=(640,1,1) block=(256,1,1) lds=0
.amdgcn_target "amdgcn-amd-amdhsa--gfx950"
.text
.globl ln_kernel
.p2align 8
.type ln_kernel,@function
ln_kernel:
    s_cmp_ge_u32 s2, 512
    s_cbranch_scc1 L_ln_done
    s_load_dwordx2 s[4:5], s[0:1], 0
    s_load_dwordx2 s[6:7], s[0:1], 8
    s_load_dwordx2 s[8:9], s[0:1], 104
    s_waitcnt lgkmcnt(0)
    s_mov_b32 s12, s4
    s_mov_b32 s13, s5
    s_mov_b32 s14, 0x280000
    s_mov_b32 s15, 0x20000
    s_mov_b32 s16, s8
    s_mov_b32 s17, s9
    s_mov_b32 s18, 0x280000
    s_mov_b32 s19, 0x20000
    s_mov_b32 s20, s6
    s_mov_b32 s21, s7
    s_mov_b32 s22, 0x2800
    s_mov_b32 s23, 0x20000
    s_add_u32 s24, s8, 0x9f00000
    s_addc_u32 s25, s9, 0
    s_mov_b32 s26, 0x420000
    s_mov_b32 s27, 0x20000
    s_add_u32 s28, s8, 0x9f00000
    s_addc_u32 s29, s9, 0
    s_mov_b32 s30, 0x80000
    s_mov_b32 s31, 0x20000
    s_add_u32 s36, s8, 0xa320000
    s_addc_u32 s37, s9, 0
    s_mov_b32 s38, 0x1000
    s_mov_b32 s39, 0x20000
    v_lshrrev_b32 v1, 6, v0
    v_and_b32 v2, 63, v0
    s_lshl_b32 s3, s2, 2
    v_add_u32 v3, s3, v1
    v_mul_u32_u24 v3, 1280, v3
    v_lshl_add_u32 v3, v2, 2, v3
    buffer_load_dword v10, v3, s[12:15], 0 offen
    buffer_load_dword v11, v3, s[12:15], 0 offen offset:256
    buffer_load_dword v12, v3, s[12:15], 0 offen offset:512
    buffer_load_dword v13, v3, s[12:15], 0 offen offset:768
    buffer_load_dword v14, v3, s[12:15], 0 offen offset:1024
    s_lshl_b32 s3, s2, 8
    v_add_u32 v4, s3, v0
    v_lshlrev_b32 v5, 4, v4
    v_mov_b32 v40, -1
    v_mov_b32 v41, -1
    v_mov_b32 v42, -1
    v_mov_b32 v43, -1
    v_add_u32 v6, 0x200000, v5
    v_add_u32 v7, 0x400000, v5
    v_and_b32 v8, 0xffff, v5
    v_cmp_le_u32 vcc, 0x4000, v8
    s_mov_b32 s34, 0x80000
    v_cmp_le_u32 s[32:33], s34, v5
    s_or_b64 vcc, vcc, s[32:33]
    s_and_saveexec_b64 s[32:33], vcc
    s_cbranch_execz L_ln_nofill
    buffer_store_dwordx4 v[40:43], v5, s[24:27], 0 offen
    L_ln_nofill:
    s_mov_b64 exec, s[32:33]
    buffer_store_dwordx4 v[40:43], v6, s[24:27], 0 offen
    buffer_store_dwordx4 v[40:43], v7, s[24:27], 0 offen
    v_lshlrev_b32 v7, 2, v4
    v_mov_b32 v8, 0
    buffer_store_dword v8, v7, s[36:39], 0 offen
    v_and_b32 v9, 1023, v4
    v_lshrrev_b32 v15, 10, v4
    v_and_b32 v6, 7, v9
    v_lshrrev_b32 v7, 3, v9
    v_mul_u32_u24 v8, 1280, v6
    v_lshl_add_u32 v8, v7, 4, v8
    v_cmp_gt_u32 vcc, 640, v9
    v_cmp_gt_u32 s[32:33], 8, v15
    s_and_b64 vcc, vcc, s[32:33]
    s_and_saveexec_b64 s[32:33], vcc
    s_cbranch_execz L_ln_nomem
    buffer_load_dwordx4 v[44:47], v8, s[20:23], 0 offen
    v_lshlrev_b32 v9, 7, v7
    v_lshl_add_u32 v9, v6, 4, v9
    v_lshl_add_u32 v9, v15, 16, v9
    s_waitcnt vmcnt(0)
    v_min_u32 v44, 0xfffffffe, v44
    v_min_u32 v45, 0xfffffffe, v45
    v_min_u32 v46, 0xfffffffe, v46
    v_min_u32 v47, 0xfffffffe, v47
    buffer_store_dwordx4 v[44:47], v9, s[28:31], 0 offen
L_ln_nomem:
    s_mov_b64 exec, s[32:33]
    s_waitcnt vmcnt(0)
    v_lshlrev_b32 v20, 16, v10
    v_and_b32 v21, 0xffff0000, v10
    v_lshlrev_b32 v22, 16, v11
    v_and_b32 v23, 0xffff0000, v11
    v_lshlrev_b32 v24, 16, v12
    v_and_b32 v25, 0xffff0000, v12
    v_lshlrev_b32 v26, 16, v13
    v_and_b32 v27, 0xffff0000, v13
    v_lshlrev_b32 v28, 16, v14
    v_and_b32 v29, 0xffff0000, v14
    v_add_f32 v30, v20, v21
    v_add_f32 v30, v30, v22
    v_add_f32 v30, v30, v23
    v_add_f32 v30, v30, v24
    v_add_f32 v30, v30, v25
    v_add_f32 v30, v30, v26
    v_add_f32 v30, v30, v27
    v_add_f32 v30, v30, v28
    v_add_f32 v30, v30, v29
    ds_swizzle_b32 v31, v30 offset:0x41f
    s_waitcnt lgkmcnt(0)
    v_add_f32 v30, v30, v31
    ds_swizzle_b32 v31, v30 offset:0x81f
    s_waitcnt lgkmcnt(0)
    v_add_f32 v30, v30, v31
    ds_swizzle_b32 v31, v30 offset:0x101f
    s_waitcnt lgkmcnt(0)
    v_add_f32 v30, v30, v31
    ds_swizzle_b32 v31, v30 offset:0x201f
    s_waitcnt lgkmcnt(0)
    v_add_f32 v30, v30, v31
    ds_swizzle_b32 v31, v30 offset:0x401f
    s_waitcnt lgkmcnt(0)
    v_add_f32 v30, v30, v31
    s_nop 0
    v_readlane_b32 s34, v30, 0
    v_readlane_b32 s35, v30, 32
    s_nop 1
    v_mov_b32 v30, s34
    v_add_f32 v30, s35, v30
    v_mul_f32 v30, 0.0015625, v30
    v_sub_f32 v32, v20, v30
    v_mul_f32 v33, v32, v32
    v_sub_f32 v32, v21, v30
    v_fmac_f32 v33, v32, v32
    v_sub_f32 v32, v22, v30
    v_fmac_f32 v33, v32, v32
    v_sub_f32 v32, v23, v30
    v_fmac_f32 v33, v32, v32
    v_sub_f32 v32, v24, v30
    v_fmac_f32 v33, v32, v32
    v_sub_f32 v32, v25, v30
    v_fmac_f32 v33, v32, v32
    v_sub_f32 v32, v26, v30
    v_fmac_f32 v33, v32, v32
    v_sub_f32 v32, v27, v30
    v_fmac_f32 v33, v32, v32
    v_sub_f32 v32, v28, v30
    v_fmac_f32 v33, v32, v32
    v_sub_f32 v32, v29, v30
    v_fmac_f32 v33, v32, v32
    ds_swizzle_b32 v31, v33 offset:0x41f
    s_waitcnt lgkmcnt(0)
    v_add_f32 v33, v33, v31
    ds_swizzle_b32 v31, v33 offset:0x81f
    s_waitcnt lgkmcnt(0)
    v_add_f32 v33, v33, v31
    ds_swizzle_b32 v31, v33 offset:0x101f
    s_waitcnt lgkmcnt(0)
    v_add_f32 v33, v33, v31
    ds_swizzle_b32 v31, v33 offset:0x201f
    s_waitcnt lgkmcnt(0)
    v_add_f32 v33, v33, v31
    ds_swizzle_b32 v31, v33 offset:0x401f
    s_waitcnt lgkmcnt(0)
    v_add_f32 v33, v33, v31
    s_nop 0
    v_readlane_b32 s34, v33, 0
    v_readlane_b32 s35, v33, 32
    s_nop 1
    v_mov_b32 v33, s34
    v_add_f32 v33, s35, v33
    v_mul_f32 v33, 0.0015625, v33
    v_cvt_pk_bf16_f32 v30, v30, v30
    v_lshlrev_b32 v30, 16, v30
    v_cvt_pk_bf16_f32 v33, v33, v33
    v_lshlrev_b32 v33, 16, v33
    v_add_f32 v33, 0x3727c5ac, v33
    v_cvt_pk_bf16_f32 v33, v33, v33
    v_lshlrev_b32 v33, 16, v33
    v_sqrt_f32 v33, v33
    s_nop 0
    v_cvt_pk_bf16_f32 v33, v33, v33
    v_lshlrev_b32 v33, 16, v33
    v_rcp_f32 v34, v33
    s_nop 0
    v_sub_f32 v20, v20, v30
    v_cvt_pk_bf16_f32 v20, v20, v20
    v_lshlrev_b32 v20, 16, v20
    v_mul_f32 v35, v20, v34
    v_fma_f32 v36, -v35, v33, v20
    v_fma_f32 v20, v36, v34, v35
    v_sub_f32 v21, v21, v30
    v_cvt_pk_bf16_f32 v21, v21, v21
    v_lshlrev_b32 v21, 16, v21
    v_mul_f32 v35, v21, v34
    v_fma_f32 v36, -v35, v33, v21
    v_fma_f32 v21, v36, v34, v35
    v_sub_f32 v22, v22, v30
    v_cvt_pk_bf16_f32 v22, v22, v22
    v_lshlrev_b32 v22, 16, v22
    v_mul_f32 v35, v22, v34
    v_fma_f32 v36, -v35, v33, v22
    v_fma_f32 v22, v36, v34, v35
    v_sub_f32 v23, v23, v30
    v_cvt_pk_bf16_f32 v23, v23, v23
    v_lshlrev_b32 v23, 16, v23
    v_mul_f32 v35, v23, v34
    v_fma_f32 v36, -v35, v33, v23
    v_fma_f32 v23, v36, v34, v35
    v_sub_f32 v24, v24, v30
    v_cvt_pk_bf16_f32 v24, v24, v24
    v_lshlrev_b32 v24, 16, v24
    v_mul_f32 v35, v24, v34
    v_fma_f32 v36, -v35, v33, v24
    v_fma_f32 v24, v36, v34, v35
    v_sub_f32 v25, v25, v30
    v_cvt_pk_bf16_f32 v25, v25, v25
    v_lshlrev_b32 v25, 16, v25
    v_mul_f32 v35, v25, v34
    v_fma_f32 v36, -v35, v33, v25
    v_fma_f32 v25, v36, v34, v35
    v_sub_f32 v26, v26, v30
    v_cvt_pk_bf16_f32 v26, v26, v26
    v_lshlrev_b32 v26, 16, v26
    v_mul_f32 v35, v26, v34
    v_fma_f32 v36, -v35, v33, v26
    v_fma_f32 v26, v36, v34, v35
    v_sub_f32 v27, v27, v30
    v_cvt_pk_bf16_f32 v27, v27, v27
    v_lshlrev_b32 v27, 16, v27
    v_mul_f32 v35, v27, v34
    v_fma_f32 v36, -v35, v33, v27
    v_fma_f32 v27, v36, v34, v35
    v_sub_f32 v28, v28, v30
    v_cvt_pk_bf16_f32 v28, v28, v28
    v_lshlrev_b32 v28, 16, v28
    v_mul_f32 v35, v28, v34
    v_fma_f32 v36, -v35, v33, v28
    v_fma_f32 v28, v36, v34, v35
    v_sub_f32 v29, v29, v30
    v_cvt_pk_bf16_f32 v29, v29, v29
    v_lshlrev_b32 v29, 16, v29
    v_mul_f32 v35, v29, v34
    v_fma_f32 v36, -v35, v33, v29
    v_fma_f32 v29, v36, v34, v35
    v_cvt_pk_bf16_f32 v10, v20, v21
    v_cvt_pk_bf16_f32 v11, v22, v23
    v_cvt_pk_bf16_f32 v12, v24, v25
    v_cvt_pk_bf16_f32 v13, v26, v27
    v_cvt_pk_bf16_f32 v14, v28, v29
    buffer_store_dword v10, v3, s[16:19], 0 offen
    buffer_store_dword v11, v3, s[16:19], 0 offen offset:256
    buffer_store_dword v12, v3, s[16:19], 0 offen offset:512
    buffer_store_dword v13, v3, s[16:19], 0 offen offset:768
    buffer_store_dword v14, v3, s[16:19], 0 offen offset:1024
L_ln_done:
    s_endpgm
.globl chain_kernel
.p2align 8
.type chain_kernel,@function
chain_kernel:
    s_cmp_ge_u32 s2, 256
    s_cbranch_scc1 L_ch_done
    s_load_dwordx2 s[4:5], s[0:1], 104
    s_load_dwordx2 s[6:7], s[0:1], 16
    s_load_dwordx2 s[8:9], s[0:1], 24
    s_load_dwordx2 s[10:11], s[0:1], 32
    s_load_dwordx2 s[12:13], s[0:1], 40
    s_load_dwordx2 s[84:85], s[0:1], 96
    s_load_dwordx2 s[86:87], s[0:1], 64
    s_load_dwordx2 s[88:89], s[0:1], 72
    v_lshrrev_b32 v1, 6, v0
    v_and_b32 v2, 63, v0
    s_nop 0
    v_readfirstlane_b32 s40, v1
    s_and_b32 s41, s2, 7
    s_lshl_b32 s41, s41, 2
    s_lshr_b32 s42, s2, 5
    s_add_u32 s41, s41, s42
    s_lshr_b32 s42, s2, 3
    s_and_b32 s42, s42, 3
    s_waitcnt lgkmcnt(0)
    s_and_b32 s43, s2, 7
    s_lshl_b32 s43, s43, 16
    s_add_u32 s43, s43, 0x9f00000
    s_add_u32 s16, s4, s43
    s_addc_u32 s17, s5, 0
    s_mov_b32 s18, 0x10000
    s_mov_b32 s19, 0x20000
    s_add_u32 s20, s4, 0x9f80000
    s_addc_u32 s21, s5, 0
    s_mov_b32 s22, 0x120000
    s_mov_b32 s23, 0x20000
    s_add_u32 s24, s4, 0xa0a0000
    s_addc_u32 s25, s5, 0
    s_mov_b32 s26, 0x280000
    s_mov_b32 s27, 0x20000
    s_add_u32 s28, s4, 0x6b00000
    s_addc_u32 s29, s5, 0
    s_mov_b32 s30, 0xc00000
    s_mov_b32 s31, 0x20000
    s_add_u32 s32, s4, 0x1a80000
    s_addc_u32 s33, s5, 0
    s_mov_b32 s34, 0x1800000
    s_mov_b32 s35, 0x20000
    s_add_u32 s36, s4, 0x3280000
    s_addc_u32 s37, s5, 0
    s_mov_b32 s38, 0x1800000
    s_mov_b32 s39, 0x20000
    s_add_u32 s92, s4, 0xa320000
    s_addc_u32 s93, s5, 0
    s_mov_b32 s94, 0x1000
    s_mov_b32 s95, 0x20000
    v_and_b32 v3, 15, v2
    v_lshrrev_b32 v4, 4, v2
    v_and_b32 v5, 7, v2
    s_cmp_ge_u32 s2, 129
    s_cbranch_scc1 L_ch_worker
    s_cmp_eq_u32 s2, 128
    s_cbranch_scc1 L_ch_monitor
    v_lshrrev_b32 v6, 1, v2
    v_and_b32 v7, 1, v2
    s_mul_i32 s43, s40, 160
    v_add_u32 v8, s43, v6
    s_mov_b32 s60, 12288
    v_mul_lo_u32 v8, v8, s60
    v_lshl_add_u32 v8, v7, 4, v8
    s_mul_i32 s43, s40, 9216
    v_lshlrev_b32 v9, 4, v2
    v_add_u32 v9, s43, v9
    v_lshrrev_b32 v10, 2, v3
    v_and_b32 v11, 3, v2
    v_lshl_add_u32 v12, v4, 3, v10
    v_lshlrev_b32 v12, 5, v12
    v_lshl_add_u32 v12, v11, 3, v12
    v_add_u32 v12, s43, v12
    v_lshl_add_u32 v13, v4, 2, v10
    v_lshlrev_b32 v13, 5, v13
    v_lshl_add_u32 v13, v11, 3, v13
    v_add_u32 v13, s43, v13
    s_mov_b32 s46, 0x780000
    s_mov_b32 s47, 0x20000
    s_mul_i32 s50, s40, 3
    s_cmp_eq_u32 s40, 3
    s_cselect_b32 s50, 8, s50
    s_mul_i32 s48, s41, 192
    v_add_u32 v14, s48, v6
    v_mul_u32_u24 v14, 1280, v14
    v_lshl_add_u32 v14, v7, 4, v14
    s_mov_b32 s52, s12
    s_mov_b32 s53, s13
    s_mov_b32 s54, 0x780000
    s_mov_b32 s55, 0x20000
    s_mul_i32 s48, s42, 9
    s_add_u32 s48, s48, 0
    s_cmp_ge_u32 s48, 12
    s_cselect_b32 s44, s8, s6
    s_cselect_b32 s45, s9, s7
    s_cselect_b32 s49, 12, 0
    s_cmp_ge_u32 s48, 24
    s_cselect_b32 s44, s10, s44
    s_cselect_b32 s45, s11, s45
    s_cselect_b32 s49, 24, s49
    s_sub_u32 s48, s48, s49
    s_lshl_b32 s48, s48, 5
    s_mul_i32 s49, s41, 384
    s_add_u32 s48, s48, s49
    s_add_u32 s48, s48, 0x0
    buffer_load_dwordx4 v[32:35], v8, s[44:47], s48 offen
    s_mul_i32 s48, s42, 9
    s_add_u32 s48, s48, 1
    s_cmp_ge_u32 s48, 12
    s_cselect_b32 s44, s8, s6
    s_cselect_b32 s45, s9, s7
    s_cselect_b32 s49, 12, 0
    s_cmp_ge_u32 s48, 24
    s_cselect_b32 s44, s10, s44
    s_cselect_b32 s45, s11, s45
    s_cselect_b32 s49, 24, s49
    s_sub_u32 s48, s48, s49
    s_lshl_b32 s48, s48, 5
    s_mul_i32 s49, s41, 384
    s_add_u32 s48, s48, s49
    s_add_u32 s48, s48, 0x0
    buffer_load_dwordx4 v[36:39], v8, s[44:47], s48 offen
    s_mul_i32 s48, s42, 9
    s_add_u32 s48, s48, 2
    s_cmp_ge_u32 s48, 12
    s_cselect_b32 s44, s8, s6
    s_cselect_b32 s45, s9, s7
    s_cselect_b32 s49, 12, 0
    s_cmp_ge_u32 s48, 24
    s_cselect_b32 s44, s10, s44
    s_cselect_b32 s45, s11, s45
    s_cselect_b32 s49, 24, s49
    s_sub_u32 s48, s48, s49
    s_lshl_b32 s48, s48, 5
    s_mul_i32 s49, s41, 384
    s_add_u32 s48, s48, s49
    s_add_u32 s48, s48, 0x0
    buffer_load_dwordx4 v[40:43], v8, s[44:47], s48 offen
    s_mul_i32 s48, s42, 9
    s_add_u32 s48, s48, 3
    s_cmp_ge_u32 s48, 12
    s_cselect_b32 s44, s8, s6
    s_cselect_b32 s45, s9, s7
    s_cselect_b32 s49, 12, 0
    s_cmp_ge_u32 s48, 24
    s_cselect_b32 s44, s10, s44
    s_cselect_b32 s45, s11, s45
    s_cselect_b32 s49, 24, s49
    s_sub_u32 s48, s48, s49
    s_lshl_b32 s48, s48, 5
    s_mul_i32 s49, s41, 384
    s_add_u32 s48, s48, s49
    s_add_u32 s48, s48, 0x0
    buffer_load_dwordx4 v[44:47], v8, s[44:47], s48 offen
    s_mul_i32 s48, s42, 9
    s_add_u32 s48, s48, 4
    s_cmp_ge_u32 s48, 12
    s_cselect_b32 s44, s8, s6
    s_cselect_b32 s45, s9, s7
    s_cselect_b32 s49, 12, 0
    s_cmp_ge_u32 s48, 24
    s_cselect_b32 s44, s10, s44
    s_cselect_b32 s45, s11, s45
    s_cselect_b32 s49, 24, s49
    s_sub_u32 s48, s48, s49
    s_lshl_b32 s48, s48, 5
    s_mul_i32 s49, s41, 384
    s_add_u32 s48, s48, s49
    s_add_u32 s48, s48, 0x0
    buffer_load_dwordx4 v[48:51], v8, s[44:47], s48 offen
    s_mul_i32 s48, s42, 9
    s_add_u32 s48, s48, 5
    s_cmp_ge_u32 s48, 12
    s_cselect_b32 s44, s8, s6
    s_cselect_b32 s45, s9, s7
    s_cselect_b32 s49, 12, 0
    s_cmp_ge_u32 s48, 24
    s_cselect_b32 s44, s10, s44
    s_cselect_b32 s45, s11, s45
    s_cselect_b32 s49, 24, s49
    s_sub_u32 s48, s48, s49
    s_lshl_b32 s48, s48, 5
    s_mul_i32 s49, s41, 384
    s_add_u32 s48, s48, s49
    s_add_u32 s48, s48, 0x0
    buffer_load_dwordx4 v[52:55], v8, s[44:47], s48 offen
    s_mul_i32 s48, s42, 9
    s_add_u32 s48, s48, 6
    s_cmp_ge_u32 s48, 12
    s_cselect_b32 s44, s8, s6
    s_cselect_b32 s45, s9, s7
    s_cselect_b32 s49, 12, 0
    s_cmp_ge_u32 s48, 24
    s_cselect_b32 s44, s10, s44
    s_cselect_b32 s45, s11, s45
    s_cselect_b32 s49, 24, s49
    s_sub_u32 s48, s48, s49
    s_lshl_b32 s48, s48, 5
    s_mul_i32 s49, s41, 384
    s_add_u32 s48, s48, s49
    s_add_u32 s48, s48, 0x0
    buffer_load_dwordx4 v[56:59], v8, s[44:47], s48 offen
    s_mul_i32 s48, s42, 9
    s_add_u32 s48, s48, 7
    s_cmp_ge_u32 s48, 12
    s_cselect_b32 s44, s8, s6
    s_cselect_b32 s45, s9, s7
    s_cselect_b32 s49, 12, 0
    s_cmp_ge_u32 s48, 24
    s_cselect_b32 s44, s10, s44
    s_cselect_b32 s45, s11, s45
    s_cselect_b32 s49, 24, s49
    s_sub_u32 s48, s48, s49
    s_lshl_b32 s48, s48, 5
    s_mul_i32 s49, s41, 384
    s_add_u32 s48, s48, s49
    s_add_u32 s48, s48, 0x0
    buffer_load_dwordx4 v[60:63], v8, s[44:47], s48 offen
    s_mul_i32 s48, s42, 9
    s_add_u32 s48, s48, 8
    s_cmp_ge_u32 s48, 12
    s_cselect_b32 s44, s8, s6
    s_cselect_b32 s45, s9, s7
    s_cselect_b32 s49, 12, 0
    s_cmp_ge_u32 s48, 24
    s_cselect_b32 s44, s10, s44
    s_cselect_b32 s45, s11, s45
    s_cselect_b32 s49, 24, s49
    s_sub_u32 s48, s48, s49
    s_lshl_b32 s48, s48, 5
    s_mul_i32 s49, s41, 384
    s_add_u32 s48, s48, s49
    s_add_u32 s48, s48, 0x0
    buffer_load_dwordx4 v[64:67], v8, s[44:47], s48 offen
    s_mul_i32 s48, s42, 9
    s_add_u32 s48, s48, 0
    s_cmp_ge_u32 s48, 12
    s_cselect_b32 s44, s8, s6
    s_cselect_b32 s45, s9, s7
    s_cselect_b32 s49, 12, 0
    s_cmp_ge_u32 s48, 24
    s_cselect_b32 s44, s10, s44
    s_cselect_b32 s45, s11, s45
    s_cselect_b32 s49, 24, s49
    s_sub_u32 s48, s48, s49
    s_lshl_b32 s48, s48, 5
    s_mul_i32 s49, s41, 384
    s_add_u32 s48, s48, s49
    s_add_u32 s48, s48, 0x60000
    buffer_load_dwordx4 v[68:71], v8, s[44:47], s48 offen
    s_mul_i32 s48, s42, 9
    s_add_u32 s48, s48, 1
    s_cmp_ge_u32 s48, 12
    s_cselect_b32 s44, s8, s6
    s_cselect_b32 s45, s9, s7
    s_cselect_b32 s49, 12, 0
    s_cmp_ge_u32 s48, 24
    s_cselect_b32 s44, s10, s44
    s_cselect_b32 s45, s11, s45
    s_cselect_b32 s49, 24, s49
    s_sub_u32 s48, s48, s49
    s_lshl_b32 s48, s48, 5
    s_mul_i32 s49, s41, 384
    s_add_u32 s48, s48, s49
    s_add_u32 s48, s48, 0x60000
    buffer_load_dwordx4 v[72:75], v8, s[44:47], s48 offen
    s_mul_i32 s48, s42, 9
    s_add_u32 s48, s48, 2
    s_cmp_ge_u32 s48, 12
    s_cselect_b32 s44, s8, s6
    s_cselect_b32 s45, s9, s7
    s_cselect_b32 s49, 12, 0
    s_cmp_ge_u32 s48, 24
    s_cselect_b32 s44, s10, s44
    s_cselect_b32 s45, s11, s45
    s_cselect_b32 s49, 24, s49
    s_sub_u32 s48, s48, s49
    s_lshl_b32 s48, s48, 5
    s_mul_i32 s49, s41, 384
    s_add_u32 s48, s48, s49
    s_add_u32 s48, s48, 0x60000
    buffer_load_dwordx4 v[76:79], v8, s[44:47], s48 offen
    s_mul_i32 s48, s42, 9
    s_add_u32 s48, s48, 3
    s_cmp_ge_u32 s48, 12
    s_cselect_b32 s44, s8, s6
    s_cselect_b32 s45, s9, s7
    s_cselect_b32 s49, 12, 0
    s_cmp_ge_u32 s48, 24
    s_cselect_b32 s44, s10, s44
    s_cselect_b32 s45, s11, s45
    s_cselect_b32 s49, 24, s49
    s_sub_u32 s48, s48, s49
    s_lshl_b32 s48, s48, 5
    s_mul_i32 s49, s41, 384
    s_add_u32 s48, s48, s49
    s_add_u32 s48, s48, 0x60000
    buffer_load_dwordx4 v[80:83], v8, s[44:47], s48 offen
    s_mul_i32 s48, s42, 9
    s_add_u32 s48, s48, 4
    s_cmp_ge_u32 s48, 12
    s_cselect_b32 s44, s8, s6
    s_cselect_b32 s45, s9, s7
    s_cselect_b32 s49, 12, 0
    s_cmp_ge_u32 s48, 24
    s_cselect_b32 s44, s10, s44
    s_cselect_b32 s45, s11, s45
    s_cselect_b32 s49, 24, s49
    s_sub_u32 s48, s48, s49
    s_lshl_b32 s48, s48, 5
    s_mul_i32 s49, s41, 384
    s_add_u32 s48, s48, s49
    s_add_u32 s48, s48, 0x60000
    buffer_load_dwordx4 v[84:87], v8, s[44:47], s48 offen
    s_mul_i32 s48, s42, 9
    s_add_u32 s48, s48, 5
    s_cmp_ge_u32 s48, 12
    s_cselect_b32 s44, s8, s6
    s_cselect_b32 s45, s9, s7
    s_cselect_b32 s49, 12, 0
    s_cmp_ge_u32 s48, 24
    s_cselect_b32 s44, s10, s44
    s_cselect_b32 s45, s11, s45
    s_cselect_b32 s49, 24, s49
    s_sub_u32 s48, s48, s49
    s_lshl_b32 s48, s48, 5
    s_mul_i32 s49, s41, 384
    s_add_u32 s48, s48, s49
    s_add_u32 s48, s48, 0x60000
    buffer_load_dwordx4 v[88:91], v8, s[44:47], s48 offen
    s_mul_i32 s48, s42, 9
    s_add_u32 s48, s48, 6
    s_cmp_ge_u32 s48, 12
    s_cselect_b32 s44, s8, s6
    s_cselect_b32 s45, s9, s7
    s_cselect_b32 s49, 12, 0
    s_cmp_ge_u32 s48, 24
    s_cselect_b32 s44, s10, s44
    s_cselect_b32 s45, s11, s45
    s_cselect_b32 s49, 24, s49
    s_sub_u32 s48, s48, s49
    s_lshl_b32 s48, s48, 5
    s_mul_i32 s49, s41, 384
    s_add_u32 s48, s48, s49
    s_add_u32 s48, s48, 0x60000
    buffer_load_dwordx4 v[92:95], v8, s[44:47], s48 offen
    s_mul_i32 s48, s42, 9
    s_add_u32 s48, s48, 7
    s_cmp_ge_u32 s48, 12
    s_cselect_b32 s44, s8, s6
    s_cselect_b32 s45, s9, s7
    s_cselect_b32 s49, 12, 0
    s_cmp_ge_u32 s48, 24
    s_cselect_b32 s44, s10, s44
    s_cselect_b32 s45, s11, s45
    s_cselect_b32 s49, 24, s49
    s_sub_u32 s48, s48, s49
    s_lshl_b32 s48, s48, 5
    s_mul_i32 s49, s41, 384
    s_add_u32 s48, s48, s49
    s_add_u32 s48, s48, 0x60000
    buffer_load_dwordx4 v[96:99], v8, s[44:47], s48 offen
    s_mul_i32 s48, s42, 9
    s_add_u32 s48, s48, 8
    s_cmp_ge_u32 s48, 12
    s_cselect_b32 s44, s8, s6
    s_cselect_b32 s45, s9, s7
    s_cselect_b32 s49, 12, 0
    s_cmp_ge_u32 s48, 24
    s_cselect_b32 s44, s10, s44
    s_cselect_b32 s45, s11, s45
    s_cselect_b32 s49, 24, s49
    s_sub_u32 s48, s48, s49
    s_lshl_b32 s48, s48, 5
    s_mul_i32 s49, s41, 384
    s_add_u32 s48, s48, s49
    s_add_u32 s48, s48, 0x60000
    buffer_load_dwordx4 v[100:103], v8, s[44:47], s48 offen
    s_mul_i32 s48, s42, 9
    s_add_u32 s48, s48, 0
    s_cmp_ge_u32 s48, 12
    s_cselect_b32 s44, s8, s6
    s_cselect_b32 s45, s9, s7
    s_cselect_b32 s49, 12, 0
    s_cmp_ge_u32 s48, 24
    s_cselect_b32 s44, s10, s44
    s_cselect_b32 s45, s11, s45
    s_cselect_b32 s49, 24, s49
    s_sub_u32 s48, s48, s49
    s_lshl_b32 s48, s48, 5
    s_mul_i32 s49, s41, 384
    s_add_u32 s48, s48, s49
    s_add_u32 s48, s48, 0xc0000
    buffer_load_dwordx4 v[104:107], v8, s[44:47], s48 offen
    s_mul_i32 s48, s42, 9
    s_add_u32 s48, s48, 1
    s_cmp_ge_u32 s48, 12
    s_cselect_b32 s44, s8, s6
    s_cselect_b32 s45, s9, s7
    s_cselect_b32 s49, 12, 0
    s_cmp_ge_u32 s48, 24
    s_cselect_b32 s44, s10, s44
    s_cselect_b32 s45, s11, s45
    s_cselect_b32 s49, 24, s49
    s_sub_u32 s48, s48, s49
    s_lshl_b32 s48, s48, 5
    s_mul_i32 s49, s41, 384
    s_add_u32 s48, s48, s49
    s_add_u32 s48, s48, 0xc0000
    buffer_load_dwordx4 v[108:111], v8, s[44:47], s48 offen
    s_mul_i32 s48, s42, 9
    s_add_u32 s48, s48, 2
    s_cmp_ge_u32 s48, 12
    s_cselect_b32 s44, s8, s6
    s_cselect_b32 s45, s9, s7
    s_cselect_b32 s49, 12, 0
    s_cmp_ge_u32 s48, 24
    s_cselect_b32 s44, s10, s44
    s_cselect_b32 s45, s11, s45
    s_cselect_b32 s49, 24, s49
    s_sub_u32 s48, s48, s49
    s_lshl_b32 s48, s48, 5
    s_mul_i32 s49, s41, 384
    s_add_u32 s48, s48, s49
    s_add_u32 s48, s48, 0xc0000
    buffer_load_dwordx4 v[112:115], v8, s[44:47], s48 offen
    s_mul_i32 s48, s42, 9
    s_add_u32 s48, s48, 3
    s_cmp_ge_u32 s48, 12
    s_cselect_b32 s44, s8, s6
    s_cselect_b32 s45, s9, s7
    s_cselect_b32 s49, 12, 0
    s_cmp_ge_u32 s48, 24
    s_cselect_b32 s44, s10, s44
    s_cselect_b32 s45, s11, s45
    s_cselect_b32 s49, 24, s49
    s_sub_u32 s48, s48, s49
    s_lshl_b32 s48, s48, 5
    s_mul_i32 s49, s41, 384
    s_add_u32 s48, s48, s49
    s_add_u32 s48, s48, 0xc0000
    buffer_load_dwordx4 v[116:119], v8, s[44:47], s48 offen
    s_mul_i32 s48, s42, 9
    s_add_u32 s48, s48, 4
    s_cmp_ge_u32 s48, 12
    s_cselect_b32 s44, s8, s6
    s_cselect_b32 s45, s9, s7
    s_cselect_b32 s49, 12, 0
    s_cmp_ge_u32 s48, 24
    s_cselect_b32 s44, s10, s44
    s_cselect_b32 s45, s11, s45
    s_cselect_b32 s49, 24, s49
    s_sub_u32 s48, s48, s49
    s_lshl_b32 s48, s48, 5
    s_mul_i32 s49, s41, 384
    s_add_u32 s48, s48, s49
    s_add_u32 s48, s48, 0xc0000
    buffer_load_dwordx4 v[120:123], v8, s[44:47], s48 offen
    s_mul_i32 s48, s42, 9
    s_add_u32 s48, s48, 5
    s_cmp_ge_u32 s48, 12
    s_cselect_b32 s44, s8, s6
    s_cselect_b32 s45, s9, s7
    s_cselect_b32 s49, 12, 0
    s_cmp_ge_u32 s48, 24
    s_cselect_b32 s44, s10, s44
    s_cselect_b32 s45, s11, s45
    s_cselect_b32 s49, 24, s49
    s_sub_u32 s48, s48, s49
    s_lshl_b32 s48, s48, 5
    s_mul_i32 s49, s41, 384
    s_add_u32 s48, s48, s49
    s_add_u32 s48, s48, 0xc0000
    buffer_load_dwordx4 v[124:127], v8, s[44:47], s48 offen
    s_mul_i32 s48, s42, 9
    s_add_u32 s48, s48, 6
    s_cmp_ge_u32 s48, 12
    s_cselect_b32 s44, s8, s6
    s_cselect_b32 s45, s9, s7
    s_cselect_b32 s49, 12, 0
    s_cmp_ge_u32 s48, 24
    s_cselect_b32 s44, s10, s44
    s_cselect_b32 s45, s11, s45
    s_cselect_b32 s49, 24, s49
    s_sub_u32 s48, s48, s49
    s_lshl_b32 s48, s48, 5
    s_mul_i32 s49, s41, 384
    s_add_u32 s48, s48, s49
    s_add_u32 s48, s48, 0xc0000
    buffer_load_dwordx4 v[128:131], v8, s[44:47], s48 offen
    s_mul_i32 s48, s42, 9
    s_add_u32 s48, s48, 7
    s_cmp_ge_u32 s48, 12
    s_cselect_b32 s44, s8, s6
    s_cselect_b32 s45, s9, s7
    s_cselect_b32 s49, 12, 0
    s_cmp_ge_u32 s48, 24
    s_cselect_b32 s44, s10, s44
    s_cselect_b32 s45, s11, s45
    s_cselect_b32 s49, 24, s49
    s_sub_u32 s48, s48, s49
    s_lshl_b32 s48, s48, 5
    s_mul_i32 s49, s41, 384
    s_add_u32 s48, s48, s49
    s_add_u32 s48, s48, 0xc0000
    buffer_load_dwordx4 v[132:135], v8, s[44:47], s48 offen
    s_mul_i32 s48, s42, 9
    s_add_u32 s48, s48, 8
    s_cmp_ge_u32 s48, 12
    s_cselect_b32 s44, s8, s6
    s_cselect_b32 s45, s9, s7
    s_cselect_b32 s49, 12, 0
    s_cmp_ge_u32 s48, 24
    s_cselect_b32 s44, s10, s44
    s_cselect_b32 s45, s11, s45
    s_cselect_b32 s49, 24, s49
    s_sub_u32 s48, s48, s49
    s_lshl_b32 s48, s48, 5
    s_mul_i32 s49, s41, 384
    s_add_u32 s48, s48, s49
    s_add_u32 s48, s48, 0xc0000
    buffer_load_dwordx4 v[136:139], v8, s[44:47], s48 offen
    s_mul_i32 s48, s42, 9
    s_add_u32 s48, s48, 0
    s_cmp_ge_u32 s48, 12
    s_cselect_b32 s44, s8, s6
    s_cselect_b32 s45, s9, s7
    s_cselect_b32 s49, 12, 0
    s_cmp_ge_u32 s48, 24
    s_cselect_b32 s44, s10, s44
    s_cselect_b32 s45, s11, s45
    s_cselect_b32 s49, 24, s49
    s_sub_u32 s48, s48, s49
    s_lshl_b32 s48, s48, 5
    s_mul_i32 s49, s41, 384
    s_add_u32 s48, s48, s49
    s_add_u32 s48, s48, 0x120000
    buffer_load_dwordx4 v[140:143], v8, s[44:47], s48 offen
    s_mul_i32 s48, s42, 9
    s_add_u32 s48, s48, 1
    s_cmp_ge_u32 s48, 12
    s_cselect_b32 s44, s8, s6
    s_cselect_b32 s45, s9, s7
    s_cselect_b32 s49, 12, 0
    s_cmp_ge_u32 s48, 24
    s_cselect_b32 s44, s10, s44
    s_cselect_b32 s45, s11, s45
    s_cselect_b32 s49, 24, s49
    s_sub_u32 s48, s48, s49
    s_lshl_b32 s48, s48, 5
    s_mul_i32 s49, s41, 384
    s_add_u32 s48, s48, s49
    s_add_u32 s48, s48, 0x120000
    buffer_load_dwordx4 v[144:147], v8, s[44:47], s48 offen
    s_mul_i32 s48, s42, 9
    s_add_u32 s48, s48, 2
    s_cmp_ge_u32 s48, 12
    s_cselect_b32 s44, s8, s6
    s_cselect_b32 s45, s9, s7
    s_cselect_b32 s49, 12, 0
    s_cmp_ge_u32 s48, 24
    s_cselect_b32 s44, s10, s44
    s_cselect_b32 s45, s11, s45
    s_cselect_b32 s49, 24, s49
    s_sub_u32 s48, s48, s49
    s_lshl_b32 s48, s48, 5
    s_mul_i32 s49, s41, 384
    s_add_u32 s48, s48, s49
    s_add_u32 s48, s48, 0x120000
    buffer_load_dwordx4 v[148:151], v8, s[44:47], s48 offen
    s_mul_i32 s48, s42, 9
    s_add_u32 s48, s48, 3
    s_cmp_ge_u32 s48, 12
    s_cselect_b32 s44, s8, s6
    s_cselect_b32 s45, s9, s7
    s_cselect_b32 s49, 12, 0
    s_cmp_ge_u32 s48, 24
    s_cselect_b32 s44, s10, s44
    s_cselect_b32 s45, s11, s45
    s_cselect_b32 s49, 24, s49
    s_sub_u32 s48, s48, s49
    s_lshl_b32 s48, s48, 5
    s_mul_i32 s49, s41, 384
    s_add_u32 s48, s48, s49
    s_add_u32 s48, s48, 0x120000
    buffer_load_dwordx4 v[152:155], v8, s[44:47], s48 offen
    s_mul_i32 s48, s42, 9
    s_add_u32 s48, s48, 4
    s_cmp_ge_u32 s48, 12
    s_cselect_b32 s44, s8, s6
    s_cselect_b32 s45, s9, s7
    s_cselect_b32 s49, 12, 0
    s_cmp_ge_u32 s48, 24
    s_cselect_b32 s44, s10, s44
    s_cselect_b32 s45, s11, s45
    s_cselect_b32 s49, 24, s49
    s_sub_u32 s48, s48, s49
    s_lshl_b32 s48, s48, 5
    s_mul_i32 s49, s41, 384
    s_add_u32 s48, s48, s49
    s_add_u32 s48, s48, 0x120000
    buffer_load_dwordx4 v[156:159], v8, s[44:47], s48 offen
    s_mul_i32 s48, s42, 9
    s_add_u32 s48, s48, 5
    s_cmp_ge_u32 s48, 12
    s_cselect_b32 s44, s8, s6
    s_cselect_b32 s45, s9, s7
    s_cselect_b32 s49, 12, 0
    s_cmp_ge_u32 s48, 24
    s_cselect_b32 s44, s10, s44
    s_cselect_b32 s45, s11, s45
    s_cselect_b32 s49, 24, s49
    s_sub_u32 s48, s48, s49
    s_lshl_b32 s48, s48, 5
    s_mul_i32 s49, s41, 384
    s_add_u32 s48, s48, s49
    s_add_u32 s48, s48, 0x120000
    buffer_load_dwordx4 v[160:163], v8, s[44:47], s48 offen
    s_mul_i32 s48, s42, 9
    s_add_u32 s48, s48, 6
    s_cmp_ge_u32 s48, 12
    s_cselect_b32 s44, s8, s6
    s_cselect_b32 s45, s9, s7
    s_cselect_b32 s49, 12, 0
    s_cmp_ge_u32 s48, 24
    s_cselect_b32 s44, s10, s44
    s_cselect_b32 s45, s11, s45
    s_cselect_b32 s49, 24, s49
    s_sub_u32 s48, s48, s49
    s_lshl_b32 s48, s48, 5
    s_mul_i32 s49, s41, 384
    s_add_u32 s48, s48, s49
    s_add_u32 s48, s48, 0x120000
    buffer_load_dwordx4 v[164:167], v8, s[44:47], s48 offen
    s_mul_i32 s48, s42, 9
    s_add_u32 s48, s48, 7
    s_cmp_ge_u32 s48, 12
    s_cselect_b32 s44, s8, s6
    s_cselect_b32 s45, s9, s7
    s_cselect_b32 s49, 12, 0
    s_cmp_ge_u32 s48, 24
    s_cselect_b32 s44, s10, s44
    s_cselect_b32 s45, s11, s45
    s_cselect_b32 s49, 24, s49
    s_sub_u32 s48, s48, s49
    s_lshl_b32 s48, s48, 5
    s_mul_i32 s49, s41, 384
    s_add_u32 s48, s48, s49
    s_add_u32 s48, s48, 0x120000
    buffer_load_dwordx4 v[168:171], v8, s[44:47], s48 offen
    s_mul_i32 s48, s42, 9
    s_add_u32 s48, s48, 8
    s_cmp_ge_u32 s48, 12
    s_cselect_b32 s44, s8, s6
    s_cselect_b32 s45, s9, s7
    s_cselect_b32 s49, 12, 0
    s_cmp_ge_u32 s48, 24
    s_cselect_b32 s44, s10, s44
    s_cselect_b32 s45, s11, s45
    s_cselect_b32 s49, 24, s49
    s_sub_u32 s48, s48, s49
    s_lshl_b32 s48, s48, 5
    s_mul_i32 s49, s41, 384
    s_add_u32 s48, s48, s49
    s_add_u32 s48, s48, 0x120000
    buffer_load_dwordx4 v[172:175], v8, s[44:47], s48 offen
    s_mul_i32 s48, s42, 9
    s_add_u32 s48, s48, 0
    s_cmp_ge_u32 s48, 12
    s_cselect_b32 s44, s8, s6
    s_cselect_b32 s45, s9, s7
    s_cselect_b32 s49, 12, 0
    s_cmp_ge_u32 s48, 24
    s_cselect_b32 s44, s10, s44
    s_cselect_b32 s45, s11, s45
    s_cselect_b32 s49, 24, s49
    s_sub_u32 s48, s48, s49
    s_lshl_b32 s48, s48, 5
    s_mul_i32 s49, s41, 384
    s_add_u32 s48, s48, s49
    s_add_u32 s48, s48, 0x180000
    buffer_load_dwordx4 v[176:179], v8, s[44:47], s48 offen
    s_mul_i32 s48, s42, 9
    s_add_u32 s48, s48, 1
    s_cmp_ge_u32 s48, 12
    s_cselect_b32 s44, s8, s6
    s_cselect_b32 s45, s9, s7
    s_cselect_b32 s49, 12, 0
    s_cmp_ge_u32 s48, 24
    s_cselect_b32 s44, s10, s44
    s_cselect_b32 s45, s11, s45
    s_cselect_b32 s49, 24, s49
    s_sub_u32 s48, s48, s49
    s_lshl_b32 s48, s48, 5
    s_mul_i32 s49, s41, 384
    s_add_u32 s48, s48, s49
    s_add_u32 s48, s48, 0x180000
    buffer_load_dwordx4 v[180:183], v8, s[44:47], s48 offen
    s_mul_i32 s48, s42, 9
    s_add_u32 s48, s48, 2
    s_cmp_ge_u32 s48, 12
    s_cselect_b32 s44, s8, s6
    s_cselect_b32 s45, s9, s7
    s_cselect_b32 s49, 12, 0
    s_cmp_ge_u32 s48, 24
    s_cselect_b32 s44, s10, s44
    s_cselect_b32 s45, s11, s45
    s_cselect_b32 s49, 24, s49
    s_sub_u32 s48, s48, s49
    s_lshl_b32 s48, s48, 5
    s_mul_i32 s49, s41, 384
    s_add_u32 s48, s48, s49
    s_add_u32 s48, s48, 0x180000
    buffer_load_dwordx4 v[184:187], v8, s[44:47], s48 offen
    s_mul_i32 s48, s42, 9
    s_add_u32 s48, s48, 3
    s_cmp_ge_u32 s48, 12
    s_cselect_b32 s44, s8, s6
    s_cselect_b32 s45, s9, s7
    s_cselect_b32 s49, 12, 0
    s_cmp_ge_u32 s48, 24
    s_cselect_b32 s44, s10, s44
    s_cselect_b32 s45, s11, s45
    s_cselect_b32 s49, 24, s49
    s_sub_u32 s48, s48, s49
    s_lshl_b32 s48, s48, 5
    s_mul_i32 s49, s41, 384
    s_add_u32 s48, s48, s49
    s_add_u32 s48, s48, 0x180000
    buffer_load_dwordx4 v[188:191], v8, s[44:47], s48 offen
    s_mul_i32 s48, s42, 9
    s_add_u32 s48, s48, 4
    s_cmp_ge_u32 s48, 12
    s_cselect_b32 s44, s8, s6
    s_cselect_b32 s45, s9, s7
    s_cselect_b32 s49, 12, 0
    s_cmp_ge_u32 s48, 24
    s_cselect_b32 s44, s10, s44
    s_cselect_b32 s45, s11, s45
    s_cselect_b32 s49, 24, s49
    s_sub_u32 s48, s48, s49
    s_lshl_b32 s48, s48, 5
    s_mul_i32 s49, s41, 384
    s_add_u32 s48, s48, s49
    s_add_u32 s48, s48, 0x180000
    buffer_load_dwordx4 v[192:195], v8, s[44:47], s48 offen
    s_mul_i32 s48, s42, 9
    s_add_u32 s48, s48, 5
    s_cmp_ge_u32 s48, 12
    s_cselect_b32 s44, s8, s6
    s_cselect_b32 s45, s9, s7
    s_cselect_b32 s49, 12, 0
    s_cmp_ge_u32 s48, 24
    s_cselect_b32 s44, s10, s44
    s_cselect_b32 s45, s11, s45
    s_cselect_b32 s49, 24, s49
    s_sub_u32 s48, s48, s49
    s_lshl_b32 s48, s48, 5
    s_mul_i32 s49, s41, 384
    s_add_u32 s48, s48, s49
    s_add_u32 s48, s48, 0x180000
    buffer_load_dwordx4 v[196:199], v8, s[44:47], s48 offen
    s_mul_i32 s48, s42, 9
    s_add_u32 s48, s48, 6
    s_cmp_ge_u32 s48, 12
    s_cselect_b32 s44, s8, s6
    s_cselect_b32 s45, s9, s7
    s_cselect_b32 s49, 12, 0
    s_cmp_ge_u32 s48, 24
    s_cselect_b32 s44, s10, s44
    s_cselect_b32 s45, s11, s45
    s_cselect_b32 s49, 24, s49
    s_sub_u32 s48, s48, s49
    s_lshl_b32 s48, s48, 5
    s_mul_i32 s49, s41, 384
    s_add_u32 s48, s48, s49
    s_add_u32 s48, s48, 0x180000
    buffer_load_dwordx4 v[200:203], v8, s[44:47], s48 offen
    s_mul_i32 s48, s42, 9
    s_add_u32 s48, s48, 7
    s_cmp_ge_u32 s48, 12
    s_cselect_b32 s44, s8, s6
    s_cselect_b32 s45, s9, s7
    s_cselect_b32 s49, 12, 0
    s_cmp_ge_u32 s48, 24
    s_cselect_b32 s44, s10, s44
    s_cselect_b32 s45, s11, s45
    s_cselect_b32 s49, 24, s49
    s_sub_u32 s48, s48, s49
    s_lshl_b32 s48, s48, 5
    s_mul_i32 s49, s41, 384
    s_add_u32 s48, s48, s49
    s_add_u32 s48, s48, 0x180000
    buffer_load_dwordx4 v[204:207], v8, s[44:47], s48 offen
    s_mul_i32 s48, s42, 9
    s_add_u32 s48, s48, 8
    s_cmp_ge_u32 s48, 12
    s_cselect_b32 s44, s8, s6
    s_cselect_b32 s45, s9, s7
    s_cselect_b32 s49, 12, 0
    s_cmp_ge_u32 s48, 24
    s_cselect_b32 s44, s10, s44
    s_cselect_b32 s45, s11, s45
    s_cselect_b32 s49, 24, s49
    s_sub_u32 s48, s48, s49
    s_lshl_b32 s48, s48, 5
    s_mul_i32 s49, s41, 384
    s_add_u32 s48, s48, s49
    s_add_u32 s48, s48, 0x180000
    buffer_load_dwordx4 v[208:211], v8, s[44:47], s48 offen
    s_add_u32 s48, s50, 0
    s_min_u32 s48, s48, 9
    s_lshl_b32 s48, s48, 5
    s_mul_i32 s49, s42, 320
    s_add_u32 s48, s48, s49
    s_add_u32 s48, s48, 0
    buffer_load_dwordx4 v[212:215], v14, s[52:55], s48 offen
    s_add_u32 s48, s50, 0
    s_min_u32 s48, s48, 9
    s_lshl_b32 s48, s48, 5
    s_mul_i32 s49, s42, 320
    s_add_u32 s48, s48, s49
    s_add_u32 s48, s48, 40960
    buffer_load_dwordx4 v[216:219], v14, s[52:55], s48 offen
    s_add_u32 s48, s50, 0
    s_min_u32 s48, s48, 9
    s_lshl_b32 s48, s48, 5
    s_mul_i32 s49, s42, 320
    s_add_u32 s48, s48, s49
    s_add_u32 s48, s48, 81920
    buffer_load_dwordx4 v[220:223], v14, s[52:55], s48 offen
    s_add_u32 s48, s50, 0
    s_min_u32 s48, s48, 9
    s_lshl_b32 s48, s48, 5
    s_mul_i32 s49, s42, 320
    s_add_u32 s48, s48, s49
    s_add_u32 s48, s48, 122880
    buffer_load_dwordx4 v[224:227], v14, s[52:55], s48 offen
    s_add_u32 s48, s50, 0
    s_min_u32 s48, s48, 9
    s_lshl_b32 s48, s48, 5
    s_mul_i32 s49, s42, 320
    s_add_u32 s48, s48, s49
    s_add_u32 s48, s48, 163840
    buffer_load_dwordx4 v[228:231], v14, s[52:55], s48 offen
    s_add_u32 s48, s50, 0
    s_min_u32 s48, s48, 9
    s_lshl_b32 s48, s48, 5
    s_mul_i32 s49, s42, 320
    s_add_u32 s48, s48, s49
    s_add_u32 s48, s48, 204800
    buffer_load_dwordx4 v[232:235], v14, s[52:55], s48 offen
    s_add_u32 s48, s50, 1
    s_min_u32 s48, s48, 9
    s_lshl_b32 s48, s48, 5
    s_mul_i32 s49, s42, 320
    s_add_u32 s48, s48, s49
    s_add_u32 s48, s48, 0
    buffer_load_dwordx4 v[236:239], v14, s[52:55], s48 offen
    s_add_u32 s48, s50, 1
    s_min_u32 s48, s48, 9
    s_lshl_b32 s48, s48, 5
    s_mul_i32 s49, s42, 320
    s_add_u32 s48, s48, s49
    s_add_u32 s48, s48, 40960
    buffer_load_dwordx4 v[240:243], v14, s[52:55], s48 offen
    s_add_u32 s48, s50, 1
    s_min_u32 s48, s48, 9
    s_lshl_b32 s48, s48, 5
    s_mul_i32 s49, s42, 320
    s_add_u32 s48, s48, s49
    s_add_u32 s48, s48, 81920
    buffer_load_dwordx4 v[244:247], v14, s[52:55], s48 offen
    s_waitcnt vmcnt(45)
    ds_write_b128 v9, v[32:35] offset:0
    ds_write_b128 v9, v[36:39] offset:1024
    ds_write_b128 v9, v[40:43] offset:2048
    ds_write_b128 v9, v[44:47] offset:3072
    ds_write_b128 v9, v[48:51] offset:4096
    ds_write_b128 v9, v[52:55] offset:5120
    ds_write_b128 v9, v[56:59] offset:6144
    ds_write_b128 v9, v[60:63] offset:7168
    ds_write_b128 v9, v[64:67] offset:8192
    s_waitcnt lgkmcnt(0)
    ds_read_b64_tr_b16 v[32:33], v12 offset:0
    ds_read_b64_tr_b16 v[34:35], v12 offset:128
    ds_read_b64_tr_b16 v[36:37], v12 offset:1024
    ds_read_b64_tr_b16 v[38:39], v12 offset:1152
    ds_read_b64_tr_b16 v[40:41], v12 offset:2048
    ds_read_b64_tr_b16 v[42:43], v12 offset:2176
    ds_read_b64_tr_b16 v[44:45], v12 offset:3072
    ds_read_b64_tr_b16 v[46:47], v12 offset:3200
    ds_read_b64_tr_b16 v[48:49], v12 offset:4096
    ds_read_b64_tr_b16 v[50:51], v12 offset:4224
    ds_read_b64_tr_b16 v[52:53], v12 offset:5120
    ds_read_b64_tr_b16 v[54:55], v12 offset:5248
    ds_read_b64_tr_b16 v[56:57], v12 offset:6144
    ds_read_b64_tr_b16 v[58:59], v12 offset:6272
    ds_read_b64_tr_b16 v[60:61], v12 offset:7168
    ds_read_b64_tr_b16 v[62:63], v12 offset:7296
    ds_read_b64_tr_b16 v[64:65], v12 offset:8192
    ds_read_b64_tr_b16 v[66:67], v12 offset:8320
    s_waitcnt lgkmcnt(0)
    v_accvgpr_write_b32 a0, v32
    v_accvgpr_write_b32 a1, v33
    v_accvgpr_write_b32 a2, v34
    v_accvgpr_write_b32 a3, v35
    v_accvgpr_write_b32 a20, v36
    v_accvgpr_write_b32 a21, v37
    v_accvgpr_write_b32 a22, v38
    v_accvgpr_write_b32 a23, v39
    v_accvgpr_write_b32 a40, v40
    v_accvgpr_write_b32 a41, v41
    v_accvgpr_write_b32 a42, v42
    v_accvgpr_write_b32 a43, v43
    v_accvgpr_write_b32 a60, v44
    v_accvgpr_write_b32 a61, v45
    v_accvgpr_write_b32 a62, v46
    v_accvgpr_write_b32 a63, v47
    v_accvgpr_write_b32 a80, v48
    v_accvgpr_write_b32 a81, v49
    v_accvgpr_write_b32 a82, v50
    v_accvgpr_write_b32 a83, v51
    v_accvgpr_write_b32 a100, v52
    v_accvgpr_write_b32 a101, v53
    v_accvgpr_write_b32 a102, v54
    v_accvgpr_write_b32 a103, v55
    v_accvgpr_write_b32 a120, v56
    v_accvgpr_write_b32 a121, v57
    v_accvgpr_write_b32 a122, v58
    v_accvgpr_write_b32 a123, v59
    v_accvgpr_write_b32 a140, v60
    v_accvgpr_write_b32 a141, v61
    v_accvgpr_write_b32 a142, v62
    v_accvgpr_write_b32 a143, v63
    v_accvgpr_write_b32 a160, v64
    v_accvgpr_write_b32 a161, v65
    v_accvgpr_write_b32 a162, v66
    v_accvgpr_write_b32 a163, v67
    s_add_u32 s48, s50, 1
    s_min_u32 s48, s48, 9
    s_lshl_b32 s48, s48, 5
    s_mul_i32 s49, s42, 320
    s_add_u32 s48, s48, s49
    s_add_u32 s48, s48, 122880
    buffer_load_dwordx4 v[32:35], v14, s[52:55], s48 offen
    s_add_u32 s48, s50, 1
    s_min_u32 s48, s48, 9
    s_lshl_b32 s48, s48, 5
    s_mul_i32 s49, s42, 320
    s_add_u32 s48, s48, s49
    s_add_u32 s48, s48, 163840
    buffer_load_dwordx4 v[36:39], v14, s[52:55], s48 offen
    s_add_u32 s48, s50, 1
    s_min_u32 s48, s48, 9
    s_lshl_b32 s48, s48, 5
    s_mul_i32 s49, s42, 320
    s_add_u32 s48, s48, s49
    s_add_u32 s48, s48, 204800
    buffer_load_dwordx4 v[40:43], v14, s[52:55], s48 offen
    s_add_u32 s48, s50, 2
    s_min_u32 s48, s48, 9
    s_lshl_b32 s48, s48, 5
    s_mul_i32 s49, s42, 320
    s_add_u32 s48, s48, s49
    s_add_u32 s48, s48, 0
    buffer_load_dwordx4 v[44:47], v14, s[52:55], s48 offen
    s_add_u32 s48, s50, 2
    s_min_u32 s48, s48, 9
    s_lshl_b32 s48, s48, 5
    s_mul_i32 s49, s42, 320
    s_add_u32 s48, s48, s49
    s_add_u32 s48, s48, 40960
    buffer_load_dwordx4 v[48:51], v14, s[52:55], s48 offen
    s_add_u32 s48, s50, 2
    s_min_u32 s48, s48, 9
    s_lshl_b32 s48, s48, 5
    s_mul_i32 s49, s42, 320
    s_add_u32 s48, s48, s49
    s_add_u32 s48, s48, 81920
    buffer_load_dwordx4 v[52:55], v14, s[52:55], s48 offen
    s_add_u32 s48, s50, 2
    s_min_u32 s48, s48, 9
    s_lshl_b32 s48, s48, 5
    s_mul_i32 s49, s42, 320
    s_add_u32 s48, s48, s49
    s_add_u32 s48, s48, 122880
    buffer_load_dwordx4 v[56:59], v14, s[52:55], s48 offen
    s_add_u32 s48, s50, 2
    s_min_u32 s48, s48, 9
    s_lshl_b32 s48, s48, 5
    s_mul_i32 s49, s42, 320
    s_add_u32 s48, s48, s49
    s_add_u32 s48, s48, 163840
    buffer_load_dwordx4 v[60:63], v14, s[52:55], s48 offen
    s_add_u32 s48, s50, 2
    s_min_u32 s48, s48, 9
    s_lshl_b32 s48, s48, 5
    s_mul_i32 s49, s42, 320
    s_add_u32 s48, s48, s49
    s_add_u32 s48, s48, 204800
    buffer_load_dwordx4 v[64:67], v14, s[52:55], s48 offen
    s_waitcnt vmcnt(45)
    ds_write_b128 v9, v[68:71] offset:0
    ds_write_b128 v9, v[72:75] offset:1024
    ds_write_b128 v9, v[76:79] offset:2048
    ds_write_b128 v9, v[80:83] offset:3072
    ds_write_b128 v9, v[84:87] offset:4096
    ds_write_b128 v9, v[88:91] offset:5120
    ds_write_b128 v9, v[92:95] offset:6144
    ds_write_b128 v9, v[96:99] offset:7168
    ds_write_b128 v9, v[100:103] offset:8192
    s_waitcnt lgkmcnt(0)
    ds_read_b64_tr_b16 v[68:69], v12 offset:0
    ds_read_b64_tr_b16 v[70:71], v12 offset:128
    ds_read_b64_tr_b16 v[72:73], v12 offset:1024
    ds_read_b64_tr_b16 v[74:75], v12 offset:1152
    ds_read_b64_tr_b16 v[76:77], v12 offset:2048
    ds_read_b64_tr_b16 v[78:79], v12 offset:2176
    ds_read_b64_tr_b16 v[80:81], v12 offset:3072
    ds_read_b64_tr_b16 v[82:83], v12 offset:3200
    ds_read_b64_tr_b16 v[84:85], v12 offset:4096
    ds_read_b64_tr_b16 v[86:87], v12 offset:4224
    ds_read_b64_tr_b16 v[88:89], v12 offset:5120
    ds_read_b64_tr_b16 v[90:91], v12 offset:5248
    ds_read_b64_tr_b16 v[92:93], v12 offset:6144
    ds_read_b64_tr_b16 v[94:95], v12 offset:6272
    ds_read_b64_tr_b16 v[96:97], v12 offset:7168
    ds_read_b64_tr_b16 v[98:99], v12 offset:7296
    ds_read_b64_tr_b16 v[100:101], v12 offset:8192
    ds_read_b64_tr_b16 v[102:103], v12 offset:8320
    s_waitcnt lgkmcnt(0)
    v_accvgpr_write_b32 a4, v68
    v_accvgpr_write_b32 a5, v69
    v_accvgpr_write_b32 a6, v70
    v_accvgpr_write_b32 a7, v71
    v_accvgpr_write_b32 a24, v72
    v_accvgpr_write_b32 a25, v73
    v_accvgpr_write_b32 a26, v74
    v_accvgpr_write_b32 a27, v75
    v_accvgpr_write_b32 a44, v76
    v_accvgpr_write_b32 a45, v77
    v_accvgpr_write_b32 a46, v78
    v_accvgpr_write_b32 a47, v79
    v_accvgpr_write_b32 a64, v80
    v_accvgpr_write_b32 a65, v81
    v_accvgpr_write_b32 a66, v82
    v_accvgpr_write_b32 a67, v83
    v_accvgpr_write_b32 a84, v84
    v_accvgpr_write_b32 a85, v85
    v_accvgpr_write_b32 a86, v86
    v_accvgpr_write_b32 a87, v87
    v_accvgpr_write_b32 a104, v88
    v_accvgpr_write_b32 a105, v89
    v_accvgpr_write_b32 a106, v90
    v_accvgpr_write_b32 a107, v91
    v_accvgpr_write_b32 a124, v92
    v_accvgpr_write_b32 a125, v93
    v_accvgpr_write_b32 a126, v94
    v_accvgpr_write_b32 a127, v95
    v_accvgpr_write_b32 a144, v96
    v_accvgpr_write_b32 a145, v97
    v_accvgpr_write_b32 a146, v98
    v_accvgpr_write_b32 a147, v99
    v_accvgpr_write_b32 a164, v100
    v_accvgpr_write_b32 a165, v101
    v_accvgpr_write_b32 a166, v102
    v_accvgpr_write_b32 a167, v103
    s_waitcnt vmcnt(36)
    ds_write_b128 v9, v[104:107] offset:0
    ds_write_b128 v9, v[108:111] offset:1024
    ds_write_b128 v9, v[112:115] offset:2048
    ds_write_b128 v9, v[116:119] offset:3072
    ds_write_b128 v9, v[120:123] offset:4096
    ds_write_b128 v9, v[124:127] offset:5120
    ds_write_b128 v9, v[128:131] offset:6144
    ds_write_b128 v9, v[132:135] offset:7168
    ds_write_b128 v9, v[136:139] offset:8192
    s_waitcnt lgkmcnt(0)
    ds_read_b64_tr_b16 v[104:105], v12 offset:0
    ds_read_b64_tr_b16 v[106:107], v12 offset:128
    ds_read_b64_tr_b16 v[108:109], v12 offset:1024
    ds_read_b64_tr_b16 v[110:111], v12 offset:1152
    ds_read_b64_tr_b16 v[112:113], v12 offset:2048
    ds_read_b64_tr_b16 v[114:115], v12 offset:2176
    ds_read_b64_tr_b16 v[116:117], v12 offset:3072
    ds_read_b64_tr_b16 v[118:119], v12 offset:3200
    ds_read_b64_tr_b16 v[120:121], v12 offset:4096
    ds_read_b64_tr_b16 v[122:123], v12 offset:4224
    ds_read_b64_tr_b16 v[124:125], v12 offset:5120
    ds_read_b64_tr_b16 v[126:127], v12 offset:5248
    ds_read_b64_tr_b16 v[128:129], v12 offset:6144
    ds_read_b64_tr_b16 v[130:131], v12 offset:6272
    ds_read_b64_tr_b16 v[132:133], v12 offset:7168
    ds_read_b64_tr_b16 v[134:135], v12 offset:7296
    ds_read_b64_tr_b16 v[136:137], v12 offset:8192
    ds_read_b64_tr_b16 v[138:139], v12 offset:8320
    s_waitcnt lgkmcnt(0)
    v_accvgpr_write_b32 a8, v104
    v_accvgpr_write_b32 a9, v105
    v_accvgpr_write_b32 a10, v106
    v_accvgpr_write_b32 a11, v107
    v_accvgpr_write_b32 a28, v108
    v_accvgpr_write_b32 a29, v109
    v_accvgpr_write_b32 a30, v110
    v_accvgpr_write_b32 a31, v111
    v_accvgpr_write_b32 a48, v112
    v_accvgpr_write_b32 a49, v113
    v_accvgpr_write_b32 a50, v114
    v_accvgpr_write_b32 a51, v115
    v_accvgpr_write_b32 a68, v116
    v_accvgpr_write_b32 a69, v117
    v_accvgpr_write_b32 a70, v118
    v_accvgpr_write_b32 a71, v119
    v_accvgpr_write_b32 a88, v120
    v_accvgpr_write_b32 a89, v121
    v_accvgpr_write_b32 a90, v122
    v_accvgpr_write_b32 a91, v123
    v_accvgpr_write_b32 a108, v124
    v_accvgpr_write_b32 a109, v125
    v_accvgpr_write_b32 a110, v126
    v_accvgpr_write_b32 a111, v127
    v_accvgpr_write_b32 a128, v128
    v_accvgpr_write_b32 a129, v129
    v_accvgpr_write_b32 a130, v130
    v_accvgpr_write_b32 a131, v131
    v_accvgpr_write_b32 a148, v132
    v_accvgpr_write_b32 a149, v133
    v_accvgpr_write_b32 a150, v134
    v_accvgpr_write_b32 a151, v135
    v_accvgpr_write_b32 a168, v136
    v_accvgpr_write_b32 a169, v137
    v_accvgpr_write_b32 a170, v138
    v_accvgpr_write_b32 a171, v139
    s_waitcnt vmcnt(27)
    ds_write_b128 v9, v[140:143] offset:0
    ds_write_b128 v9, v[144:147] offset:1024
    ds_write_b128 v9, v[148:151] offset:2048
    ds_write_b128 v9, v[152:155] offset:3072
    ds_write_b128 v9, v[156:159] offset:4096
    ds_write_b128 v9, v[160:163] offset:5120
    ds_write_b128 v9, v[164:167] offset:6144
    ds_write_b128 v9, v[168:171] offset:7168
    ds_write_b128 v9, v[172:175] offset:8192
    s_waitcnt lgkmcnt(0)
    ds_read_b64_tr_b16 v[140:141], v12 offset:0
    ds_read_b64_tr_b16 v[142:143], v12 offset:128
    ds_read_b64_tr_b16 v[144:145], v12 offset:1024
    ds_read_b64_tr_b16 v[146:147], v12 offset:1152
    ds_read_b64_tr_b16 v[148:149], v12 offset:2048
    ds_read_b64_tr_b16 v[150:151], v12 offset:2176
    ds_read_b64_tr_b16 v[152:153], v12 offset:3072
    ds_read_b64_tr_b16 v[154:155], v12 offset:3200
    ds_read_b64_tr_b16 v[156:157], v12 offset:4096
    ds_read_b64_tr_b16 v[158:159], v12 offset:4224
    ds_read_b64_tr_b16 v[160:161], v12 offset:5120
    ds_read_b64_tr_b16 v[162:163], v12 offset:5248
    ds_read_b64_tr_b16 v[164:165], v12 offset:6144
    ds_read_b64_tr_b16 v[166:167], v12 offset:6272
    ds_read_b64_tr_b16 v[168:169], v12 offset:7168
    ds_read_b64_tr_b16 v[170:171], v12 offset:7296
    ds_read_b64_tr_b16 v[172:173], v12 offset:8192
    ds_read_b64_tr_b16 v[174:175], v12 offset:8320
    s_waitcnt lgkmcnt(0)
    v_accvgpr_write_b32 a12, v140
    v_accvgpr_write_b32 a13, v141
    v_accvgpr_write_b32 a14, v142
    v_accvgpr_write_b32 a15, v143
    v_accvgpr_write_b32 a32, v144
    v_accvgpr_write_b32 a33, v145
    v_accvgpr_write_b32 a34, v146
    v_accvgpr_write_b32 a35, v147
    v_accvgpr_write_b32 a52, v148
    v_accvgpr_write_b32 a53, v149
    v_accvgpr_write_b32 a54, v150
    v_accvgpr_write_b32 a55, v151
    v_accvgpr_write_b32 a72, v152
    v_accvgpr_write_b32 a73, v153
    v_accvgpr_write_b32 a74, v154
    v_accvgpr_write_b32 a75, v155
    v_accvgpr_write_b32 a92, v156
    v_accvgpr_write_b32 a93, v157
    v_accvgpr_write_b32 a94, v158
    v_accvgpr_write_b32 a95, v159
    v_accvgpr_write_b32 a112, v160
    v_accvgpr_write_b32 a113, v161
    v_accvgpr_write_b32 a114, v162
    v_accvgpr_write_b32 a115, v163
    v_accvgpr_write_b32 a132, v164
    v_accvgpr_write_b32 a133, v165
    v_accvgpr_write_b32 a134, v166
    v_accvgpr_write_b32 a135, v167
    v_accvgpr_write_b32 a152, v168
    v_accvgpr_write_b32 a153, v169
    v_accvgpr_write_b32 a154, v170
    v_accvgpr_write_b32 a155, v171
    v_accvgpr_write_b32 a172, v172
    v_accvgpr_write_b32 a173, v173
    v_accvgpr_write_b32 a174, v174
    v_accvgpr_write_b32 a175, v175
    s_waitcnt vmcnt(18)
    ds_write_b128 v9, v[176:179] offset:0
    ds_write_b128 v9, v[180:183] offset:1024
    ds_write_b128 v9, v[184:187] offset:2048
    ds_write_b128 v9, v[188:191] offset:3072
    ds_write_b128 v9, v[192:195] offset:4096
    ds_write_b128 v9, v[196:199] offset:5120
    ds_write_b128 v9, v[200:203] offset:6144
    ds_write_b128 v9, v[204:207] offset:7168
    ds_write_b128 v9, v[208:211] offset:8192
    s_waitcnt lgkmcnt(0)
    ds_read_b64_tr_b16 v[176:177], v12 offset:0
    ds_read_b64_tr_b16 v[178:179], v12 offset:128
    ds_read_b64_tr_b16 v[180:181], v12 offset:1024
    ds_read_b64_tr_b16 v[182:183], v12 offset:1152
    ds_read_b64_tr_b16 v[184:185], v12 offset:2048
    ds_read_b64_tr_b16 v[186:187], v12 offset:2176
    ds_read_b64_tr_b16 v[188:189], v12 offset:3072
    ds_read_b64_tr_b16 v[190:191], v12 offset:3200
    ds_read_b64_tr_b16 v[192:193], v12 offset:4096
    ds_read_b64_tr_b16 v[194:195], v12 offset:4224
    ds_read_b64_tr_b16 v[196:197], v12 offset:5120
    ds_read_b64_tr_b16 v[198:199], v12 offset:5248
    ds_read_b64_tr_b16 v[200:201], v12 offset:6144
    ds_read_b64_tr_b16 v[202:203], v12 offset:6272
    ds_read_b64_tr_b16 v[204:205], v12 offset:7168
    ds_read_b64_tr_b16 v[206:207], v12 offset:7296
    ds_read_b64_tr_b16 v[208:209], v12 offset:8192
    ds_read_b64_tr_b16 v[210:211], v12 offset:8320
    s_waitcnt lgkmcnt(0)
    v_accvgpr_write_b32 a16, v176
    v_accvgpr_write_b32 a17, v177
    v_accvgpr_write_b32 a18, v178
    v_accvgpr_write_b32 a19, v179
    v_accvgpr_write_b32 a36, v180
    v_accvgpr_write_b32 a37, v181
    v_accvgpr_write_b32 a38, v182
    v_accvgpr_write_b32 a39, v183
    v_accvgpr_write_b32 a56, v184
    v_accvgpr_write_b32 a57, v185
    v_accvgpr_write_b32 a58, v186
    v_accvgpr_write_b32 a59, v187
    v_accvgpr_write_b32 a76, v188
    v_accvgpr_write_b32 a77, v189
    v_accvgpr_write_b32 a78, v190
    v_accvgpr_write_b32 a79, v191
    v_accvgpr_write_b32 a96, v192
    v_accvgpr_write_b32 a97, v193
    v_accvgpr_write_b32 a98, v194
    v_accvgpr_write_b32 a99, v195
    v_accvgpr_write_b32 a116, v196
    v_accvgpr_write_b32 a117, v197
    v_accvgpr_write_b32 a118, v198
    v_accvgpr_write_b32 a119, v199
    v_accvgpr_write_b32 a136, v200
    v_accvgpr_write_b32 a137, v201
    v_accvgpr_write_b32 a138, v202
    v_accvgpr_write_b32 a139, v203
    v_accvgpr_write_b32 a156, v204
    v_accvgpr_write_b32 a157, v205
    v_accvgpr_write_b32 a158, v206
    v_accvgpr_write_b32 a159, v207
    v_accvgpr_write_b32 a176, v208
    v_accvgpr_write_b32 a177, v209
    v_accvgpr_write_b32 a178, v210
    v_accvgpr_write_b32 a179, v211
    s_waitcnt vmcnt(9)
    ds_write_b128 v9, v[212:215] offset:0
    ds_write_b128 v9, v[216:219] offset:1024
    ds_write_b128 v9, v[220:223] offset:2048
    ds_write_b128 v9, v[224:227] offset:3072
    ds_write_b128 v9, v[228:231] offset:4096
    ds_write_b128 v9, v[232:235] offset:5120
    ds_write_b128 v9, v[236:239] offset:6144
    ds_write_b128 v9, v[240:243] offset:7168
    ds_write_b128 v9, v[244:247] offset:8192
    s_waitcnt lgkmcnt(0)
    ds_read_b64_tr_b16 v[212:213], v13 offset:0
    ds_read_b64_tr_b16 v[214:215], v13 offset:512
    ds_read_b64_tr_b16 v[216:217], v13 offset:1024
    ds_read_b64_tr_b16 v[218:219], v13 offset:1536
    ds_read_b64_tr_b16 v[220:221], v13 offset:2048
    ds_read_b64_tr_b16 v[222:223], v13 offset:2560
    ds_read_b64_tr_b16 v[224:225], v13 offset:3072
    ds_read_b64_tr_b16 v[226:227], v13 offset:3584
    ds_read_b64_tr_b16 v[228:229], v13 offset:4096
    ds_read_b64_tr_b16 v[230:231], v13 offset:4608
    ds_read_b64_tr_b16 v[232:233], v13 offset:5120
    ds_read_b64_tr_b16 v[234:235], v13 offset:5632
    ds_read_b64_tr_b16 v[236:237], v13 offset:6144
    ds_read_b64_tr_b16 v[238:239], v13 offset:6656
    ds_read_b64_tr_b16 v[240:241], v13 offset:7168
    ds_read_b64_tr_b16 v[242:243], v13 offset:7680
    ds_read_b64_tr_b16 v[244:245], v13 offset:8192
    ds_read_b64_tr_b16 v[246:247], v13 offset:8704
    s_waitcnt lgkmcnt(0)
    v_accvgpr_write_b32 a180, v212
    v_accvgpr_write_b32 a181, v213
    v_accvgpr_write_b32 a182, v214
    v_accvgpr_write_b32 a183, v215
    v_accvgpr_write_b32 a184, v216
    v_accvgpr_write_b32 a185, v217
    v_accvgpr_write_b32 a186, v218
    v_accvgpr_write_b32 a187, v219
    v_accvgpr_write_b32 a188, v220
    v_accvgpr_write_b32 a189, v221
    v_accvgpr_write_b32 a190, v222
    v_accvgpr_write_b32 a191, v223
    v_accvgpr_write_b32 a192, v224
    v_accvgpr_write_b32 a193, v225
    v_accvgpr_write_b32 a194, v226
    v_accvgpr_write_b32 a195, v227
    v_accvgpr_write_b32 a196, v228
    v_accvgpr_write_b32 a197, v229
    v_accvgpr_write_b32 a198, v230
    v_accvgpr_write_b32 a199, v231
    v_accvgpr_write_b32 a200, v232
    v_accvgpr_write_b32 a201, v233
    v_accvgpr_write_b32 a202, v234
    v_accvgpr_write_b32 a203, v235
    v_accvgpr_write_b32 a204, v236
    v_accvgpr_write_b32 a205, v237
    v_accvgpr_write_b32 a206, v238
    v_accvgpr_write_b32 a207, v239
    v_accvgpr_write_b32 a208, v240
    v_accvgpr_write_b32 a209, v241
    v_accvgpr_write_b32 a210, v242
    v_accvgpr_write_b32 a211, v243
    v_accvgpr_write_b32 a212, v244
    v_accvgpr_write_b32 a213, v245
    v_accvgpr_write_b32 a214, v246
    v_accvgpr_write_b32 a215, v247
    s_waitcnt vmcnt(0)
    ds_write_b128 v9, v[32:35] offset:0
    ds_write_b128 v9, v[36:39] offset:1024
    ds_write_b128 v9, v[40:43] offset:2048
    ds_write_b128 v9, v[44:47] offset:3072
    ds_write_b128 v9, v[48:51] offset:4096
    ds_write_b128 v9, v[52:55] offset:5120
    ds_write_b128 v9, v[56:59] offset:6144
    ds_write_b128 v9, v[60:63] offset:7168
    ds_write_b128 v9, v[64:67] offset:8192
    s_waitcnt lgkmcnt(0)
    ds_read_b64_tr_b16 v[32:33], v13 offset:0
    ds_read_b64_tr_b16 v[34:35], v13 offset:512
    ds_read_b64_tr_b16 v[36:37], v13 offset:1024
    ds_read_b64_tr_b16 v[38:39], v13 offset:1536
    ds_read_b64_tr_b16 v[40:41], v13 offset:2048
    ds_read_b64_tr_b16 v[42:43], v13 offset:2560
    ds_read_b64_tr_b16 v[44:45], v13 offset:3072
    ds_read_b64_tr_b16 v[46:47], v13 offset:3584
    ds_read_b64_tr_b16 v[48:49], v13 offset:4096
    ds_read_b64_tr_b16 v[50:51], v13 offset:4608
    ds_read_b64_tr_b16 v[52:53], v13 offset:5120
    ds_read_b64_tr_b16 v[54:55], v13 offset:5632
    ds_read_b64_tr_b16 v[56:57], v13 offset:6144
    ds_read_b64_tr_b16 v[58:59], v13 offset:6656
    ds_read_b64_tr_b16 v[60:61], v13 offset:7168
    ds_read_b64_tr_b16 v[62:63], v13 offset:7680
    ds_read_b64_tr_b16 v[64:65], v13 offset:8192
    ds_read_b64_tr_b16 v[66:67], v13 offset:8704
    s_waitcnt lgkmcnt(0)
    v_accvgpr_write_b32 a216, v32
    v_accvgpr_write_b32 a217, v33
    v_accvgpr_write_b32 a218, v34
    v_accvgpr_write_b32 a219, v35
    v_accvgpr_write_b32 a220, v36
    v_accvgpr_write_b32 a221, v37
    v_accvgpr_write_b32 a222, v38
    v_accvgpr_write_b32 a223, v39
    v_accvgpr_write_b32 a224, v40
    v_accvgpr_write_b32 a225, v41
    v_accvgpr_write_b32 a226, v42
    v_accvgpr_write_b32 a227, v43
    v_accvgpr_write_b32 a228, v44
    v_accvgpr_write_b32 a229, v45
    v_accvgpr_write_b32 a230, v46
    v_accvgpr_write_b32 a231, v47
    v_accvgpr_write_b32 a232, v48
    v_accvgpr_write_b32 a233, v49
    v_accvgpr_write_b32 a234, v50
    v_accvgpr_write_b32 a235, v51
    v_accvgpr_write_b32 a236, v52
    v_accvgpr_write_b32 a237, v53
    v_accvgpr_write_b32 a238, v54
    v_accvgpr_write_b32 a239, v55
    v_accvgpr_write_b32 a240, v56
    v_accvgpr_write_b32 a241, v57
    v_accvgpr_write_b32 a242, v58
    v_accvgpr_write_b32 a243, v59
    v_accvgpr_write_b32 a244, v60
    v_accvgpr_write_b32 a245, v61
    v_accvgpr_write_b32 a246, v62
    v_accvgpr_write_b32 a247, v63
    v_accvgpr_write_b32 a248, v64
    v_accvgpr_write_b32 a249, v65
    v_accvgpr_write_b32 a250, v66
    v_accvgpr_write_b32 a251, v67
    v_lshl_add_u32 v6, v4, 3, v5
    v_lshlrev_b32 v6, 4, v6
    v_mov_b32 v7, v6
    s_mul_i32 s43, s40, 2560
    v_add_u32 v6, s43, v6
    v_add_u32 v7, 36864, v7
    v_mov_b32 v8, v9
    v_lshrrev_b32 v10, 4, v0
    v_and_b32 v11, 15, v0
    s_mul_i32 s43, s42, 9
    v_add_u32 v12, s43, v10
    v_lshrrev_b32 v13, 3, v11
    v_lshlrev_b32 v13, 5, v13
    v_and_b32 v14, 7, v11
    v_add_u32 v13, v13, v14
    v_cmp_le_u32 vcc, 24, v12
    s_nop 1
    v_cndmask_b32 v13, v13, v11, vcc
    v_lshlrev_b32 v13, 4, v13
    v_lshl_add_u32 v9, v10, 10, v13
    s_mul_i32 s43, s41, 9216
    s_mul_i32 s48, s42, 2304
    s_add_u32 s43, s43, s48
    v_lshlrev_b32 v10, 4, v0
    v_add_u32 v10, s43, v10
    s_mul_i32 s43, s41, 6144
    s_add_u32 s43, s43, s48
    s_sub_u32 s43, s43, 3072
    v_lshlrev_b32 v11, 4, v0
    v_add_u32 v11, s43, v11
    v_cmp_gt_u32 vcc, 144, v0
    s_mov_b64 s[52:53], vcc
    v_cmp_le_u32 vcc, 12, v12
    s_and_b64 s[54:55], vcc, s[52:53]
    s_mul_i32 s43, s41, 9216
    s_mul_i32 s48, s40, 2304
    s_add_u32 s43, s43, s48
    v_lshlrev_b32 v12, 4, v2
    v_min_u32 v13, 15, v2
    v_lshlrev_b32 v13, 4, v13
    v_add_u32 v13, 2048, v13
    v_add_u32 v15, s48, v12
    v_add_u32 v15, 36864, v15
    v_add_u32 v16, s48, v13
    v_add_u32 v16, 36864, v16
    v_add_u32 v12, s43, v12
    v_add_u32 v13, s43, v13
    v_and_b32 v14, 1, v4
    v_lshlrev_b32 v14, 3, v14
    v_lshl_add_u32 v14, v3, 4, v14
    v_add_u32 v14, 43008, v14
    s_mul_i32 s43, s42, 20
    s_lshl_b32 s48, s50, 1
    s_add_u32 s43, s43, s48
    v_lshrrev_b32 v17, 1, v4
    v_add_u32 v17, s43, v17
    v_lshlrev_b32 v17, 13, v17
    v_and_b32 v18, 1, v4
    v_lshl_add_u32 v18, v18, 3, v5
    v_lshl_add_u32 v17, v18, 4, v17
    s_lshl_b32 s43, s41, 8
    v_add_u32 v17, s43, v17
    v_cmp_gt_u32 s[56:57], 8, v3
    v_cmp_gt_u32 s[58:59], 2, v4
    s_mov_b32 s60, 12288
    v_mul_lo_u32 v18, v3, s60
    s_mul_i32 s43, s41, 384
    v_add_u32 v18, s43, v18
    v_lshl_add_u32 v18, v4, 4, v18
    v_add_u32 v19, 0x30000, v18
    s_mul_i32 s43, s41, 12288
    v_lshlrev_b32 v20, 4, v2
    v_add_u32 v20, s43, v20
    v_add_u32 v21, 4096, v20
    v_add_u32 v22, 8192, v20
    s_lshr_b32 s43, s2, 3
    s_mul_i32 s43, s43, 5
    s_add_u32 s43, s43, s40
    s_lshl_b32 s48, s43, 13
    v_lshlrev_b32 v23, 4, v2
    v_add_u32 v23, s48, v23
    v_lshrrev_b32 v22, 3, v2
    v_and_b32 v22, 1, v22
    v_lshlrev_b32 v22, 3, v22
    v_lshl_add_u32 v22, v5, 4, v22
    s_lshl_b32 s48, s43, 7
    v_add_u32 v1, s48, v22
    s_mov_b32 s61, 0.07216878364870322
    s_lshl_b32 s75, s41, 2
    s_add_u32 s75, s75, s42
    s_mov_b32 s62, 0
    s_mov_b32 s65, 0
    s_cmp_ge_u32 s40, 2
    s_cselect_b32 s44, s36, s32
    s_cselect_b32 s45, s37, s33
    s_mov_b32 s46, 0x1800000
    s_mov_b32 s47, 0x20000
    s_cselect_b32 s48, 1024, 64
    s_mov_b32 s49, 393216
    s_cmp_eq_u32 s40, 3
    s_cselect_b32 s63, 6144, 0
    s_cmp_eq_u32 s40, 1
    s_cselect_b64 vcc, -1, 0
    s_nop 1
    v_cndmask_b32 v18, v18, v19, vcc
    s_cmp_ge_u32 s40, 2
    s_cselect_b64 vcc, -1, 0
    s_nop 1
    v_cndmask_b32 v18, v18, v20, vcc
    s_mul_i32 s64, s40, 6144
    s_add_u32 s64, s64, 46080
    v_lshlrev_b32 v19, 4, v2
    v_add_u32 v19, 46080, v19
    s_mov_b32 s51, 0
    s_getreg_b32 s66, hwreg(HW_REG_XCC_ID)
    s_add_u32 s66, s66, 1
    v_mov_b32 v25, s66
    s_and_b32 s67, s2, 7
    s_lshl_b32 s67, s67, 6
    s_add_u32 s67, s67, 1024
    s_lshr_b32 s68, s2, 3
    s_lshl_b32 s68, s68, 2
    s_add_u32 s68, s68, s67
    v_mov_b32 v24, s68
    s_mov_b64 exec, 1
    buffer_store_dword v25, v24, s[92:95], 0 offen sc1
    s_mov_b64 exec, -1
    v_and_b32 v24, 15, v2
    v_lshl_add_u32 v24, v24, 2, s67
    s_mov_b32 s74, 0
L_ch_xw:
    buffer_load_dword v25, v24, s[92:95], 0 offen sc1
    s_waitcnt vmcnt(0)
    v_cmp_eq_u32 vcc, 0, v25
    s_add_u32 s74, s74, 1
    s_cmp_ge_u32 s74, 262144
    s_cbranch_scc1 L_ch_done
    s_nop 1
    s_cbranch_vccnz L_ch_xw
    v_cmp_ne_u32 vcc, s66, v25
    s_nop 4
    s_cmp_eq_u64 vcc, 0
    s_cselect_b32 s51, 1, 0
    s_lshr_b32 s66, s62, 3
    s_lshr_b32 s67, s62, 1
    s_add_u32 s67, s67, 48
    s_cmp_lt_u32 s62, 8
    s_cselect_b32 s66, s67, s66
    s_lshl_b32 s66, s66, 2
    v_mov_b32 v24, s66
    s_mov_b32 s74, 0
L_ch_kv0:
    buffer_load_dword v25, v24, s[92:95], 0 offen sc1
    s_waitcnt vmcnt(0)
    v_readfirstlane_b32 s66, v25
    s_add_u32 s74, s74, 1
    s_cmp_ge_u32 s74, 1048576
    s_cbranch_scc1 L_ch_done
    s_cmp_ge_u32 s66, 48
    s_cbranch_scc1 L_ch_kvok0
    s_sleep 8
    s_branch L_ch_kv0
L_ch_kvok0:
    s_mov_b32 s66, s63
    s_add_u32 m0, s64, 0
    s_nop 0
    buffer_load_dwordx4 v18, s[44:47], s66 offen sc1 lds
    s_add_u32 m0, s64, 1024
    s_add_u32 s66, s66, s48
    buffer_load_dwordx4 v18, s[44:47], s66 offen sc1 lds
    s_add_u32 m0, s64, 2048
    s_add_u32 s66, s66, s48
    buffer_load_dwordx4 v18, s[44:47], s66 offen sc1 lds
    s_add_u32 m0, s64, 3072
    s_add_u32 s66, s66, s48
    buffer_load_dwordx4 v18, s[44:47], s66 offen sc1 lds
    s_add_u32 m0, s64, 4096
    s_add_u32 s66, s66, s48
    buffer_load_dwordx4 v18, s[44:47], s66 offen sc1 lds
    s_add_u32 m0, s64, 5120
    s_add_u32 s66, s66, s48
    buffer_load_dwordx4 v18, s[44:47], s66 offen sc1 lds
    s_add_u32 s63, s63, s49
    s_barrier
L_ch_step:
    s_and_b32 s66, s62, 3
    s_lshl_b32 s67, s66, 14
    s_mul_i32 s68, s66, 294912
    s_mul_i32 s69, s66, 655360
    s_add_u32 s66, s62, 2
    s_and_b32 s66, s66, 3
    s_mul_i32 s70, s66, 294912
    s_mul_i32 s71, s66, 655360
    s_add_u32 s66, s62, 1
    s_and_b32 s66, s66, 3
    s_lshl_b32 s72, s66, 14
    s_add_u32 s66, s62, 3
    s_and_b32 s66, s66, 3
    s_lshl_b32 s73, s66, 14
    s_mov_b32 s74, 0
L_ch_pollA:
L_ch_pollA_:
    buffer_load_dwordx4 v[32:35], v6, s[16:19], s67 offen offset:0 sc1
    buffer_load_dwordx4 v[36:39], v6, s[16:19], s67 offen offset:512 sc1
    buffer_load_dwordx4 v[40:43], v6, s[16:19], s67 offen offset:1024 sc1
    buffer_load_dwordx4 v[44:47], v6, s[16:19], s67 offen offset:1536 sc1
    buffer_load_dwordx4 v[48:51], v6, s[16:19], s67 offen offset:2048 sc1
    s_waitcnt vmcnt(0)
    v_max3_u32 v24, v32, v33, v34
    v_max3_u32 v24, v24, v35, v36
    v_max3_u32 v24, v24, v37, v38
    v_max3_u32 v24, v24, v39, v40
    v_max3_u32 v24, v24, v41, v42
    v_max3_u32 v24, v24, v43, v44
    v_max3_u32 v24, v24, v45, v46
    v_max3_u32 v24, v24, v47, v48
    v_max3_u32 v24, v24, v49, v50
    v_max_u32 v24, v24, v51
    v_cmp_eq_u32 vcc, -1, v24
    s_nop 1
    s_cbranch_vccz L_ch_okA_0
    s_add_u32 s74, s74, 1
    s_cmp_ge_u32 s74, 262144
    s_cbranch_scc1 L_ch_done
    s_branch L_ch_pollA_
L_ch_okA_0:
    s_cmp_eq_u32 s42, 2
    s_cbranch_scc1 L_ch_p1_mix
    s_cmp_eq_u32 s42, 3
    s_cbranch_scc1 L_ch_p1_n
    v_mfma_f32_16x16x32_bf16 v[52:55], a[0:3], v[32:35], 0
    v_mfma_f32_16x16x32_bf16 v[56:59], a[20:23], v[32:35], 0
    v_mfma_f32_16x16x32_bf16 v[60:63], a[40:43], v[32:35], 0
    v_mfma_f32_16x16x32_bf16 v[64:67], a[60:63], v[32:35], 0
    v_mfma_f32_16x16x32_bf16 v[68:71], a[80:83], v[32:35], 0
    v_mfma_f32_16x16x32_bf16 v[72:75], a[100:103], v[32:35], 0
    v_mfma_f32_16x16x32_bf16 v[76:79], a[120:123], v[32:35], 0
    v_mfma_f32_16x16x32_bf16 v[80:83], a[140:143], v[32:35], 0
    v_mfma_f32_16x16x32_bf16 v[84:87], a[160:163], v[32:35], 0
    v_mfma_f32_16x16x32_bf16 v[52:55], a[4:7], v[36:39], v[52:55]
    v_mfma_f32_16x16x32_bf16 v[56:59], a[24:27], v[36:39], v[56:59]
    v_mfma_f32_16x16x32_bf16 v[60:63], a[44:47], v[36:39], v[60:63]
    v_mfma_f32_16x16x32_bf16 v[64:67], a[64:67], v[36:39], v[64:67]
    v_mfma_f32_16x16x32_bf16 v[68:71], a[84:87], v[36:39], v[68:71]
    v_mfma_f32_16x16x32_bf16 v[72:75], a[104:107], v[36:39], v[72:75]
    v_mfma_f32_16x16x32_bf16 v[76:79], a[124:127], v[36:39], v[76:79]
    v_mfma_f32_16x16x32_bf16 v[80:83], a[144:147], v[36:39], v[80:83]
    v_mfma_f32_16x16x32_bf16 v[84:87], a[164:167], v[36:39], v[84:87]
    v_mfma_f32_16x16x32_bf16 v[52:55], a[8:11], v[40:43], v[52:55]
    v_mfma_f32_16x16x32_bf16 v[56:59], a[28:31], v[40:43], v[56:59]
    v_mfma_f32_16x16x32_bf16 v[60:63], a[48:51], v[40:43], v[60:63]
    v_mfma_f32_16x16x32_bf16 v[64:67], a[68:71], v[40:43], v[64:67]
    v_mfma_f32_16x16x32_bf16 v[68:71], a[88:91], v[40:43], v[68:71]
    v_mfma_f32_16x16x32_bf16 v[72:75], a[108:111], v[40:43], v[72:75]
    v_mfma_f32_16x16x32_bf16 v[76:79], a[128:131], v[40:43], v[76:79]
    v_mfma_f32_16x16x32_bf16 v[80:83], a[148:151], v[40:43], v[80:83]
    v_mfma_f32_16x16x32_bf16 v[84:87], a[168:171], v[40:43], v[84:87]
    v_mfma_f32_16x16x32_bf16 v[52:55], a[12:15], v[44:47], v[52:55]
    v_mfma_f32_16x16x32_bf16 v[56:59], a[32:35], v[44:47], v[56:59]
    v_mfma_f32_16x16x32_bf16 v[60:63], a[52:55], v[44:47], v[60:63]
    v_mfma_f32_16x16x32_bf16 v[64:67], a[72:75], v[44:47], v[64:67]
    v_mfma_f32_16x16x32_bf16 v[68:71], a[92:95], v[44:47], v[68:71]
    v_mfma_f32_16x16x32_bf16 v[72:75], a[112:115], v[44:47], v[72:75]
    v_mfma_f32_16x16x32_bf16 v[76:79], a[132:135], v[44:47], v[76:79]
    v_mfma_f32_16x16x32_bf16 v[80:83], a[152:155], v[44:47], v[80:83]
    v_mfma_f32_16x16x32_bf16 v[84:87], a[172:175], v[44:47], v[84:87]
    v_mfma_f32_16x16x32_bf16 v[52:55], a[16:19], v[48:51], v[52:55]
    v_mfma_f32_16x16x32_bf16 v[56:59], a[36:39], v[48:51], v[56:59]
    v_mfma_f32_16x16x32_bf16 v[60:63], a[56:59], v[48:51], v[60:63]
    v_mfma_f32_16x16x32_bf16 v[64:67], a[76:79], v[48:51], v[64:67]
    v_mfma_f32_16x16x32_bf16 v[68:71], a[96:99], v[48:51], v[68:71]
    v_mfma_f32_16x16x32_bf16 v[72:75], a[116:119], v[48:51], v[72:75]
    v_mfma_f32_16x16x32_bf16 v[76:79], a[136:139], v[48:51], v[76:79]
    v_mfma_f32_16x16x32_bf16 v[80:83], a[156:159], v[48:51], v[80:83]
    v_mfma_f32_16x16x32_bf16 v[84:87], a[176:179], v[48:51], v[84:87]
    s_branch L_ch_p1_done
L_ch_p1_mix:
    v_mfma_f32_16x16x32_bf16 v[52:55], a[0:3], v[32:35], 0
    v_mfma_f32_16x16x32_bf16 v[56:59], a[20:23], v[32:35], 0
    v_mfma_f32_16x16x32_bf16 v[60:63], a[40:43], v[32:35], 0
    v_mfma_f32_16x16x32_bf16 v[64:67], a[60:63], v[32:35], 0
    v_mfma_f32_16x16x32_bf16 v[68:71], a[80:83], v[32:35], 0
    v_mfma_f32_16x16x32_bf16 v[72:75], a[100:103], v[32:35], 0
    v_mfma_f32_16x16x32_bf16 v[76:79], v[32:35], a[120:123], 0
    v_mfma_f32_16x16x32_bf16 v[80:83], v[32:35], a[140:143], 0
    v_mfma_f32_16x16x32_bf16 v[84:87], v[32:35], a[160:163], 0
    v_mfma_f32_16x16x32_bf16 v[52:55], a[4:7], v[36:39], v[52:55]
    v_mfma_f32_16x16x32_bf16 v[56:59], a[24:27], v[36:39], v[56:59]
    v_mfma_f32_16x16x32_bf16 v[60:63], a[44:47], v[36:39], v[60:63]
    v_mfma_f32_16x16x32_bf16 v[64:67], a[64:67], v[36:39], v[64:67]
    v_mfma_f32_16x16x32_bf16 v[68:71], a[84:87], v[36:39], v[68:71]
    v_mfma_f32_16x16x32_bf16 v[72:75], a[104:107], v[36:39], v[72:75]
    v_mfma_f32_16x16x32_bf16 v[76:79], v[36:39], a[124:127], v[76:79]
    v_mfma_f32_16x16x32_bf16 v[80:83], v[36:39], a[144:147], v[80:83]
    v_mfma_f32_16x16x32_bf16 v[84:87], v[36:39], a[164:167], v[84:87]
    v_mfma_f32_16x16x32_bf16 v[52:55], a[8:11], v[40:43], v[52:55]
    v_mfma_f32_16x16x32_bf16 v[56:59], a[28:31], v[40:43], v[56:59]
    v_mfma_f32_16x16x32_bf16 v[60:63], a[48:51], v[40:43], v[60:63]
    v_mfma_f32_16x16x32_bf16 v[64:67], a[68:71], v[40:43], v[64:67]
    v_mfma_f32_16x16x32_bf16 v[68:71], a[88:91], v[40:43], v[68:71]
    v_mfma_f32_16x16x32_bf16 v[72:75], a[108:111], v[40:43], v[72:75]
    v_mfma_f32_16x16x32_bf16 v[76:79], v[40:43], a[128:131], v[76:79]
    v_mfma_f32_16x16x32_bf16 v[80:83], v[40:43], a[148:151], v[80:83]
    v_mfma_f32_16x16x32_bf16 v[84:87], v[40:43], a[168:171], v[84:87]
    v_mfma_f32_16x16x32_bf16 v[52:55], a[12:15], v[44:47], v[52:55]
    v_mfma_f32_16x16x32_bf16 v[56:59], a[32:35], v[44:47], v[56:59]
    v_mfma_f32_16x16x32_bf16 v[60:63], a[52:55], v[44:47], v[60:63]
    v_mfma_f32_16x16x32_bf16 v[64:67], a[72:75], v[44:47], v[64:67]
    v_mfma_f32_16x16x32_bf16 v[68:71], a[92:95], v[44:47], v[68:71]
    v_mfma_f32_16x16x32_bf16 v[72:75], a[112:115], v[44:47], v[72:75]
    v_mfma_f32_16x16x32_bf16 v[76:79], v[44:47], a[132:135], v[76:79]
    v_mfma_f32_16x16x32_bf16 v[80:83], v[44:47], a[152:155], v[80:83]
    v_mfma_f32_16x16x32_bf16 v[84:87], v[44:47], a[172:175], v[84:87]
    v_mfma_f32_16x16x32_bf16 v[52:55], a[16:19], v[48:51], v[52:55]
    v_mfma_f32_16x16x32_bf16 v[56:59], a[36:39], v[48:51], v[56:59]
    v_mfma_f32_16x16x32_bf16 v[60:63], a[56:59], v[48:51], v[60:63]
    v_mfma_f32_16x16x32_bf16 v[64:67], a[76:79], v[48:51], v[64:67]
    v_mfma_f32_16x16x32_bf16 v[68:71], a[96:99], v[48:51], v[68:71]
    v_mfma_f32_16x16x32_bf16 v[72:75], a[116:119], v[48:51], v[72:75]
    v_mfma_f32_16x16x32_bf16 v[76:79], v[48:51], a[136:139], v[76:79]
    v_mfma_f32_16x16x32_bf16 v[80:83], v[48:51], a[156:159], v[80:83]
    v_mfma_f32_16x16x32_bf16 v[84:87], v[48:51], a[176:179], v[84:87]
    s_branch L_ch_p1_done
L_ch_p1_n:
    v_mfma_f32_16x16x32_bf16 v[52:55], v[32:35], a[0:3], 0
    v_mfma_f32_16x16x32_bf16 v[56:59], v[32:35], a[20:23], 0
    v_mfma_f32_16x16x32_bf16 v[60:63], v[32:35], a[40:43], 0
    v_mfma_f32_16x16x32_bf16 v[64:67], v[32:35], a[60:63], 0
    v_mfma_f32_16x16x32_bf16 v[68:71], v[32:35], a[80:83], 0
    v_mfma_f32_16x16x32_bf16 v[72:75], v[32:35], a[100:103], 0
    v_mfma_f32_16x16x32_bf16 v[76:79], v[32:35], a[120:123], 0
    v_mfma_f32_16x16x32_bf16 v[80:83], v[32:35], a[140:143], 0
    v_mfma_f32_16x16x32_bf16 v[84:87], v[32:35], a[160:163], 0
    v_mfma_f32_16x16x32_bf16 v[52:55], v[36:39], a[4:7], v[52:55]
    v_mfma_f32_16x16x32_bf16 v[56:59], v[36:39], a[24:27], v[56:59]
    v_mfma_f32_16x16x32_bf16 v[60:63], v[36:39], a[44:47], v[60:63]
    v_mfma_f32_16x16x32_bf16 v[64:67], v[36:39], a[64:67], v[64:67]
    v_mfma_f32_16x16x32_bf16 v[68:71], v[36:39], a[84:87], v[68:71]
    v_mfma_f32_16x16x32_bf16 v[72:75], v[36:39], a[104:107], v[72:75]
    v_mfma_f32_16x16x32_bf16 v[76:79], v[36:39], a[124:127], v[76:79]
    v_mfma_f32_16x16x32_bf16 v[80:83], v[36:39], a[144:147], v[80:83]
    v_mfma_f32_16x16x32_bf16 v[84:87], v[36:39], a[164:167], v[84:87]
    v_mfma_f32_16x16x32_bf16 v[52:55], v[40:43], a[8:11], v[52:55]
    v_mfma_f32_16x16x32_bf16 v[56:59], v[40:43], a[28:31], v[56:59]
    v_mfma_f32_16x16x32_bf16 v[60:63], v[40:43], a[48:51], v[60:63]
    v_mfma_f32_16x16x32_bf16 v[64:67], v[40:43], a[68:71], v[64:67]
    v_mfma_f32_16x16x32_bf16 v[68:71], v[40:43], a[88:91], v[68:71]
    v_mfma_f32_16x16x32_bf16 v[72:75], v[40:43], a[108:111], v[72:75]
    v_mfma_f32_16x16x32_bf16 v[76:79], v[40:43], a[128:131], v[76:79]
    v_mfma_f32_16x16x32_bf16 v[80:83], v[40:43], a[148:151], v[80:83]
    v_mfma_f32_16x16x32_bf16 v[84:87], v[40:43], a[168:171], v[84:87]
    v_mfma_f32_16x16x32_bf16 v[52:55], v[44:47], a[12:15], v[52:55]
    v_mfma_f32_16x16x32_bf16 v[56:59], v[44:47], a[32:35], v[56:59]
    v_mfma_f32_16x16x32_bf16 v[60:63], v[44:47], a[52:55], v[60:63]
    v_mfma_f32_16x16x32_bf16 v[64:67], v[44:47], a[72:75], v[64:67]
    v_mfma_f32_16x16x32_bf16 v[68:71], v[44:47], a[92:95], v[68:71]
    v_mfma_f32_16x16x32_bf16 v[72:75], v[44:47], a[112:115], v[72:75]
    v_mfma_f32_16x16x32_bf16 v[76:79], v[44:47], a[132:135], v[76:79]
    v_mfma_f32_16x16x32_bf16 v[80:83], v[44:47], a[152:155], v[80:83]
    v_mfma_f32_16x16x32_bf16 v[84:87], v[44:47], a[172:175], v[84:87]
    v_mfma_f32_16x16x32_bf16 v[52:55], v[48:51], a[16:19], v[52:55]
    v_mfma_f32_16x16x32_bf16 v[56:59], v[48:51], a[36:39], v[56:59]
    v_mfma_f32_16x16x32_bf16 v[60:63], v[48:51], a[56:59], v[60:63]
    v_mfma_f32_16x16x32_bf16 v[64:67], v[48:51], a[76:79], v[64:67]
    v_mfma_f32_16x16x32_bf16 v[68:71], v[48:51], a[96:99], v[68:71]
    v_mfma_f32_16x16x32_bf16 v[72:75], v[48:51], a[116:119], v[72:75]
    v_mfma_f32_16x16x32_bf16 v[76:79], v[48:51], a[136:139], v[76:79]
    v_mfma_f32_16x16x32_bf16 v[80:83], v[48:51], a[156:159], v[80:83]
    v_mfma_f32_16x16x32_bf16 v[84:87], v[48:51], a[176:179], v[84:87]
L_ch_p1_done:
    s_nop 7
    s_nop 1
    ds_write_b128 v8, v[52:55] offset:0
    ds_write_b128 v8, v[56:59] offset:1024
    ds_write_b128 v8, v[60:63] offset:2048
    ds_write_b128 v8, v[64:67] offset:3072
    ds_write_b128 v8, v[68:71] offset:4096
    ds_write_b128 v8, v[72:75] offset:5120
    ds_write_b128 v8, v[76:79] offset:6144
    ds_write_b128 v8, v[80:83] offset:7168
    ds_write_b128 v8, v[84:87] offset:8192
    s_waitcnt lgkmcnt(0)
    s_barrier
    s_mov_b64 exec, s[52:53]
    s_cbranch_execz L_ch_nopub
    ds_read_b128 v[32:35], v9 offset:0
    ds_read_b128 v[36:39], v9 offset:256
    ds_read_b128 v[40:43], v9 offset:9216
    ds_read_b128 v[44:47], v9 offset:9472
    ds_read_b128 v[48:51], v9 offset:18432
    ds_read_b128 v[52:55], v9 offset:18688
    ds_read_b128 v[56:59], v9 offset:27648
    ds_read_b128 v[60:63], v9 offset:27904
    s_waitcnt lgkmcnt(0)
    v_add_f32 v32, v32, v40
    v_add_f32 v48, v48, v56
    v_add_f32 v32, v32, v48
    v_add_f32 v33, v33, v41
    v_add_f32 v49, v49, v57
    v_add_f32 v33, v33, v49
    v_add_f32 v34, v34, v42
    v_add_f32 v50, v50, v58
    v_add_f32 v34, v34, v50
    v_add_f32 v35, v35, v43
    v_add_f32 v51, v51, v59
    v_add_f32 v35, v35, v51
    v_add_f32 v36, v36, v44
    v_add_f32 v52, v52, v60
    v_add_f32 v36, v36, v52
    v_add_f32 v37, v37, v45
    v_add_f32 v53, v53, v61
    v_add_f32 v37, v37, v53
    v_add_f32 v38, v38, v46
    v_add_f32 v54, v54, v62
    v_add_f32 v38, v38, v54
    v_add_f32 v39, v39, v47
    v_add_f32 v55, v55, v63
    v_add_f32 v39, v39, v55
    v_cvt_pk_bf16_f32 v40, v32, v33
    v_min_u32 v40, 0xfffffffe, v40
    v_cvt_pk_bf16_f32 v41, v34, v35
    v_min_u32 v41, 0xfffffffe, v41
    v_cvt_pk_bf16_f32 v42, v36, v37
    v_min_u32 v42, 0xfffffffe, v42
    v_cvt_pk_bf16_f32 v43, v38, v39
    v_min_u32 v43, 0xfffffffe, v43
    s_cmp_eq_u32 s51, 1
    s_cbranch_scc1 L_ch_pubf
    buffer_store_dwordx4 v[40:43], v10, s[20:23], s68 offen sc1
    s_branch L_ch_pubd
L_ch_pubf:
    buffer_store_dwordx4 v[40:43], v10, s[20:23], s68 offen
L_ch_pubd:
    v_accvgpr_write_b32 a252, v40
    v_accvgpr_write_b32 a253, v41
    v_accvgpr_write_b32 a254, v42
    v_accvgpr_write_b32 a255, v43
L_ch_nopub:
    s_mov_b64 exec, -1
    s_cmp_eq_u32 s62, 63
    s_cbranch_scc1 L_ch_last
    ds_read_b128 v[88:91], v19 offset:0
    ds_read_b128 v[92:95], v19 offset:1024
    ds_read_b128 v[96:99], v19 offset:2048
    ds_read_b128 v[100:103], v19 offset:3072
    ds_read_b128 v[104:107], v19 offset:4096
    ds_read_b128 v[108:111], v19 offset:5120
    ds_read_b128 v[112:115], v19 offset:6144
    ds_read_b128 v[116:119], v19 offset:7168
    ds_read_b128 v[120:123], v19 offset:8192
    ds_read_b128 v[124:127], v19 offset:9216
    ds_read_b128 v[128:131], v19 offset:10240
    ds_read_b128 v[132:135], v19 offset:11264
    ds_read_b128 v[136:139], v19 offset:12288
    ds_read_b128 v[140:143], v19 offset:13312
    ds_read_b128 v[144:147], v19 offset:14336
    ds_read_b128 v[148:151], v19 offset:15360
    ds_read_b128 v[152:155], v19 offset:16384
    ds_read_b128 v[156:159], v19 offset:17408
    ds_read_b128 v[160:163], v19 offset:18432
    ds_read_b128 v[164:167], v19 offset:19456
    ds_read_b128 v[168:171], v19 offset:20480
    ds_read_b128 v[172:175], v19 offset:21504
    ds_read_b128 v[176:179], v19 offset:22528
    ds_read_b128 v[180:183], v19 offset:23552
    s_mov_b32 s74, 0
    s_sleep 4
L_ch_pollB_:
    buffer_load_dwordx4 v[32:35], v12, s[20:23], s68 offen sc1
    buffer_load_dwordx4 v[36:39], v12, s[20:23], s68 offen offset:1024 sc1
    buffer_load_dwordx4 v[40:43], v13, s[20:23], s68 offen sc1
    s_waitcnt vmcnt(0)
    v_max3_u32 v24, v32, v33, v34
    v_max3_u32 v24, v24, v35, v36
    v_max3_u32 v24, v24, v37, v38
    v_max3_u32 v24, v24, v39, v40
    v_max3_u32 v24, v24, v41, v42
    v_max_u32 v24, v24, v43
    v_cmp_eq_u32 vcc, -1, v24
    s_nop 1
    s_cbranch_vccz L_ch_okB_0
    s_add_u32 s74, s74, 1
    s_cmp_ge_u32 s74, 262144
    s_cbranch_scc1 L_ch_done
    s_branch L_ch_pollB_
L_ch_okB_0:
    ds_write_b128 v15, v[32:35]
    ds_write_b128 v15, v[36:39] offset:1024
    ds_write_b128 v16, v[40:43]
    s_waitcnt lgkmcnt(0)
    s_barrier
    s_add_u32 s90, s62, 1
    s_cmp_lt_u32 s90, 8
    s_cselect_b32 s67, 1, 7
    s_and_b32 s66, s90, s67
    s_cmp_lg_u32 s66, 0
    s_cbranch_scc1 L_ch_kvok1
    s_lshr_b32 s66, s90, 3
    s_lshr_b32 s67, s90, 1
    s_add_u32 s67, s67, 48
    s_cmp_lt_u32 s90, 8
    s_cselect_b32 s66, s67, s66
    s_lshl_b32 s66, s66, 2
    v_mov_b32 v24, s66
    s_mov_b32 s74, 0
L_ch_kv1:
    buffer_load_dword v25, v24, s[92:95], 0 offen sc1
    s_waitcnt vmcnt(0)
    v_readfirstlane_b32 s66, v25
    s_add_u32 s74, s74, 1
    s_cmp_ge_u32 s74, 1048576
    s_cbranch_scc1 L_ch_done
    s_cmp_ge_u32 s66, 48
    s_cbranch_scc1 L_ch_kvok1
    s_sleep 8
    s_branch L_ch_kv1
L_ch_kvok1:
    s_mov_b32 s66, s63
    s_add_u32 m0, s64, 0
    s_nop 0
    buffer_load_dwordx4 v18, s[44:47], s66 offen sc1 lds
    s_add_u32 m0, s64, 1024
    s_add_u32 s66, s66, s48
    buffer_load_dwordx4 v18, s[44:47], s66 offen sc1 lds
    s_add_u32 m0, s64, 2048
    s_add_u32 s66, s66, s48
    buffer_load_dwordx4 v18, s[44:47], s66 offen sc1 lds
    s_add_u32 m0, s64, 3072
    s_add_u32 s66, s66, s48
    buffer_load_dwordx4 v18, s[44:47], s66 offen sc1 lds
    s_add_u32 m0, s64, 4096
    s_add_u32 s66, s66, s48
    buffer_load_dwordx4 v18, s[44:47], s66 offen sc1 lds
    s_add_u32 m0, s64, 5120
    s_add_u32 s66, s66, s48
    buffer_load_dwordx4 v18, s[44:47], s66 offen sc1 lds
    s_add_u32 s63, s63, s49
    ds_read_b128 v[184:187], v7 offset:0
    ds_read_b128 v[208:211], v7 offset:3072
    ds_read_b128 v[188:191], v7 offset:512
    ds_read_b128 v[212:215], v7 offset:3584
    ds_read_b128 v[192:195], v7 offset:1024
    ds_read_b128 v[216:219], v7 offset:4096
    ds_read_b128 v[196:199], v7 offset:1536
    ds_read_b128 v[220:223], v7 offset:4608
    ds_read_b128 v[200:203], v7 offset:2048
    ds_read_b128 v[224:227], v7 offset:5120
    ds_read_b128 v[204:207], v7 offset:2560
    ds_read_b128 v[228:231], v7 offset:5632
    s_waitcnt lgkmcnt(0)
    ds_read_b64 v[232:233], v14 offset:0
    ds_read_b64 v[234:235], v14 offset:256
    ds_read_b64 v[236:237], v14 offset:512
    ds_read_b64 v[238:239], v14 offset:768
    ds_read_b64 v[240:241], v14 offset:1024
    ds_read_b64 v[242:243], v14 offset:1280
    ds_read_b64 v[244:245], v14 offset:1536
    ds_read_b64 v[246:247], v14 offset:1792
    ds_read_b64 v[248:249], v14 offset:2048
    ds_read_b64 v[250:251], v14 offset:2304
    ds_read_b64 v[252:253], v14 offset:2560
    ds_read_b64 v[254:255], v14 offset:2816
    v_mfma_f32_16x16x32_bf16 v[76:79], v[208:211], v[184:187], 0
    v_mfma_f32_16x16x32_bf16 v[80:83], v[88:91], v[184:187], 0
    v_mfma_f32_16x16x32_bf16 v[84:87], v[112:115], v[184:187], 0
    v_mfma_f32_16x16x32_bf16 v[76:79], v[212:215], v[188:191], v[76:79]
    v_mfma_f32_16x16x32_bf16 v[80:83], v[92:95], v[188:191], v[80:83]
    v_mfma_f32_16x16x32_bf16 v[84:87], v[116:119], v[188:191], v[84:87]
    v_mfma_f32_16x16x32_bf16 v[76:79], v[216:219], v[192:195], v[76:79]
    v_mfma_f32_16x16x32_bf16 v[80:83], v[96:99], v[192:195], v[80:83]
    v_mfma_f32_16x16x32_bf16 v[84:87], v[120:123], v[192:195], v[84:87]
    v_mfma_f32_16x16x32_bf16 v[76:79], v[220:223], v[196:199], v[76:79]
    v_mfma_f32_16x16x32_bf16 v[80:83], v[100:103], v[196:199], v[80:83]
    v_mfma_f32_16x16x32_bf16 v[84:87], v[124:127], v[196:199], v[84:87]
    v_mfma_f32_16x16x32_bf16 v[76:79], v[224:227], v[200:203], v[76:79]
    v_mfma_f32_16x16x32_bf16 v[80:83], v[104:107], v[200:203], v[80:83]
    v_mfma_f32_16x16x32_bf16 v[84:87], v[128:131], v[200:203], v[84:87]
    v_mfma_f32_16x16x32_bf16 v[76:79], v[228:231], v[204:207], v[76:79]
    v_mfma_f32_16x16x32_bf16 v[80:83], v[108:111], v[204:207], v[80:83]
    v_mfma_f32_16x16x32_bf16 v[84:87], v[132:135], v[204:207], v[84:87]
    v_mov_b32 v26, 0xce6e6b28
    s_nop 7
    s_nop 1
    v_cvt_pk_bf16_f32 v76, v76, v77
    v_cvt_pk_bf16_f32 v78, v78, v79
    v_cvt_pk_bf16_f32 v80, v80, v81
    v_cvt_pk_bf16_f32 v82, v82, v83
    v_cvt_pk_bf16_f32 v84, v84, v85
    v_cvt_pk_bf16_f32 v86, v86, v87
    v_and_b32 v77, 0xffff0000, v76
    v_and_b32 v79, 0xffff0000, v78
    v_and_b32 v81, 0xffff0000, v80
    v_and_b32 v83, 0xffff0000, v82
    v_and_b32 v85, 0xffff0000, v84
    v_and_b32 v87, 0xffff0000, v86
    v_lshlrev_b32 v76, 16, v76
    v_lshlrev_b32 v78, 16, v78
    v_lshlrev_b32 v80, 16, v80
    v_lshlrev_b32 v82, 16, v82
    v_lshlrev_b32 v84, 16, v84
    v_lshlrev_b32 v86, 16, v86
    v_mul_f32 v76, s61, v76
    v_mul_f32 v77, s61, v77
    v_mul_f32 v78, s61, v78
    v_mul_f32 v79, s61, v79
    v_mul_f32 v80, s61, v80
    v_mul_f32 v81, s61, v81
    v_mul_f32 v82, s61, v82
    v_mul_f32 v83, s61, v83
    v_mul_f32 v84, s61, v84
    v_mul_f32 v85, s61, v85
    v_mul_f32 v86, s61, v86
    v_mul_f32 v87, s61, v87
    v_cvt_pk_bf16_f32 v76, v76, v77
    v_cvt_pk_bf16_f32 v78, v78, v79
    v_cvt_pk_bf16_f32 v80, v80, v81
    v_cvt_pk_bf16_f32 v82, v82, v83
    v_cvt_pk_bf16_f32 v84, v84, v85
    v_cvt_pk_bf16_f32 v86, v86, v87
    v_and_b32 v77, 0xffff0000, v76
    v_and_b32 v79, 0xffff0000, v78
    v_and_b32 v81, 0xffff0000, v80
    v_and_b32 v83, 0xffff0000, v82
    v_and_b32 v85, 0xffff0000, v84
    v_and_b32 v87, 0xffff0000, v86
    v_lshlrev_b32 v76, 16, v76
    v_lshlrev_b32 v78, 16, v78
    v_lshlrev_b32 v80, 16, v80
    v_lshlrev_b32 v82, 16, v82
    v_lshlrev_b32 v84, 16, v84
    v_lshlrev_b32 v86, 16, v86
    v_cndmask_b32 v76, v26, v76, s[58:59]
    v_cndmask_b32 v77, v26, v77, s[58:59]
    v_cndmask_b32 v78, v26, v78, s[58:59]
    v_cndmask_b32 v79, v26, v79, s[58:59]
    v_max3_f32 v24, v76, v77, v78
    v_max3_f32 v25, v79, v80, v81
    v_max3_f32 v24, v24, v82, v83
    v_max3_f32 v25, v25, v84, v85
    v_max3_f32 v24, v24, v86, v87
    v_max_f32 v25, v25, v24
    v_mov_b32 v24, v25
    s_nop 1
    v_permlane32_swap_b32 v25, v24
    s_nop 1
    v_max_f32 v25, v25, v24
    v_mov_b32 v24, v25
    s_nop 1
    v_permlane16_swap_b32 v25, v24
    s_nop 1
    v_max_f32 v25, v25, v24
    v_mul_f32 v25, -1.4426950408889634, v25
    v_mov_b32 v24, 1.4426950408889634
    v_fma_f32 v76, v76, v24, v25
    v_fma_f32 v77, v77, v24, v25
    v_fma_f32 v78, v78, v24, v25
    v_fma_f32 v79, v79, v24, v25
    v_fma_f32 v80, v80, v24, v25
    v_fma_f32 v81, v81, v24, v25
    v_fma_f32 v82, v82, v24, v25
    v_fma_f32 v83, v83, v24, v25
    v_fma_f32 v84, v84, v24, v25
    v_fma_f32 v85, v85, v24, v25
    v_fma_f32 v86, v86, v24, v25
    v_fma_f32 v87, v87, v24, v25
    v_exp_f32 v76, v76
    v_exp_f32 v77, v77
    v_exp_f32 v78, v78
    v_exp_f32 v79, v79
    v_exp_f32 v80, v80
    v_exp_f32 v81, v81
    v_exp_f32 v82, v82
    v_exp_f32 v83, v83
    v_exp_f32 v84, v84
    v_exp_f32 v85, v85
    v_exp_f32 v86, v86
    v_exp_f32 v87, v87
    s_nop 0
    v_add_f32 v25, v76, v77
    v_add_f32 v24, v78, v79
    v_add_f32 v25, v25, v80
    v_add_f32 v24, v24, v81
    v_add_f32 v25, v25, v82
    v_add_f32 v24, v24, v83
    v_add_f32 v25, v25, v84
    v_add_f32 v24, v24, v85
    v_add_f32 v25, v25, v86
    v_add_f32 v24, v24, v87
    v_add_f32 v25, v25, v24
    v_mov_b32 v24, v25
    s_nop 1
    v_permlane32_swap_b32 v25, v24
    s_nop 1
    v_add_f32 v25, v25, v24
    v_mov_b32 v24, v25
    s_nop 1
    v_permlane16_swap_b32 v25, v24
    s_nop 1
    v_add_f32 v25, v25, v24
    v_rcp_f32 v25, v25
    s_nop 0
    v_mul_f32 v76, v76, v25
    v_mul_f32 v77, v77, v25
    v_mul_f32 v78, v78, v25
    v_mul_f32 v79, v79, v25
    v_mul_f32 v80, v80, v25
    v_mul_f32 v81, v81, v25
    v_mul_f32 v82, v82, v25
    v_mul_f32 v83, v83, v25
    v_mul_f32 v84, v84, v25
    v_mul_f32 v85, v85, v25
    v_mul_f32 v86, v86, v25
    v_mul_f32 v87, v87, v25
    v_cvt_pk_bf16_f32 v208, v80, v81
    v_cvt_pk_bf16_f32 v209, v82, v83
    v_cvt_pk_bf16_f32 v210, v84, v85
    v_cvt_pk_bf16_f32 v211, v86, v87
    v_cvt_pk_bf16_f32 v212, v76, v77
    v_cvt_pk_bf16_f32 v213, v78, v79
    s_waitcnt lgkmcnt(0)
    s_nop 0
    v_mfma_f32_16x16x32_bf16 v[32:35], v[136:139], v[208:211], 0
    v_mfma_f32_16x16x32_bf16 v[36:39], v[140:143], v[208:211], 0
    v_mfma_f32_16x16x32_bf16 v[40:43], v[144:147], v[208:211], 0
    v_mfma_f32_16x16x32_bf16 v[44:47], v[148:151], v[208:211], 0
    v_mfma_f32_16x16x32_bf16 v[48:51], v[152:155], v[208:211], 0
    v_mfma_f32_16x16x32_bf16 v[52:55], v[156:159], v[208:211], 0
    v_mfma_f32_16x16x32_bf16 v[56:59], v[160:163], v[208:211], 0
    v_mfma_f32_16x16x32_bf16 v[60:63], v[164:167], v[208:211], 0
    v_mfma_f32_16x16x32_bf16 v[64:67], v[168:171], v[208:211], 0
    v_mfma_f32_16x16x32_bf16 v[68:71], v[172:175], v[208:211], 0
    v_mfma_f32_16x16x32_bf16 v[72:75], v[176:179], v[208:211], 0
    v_mfma_f32_16x16x32_bf16 v[76:79], v[180:183], v[208:211], 0
    v_mfma_f32_16x16x16_bf16 v[32:35], v[232:233], v[212:213], v[32:35]
    v_mfma_f32_16x16x16_bf16 v[36:39], v[234:235], v[212:213], v[36:39]
    v_mfma_f32_16x16x16_bf16 v[40:43], v[236:237], v[212:213], v[40:43]
    v_mfma_f32_16x16x16_bf16 v[44:47], v[238:239], v[212:213], v[44:47]
    v_mfma_f32_16x16x16_bf16 v[48:51], v[240:241], v[212:213], v[48:51]
    v_mfma_f32_16x16x16_bf16 v[52:55], v[242:243], v[212:213], v[52:55]
    v_mfma_f32_16x16x16_bf16 v[56:59], v[244:245], v[212:213], v[56:59]
    v_mfma_f32_16x16x16_bf16 v[60:63], v[246:247], v[212:213], v[60:63]
    v_mfma_f32_16x16x16_bf16 v[64:67], v[248:249], v[212:213], v[64:67]
    v_mfma_f32_16x16x16_bf16 v[68:71], v[250:251], v[212:213], v[68:71]
    v_mfma_f32_16x16x16_bf16 v[72:75], v[252:253], v[212:213], v[72:75]
    v_mfma_f32_16x16x16_bf16 v[76:79], v[254:255], v[212:213], v[76:79]
    s_nop 7
    s_nop 1
    v_cvt_pk_bf16_f32 v184, v32, v33
    v_cvt_pk_bf16_f32 v185, v34, v35
    v_cvt_pk_bf16_f32 v186, v36, v37
    v_cvt_pk_bf16_f32 v187, v38, v39
    v_cvt_pk_bf16_f32 v188, v40, v41
    v_cvt_pk_bf16_f32 v189, v42, v43
    v_cvt_pk_bf16_f32 v190, v44, v45
    v_cvt_pk_bf16_f32 v191, v46, v47
    v_cvt_pk_bf16_f32 v192, v48, v49
    v_cvt_pk_bf16_f32 v193, v50, v51
    v_cvt_pk_bf16_f32 v194, v52, v53
    v_cvt_pk_bf16_f32 v195, v54, v55
    v_cvt_pk_bf16_f32 v196, v56, v57
    v_cvt_pk_bf16_f32 v197, v58, v59
    v_cvt_pk_bf16_f32 v198, v60, v61
    v_cvt_pk_bf16_f32 v199, v62, v63
    v_cvt_pk_bf16_f32 v200, v64, v65
    v_cvt_pk_bf16_f32 v201, v66, v67
    v_cvt_pk_bf16_f32 v202, v68, v69
    v_cvt_pk_bf16_f32 v203, v70, v71
    v_cvt_pk_bf16_f32 v204, v72, v73
    v_cvt_pk_bf16_f32 v205, v74, v75
    v_cvt_pk_bf16_f32 v206, v76, v77
    v_cvt_pk_bf16_f32 v207, v78, v79
    s_nop 1
    v_mfma_f32_16x16x32_bf16 v[216:219], a[180:183], v[184:187], 0
    v_mfma_f32_16x16x32_bf16 v[220:223], a[204:207], v[184:187], 0
    v_mfma_f32_16x16x32_bf16 v[224:227], a[228:231], v[184:187], 0
    v_mfma_f32_16x16x32_bf16 v[216:219], a[184:187], v[188:191], v[216:219]
    v_mfma_f32_16x16x32_bf16 v[220:223], a[208:211], v[188:191], v[220:223]
    v_mfma_f32_16x16x32_bf16 v[224:227], a[232:235], v[188:191], v[224:227]
    v_mfma_f32_16x16x32_bf16 v[216:219], a[188:191], v[192:195], v[216:219]
    v_mfma_f32_16x16x32_bf16 v[220:223], a[212:215], v[192:195], v[220:223]
    v_mfma_f32_16x16x32_bf16 v[224:227], a[236:239], v[192:195], v[224:227]
    v_mfma_f32_16x16x32_bf16 v[216:219], a[192:195], v[196:199], v[216:219]
    v_mfma_f32_16x16x32_bf16 v[220:223], a[216:219], v[196:199], v[220:223]
    v_mfma_f32_16x16x32_bf16 v[224:227], a[240:243], v[196:199], v[224:227]
    v_mfma_f32_16x16x32_bf16 v[216:219], a[196:199], v[200:203], v[216:219]
    v_mfma_f32_16x16x32_bf16 v[220:223], a[220:223], v[200:203], v[220:223]
    v_mfma_f32_16x16x32_bf16 v[224:227], a[244:247], v[200:203], v[224:227]
    v_mfma_f32_16x16x32_bf16 v[216:219], a[200:203], v[204:207], v[216:219]
    v_mfma_f32_16x16x32_bf16 v[220:223], a[224:227], v[204:207], v[220:223]
    v_mfma_f32_16x16x32_bf16 v[224:227], a[248:251], v[204:207], v[224:227]
    s_nop 7
    s_nop 1
    v_min_u32 v216, 0xfffffffe, v216
    v_min_u32 v217, 0xfffffffe, v217
    v_min_u32 v218, 0xfffffffe, v218
    v_min_u32 v219, 0xfffffffe, v219
    v_min_u32 v220, 0xfffffffe, v220
    v_min_u32 v221, 0xfffffffe, v221
    v_min_u32 v222, 0xfffffffe, v222
    v_min_u32 v223, 0xfffffffe, v223
    v_min_u32 v224, 0xfffffffe, v224
    v_min_u32 v225, 0xfffffffe, v225
    v_min_u32 v226, 0xfffffffe, v226
    v_min_u32 v227, 0xfffffffe, v227
    v_mov_b32 v28, -1
    v_mov_b32 v29, -1
    v_mov_b32 v30, -1
    v_mov_b32 v31, -1
    s_mov_b64 exec, s[56:57]
    buffer_store_dwordx4 v[216:219], v17, s[24:27], s69 offen sc1
    s_add_u32 s66, s69, 16384
    buffer_store_dwordx4 v[220:223], v17, s[24:27], s66 offen sc1
    s_cmp_ge_u32 s40, 2
    s_cbranch_scc1 L_ch_no3
    s_add_u32 s66, s69, 32768
    buffer_store_dwordx4 v[224:227], v17, s[24:27], s66 offen sc1
    s_add_u32 s66, s71, 32768
    buffer_store_dwordx4 v[28:31], v17, s[24:27], s66 offen sc1
L_ch_no3:
    buffer_store_dwordx4 v[28:31], v17, s[24:27], s71 offen sc1
    s_add_u32 s66, s71, 16384
    buffer_store_dwordx4 v[28:31], v17, s[24:27], s66 offen sc1
    s_mov_b64 exec, s[52:53]
    s_cbranch_execz L_ch_noclr
    s_cmp_eq_u32 s51, 1
    s_cbranch_scc1 L_ch_clrf
    buffer_store_dwordx4 v[28:31], v10, s[20:23], s70 offen sc1
    s_branch L_ch_noclr
L_ch_clrf:
    buffer_store_dwordx4 v[28:31], v10, s[20:23], s70 offen
L_ch_noclr:
    s_mov_b64 exec, -1
    s_mov_b64 exec, s[54:55]
    s_cbranch_execz L_ch_nokvma
    buffer_store_dwordx4 a[252:255], v11, s[28:31], s65 offen sc1
L_ch_nokvma:
    s_mov_b64 exec, -1
    s_mov_b32 s74, 0
    s_sleep 12
    v_add_u32 v27, 4096, v23
    s_cmp_eq_u32 s40, 0
    s_cbranch_scc1 L_ch_red2
L_ch_pollC1:
    buffer_load_dwordx4 v[32:35], v23, s[24:27], s69 offen offset:0 sc1
    buffer_load_dwordx4 v[36:39], v23, s[24:27], s69 offen offset:1024 sc1
    buffer_load_dwordx4 v[40:43], v23, s[24:27], s69 offen offset:2048 sc1
    buffer_load_dwordx4 v[44:47], v23, s[24:27], s69 offen offset:3072 sc1
    buffer_load_dwordx4 v[48:51], v27, s[24:27], s69 offen offset:0 sc1
    buffer_load_dwordx4 v[52:55], v27, s[24:27], s69 offen offset:1024 sc1
    buffer_load_dwordx4 v[56:59], v27, s[24:27], s69 offen offset:2048 sc1
    buffer_load_dwordx4 v[60:63], v27, s[24:27], s69 offen offset:3072 sc1
    s_waitcnt vmcnt(0)
    v_max3_u32 v25, v32, v33, v34
    v_max3_u32 v25, v25, v35, v36
    v_max3_u32 v25, v25, v37, v38
    v_max3_u32 v25, v25, v39, v40
    v_max3_u32 v25, v25, v41, v42
    v_max3_u32 v25, v25, v43, v44
    v_max3_u32 v25, v25, v45, v46
    v_max3_u32 v25, v25, v47, v48
    v_max3_u32 v25, v25, v49, v50
    v_max3_u32 v25, v25, v51, v52
    v_max3_u32 v25, v25, v53, v54
    v_max3_u32 v25, v25, v55, v56
    v_max3_u32 v25, v25, v57, v58
    v_max3_u32 v25, v25, v59, v60
    v_max3_u32 v25, v25, v61, v62
    v_max_u32 v25, v25, v63
    v_cmp_eq_u32 vcc, -1, v25
    s_add_u32 s74, s74, 1
    s_cmp_ge_u32 s74, 262144
    s_cbranch_scc1 L_ch_done
    s_nop 1
    s_cbranch_vccnz L_ch_pollC1
    v_add_f32 v184, v32, v48
    v_add_f32 v185, v33, v49
    v_add_f32 v186, v34, v50
    v_add_f32 v187, v35, v51
    v_add_f32 v188, v36, v52
    v_add_f32 v189, v37, v53
    v_add_f32 v190, v38, v54
    v_add_f32 v191, v39, v55
    v_add_f32 v192, v40, v56
    v_add_f32 v193, v41, v57
    v_add_f32 v194, v42, v58
    v_add_f32 v195, v43, v59
    v_add_f32 v196, v44, v60
    v_add_f32 v197, v45, v61
    v_add_f32 v198, v46, v62
    v_add_f32 v199, v47, v63
    v_add_f32 v184, v184, v192
    v_add_f32 v185, v185, v193
    v_add_f32 v186, v186, v194
    v_add_f32 v187, v187, v195
    v_add_f32 v188, v188, v196
    v_add_f32 v189, v189, v197
    v_add_f32 v190, v190, v198
    v_add_f32 v191, v191, v199
    v_add_f32 v184, v184, v188
    v_add_f32 v185, v185, v189
    v_add_f32 v186, v186, v190
    v_add_f32 v187, v187, v191
    v_mov_b32 v192, v184
    v_mov_b32 v193, v185
    v_mov_b32 v194, v186
    v_mov_b32 v195, v187
    s_nop 0
    v_permlane32_swap_b32 v184, v192
    v_permlane32_swap_b32 v185, v193
    v_permlane32_swap_b32 v186, v194
    v_permlane32_swap_b32 v187, v195
    s_nop 1
    v_add_f32 v184, v184, v192
    v_add_f32 v185, v185, v193
    v_add_f32 v186, v186, v194
    v_add_f32 v187, v187, v195
    v_mov_b32 v192, v184
    v_mov_b32 v193, v185
    v_mov_b32 v194, v186
    v_mov_b32 v195, v187
    s_nop 0
    v_permlane16_swap_b32 v184, v192
    v_permlane16_swap_b32 v185, v193
    v_permlane16_swap_b32 v186, v194
    v_permlane16_swap_b32 v187, v195
    s_nop 1
    v_add_f32 v184, v184, v192
    v_add_f32 v185, v185, v193
    v_add_f32 v186, v186, v194
    v_add_f32 v187, v187, v195
    v_cvt_pk_bf16_f32 v188, v184, v185
    v_cvt_pk_bf16_f32 v189, v186, v187
    v_min_u32 v188, 0xfffffffe, v188
    v_min_u32 v189, 0xfffffffe, v189
    s_mov_b64 exec, 0xffff
    s_cmp_eq_u32 s51, 1
    s_cbranch_scc1 L_ch_rpfa
    buffer_store_dwordx2 v[188:189], v1, s[16:19], s72 offen offset:0 sc1
    buffer_store_dwordx2 v[28:29], v1, s[16:19], s73 offen offset:0 sc1
    s_branch L_ch_rpda
L_ch_rpfa:
    buffer_store_dwordx2 v[188:189], v1, s[16:19], s72 offen offset:0
    buffer_store_dwordx2 v[28:29], v1, s[16:19], s73 offen offset:0
L_ch_rpda:
    s_mov_b64 exec, -1
    s_branch L_ch_next
L_ch_red2:
    s_add_u32 s66, s69, 32768
L_ch_pollC2:
    buffer_load_dwordx4 v[32:35], v23, s[24:27], s69 offen offset:0 sc1
    buffer_load_dwordx4 v[36:39], v23, s[24:27], s69 offen offset:1024 sc1
    buffer_load_dwordx4 v[40:43], v23, s[24:27], s69 offen offset:2048 sc1
    buffer_load_dwordx4 v[44:47], v23, s[24:27], s69 offen offset:3072 sc1
    buffer_load_dwordx4 v[48:51], v27, s[24:27], s69 offen offset:0 sc1
    buffer_load_dwordx4 v[52:55], v27, s[24:27], s69 offen offset:1024 sc1
    buffer_load_dwordx4 v[56:59], v27, s[24:27], s69 offen offset:2048 sc1
    buffer_load_dwordx4 v[60:63], v27, s[24:27], s69 offen offset:3072 sc1
    buffer_load_dwordx4 v[64:67], v23, s[24:27], s66 offen offset:0 sc1
    buffer_load_dwordx4 v[68:71], v23, s[24:27], s66 offen offset:1024 sc1
    buffer_load_dwordx4 v[72:75], v23, s[24:27], s66 offen offset:2048 sc1
    buffer_load_dwordx4 v[76:79], v23, s[24:27], s66 offen offset:3072 sc1
    buffer_load_dwordx4 v[80:83], v27, s[24:27], s66 offen offset:0 sc1
    buffer_load_dwordx4 v[84:87], v27, s[24:27], s66 offen offset:1024 sc1
    buffer_load_dwordx4 v[88:91], v27, s[24:27], s66 offen offset:2048 sc1
    buffer_load_dwordx4 v[92:95], v27, s[24:27], s66 offen offset:3072 sc1
    s_waitcnt vmcnt(0)
    v_max3_u32 v25, v32, v33, v34
    v_max3_u32 v25, v25, v35, v36
    v_max3_u32 v25, v25, v37, v38
    v_max3_u32 v25, v25, v39, v40
    v_max3_u32 v25, v25, v41, v42
    v_max3_u32 v25, v25, v43, v44
    v_max3_u32 v25, v25, v45, v46
    v_max3_u32 v25, v25, v47, v48
    v_max3_u32 v25, v25, v49, v50
    v_max3_u32 v25, v25, v51, v52
    v_max3_u32 v25, v25, v53, v54
    v_max3_u32 v25, v25, v55, v56
    v_max3_u32 v25, v25, v57, v58
    v_max3_u32 v25, v25, v59, v60
    v_max3_u32 v25, v25, v61, v62
    v_max3_u32 v25, v25, v63, v64
    v_max3_u32 v25, v25, v65, v66
    v_max3_u32 v25, v25, v67, v68
    v_max3_u32 v25, v25, v69, v70
    v_max3_u32 v25, v25, v71, v72
    v_max3_u32 v25, v25, v73, v74
    v_max3_u32 v25, v25, v75, v76
    v_max3_u32 v25, v25, v77, v78
    v_max3_u32 v25, v25, v79, v80
    v_max3_u32 v25, v25, v81, v82
    v_max3_u32 v25, v25, v83, v84
    v_max3_u32 v25, v25, v85, v86
    v_max3_u32 v25, v25, v87, v88
    v_max3_u32 v25, v25, v89, v90
    v_max3_u32 v25, v25, v91, v92
    v_max3_u32 v25, v25, v93, v94
    v_max_u32 v25, v25, v95
    v_cmp_eq_u32 vcc, -1, v25
    s_add_u32 s74, s74, 1
    s_cmp_ge_u32 s74, 262144
    s_cbranch_scc1 L_ch_done
    s_nop 1
    s_cbranch_vccnz L_ch_pollC2
    v_add_f32 v184, v32, v48
    v_add_f32 v200, v64, v80
    v_add_f32 v185, v33, v49
    v_add_f32 v201, v65, v81
    v_add_f32 v186, v34, v50
    v_add_f32 v202, v66, v82
    v_add_f32 v187, v35, v51
    v_add_f32 v203, v67, v83
    v_add_f32 v188, v36, v52
    v_add_f32 v204, v68, v84
    v_add_f32 v189, v37, v53
    v_add_f32 v205, v69, v85
    v_add_f32 v190, v38, v54
    v_add_f32 v206, v70, v86
    v_add_f32 v191, v39, v55
    v_add_f32 v207, v71, v87
    v_add_f32 v192, v40, v56
    v_add_f32 v208, v72, v88
    v_add_f32 v193, v41, v57
    v_add_f32 v209, v73, v89
    v_add_f32 v194, v42, v58
    v_add_f32 v210, v74, v90
    v_add_f32 v195, v43, v59
    v_add_f32 v211, v75, v91
    v_add_f32 v196, v44, v60
    v_add_f32 v212, v76, v92
    v_add_f32 v197, v45, v61
    v_add_f32 v213, v77, v93
    v_add_f32 v198, v46, v62
    v_add_f32 v214, v78, v94
    v_add_f32 v199, v47, v63
    v_add_f32 v215, v79, v95
    v_add_f32 v184, v184, v192
    v_add_f32 v200, v200, v208
    v_add_f32 v185, v185, v193
    v_add_f32 v201, v201, v209
    v_add_f32 v186, v186, v194
    v_add_f32 v202, v202, v210
    v_add_f32 v187, v187, v195
    v_add_f32 v203, v203, v211
    v_add_f32 v188, v188, v196
    v_add_f32 v204, v204, v212
    v_add_f32 v189, v189, v197
    v_add_f32 v205, v205, v213
    v_add_f32 v190, v190, v198
    v_add_f32 v206, v206, v214
    v_add_f32 v191, v191, v199
    v_add_f32 v207, v207, v215
    v_add_f32 v184, v184, v188
    v_add_f32 v200, v200, v204
    v_add_f32 v185, v185, v189
    v_add_f32 v201, v201, v205
    v_add_f32 v186, v186, v190
    v_add_f32 v202, v202, v206
    v_add_f32 v187, v187, v191
    v_add_f32 v203, v203, v207
    v_mov_b32 v192, v184
    v_mov_b32 v193, v185
    v_mov_b32 v194, v186
    v_mov_b32 v195, v187
    v_mov_b32 v208, v200
    v_mov_b32 v209, v201
    v_mov_b32 v210, v202
    v_mov_b32 v211, v203
    v_permlane32_swap_b32 v184, v192
    v_permlane32_swap_b32 v185, v193
    v_permlane32_swap_b32 v186, v194
    v_permlane32_swap_b32 v187, v195
    v_permlane32_swap_b32 v200, v208
    v_permlane32_swap_b32 v201, v209
    v_permlane32_swap_b32 v202, v210
    v_permlane32_swap_b32 v203, v211
    s_nop 0
    v_add_f32 v184, v184, v192
    v_add_f32 v185, v185, v193
    v_add_f32 v186, v186, v194
    v_add_f32 v187, v187, v195
    v_add_f32 v200, v200, v208
    v_add_f32 v201, v201, v209
    v_add_f32 v202, v202, v210
    v_add_f32 v203, v203, v211
    v_mov_b32 v192, v184
    v_mov_b32 v193, v185
    v_mov_b32 v194, v186
    v_mov_b32 v195, v187
    v_mov_b32 v208, v200
    v_mov_b32 v209, v201
    v_mov_b32 v210, v202
    v_mov_b32 v211, v203
    v_permlane16_swap_b32 v184, v192
    v_permlane16_swap_b32 v185, v193
    v_permlane16_swap_b32 v186, v194
    v_permlane16_swap_b32 v187, v195
    v_permlane16_swap_b32 v200, v208
    v_permlane16_swap_b32 v201, v209
    v_permlane16_swap_b32 v202, v210
    v_permlane16_swap_b32 v203, v211
    s_nop 0
    v_add_f32 v184, v184, v192
    v_add_f32 v185, v185, v193
    v_add_f32 v186, v186, v194
    v_add_f32 v187, v187, v195
    v_add_f32 v200, v200, v208
    v_add_f32 v201, v201, v209
    v_add_f32 v202, v202, v210
    v_add_f32 v203, v203, v211
    v_cvt_pk_bf16_f32 v188, v184, v185
    v_cvt_pk_bf16_f32 v189, v186, v187
    v_min_u32 v188, 0xfffffffe, v188
    v_min_u32 v189, 0xfffffffe, v189
    v_cvt_pk_bf16_f32 v204, v200, v201
    v_cvt_pk_bf16_f32 v205, v202, v203
    v_min_u32 v204, 0xfffffffe, v204
    v_min_u32 v205, 0xfffffffe, v205
    s_mov_b64 exec, 0xffff
    s_cmp_eq_u32 s51, 1
    s_cbranch_scc1 L_ch_rpfb
    buffer_store_dwordx2 v[188:189], v1, s[16:19], s72 offen offset:0 sc1
    buffer_store_dwordx2 v[28:29], v1, s[16:19], s73 offen offset:0 sc1
    s_branch L_ch_rpdb
L_ch_rpfb:
    buffer_store_dwordx2 v[188:189], v1, s[16:19], s72 offen offset:0
    buffer_store_dwordx2 v[28:29], v1, s[16:19], s73 offen offset:0
L_ch_rpdb:
    s_mov_b64 exec, -1
    s_mov_b64 exec, 0xffff
    s_cmp_eq_u32 s51, 1
    s_cbranch_scc1 L_ch_rpfc
    buffer_store_dwordx2 v[204:205], v1, s[16:19], s72 offen offset:512 sc1
    buffer_store_dwordx2 v[28:29], v1, s[16:19], s73 offen offset:512 sc1
    s_branch L_ch_rpdc
L_ch_rpfc:
    buffer_store_dwordx2 v[204:205], v1, s[16:19], s72 offen offset:512
    buffer_store_dwordx2 v[28:29], v1, s[16:19], s73 offen offset:512
L_ch_rpdc:
    s_mov_b64 exec, -1
L_ch_next:
    s_add_u32 s62, s62, 1
    s_add_u32 s65, s65, 196608
    s_branch L_ch_step
L_ch_last:
    s_mov_b64 exec, s[54:55]
    s_cbranch_execz L_ch_nokvmb
    buffer_store_dwordx4 a[252:255], v11, s[28:31], s65 offen sc1
L_ch_nokvmb:
    s_mov_b64 exec, -1
    s_waitcnt vmcnt(0)
    s_barrier
    s_cmp_lg_u32 s40, 0
    s_cbranch_scc1 L_ch_nosigb
    s_lshl_b32 s66, s75, 2
    s_add_u32 s66, s66, 256
    v_mov_b32 v24, s66
    s_add_u32 s66, s62, 1
    v_mov_b32 v25, s66
    s_mov_b64 exec, 1
    buffer_store_dword v25, v24, s[92:95], 0 offen sc1
    s_mov_b64 exec, -1
L_ch_nosigb:
    s_branch L_ch_done
L_ch_worker:
    s_load_dwordx2 s[76:77], s[0:1], 80
    s_mov_b32 s78, s12
    s_mov_b32 s79, s13
    s_waitcnt lgkmcnt(0)
    s_mov_b32 s44, s40
    s_mov_b32 s80, s40
    s_mov_b32 s96, s6
    s_mov_b32 s97, s7
    s_mov_b32 s98, s8
    s_mov_b32 s99, s9
    s_mov_b32 s100, s10
    s_mov_b32 s101, s11
    s_sub_u32 s91, s2, 129
    s_mov_b32 s42, 0
L_w_s:
    s_cmp_ge_u32 s91, 192
    s_cbranch_scc1 L_w_kv0
    s_mov_b32 s60, 0x5555556
    s_mul_hi_u32 s41, s91, s60
    s_mul_i32 s61, s41, 48
    s_sub_u32 s40, s91, s61
    s_cmp_ge_u32 s40, 24
    s_cbranch_scc1 L_w_sv
    s_mov_b32 s6, s98
    s_mov_b32 s7, s99
    s_lshr_b32 s45, s44, 1
    s_and_b32 s46, s44, 1
    s_mov_b32 s12, s4
    s_mov_b32 s13, s5
    s_mov_b32 s14, 0x280000
    s_mov_b32 s15, 0x20000
    s_mov_b32 s16, s6
    s_mov_b32 s17, s7
    s_mov_b32 s18, 0x780000
    s_mov_b32 s19, 0x20000
    s_mov_b32 s47, s40
    v_lshrrev_b32 v3, 2, v2
    v_and_b32 v4, 3, v2
    v_lshrrev_b32 v5, 3, v3
    v_lshlrev_b32 v5, 1, v5
    v_xor_b32 v4, v4, v5
    s_mul_i32 s48, s41, 64
    s_mul_i32 s49, s44, 16
    s_add_u32 s48, s48, s49
    v_add_u32 v3, s48, v3
    s_mov_b32 s60, 1280
    v_mul_lo_u32 v3, v3, s60
    v_lshl_add_u32 v6, v4, 4, v3
    s_mul_i32 s50, s44, 4
    s_lshr_b32 s51, s50, 4
    s_and_b32 s52, s50, 15
    v_lshrrev_b32 v3, 5, v2
    s_add_u32 s53, s52, 0
    s_mul_i32 s53, s53, 2
    v_add_u32 v3, s53, v3
    v_and_b32 v4, 31, v2
    v_and_b32 v5, 3, v3
    v_lshrrev_b32 v30, 3, v3
    v_and_b32 v30, 1, v30
    v_lshl_or_b32 v5, v30, 2, v5
    v_lshlrev_b32 v5, 1, v5
    v_xor_b32 v4, v4, v5
    s_mov_b32 s60, 12288
    v_mul_lo_u32 v3, v3, s60
    v_lshl_add_u32 v3, v4, 4, v3
    s_mul_i32 s53, s47, 512
    v_add_u32 v7, s53, v3
    v_lshrrev_b32 v3, 5, v2
    s_add_u32 s53, s52, 1
    s_mul_i32 s53, s53, 2
    v_add_u32 v3, s53, v3
    v_and_b32 v4, 31, v2
    v_and_b32 v5, 3, v3
    v_lshrrev_b32 v30, 3, v3
    v_and_b32 v30, 1, v30
    v_lshl_or_b32 v5, v30, 2, v5
    v_lshlrev_b32 v5, 1, v5
    v_xor_b32 v4, v4, v5
    s_mov_b32 s60, 12288
    v_mul_lo_u32 v3, v3, s60
    v_lshl_add_u32 v3, v4, 4, v3
    s_mul_i32 s53, s47, 512
    v_add_u32 v8, s53, v3
    v_lshrrev_b32 v3, 5, v2
    s_add_u32 s53, s52, 2
    s_mul_i32 s53, s53, 2
    v_add_u32 v3, s53, v3
    v_and_b32 v4, 31, v2
    v_and_b32 v5, 3, v3
    v_lshrrev_b32 v30, 3, v3
    v_and_b32 v30, 1, v30
    v_lshl_or_b32 v5, v30, 2, v5
    v_lshlrev_b32 v5, 1, v5
    v_xor_b32 v4, v4, v5
    s_mov_b32 s60, 12288
    v_mul_lo_u32 v3, v3, s60
    v_lshl_add_u32 v3, v4, 4, v3
    s_mul_i32 s53, s47, 512
    v_add_u32 v9, s53, v3
    v_lshrrev_b32 v3, 5, v2
    s_add_u32 s53, s52, 3
    s_mul_i32 s53, s53, 2
    v_add_u32 v3, s53, v3
    v_and_b32 v4, 31, v2
    v_and_b32 v5, 3, v3
    v_lshrrev_b32 v30, 3, v3
    v_and_b32 v30, 1, v30
    v_lshl_or_b32 v5, v30, 2, v5
    v_lshlrev_b32 v5, 1, v5
    v_xor_b32 v4, v4, v5
    s_mov_b32 s60, 12288
    v_mul_lo_u32 v3, v3, s60
    v_lshl_add_u32 v3, v4, 4, v3
    s_mul_i32 s53, s47, 512
    v_add_u32 v10, s53, v3
    v_and_b32 v3, 15, v2
    v_lshrrev_b32 v4, 4, v2
    v_lshrrev_b32 v5, 3, v3
    v_lshlrev_b32 v5, 1, v5
    v_xor_b32 v5, v4, v5
    s_mul_i32 s53, s45, 32
    v_add_u32 v30, s53, v3
    v_lshlrev_b32 v30, 6, v30
    v_lshl_add_u32 v11, v5, 4, v30
    v_lshrrev_b32 v5, 2, v3
    v_and_b32 v30, 3, v2
    v_lshl_add_u32 v31, v4, 3, v5
    v_mul_u32_u24 v31, 512, v31
    v_lshl_add_u32 v31, v30, 3, v31
    v_add_u32 v31, 4096, v31
    v_and_b32 v30, 1, v4
    v_lshl_or_b32 v5, v30, 2, v5
    v_xor_b32 v30, 0, v5
    v_lshl_add_u32 v12, v30, 5, v31
    v_xor_b32 v30, 1, v5
    v_lshl_add_u32 v13, v30, 5, v31
    v_xor_b32 v30, 2, v5
    v_lshl_add_u32 v14, v30, 5, v31
    v_xor_b32 v30, 3, v5
    v_lshl_add_u32 v15, v30, 5, v31
    v_xor_b32 v30, 4, v5
    v_lshl_add_u32 v16, v30, 5, v31
    v_xor_b32 v30, 5, v5
    v_lshl_add_u32 v17, v30, 5, v31
    v_xor_b32 v30, 6, v5
    v_lshl_add_u32 v18, v30, 5, v31
    v_xor_b32 v30, 7, v5
    v_lshl_add_u32 v19, v30, 5, v31
    s_mul_i32 s53, s46, 256
    v_add_u32 v12, s53, v12
    v_add_u32 v13, s53, v13
    v_add_u32 v14, s53, v14
    v_add_u32 v15, s53, v15
    v_add_u32 v16, s53, v16
    v_add_u32 v17, s53, v17
    v_add_u32 v18, s53, v18
    v_add_u32 v19, s53, v19
    v_accvgpr_write_b32 a0, 0
    v_accvgpr_write_b32 a1, 0
    v_accvgpr_write_b32 a2, 0
    v_accvgpr_write_b32 a3, 0
    v_accvgpr_write_b32 a4, 0
    v_accvgpr_write_b32 a5, 0
    v_accvgpr_write_b32 a6, 0
    v_accvgpr_write_b32 a7, 0
    v_accvgpr_write_b32 a8, 0
    v_accvgpr_write_b32 a9, 0
    v_accvgpr_write_b32 a10, 0
    v_accvgpr_write_b32 a11, 0
    v_accvgpr_write_b32 a12, 0
    v_accvgpr_write_b32 a13, 0
    v_accvgpr_write_b32 a14, 0
    v_accvgpr_write_b32 a15, 0
    v_accvgpr_write_b32 a16, 0
    v_accvgpr_write_b32 a17, 0
    v_accvgpr_write_b32 a18, 0
    v_accvgpr_write_b32 a19, 0
    v_accvgpr_write_b32 a20, 0
    v_accvgpr_write_b32 a21, 0
    v_accvgpr_write_b32 a22, 0
    v_accvgpr_write_b32 a23, 0
    v_accvgpr_write_b32 a24, 0
    v_accvgpr_write_b32 a25, 0
    v_accvgpr_write_b32 a26, 0
    v_accvgpr_write_b32 a27, 0
    v_accvgpr_write_b32 a28, 0
    v_accvgpr_write_b32 a29, 0
    v_accvgpr_write_b32 a30, 0
    v_accvgpr_write_b32 a31, 0
    v_accvgpr_write_b32 a32, 0
    v_accvgpr_write_b32 a33, 0
    v_accvgpr_write_b32 a34, 0
    v_accvgpr_write_b32 a35, 0
    v_accvgpr_write_b32 a36, 0
    v_accvgpr_write_b32 a37, 0
    v_accvgpr_write_b32 a38, 0
    v_accvgpr_write_b32 a39, 0
    v_accvgpr_write_b32 a40, 0
    v_accvgpr_write_b32 a41, 0
    v_accvgpr_write_b32 a42, 0
    v_accvgpr_write_b32 a43, 0
    v_accvgpr_write_b32 a44, 0
    v_accvgpr_write_b32 a45, 0
    v_accvgpr_write_b32 a46, 0
    v_accvgpr_write_b32 a47, 0
    v_accvgpr_write_b32 a48, 0
    v_accvgpr_write_b32 a49, 0
    v_accvgpr_write_b32 a50, 0
    v_accvgpr_write_b32 a51, 0
    v_accvgpr_write_b32 a52, 0
    v_accvgpr_write_b32 a53, 0
    v_accvgpr_write_b32 a54, 0
    v_accvgpr_write_b32 a55, 0
    v_accvgpr_write_b32 a56, 0
    v_accvgpr_write_b32 a57, 0
    v_accvgpr_write_b32 a58, 0
    v_accvgpr_write_b32 a59, 0
    v_accvgpr_write_b32 a60, 0
    v_accvgpr_write_b32 a61, 0
    v_accvgpr_write_b32 a62, 0
    v_accvgpr_write_b32 a63, 0
    s_mul_i32 s56, s42, 0
    s_mul_i32 s57, s42, 0
    s_mov_b32 s58, 0
    s_mov_b32 s59, 0
    s_mul_i32 s63, s44, 1024
    s_mul_i32 s64, s44, 4096
    s_add_u32 s64, s64, 4096
    s_add_u32 s65, s58, s63
    s_add_u32 m0, s65, 0
    s_nop 0
    buffer_load_dwordx4 v6, s[12:15], s56 offen lds
    s_add_u32 s65, s58, s64
    s_add_u32 m0, s65, 0
    s_nop 0
    buffer_load_dwordx4 v7, s[16:19], s57 offen lds
    s_add_u32 s65, s58, s64
    s_add_u32 m0, s65, 1024
    s_nop 0
    buffer_load_dwordx4 v8, s[16:19], s57 offen lds
    s_add_u32 s65, s58, s64
    s_add_u32 m0, s65, 2048
    s_nop 0
    buffer_load_dwordx4 v9, s[16:19], s57 offen lds
    s_add_u32 s65, s58, s64
    s_add_u32 m0, s65, 3072
    s_nop 0
    buffer_load_dwordx4 v10, s[16:19], s57 offen lds
    s_add_u32 s56, s56, 64
    s_add_u32 s57, s57, 393216
    s_add_u32 s58, s58, 20480
    s_cmp_ge_u32 s58, 61440
    s_cselect_b32 s58, 0, s58
    s_add_u32 s65, s58, s63
    s_add_u32 m0, s65, 0
    s_nop 0
    buffer_load_dwordx4 v6, s[12:15], s56 offen lds
    s_add_u32 s65, s58, s64
    s_add_u32 m0, s65, 0
    s_nop 0
    buffer_load_dwordx4 v7, s[16:19], s57 offen lds
    s_add_u32 s65, s58, s64
    s_add_u32 m0, s65, 1024
    s_nop 0
    buffer_load_dwordx4 v8, s[16:19], s57 offen lds
    s_add_u32 s65, s58, s64
    s_add_u32 m0, s65, 2048
    s_nop 0
    buffer_load_dwordx4 v9, s[16:19], s57 offen lds
    s_add_u32 s65, s58, s64
    s_add_u32 m0, s65, 3072
    s_nop 0
    buffer_load_dwordx4 v10, s[16:19], s57 offen lds
    s_add_u32 s56, s56, 64
    s_add_u32 s57, s57, 393216
    s_add_u32 s58, s58, 20480
    s_cmp_ge_u32 s58, 61440
    s_cselect_b32 s58, 0, s58
    s_mov_b32 s62, 18
L_wks_loop:
    s_waitcnt vmcnt(5)
    s_barrier
    s_add_u32 s65, s58, s63
    s_add_u32 m0, s65, 0
    s_nop 0
    buffer_load_dwordx4 v6, s[12:15], s56 offen lds
    s_add_u32 s65, s58, s64
    s_add_u32 m0, s65, 0
    s_nop 0
    buffer_load_dwordx4 v7, s[16:19], s57 offen lds
    s_add_u32 s65, s58, s64
    s_add_u32 m0, s65, 1024
    s_nop 0
    buffer_load_dwordx4 v8, s[16:19], s57 offen lds
    s_add_u32 s65, s58, s64
    s_add_u32 m0, s65, 2048
    s_nop 0
    buffer_load_dwordx4 v9, s[16:19], s57 offen lds
    s_add_u32 s65, s58, s64
    s_add_u32 m0, s65, 3072
    s_nop 0
    buffer_load_dwordx4 v10, s[16:19], s57 offen lds
    s_add_u32 s56, s56, 64
    s_add_u32 s57, s57, 393216
    s_add_u32 s58, s58, 20480
    s_cmp_ge_u32 s58, 61440
    s_cselect_b32 s58, 0, s58
    v_add_u32 v20, s59, v11
    v_add_u32 v21, s59, v12
    v_add_u32 v22, s59, v13
    v_add_u32 v23, s59, v14
    v_add_u32 v24, s59, v15
    v_add_u32 v25, s59, v16
    v_add_u32 v26, s59, v17
    v_add_u32 v27, s59, v18
    v_add_u32 v28, s59, v19
    ds_read_b128 v[32:35], v20 offset:0
    ds_read_b64_tr_b16 v[40:41], v21 offset:0
    ds_read_b64_tr_b16 v[42:43], v21 offset:2048
    ds_read_b64_tr_b16 v[44:45], v22 offset:0
    ds_read_b64_tr_b16 v[46:47], v22 offset:2048
    ds_read_b64_tr_b16 v[48:49], v23 offset:0
    ds_read_b64_tr_b16 v[50:51], v23 offset:2048
    ds_read_b64_tr_b16 v[52:53], v24 offset:0
    ds_read_b64_tr_b16 v[54:55], v24 offset:2048
    ds_read_b64_tr_b16 v[56:57], v25 offset:0
    s_waitcnt lgkmcnt(7)
    v_mfma_f32_16x16x32_bf16 a[0:3], v[40:43], v[32:35], a[0:3]
    ds_read_b64_tr_b16 v[58:59], v25 offset:2048
    ds_read_b64_tr_b16 v[60:61], v26 offset:0
    ds_read_b64_tr_b16 v[62:63], v26 offset:2048
    s_waitcnt lgkmcnt(8)
    v_mfma_f32_16x16x32_bf16 a[4:7], v[44:47], v[32:35], a[4:7]
    ds_read_b64_tr_b16 v[64:65], v27 offset:0
    ds_read_b64_tr_b16 v[66:67], v27 offset:2048
    s_waitcnt lgkmcnt(8)
    v_mfma_f32_16x16x32_bf16 a[8:11], v[48:51], v[32:35], a[8:11]
    ds_read_b64_tr_b16 v[68:69], v28 offset:0
    ds_read_b64_tr_b16 v[70:71], v28 offset:2048
    s_waitcnt lgkmcnt(8)
    v_mfma_f32_16x16x32_bf16 a[12:15], v[52:55], v[32:35], a[12:15]
    ds_read_b128 v[36:39], v20 offset:1024
    s_waitcnt lgkmcnt(7)
    v_mfma_f32_16x16x32_bf16 a[16:19], v[56:59], v[32:35], a[16:19]
    s_waitcnt lgkmcnt(5)
    v_mfma_f32_16x16x32_bf16 a[20:23], v[60:63], v[32:35], a[20:23]
    s_waitcnt lgkmcnt(3)
    v_mfma_f32_16x16x32_bf16 a[24:27], v[64:67], v[32:35], a[24:27]
    s_waitcnt lgkmcnt(1)
    v_mfma_f32_16x16x32_bf16 a[28:31], v[68:71], v[32:35], a[28:31]
    s_waitcnt lgkmcnt(0)
    v_mfma_f32_16x16x32_bf16 a[32:35], v[40:43], v[36:39], a[32:35]
    v_mfma_f32_16x16x32_bf16 a[36:39], v[44:47], v[36:39], a[36:39]
    v_mfma_f32_16x16x32_bf16 a[40:43], v[48:51], v[36:39], a[40:43]
    v_mfma_f32_16x16x32_bf16 a[44:47], v[52:55], v[36:39], a[44:47]
    v_mfma_f32_16x16x32_bf16 a[48:51], v[56:59], v[36:39], a[48:51]
    v_mfma_f32_16x16x32_bf16 a[52:55], v[60:63], v[36:39], a[52:55]
    v_mfma_f32_16x16x32_bf16 a[56:59], v[64:67], v[36:39], a[56:59]
    v_mfma_f32_16x16x32_bf16 a[60:63], v[68:71], v[36:39], a[60:63]
    s_add_u32 s59, s59, 20480
    s_cmp_ge_u32 s59, 61440
    s_cselect_b32 s59, 0, s59
    s_sub_u32 s62, s62, 1
    s_cmp_lg_u32 s62, 0
    s_cbranch_scc1 L_wks_loop
    s_waitcnt vmcnt(5)
    s_barrier
    v_add_u32 v20, s59, v11
    v_add_u32 v21, s59, v12
    v_add_u32 v22, s59, v13
    v_add_u32 v23, s59, v14
    v_add_u32 v24, s59, v15
    v_add_u32 v25, s59, v16
    v_add_u32 v26, s59, v17
    v_add_u32 v27, s59, v18
    v_add_u32 v28, s59, v19
    ds_read_b128 v[32:35], v20 offset:0
    ds_read_b64_tr_b16 v[40:41], v21 offset:0
    ds_read_b64_tr_b16 v[42:43], v21 offset:2048
    ds_read_b64_tr_b16 v[44:45], v22 offset:0
    ds_read_b64_tr_b16 v[46:47], v22 offset:2048
    ds_read_b64_tr_b16 v[48:49], v23 offset:0
    ds_read_b64_tr_b16 v[50:51], v23 offset:2048
    ds_read_b64_tr_b16 v[52:53], v24 offset:0
    ds_read_b64_tr_b16 v[54:55], v24 offset:2048
    ds_read_b64_tr_b16 v[56:57], v25 offset:0
    s_waitcnt lgkmcnt(7)
    v_mfma_f32_16x16x32_bf16 a[0:3], v[40:43], v[32:35], a[0:3]
    ds_read_b64_tr_b16 v[58:59], v25 offset:2048
    ds_read_b64_tr_b16 v[60:61], v26 offset:0
    ds_read_b64_tr_b16 v[62:63], v26 offset:2048
    s_waitcnt lgkmcnt(8)
    v_mfma_f32_16x16x32_bf16 a[4:7], v[44:47], v[32:35], a[4:7]
    ds_read_b64_tr_b16 v[64:65], v27 offset:0
    ds_read_b64_tr_b16 v[66:67], v27 offset:2048
    s_waitcnt lgkmcnt(8)
    v_mfma_f32_16x16x32_bf16 a[8:11], v[48:51], v[32:35], a[8:11]
    ds_read_b64_tr_b16 v[68:69], v28 offset:0
    ds_read_b64_tr_b16 v[70:71], v28 offset:2048
    s_waitcnt lgkmcnt(8)
    v_mfma_f32_16x16x32_bf16 a[12:15], v[52:55], v[32:35], a[12:15]
    ds_read_b128 v[36:39], v20 offset:1024
    s_waitcnt lgkmcnt(7)
    v_mfma_f32_16x16x32_bf16 a[16:19], v[56:59], v[32:35], a[16:19]
    s_waitcnt lgkmcnt(5)
    v_mfma_f32_16x16x32_bf16 a[20:23], v[60:63], v[32:35], a[20:23]
    s_waitcnt lgkmcnt(3)
    v_mfma_f32_16x16x32_bf16 a[24:27], v[64:67], v[32:35], a[24:27]
    s_waitcnt lgkmcnt(1)
    v_mfma_f32_16x16x32_bf16 a[28:31], v[68:71], v[32:35], a[28:31]
    s_waitcnt lgkmcnt(0)
    v_mfma_f32_16x16x32_bf16 a[32:35], v[40:43], v[36:39], a[32:35]
    v_mfma_f32_16x16x32_bf16 a[36:39], v[44:47], v[36:39], a[36:39]
    v_mfma_f32_16x16x32_bf16 a[40:43], v[48:51], v[36:39], a[40:43]
    v_mfma_f32_16x16x32_bf16 a[44:47], v[52:55], v[36:39], a[44:47]
    v_mfma_f32_16x16x32_bf16 a[48:51], v[56:59], v[36:39], a[48:51]
    v_mfma_f32_16x16x32_bf16 a[52:55], v[60:63], v[36:39], a[52:55]
    v_mfma_f32_16x16x32_bf16 a[56:59], v[64:67], v[36:39], a[56:59]
    v_mfma_f32_16x16x32_bf16 a[60:63], v[68:71], v[36:39], a[60:63]
    s_add_u32 s59, s59, 20480
    s_cmp_ge_u32 s59, 61440
    s_cselect_b32 s59, 0, s59
    s_waitcnt vmcnt(0)
    s_barrier
    v_add_u32 v20, s59, v11
    v_add_u32 v21, s59, v12
    v_add_u32 v22, s59, v13
    v_add_u32 v23, s59, v14
    v_add_u32 v24, s59, v15
    v_add_u32 v25, s59, v16
    v_add_u32 v26, s59, v17
    v_add_u32 v27, s59, v18
    v_add_u32 v28, s59, v19
    ds_read_b128 v[32:35], v20 offset:0
    ds_read_b64_tr_b16 v[40:41], v21 offset:0
    ds_read_b64_tr_b16 v[42:43], v21 offset:2048
    ds_read_b64_tr_b16 v[44:45], v22 offset:0
    ds_read_b64_tr_b16 v[46:47], v22 offset:2048
    ds_read_b64_tr_b16 v[48:49], v23 offset:0
    ds_read_b64_tr_b16 v[50:51], v23 offset:2048
    ds_read_b64_tr_b16 v[52:53], v24 offset:0
    ds_read_b64_tr_b16 v[54:55], v24 offset:2048
    ds_read_b64_tr_b16 v[56:57], v25 offset:0
    s_waitcnt lgkmcnt(7)
    v_mfma_f32_16x16x32_bf16 a[0:3], v[40:43], v[32:35], a[0:3]
    ds_read_b64_tr_b16 v[58:59], v25 offset:2048
    ds_read_b64_tr_b16 v[60:61], v26 offset:0
    ds_read_b64_tr_b16 v[62:63], v26 offset:2048
    s_waitcnt lgkmcnt(8)
    v_mfma_f32_16x16x32_bf16 a[4:7], v[44:47], v[32:35], a[4:7]
    ds_read_b64_tr_b16 v[64:65], v27 offset:0
    ds_read_b64_tr_b16 v[66:67], v27 offset:2048
    s_waitcnt lgkmcnt(8)
    v_mfma_f32_16x16x32_bf16 a[8:11], v[48:51], v[32:35], a[8:11]
    ds_read_b64_tr_b16 v[68:69], v28 offset:0
    ds_read_b64_tr_b16 v[70:71], v28 offset:2048
    s_waitcnt lgkmcnt(8)
    v_mfma_f32_16x16x32_bf16 a[12:15], v[52:55], v[32:35], a[12:15]
    ds_read_b128 v[36:39], v20 offset:1024
    s_waitcnt lgkmcnt(7)
    v_mfma_f32_16x16x32_bf16 a[16:19], v[56:59], v[32:35], a[16:19]
    s_waitcnt lgkmcnt(5)
    v_mfma_f32_16x16x32_bf16 a[20:23], v[60:63], v[32:35], a[20:23]
    s_waitcnt lgkmcnt(3)
    v_mfma_f32_16x16x32_bf16 a[24:27], v[64:67], v[32:35], a[24:27]
    s_waitcnt lgkmcnt(1)
    v_mfma_f32_16x16x32_bf16 a[28:31], v[68:71], v[32:35], a[28:31]
    s_waitcnt lgkmcnt(0)
    v_mfma_f32_16x16x32_bf16 a[32:35], v[40:43], v[36:39], a[32:35]
    v_mfma_f32_16x16x32_bf16 a[36:39], v[44:47], v[36:39], a[36:39]
    v_mfma_f32_16x16x32_bf16 a[40:43], v[48:51], v[36:39], a[40:43]
    v_mfma_f32_16x16x32_bf16 a[44:47], v[52:55], v[36:39], a[44:47]
    v_mfma_f32_16x16x32_bf16 a[48:51], v[56:59], v[36:39], a[48:51]
    v_mfma_f32_16x16x32_bf16 a[52:55], v[60:63], v[36:39], a[52:55]
    v_mfma_f32_16x16x32_bf16 a[56:59], v[64:67], v[36:39], a[56:59]
    v_mfma_f32_16x16x32_bf16 a[60:63], v[68:71], v[36:39], a[60:63]
    s_add_u32 s59, s59, 20480
    s_cmp_ge_u32 s59, 61440
    s_cselect_b32 s59, 0, s59
    s_nop 7
    s_nop 7
    s_add_u32 s28, s4, 0x1a80000
    s_addc_u32 s29, s5, 0
    s_mov_b32 s30, 0x1800000
    s_mov_b32 s31, 0x20000
    v_and_b32 v3, 15, v2
    v_lshrrev_b32 v4, 4, v2
    s_mul_i32 s53, s41, 64
    s_mul_i32 s54, s45, 32
    s_add_u32 s53, s53, s54
    v_add_u32 v3, s53, v3
    s_mov_b32 s60, 12288
    v_mul_lo_u32 v3, v3, s60
    s_mul_i32 s53, s47, 256
    s_mul_i32 s54, s46, 128
    s_add_u32 s53, s53, s54
    v_lshl_add_u32 v4, v4, 2, s53
    v_lshl_add_u32 v3, v4, 1, v3
    v_accvgpr_read_b32 v48, a0
    v_accvgpr_read_b32 v49, a1
    v_accvgpr_read_b32 v50, a2
    v_accvgpr_read_b32 v51, a3
    v_cvt_pk_bf16_f32 v32, v48, v49
    v_cvt_pk_bf16_f32 v33, v50, v51
    buffer_store_dwordx2 v[32:33], v3, s[28:31], 0 offen offset:0 sc1
    v_accvgpr_read_b32 v56, a4
    v_accvgpr_read_b32 v57, a5
    v_accvgpr_read_b32 v58, a6
    v_accvgpr_read_b32 v59, a7
    v_cvt_pk_bf16_f32 v36, v56, v57
    v_cvt_pk_bf16_f32 v37, v58, v59
    buffer_store_dwordx2 v[36:37], v3, s[28:31], 0 offen offset:32 sc1
    v_accvgpr_read_b32 v48, a8
    v_accvgpr_read_b32 v49, a9
    v_accvgpr_read_b32 v50, a10
    v_accvgpr_read_b32 v51, a11
    v_cvt_pk_bf16_f32 v40, v48, v49
    v_cvt_pk_bf16_f32 v41, v50, v51
    buffer_store_dwordx2 v[40:41], v3, s[28:31], 0 offen offset:64 sc1
    v_accvgpr_read_b32 v56, a12
    v_accvgpr_read_b32 v57, a13
    v_accvgpr_read_b32 v58, a14
    v_accvgpr_read_b32 v59, a15
    v_cvt_pk_bf16_f32 v44, v56, v57
    v_cvt_pk_bf16_f32 v45, v58, v59
    buffer_store_dwordx2 v[44:45], v3, s[28:31], 0 offen offset:96 sc1
    v_accvgpr_read_b32 v48, a16
    v_accvgpr_read_b32 v49, a17
    v_accvgpr_read_b32 v50, a18
    v_accvgpr_read_b32 v51, a19
    v_cvt_pk_bf16_f32 v32, v48, v49
    v_cvt_pk_bf16_f32 v33, v50, v51
    buffer_store_dwordx2 v[32:33], v3, s[28:31], 0 offen offset:128 sc1
    v_accvgpr_read_b32 v56, a20
    v_accvgpr_read_b32 v57, a21
    v_accvgpr_read_b32 v58, a22
    v_accvgpr_read_b32 v59, a23
    v_cvt_pk_bf16_f32 v36, v56, v57
    v_cvt_pk_bf16_f32 v37, v58, v59
    buffer_store_dwordx2 v[36:37], v3, s[28:31], 0 offen offset:160 sc1
    v_accvgpr_read_b32 v48, a24
    v_accvgpr_read_b32 v49, a25
    v_accvgpr_read_b32 v50, a26
    v_accvgpr_read_b32 v51, a27
    v_cvt_pk_bf16_f32 v40, v48, v49
    v_cvt_pk_bf16_f32 v41, v50, v51
    buffer_store_dwordx2 v[40:41], v3, s[28:31], 0 offen offset:192 sc1
    v_accvgpr_read_b32 v56, a28
    v_accvgpr_read_b32 v57, a29
    v_accvgpr_read_b32 v58, a30
    v_accvgpr_read_b32 v59, a31
    v_cvt_pk_bf16_f32 v44, v56, v57
    v_cvt_pk_bf16_f32 v45, v58, v59
    buffer_store_dwordx2 v[44:45], v3, s[28:31], 0 offen offset:224 sc1
    v_add_u32 v3, 0x30000, v3
    v_accvgpr_read_b32 v48, a32
    v_accvgpr_read_b32 v49, a33
    v_accvgpr_read_b32 v50, a34
    v_accvgpr_read_b32 v51, a35
    v_cvt_pk_bf16_f32 v32, v48, v49
    v_cvt_pk_bf16_f32 v33, v50, v51
    buffer_store_dwordx2 v[32:33], v3, s[28:31], 0 offen offset:0 sc1
    v_accvgpr_read_b32 v56, a36
    v_accvgpr_read_b32 v57, a37
    v_accvgpr_read_b32 v58, a38
    v_accvgpr_read_b32 v59, a39
    v_cvt_pk_bf16_f32 v36, v56, v57
    v_cvt_pk_bf16_f32 v37, v58, v59
    buffer_store_dwordx2 v[36:37], v3, s[28:31], 0 offen offset:32 sc1
    v_accvgpr_read_b32 v48, a40
    v_accvgpr_read_b32 v49, a41
    v_accvgpr_read_b32 v50, a42
    v_accvgpr_read_b32 v51, a43
    v_cvt_pk_bf16_f32 v40, v48, v49
    v_cvt_pk_bf16_f32 v41, v50, v51
    buffer_store_dwordx2 v[40:41], v3, s[28:31], 0 offen offset:64 sc1
    v_accvgpr_read_b32 v56, a44
    v_accvgpr_read_b32 v57, a45
    v_accvgpr_read_b32 v58, a46
    v_accvgpr_read_b32 v59, a47
    v_cvt_pk_bf16_f32 v44, v56, v57
    v_cvt_pk_bf16_f32 v45, v58, v59
    buffer_store_dwordx2 v[44:45], v3, s[28:31], 0 offen offset:96 sc1
    v_accvgpr_read_b32 v48, a48
    v_accvgpr_read_b32 v49, a49
    v_accvgpr_read_b32 v50, a50
    v_accvgpr_read_b32 v51, a51
    v_cvt_pk_bf16_f32 v32, v48, v49
    v_cvt_pk_bf16_f32 v33, v50, v51
    buffer_store_dwordx2 v[32:33], v3, s[28:31], 0 offen offset:128 sc1
    v_accvgpr_read_b32 v56, a52
    v_accvgpr_read_b32 v57, a53
    v_accvgpr_read_b32 v58, a54
    v_accvgpr_read_b32 v59, a55
    v_cvt_pk_bf16_f32 v36, v56, v57
    v_cvt_pk_bf16_f32 v37, v58, v59
    buffer_store_dwordx2 v[36:37], v3, s[28:31], 0 offen offset:160 sc1
    v_accvgpr_read_b32 v48, a56
    v_accvgpr_read_b32 v49, a57
    v_accvgpr_read_b32 v50, a58
    v_accvgpr_read_b32 v51, a59
    v_cvt_pk_bf16_f32 v40, v48, v49
    v_cvt_pk_bf16_f32 v41, v50, v51
    buffer_store_dwordx2 v[40:41], v3, s[28:31], 0 offen offset:192 sc1
    v_accvgpr_read_b32 v56, a60
    v_accvgpr_read_b32 v57, a61
    v_accvgpr_read_b32 v58, a62
    v_accvgpr_read_b32 v59, a63
    v_cvt_pk_bf16_f32 v44, v56, v57
    v_cvt_pk_bf16_f32 v45, v58, v59
    buffer_store_dwordx2 v[44:45], v3, s[28:31], 0 offen offset:224 sc1
    s_branch L_w_ssig
L_w_sv:
    s_sub_u32 s40, s40, 24
    s_mov_b32 s6, s100
    s_mov_b32 s7, s101
    s_lshr_b32 s45, s44, 1
    s_and_b32 s46, s44, 1
    s_mov_b32 s12, s4
    s_mov_b32 s13, s5
    s_mov_b32 s14, 0x280000
    s_mov_b32 s15, 0x20000
    s_mov_b32 s16, s6
    s_mov_b32 s17, s7
    s_mov_b32 s18, 0x780000
    s_mov_b32 s19, 0x20000
    s_mov_b32 s47, s40
    v_lshrrev_b32 v3, 2, v2
    v_and_b32 v4, 3, v2
    v_lshrrev_b32 v5, 3, v3
    v_lshlrev_b32 v5, 1, v5
    v_xor_b32 v4, v4, v5
    s_mul_i32 s48, s41, 64
    s_mul_i32 s49, s44, 16
    s_add_u32 s48, s48, s49
    v_add_u32 v3, s48, v3
    s_mov_b32 s60, 1280
    v_mul_lo_u32 v3, v3, s60
    v_lshl_add_u32 v6, v4, 4, v3
    s_mul_i32 s50, s44, 4
    s_lshr_b32 s51, s50, 4
    s_and_b32 s52, s50, 15
    v_lshrrev_b32 v3, 5, v2
    s_add_u32 s53, s52, 0
    s_mul_i32 s53, s53, 2
    v_add_u32 v3, s53, v3
    v_and_b32 v4, 31, v2
    v_and_b32 v5, 3, v3
    v_lshrrev_b32 v30, 3, v3
    v_and_b32 v30, 1, v30
    v_lshl_or_b32 v5, v30, 2, v5
    v_lshlrev_b32 v5, 1, v5
    v_xor_b32 v4, v4, v5
    s_mov_b32 s60, 12288
    v_mul_lo_u32 v3, v3, s60
    v_lshl_add_u32 v3, v4, 4, v3
    s_mul_i32 s53, s47, 512
    v_add_u32 v7, s53, v3
    v_lshrrev_b32 v3, 5, v2
    s_add_u32 s53, s52, 1
    s_mul_i32 s53, s53, 2
    v_add_u32 v3, s53, v3
    v_and_b32 v4, 31, v2
    v_and_b32 v5, 3, v3
    v_lshrrev_b32 v30, 3, v3
    v_and_b32 v30, 1, v30
    v_lshl_or_b32 v5, v30, 2, v5
    v_lshlrev_b32 v5, 1, v5
    v_xor_b32 v4, v4, v5
    s_mov_b32 s60, 12288
    v_mul_lo_u32 v3, v3, s60
    v_lshl_add_u32 v3, v4, 4, v3
    s_mul_i32 s53, s47, 512
    v_add_u32 v8, s53, v3
    v_lshrrev_b32 v3, 5, v2
    s_add_u32 s53, s52, 2
    s_mul_i32 s53, s53, 2
    v_add_u32 v3, s53, v3
    v_and_b32 v4, 31, v2
    v_and_b32 v5, 3, v3
    v_lshrrev_b32 v30, 3, v3
    v_and_b32 v30, 1, v30
    v_lshl_or_b32 v5, v30, 2, v5
    v_lshlrev_b32 v5, 1, v5
    v_xor_b32 v4, v4, v5
    s_mov_b32 s60, 12288
    v_mul_lo_u32 v3, v3, s60
    v_lshl_add_u32 v3, v4, 4, v3
    s_mul_i32 s53, s47, 512
    v_add_u32 v9, s53, v3
    v_lshrrev_b32 v3, 5, v2
    s_add_u32 s53, s52, 3
    s_mul_i32 s53, s53, 2
    v_add_u32 v3, s53, v3
    v_and_b32 v4, 31, v2
    v_and_b32 v5, 3, v3
    v_lshrrev_b32 v30, 3, v3
    v_and_b32 v30, 1, v30
    v_lshl_or_b32 v5, v30, 2, v5
    v_lshlrev_b32 v5, 1, v5
    v_xor_b32 v4, v4, v5
    s_mov_b32 s60, 12288
    v_mul_lo_u32 v3, v3, s60
    v_lshl_add_u32 v3, v4, 4, v3
    s_mul_i32 s53, s47, 512
    v_add_u32 v10, s53, v3
    v_and_b32 v3, 15, v2
    v_lshrrev_b32 v4, 4, v2
    v_lshrrev_b32 v5, 3, v3
    v_lshlrev_b32 v5, 1, v5
    v_xor_b32 v5, v4, v5
    s_mul_i32 s53, s45, 32
    v_add_u32 v30, s53, v3
    v_lshlrev_b32 v30, 6, v30
    v_lshl_add_u32 v11, v5, 4, v30
    v_lshrrev_b32 v5, 2, v3
    v_and_b32 v30, 3, v2
    v_lshl_add_u32 v31, v4, 3, v5
    v_mul_u32_u24 v31, 512, v31
    v_lshl_add_u32 v31, v30, 3, v31
    v_add_u32 v31, 4096, v31
    v_and_b32 v30, 1, v4
    v_lshl_or_b32 v5, v30, 2, v5
    v_xor_b32 v30, 0, v5
    v_lshl_add_u32 v12, v30, 5, v31
    v_xor_b32 v30, 1, v5
    v_lshl_add_u32 v13, v30, 5, v31
    v_xor_b32 v30, 2, v5
    v_lshl_add_u32 v14, v30, 5, v31
    v_xor_b32 v30, 3, v5
    v_lshl_add_u32 v15, v30, 5, v31
    v_xor_b32 v30, 4, v5
    v_lshl_add_u32 v16, v30, 5, v31
    v_xor_b32 v30, 5, v5
    v_lshl_add_u32 v17, v30, 5, v31
    v_xor_b32 v30, 6, v5
    v_lshl_add_u32 v18, v30, 5, v31
    v_xor_b32 v30, 7, v5
    v_lshl_add_u32 v19, v30, 5, v31
    s_mul_i32 s53, s46, 256
    v_add_u32 v12, s53, v12
    v_add_u32 v13, s53, v13
    v_add_u32 v14, s53, v14
    v_add_u32 v15, s53, v15
    v_add_u32 v16, s53, v16
    v_add_u32 v17, s53, v17
    v_add_u32 v18, s53, v18
    v_add_u32 v19, s53, v19
    v_accvgpr_write_b32 a0, 0
    v_accvgpr_write_b32 a1, 0
    v_accvgpr_write_b32 a2, 0
    v_accvgpr_write_b32 a3, 0
    v_accvgpr_write_b32 a4, 0
    v_accvgpr_write_b32 a5, 0
    v_accvgpr_write_b32 a6, 0
    v_accvgpr_write_b32 a7, 0
    v_accvgpr_write_b32 a8, 0
    v_accvgpr_write_b32 a9, 0
    v_accvgpr_write_b32 a10, 0
    v_accvgpr_write_b32 a11, 0
    v_accvgpr_write_b32 a12, 0
    v_accvgpr_write_b32 a13, 0
    v_accvgpr_write_b32 a14, 0
    v_accvgpr_write_b32 a15, 0
    v_accvgpr_write_b32 a16, 0
    v_accvgpr_write_b32 a17, 0
    v_accvgpr_write_b32 a18, 0
    v_accvgpr_write_b32 a19, 0
    v_accvgpr_write_b32 a20, 0
    v_accvgpr_write_b32 a21, 0
    v_accvgpr_write_b32 a22, 0
    v_accvgpr_write_b32 a23, 0
    v_accvgpr_write_b32 a24, 0
    v_accvgpr_write_b32 a25, 0
    v_accvgpr_write_b32 a26, 0
    v_accvgpr_write_b32 a27, 0
    v_accvgpr_write_b32 a28, 0
    v_accvgpr_write_b32 a29, 0
    v_accvgpr_write_b32 a30, 0
    v_accvgpr_write_b32 a31, 0
    v_accvgpr_write_b32 a32, 0
    v_accvgpr_write_b32 a33, 0
    v_accvgpr_write_b32 a34, 0
    v_accvgpr_write_b32 a35, 0
    v_accvgpr_write_b32 a36, 0
    v_accvgpr_write_b32 a37, 0
    v_accvgpr_write_b32 a38, 0
    v_accvgpr_write_b32 a39, 0
    v_accvgpr_write_b32 a40, 0
    v_accvgpr_write_b32 a41, 0
    v_accvgpr_write_b32 a42, 0
    v_accvgpr_write_b32 a43, 0
    v_accvgpr_write_b32 a44, 0
    v_accvgpr_write_b32 a45, 0
    v_accvgpr_write_b32 a46, 0
    v_accvgpr_write_b32 a47, 0
    v_accvgpr_write_b32 a48, 0
    v_accvgpr_write_b32 a49, 0
    v_accvgpr_write_b32 a50, 0
    v_accvgpr_write_b32 a51, 0
    v_accvgpr_write_b32 a52, 0
    v_accvgpr_write_b32 a53, 0
    v_accvgpr_write_b32 a54, 0
    v_accvgpr_write_b32 a55, 0
    v_accvgpr_write_b32 a56, 0
    v_accvgpr_write_b32 a57, 0
    v_accvgpr_write_b32 a58, 0
    v_accvgpr_write_b32 a59, 0
    v_accvgpr_write_b32 a60, 0
    v_accvgpr_write_b32 a61, 0
    v_accvgpr_write_b32 a62, 0
    v_accvgpr_write_b32 a63, 0
    s_mul_i32 s56, s42, 0
    s_mul_i32 s57, s42, 0
    s_mov_b32 s58, 0
    s_mov_b32 s59, 0
    s_mul_i32 s63, s44, 1024
    s_mul_i32 s64, s44, 4096
    s_add_u32 s64, s64, 4096
    s_add_u32 s65, s58, s63
    s_add_u32 m0, s65, 0
    s_nop 0
    buffer_load_dwordx4 v6, s[12:15], s56 offen lds
    s_add_u32 s65, s58, s64
    s_add_u32 m0, s65, 0
    s_nop 0
    buffer_load_dwordx4 v7, s[16:19], s57 offen lds
    s_add_u32 s65, s58, s64
    s_add_u32 m0, s65, 1024
    s_nop 0
    buffer_load_dwordx4 v8, s[16:19], s57 offen lds
    s_add_u32 s65, s58, s64
    s_add_u32 m0, s65, 2048
    s_nop 0
    buffer_load_dwordx4 v9, s[16:19], s57 offen lds
    s_add_u32 s65, s58, s64
    s_add_u32 m0, s65, 3072
    s_nop 0
    buffer_load_dwordx4 v10, s[16:19], s57 offen lds
    s_add_u32 s56, s56, 64
    s_add_u32 s57, s57, 393216
    s_add_u32 s58, s58, 20480
    s_cmp_ge_u32 s58, 61440
    s_cselect_b32 s58, 0, s58
    s_add_u32 s65, s58, s63
    s_add_u32 m0, s65, 0
    s_nop 0
    buffer_load_dwordx4 v6, s[12:15], s56 offen lds
    s_add_u32 s65, s58, s64
    s_add_u32 m0, s65, 0
    s_nop 0
    buffer_load_dwordx4 v7, s[16:19], s57 offen lds
    s_add_u32 s65, s58, s64
    s_add_u32 m0, s65, 1024
    s_nop 0
    buffer_load_dwordx4 v8, s[16:19], s57 offen lds
    s_add_u32 s65, s58, s64
    s_add_u32 m0, s65, 2048
    s_nop 0
    buffer_load_dwordx4 v9, s[16:19], s57 offen lds
    s_add_u32 s65, s58, s64
    s_add_u32 m0, s65, 3072
    s_nop 0
    buffer_load_dwordx4 v10, s[16:19], s57 offen lds
    s_add_u32 s56, s56, 64
    s_add_u32 s57, s57, 393216
    s_add_u32 s58, s58, 20480
    s_cmp_ge_u32 s58, 61440
    s_cselect_b32 s58, 0, s58
    s_mov_b32 s62, 18
L_wvs_loop:
    s_waitcnt vmcnt(5)
    s_barrier
    s_add_u32 s65, s58, s63
    s_add_u32 m0, s65, 0
    s_nop 0
    buffer_load_dwordx4 v6, s[12:15], s56 offen lds
    s_add_u32 s65, s58, s64
    s_add_u32 m0, s65, 0
    s_nop 0
    buffer_load_dwordx4 v7, s[16:19], s57 offen lds
    s_add_u32 s65, s58, s64
    s_add_u32 m0, s65, 1024
    s_nop 0
    buffer_load_dwordx4 v8, s[16:19], s57 offen lds
    s_add_u32 s65, s58, s64
    s_add_u32 m0, s65, 2048
    s_nop 0
    buffer_load_dwordx4 v9, s[16:19], s57 offen lds
    s_add_u32 s65, s58, s64
    s_add_u32 m0, s65, 3072
    s_nop 0
    buffer_load_dwordx4 v10, s[16:19], s57 offen lds
    s_add_u32 s56, s56, 64
    s_add_u32 s57, s57, 393216
    s_add_u32 s58, s58, 20480
    s_cmp_ge_u32 s58, 61440
    s_cselect_b32 s58, 0, s58
    v_add_u32 v20, s59, v11
    v_add_u32 v21, s59, v12
    v_add_u32 v22, s59, v13
    v_add_u32 v23, s59, v14
    v_add_u32 v24, s59, v15
    v_add_u32 v25, s59, v16
    v_add_u32 v26, s59, v17
    v_add_u32 v27, s59, v18
    v_add_u32 v28, s59, v19
    ds_read_b128 v[32:35], v20 offset:0
    ds_read_b64_tr_b16 v[40:41], v21 offset:0
    ds_read_b64_tr_b16 v[42:43], v21 offset:2048
    ds_read_b64_tr_b16 v[44:45], v22 offset:0
    ds_read_b64_tr_b16 v[46:47], v22 offset:2048
    ds_read_b64_tr_b16 v[48:49], v23 offset:0
    ds_read_b64_tr_b16 v[50:51], v23 offset:2048
    ds_read_b64_tr_b16 v[52:53], v24 offset:0
    ds_read_b64_tr_b16 v[54:55], v24 offset:2048
    ds_read_b64_tr_b16 v[56:57], v25 offset:0
    s_waitcnt lgkmcnt(7)
    v_mfma_f32_16x16x32_bf16 a[0:3], v[32:35], v[40:43], a[0:3]
    ds_read_b64_tr_b16 v[58:59], v25 offset:2048
    ds_read_b64_tr_b16 v[60:61], v26 offset:0
    ds_read_b64_tr_b16 v[62:63], v26 offset:2048
    s_waitcnt lgkmcnt(8)
    v_mfma_f32_16x16x32_bf16 a[4:7], v[32:35], v[44:47], a[4:7]
    ds_read_b64_tr_b16 v[64:65], v27 offset:0
    ds_read_b64_tr_b16 v[66:67], v27 offset:2048
    s_waitcnt lgkmcnt(8)
    v_mfma_f32_16x16x32_bf16 a[8:11], v[32:35], v[48:51], a[8:11]
    ds_read_b64_tr_b16 v[68:69], v28 offset:0
    ds_read_b64_tr_b16 v[70:71], v28 offset:2048
    s_waitcnt lgkmcnt(8)
    v_mfma_f32_16x16x32_bf16 a[12:15], v[32:35], v[52:55], a[12:15]
    ds_read_b128 v[36:39], v20 offset:1024
    s_waitcnt lgkmcnt(7)
    v_mfma_f32_16x16x32_bf16 a[16:19], v[32:35], v[56:59], a[16:19]
    s_waitcnt lgkmcnt(5)
    v_mfma_f32_16x16x32_bf16 a[20:23], v[32:35], v[60:63], a[20:23]
    s_waitcnt lgkmcnt(3)
    v_mfma_f32_16x16x32_bf16 a[24:27], v[32:35], v[64:67], a[24:27]
    s_waitcnt lgkmcnt(1)
    v_mfma_f32_16x16x32_bf16 a[28:31], v[32:35], v[68:71], a[28:31]
    s_waitcnt lgkmcnt(0)
    v_mfma_f32_16x16x32_bf16 a[32:35], v[36:39], v[40:43], a[32:35]
    v_mfma_f32_16x16x32_bf16 a[36:39], v[36:39], v[44:47], a[36:39]
    v_mfma_f32_16x16x32_bf16 a[40:43], v[36:39], v[48:51], a[40:43]
    v_mfma_f32_16x16x32_bf16 a[44:47], v[36:39], v[52:55], a[44:47]
    v_mfma_f32_16x16x32_bf16 a[48:51], v[36:39], v[56:59], a[48:51]
    v_mfma_f32_16x16x32_bf16 a[52:55], v[36:39], v[60:63], a[52:55]
    v_mfma_f32_16x16x32_bf16 a[56:59], v[36:39], v[64:67], a[56:59]
    v_mfma_f32_16x16x32_bf16 a[60:63], v[36:39], v[68:71], a[60:63]
    s_add_u32 s59, s59, 20480
    s_cmp_ge_u32 s59, 61440
    s_cselect_b32 s59, 0, s59
    s_sub_u32 s62, s62, 1
    s_cmp_lg_u32 s62, 0
    s_cbranch_scc1 L_wvs_loop
    s_waitcnt vmcnt(5)
    s_barrier
    v_add_u32 v20, s59, v11
    v_add_u32 v21, s59, v12
    v_add_u32 v22, s59, v13
    v_add_u32 v23, s59, v14
    v_add_u32 v24, s59, v15
    v_add_u32 v25, s59, v16
    v_add_u32 v26, s59, v17
    v_add_u32 v27, s59, v18
    v_add_u32 v28, s59, v19
    ds_read_b128 v[32:35], v20 offset:0
    ds_read_b64_tr_b16 v[40:41], v21 offset:0
    ds_read_b64_tr_b16 v[42:43], v21 offset:2048
    ds_read_b64_tr_b16 v[44:45], v22 offset:0
    ds_read_b64_tr_b16 v[46:47], v22 offset:2048
    ds_read_b64_tr_b16 v[48:49], v23 offset:0
    ds_read_b64_tr_b16 v[50:51], v23 offset:2048
    ds_read_b64_tr_b16 v[52:53], v24 offset:0
    ds_read_b64_tr_b16 v[54:55], v24 offset:2048
    ds_read_b64_tr_b16 v[56:57], v25 offset:0
    s_waitcnt lgkmcnt(7)
    v_mfma_f32_16x16x32_bf16 a[0:3], v[32:35], v[40:43], a[0:3]
    ds_read_b64_tr_b16 v[58:59], v25 offset:2048
    ds_read_b64_tr_b16 v[60:61], v26 offset:0
    ds_read_b64_tr_b16 v[62:63], v26 offset:2048
    s_waitcnt lgkmcnt(8)
    v_mfma_f32_16x16x32_bf16 a[4:7], v[32:35], v[44:47], a[4:7]
    ds_read_b64_tr_b16 v[64:65], v27 offset:0
    ds_read_b64_tr_b16 v[66:67], v27 offset:2048
    s_waitcnt lgkmcnt(8)
    v_mfma_f32_16x16x32_bf16 a[8:11], v[32:35], v[48:51], a[8:11]
    ds_read_b64_tr_b16 v[68:69], v28 offset:0
    ds_read_b64_tr_b16 v[70:71], v28 offset:2048
    s_waitcnt lgkmcnt(8)
    v_mfma_f32_16x16x32_bf16 a[12:15], v[32:35], v[52:55], a[12:15]
    ds_read_b128 v[36:39], v20 offset:1024
    s_waitcnt lgkmcnt(7)
    v_mfma_f32_16x16x32_bf16 a[16:19], v[32:35], v[56:59], a[16:19]
    s_waitcnt lgkmcnt(5)
    v_mfma_f32_16x16x32_bf16 a[20:23], v[32:35], v[60:63], a[20:23]
    s_waitcnt lgkmcnt(3)
    v_mfma_f32_16x16x32_bf16 a[24:27], v[32:35], v[64:67], a[24:27]
    s_waitcnt lgkmcnt(1)
    v_mfma_f32_16x16x32_bf16 a[28:31], v[32:35], v[68:71], a[28:31]
    s_waitcnt lgkmcnt(0)
    v_mfma_f32_16x16x32_bf16 a[32:35], v[36:39], v[40:43], a[32:35]
    v_mfma_f32_16x16x32_bf16 a[36:39], v[36:39], v[44:47], a[36:39]
    v_mfma_f32_16x16x32_bf16 a[40:43], v[36:39], v[48:51], a[40:43]
    v_mfma_f32_16x16x32_bf16 a[44:47], v[36:39], v[52:55], a[44:47]
    v_mfma_f32_16x16x32_bf16 a[48:51], v[36:39], v[56:59], a[48:51]
    v_mfma_f32_16x16x32_bf16 a[52:55], v[36:39], v[60:63], a[52:55]
    v_mfma_f32_16x16x32_bf16 a[56:59], v[36:39], v[64:67], a[56:59]
    v_mfma_f32_16x16x32_bf16 a[60:63], v[36:39], v[68:71], a[60:63]
    s_add_u32 s59, s59, 20480
    s_cmp_ge_u32 s59, 61440
    s_cselect_b32 s59, 0, s59
    s_waitcnt vmcnt(0)
    s_barrier
    v_add_u32 v20, s59, v11
    v_add_u32 v21, s59, v12
    v_add_u32 v22, s59, v13
    v_add_u32 v23, s59, v14
    v_add_u32 v24, s59, v15
    v_add_u32 v25, s59, v16
    v_add_u32 v26, s59, v17
    v_add_u32 v27, s59, v18
    v_add_u32 v28, s59, v19
    ds_read_b128 v[32:35], v20 offset:0
    ds_read_b64_tr_b16 v[40:41], v21 offset:0
    ds_read_b64_tr_b16 v[42:43], v21 offset:2048
    ds_read_b64_tr_b16 v[44:45], v22 offset:0
    ds_read_b64_tr_b16 v[46:47], v22 offset:2048
    ds_read_b64_tr_b16 v[48:49], v23 offset:0
    ds_read_b64_tr_b16 v[50:51], v23 offset:2048
    ds_read_b64_tr_b16 v[52:53], v24 offset:0
    ds_read_b64_tr_b16 v[54:55], v24 offset:2048
    ds_read_b64_tr_b16 v[56:57], v25 offset:0
    s_waitcnt lgkmcnt(7)
    v_mfma_f32_16x16x32_bf16 a[0:3], v[32:35], v[40:43], a[0:3]
    ds_read_b64_tr_b16 v[58:59], v25 offset:2048
    ds_read_b64_tr_b16 v[60:61], v26 offset:0
    ds_read_b64_tr_b16 v[62:63], v26 offset:2048
    s_waitcnt lgkmcnt(8)
    v_mfma_f32_16x16x32_bf16 a[4:7], v[32:35], v[44:47], a[4:7]
    ds_read_b64_tr_b16 v[64:65], v27 offset:0
    ds_read_b64_tr_b16 v[66:67], v27 offset:2048
    s_waitcnt lgkmcnt(8)
    v_mfma_f32_16x16x32_bf16 a[8:11], v[32:35], v[48:51], a[8:11]
    ds_read_b64_tr_b16 v[68:69], v28 offset:0
    ds_read_b64_tr_b16 v[70:71], v28 offset:2048
    s_waitcnt lgkmcnt(8)
    v_mfma_f32_16x16x32_bf16 a[12:15], v[32:35], v[52:55], a[12:15]
    ds_read_b128 v[36:39], v20 offset:1024
    s_waitcnt lgkmcnt(7)
    v_mfma_f32_16x16x32_bf16 a[16:19], v[32:35], v[56:59], a[16:19]
    s_waitcnt lgkmcnt(5)
    v_mfma_f32_16x16x32_bf16 a[20:23], v[32:35], v[60:63], a[20:23]
    s_waitcnt lgkmcnt(3)
    v_mfma_f32_16x16x32_bf16 a[24:27], v[32:35], v[64:67], a[24:27]
    s_waitcnt lgkmcnt(1)
    v_mfma_f32_16x16x32_bf16 a[28:31], v[32:35], v[68:71], a[28:31]
    s_waitcnt lgkmcnt(0)
    v_mfma_f32_16x16x32_bf16 a[32:35], v[36:39], v[40:43], a[32:35]
    v_mfma_f32_16x16x32_bf16 a[36:39], v[36:39], v[44:47], a[36:39]
    v_mfma_f32_16x16x32_bf16 a[40:43], v[36:39], v[48:51], a[40:43]
    v_mfma_f32_16x16x32_bf16 a[44:47], v[36:39], v[52:55], a[44:47]
    v_mfma_f32_16x16x32_bf16 a[48:51], v[36:39], v[56:59], a[48:51]
    v_mfma_f32_16x16x32_bf16 a[52:55], v[36:39], v[60:63], a[52:55]
    v_mfma_f32_16x16x32_bf16 a[56:59], v[36:39], v[64:67], a[56:59]
    v_mfma_f32_16x16x32_bf16 a[60:63], v[36:39], v[68:71], a[60:63]
    s_add_u32 s59, s59, 20480
    s_cmp_ge_u32 s59, 61440
    s_cselect_b32 s59, 0, s59
    s_nop 7
    s_nop 7
    s_add_u32 s28, s4, 0x3280000
    s_addc_u32 s29, s5, 0
    s_mov_b32 s30, 0x1800000
    s_mov_b32 s31, 0x20000
    s_mul_i32 s53, s41, 2
    s_mul_i32 s54, s45, 1
    s_add_u32 s53, s53, s54
    s_mul_i32 s53, s53, 393216
    s_mul_i32 s54, s47, 16
    s_mul_i32 s55, s46, 8
    s_add_u32 s54, s54, s55
    s_lshl_b32 s54, s54, 10
    s_add_u32 s53, s53, s54
    v_lshlrev_b32 v3, 4, v2
    v_add_u32 v3, s53, v3
    v_add_u32 v4, 4096, v3
    v_accvgpr_read_b32 v48, a0
    v_accvgpr_read_b32 v49, a1
    v_accvgpr_read_b32 v50, a2
    v_accvgpr_read_b32 v51, a3
    v_accvgpr_read_b32 v52, a32
    v_accvgpr_read_b32 v53, a33
    v_accvgpr_read_b32 v54, a34
    v_accvgpr_read_b32 v55, a35
    v_cvt_pk_bf16_f32 v32, v48, v49
    v_cvt_pk_bf16_f32 v33, v50, v51
    v_cvt_pk_bf16_f32 v34, v52, v53
    v_cvt_pk_bf16_f32 v35, v54, v55
    buffer_store_dwordx4 v[32:35], v3, s[28:31], 0 offen offset:0 sc1
    v_accvgpr_read_b32 v56, a4
    v_accvgpr_read_b32 v57, a5
    v_accvgpr_read_b32 v58, a6
    v_accvgpr_read_b32 v59, a7
    v_accvgpr_read_b32 v60, a36
    v_accvgpr_read_b32 v61, a37
    v_accvgpr_read_b32 v62, a38
    v_accvgpr_read_b32 v63, a39
    v_cvt_pk_bf16_f32 v36, v56, v57
    v_cvt_pk_bf16_f32 v37, v58, v59
    v_cvt_pk_bf16_f32 v38, v60, v61
    v_cvt_pk_bf16_f32 v39, v62, v63
    buffer_store_dwordx4 v[36:39], v3, s[28:31], 0 offen offset:1024 sc1
    v_accvgpr_read_b32 v48, a8
    v_accvgpr_read_b32 v49, a9
    v_accvgpr_read_b32 v50, a10
    v_accvgpr_read_b32 v51, a11
    v_accvgpr_read_b32 v52, a40
    v_accvgpr_read_b32 v53, a41
    v_accvgpr_read_b32 v54, a42
    v_accvgpr_read_b32 v55, a43
    v_cvt_pk_bf16_f32 v40, v48, v49
    v_cvt_pk_bf16_f32 v41, v50, v51
    v_cvt_pk_bf16_f32 v42, v52, v53
    v_cvt_pk_bf16_f32 v43, v54, v55
    buffer_store_dwordx4 v[40:43], v3, s[28:31], 0 offen offset:2048 sc1
    v_accvgpr_read_b32 v56, a12
    v_accvgpr_read_b32 v57, a13
    v_accvgpr_read_b32 v58, a14
    v_accvgpr_read_b32 v59, a15
    v_accvgpr_read_b32 v60, a44
    v_accvgpr_read_b32 v61, a45
    v_accvgpr_read_b32 v62, a46
    v_accvgpr_read_b32 v63, a47
    v_cvt_pk_bf16_f32 v44, v56, v57
    v_cvt_pk_bf16_f32 v45, v58, v59
    v_cvt_pk_bf16_f32 v46, v60, v61
    v_cvt_pk_bf16_f32 v47, v62, v63
    buffer_store_dwordx4 v[44:47], v3, s[28:31], 0 offen offset:3072 sc1
    v_accvgpr_read_b32 v48, a16
    v_accvgpr_read_b32 v49, a17
    v_accvgpr_read_b32 v50, a18
    v_accvgpr_read_b32 v51, a19
    v_accvgpr_read_b32 v52, a48
    v_accvgpr_read_b32 v53, a49
    v_accvgpr_read_b32 v54, a50
    v_accvgpr_read_b32 v55, a51
    v_cvt_pk_bf16_f32 v32, v48, v49
    v_cvt_pk_bf16_f32 v33, v50, v51
    v_cvt_pk_bf16_f32 v34, v52, v53
    v_cvt_pk_bf16_f32 v35, v54, v55
    buffer_store_dwordx4 v[32:35], v4, s[28:31], 0 offen offset:0 sc1
    v_accvgpr_read_b32 v56, a20
    v_accvgpr_read_b32 v57, a21
    v_accvgpr_read_b32 v58, a22
    v_accvgpr_read_b32 v59, a23
    v_accvgpr_read_b32 v60, a52
    v_accvgpr_read_b32 v61, a53
    v_accvgpr_read_b32 v62, a54
    v_accvgpr_read_b32 v63, a55
    v_cvt_pk_bf16_f32 v36, v56, v57
    v_cvt_pk_bf16_f32 v37, v58, v59
    v_cvt_pk_bf16_f32 v38, v60, v61
    v_cvt_pk_bf16_f32 v39, v62, v63
    buffer_store_dwordx4 v[36:39], v4, s[28:31], 0 offen offset:1024 sc1
    v_accvgpr_read_b32 v48, a24
    v_accvgpr_read_b32 v49, a25
    v_accvgpr_read_b32 v50, a26
    v_accvgpr_read_b32 v51, a27
    v_accvgpr_read_b32 v52, a56
    v_accvgpr_read_b32 v53, a57
    v_accvgpr_read_b32 v54, a58
    v_accvgpr_read_b32 v55, a59
    v_cvt_pk_bf16_f32 v40, v48, v49
    v_cvt_pk_bf16_f32 v41, v50, v51
    v_cvt_pk_bf16_f32 v42, v52, v53
    v_cvt_pk_bf16_f32 v43, v54, v55
    buffer_store_dwordx4 v[40:43], v4, s[28:31], 0 offen offset:2048 sc1
    v_accvgpr_read_b32 v56, a28
    v_accvgpr_read_b32 v57, a29
    v_accvgpr_read_b32 v58, a30
    v_accvgpr_read_b32 v59, a31
    v_accvgpr_read_b32 v60, a60
    v_accvgpr_read_b32 v61, a61
    v_accvgpr_read_b32 v62, a62
    v_accvgpr_read_b32 v63, a63
    v_cvt_pk_bf16_f32 v44, v56, v57
    v_cvt_pk_bf16_f32 v45, v58, v59
    v_cvt_pk_bf16_f32 v46, v60, v61
    v_cvt_pk_bf16_f32 v47, v62, v63
    buffer_store_dwordx4 v[44:47], v4, s[28:31], 0 offen offset:3072 sc1
L_w_ssig:
    s_waitcnt vmcnt(0)
    s_barrier
    s_cmp_lg_u32 s44, 0
    s_cbranch_scc1 L_w_snosig
    s_lshl_b32 s66, s41, 2
    s_add_u32 s66, s66, 192
    v_mov_b32 v24, s66
    v_mov_b32 v25, 1
    s_mov_b64 exec, 1
    buffer_atomic_add v25, v24, s[92:95], 0 offen sc1
    s_mov_b64 exec, -1
L_w_snosig:
    s_add_u32 s91, s91, 127
    s_branch L_w_s
L_w_kv0:
    s_sub_u32 s91, s91, 192
L_w_kv:
    s_cmp_ge_u32 s91, 336
    s_cbranch_scc1 L_w_q0
    s_mov_b32 s60, 0x5555556
    s_mul_hi_u32 s41, s91, s60
    s_mul_i32 s61, s41, 48
    s_sub_u32 s40, s91, s61
    s_add_u32 s41, s41, 1
    s_cmp_ge_u32 s40, 24
    s_cbranch_scc1 L_w_v
    s_mov_b32 s6, s98
    s_mov_b32 s7, s99
    s_lshr_b32 s45, s44, 1
    s_and_b32 s46, s44, 1
    s_mov_b32 s12, s4
    s_mov_b32 s13, s5
    s_mov_b32 s14, 0x280000
    s_mov_b32 s15, 0x20000
    s_mov_b32 s16, s6
    s_mov_b32 s17, s7
    s_mov_b32 s18, 0x780000
    s_mov_b32 s19, 0x20000
    s_mov_b32 s47, s40
    v_lshrrev_b32 v3, 2, v2
    v_and_b32 v4, 3, v2
    v_lshrrev_b32 v5, 3, v3
    v_lshlrev_b32 v5, 1, v5
    v_xor_b32 v4, v4, v5
    s_mul_i32 s48, s41, 256
    s_mul_i32 s49, s44, 64
    s_add_u32 s48, s48, s49
    v_add_u32 v3, s48, v3
    s_mov_b32 s60, 1280
    v_mul_lo_u32 v3, v3, s60
    v_lshl_add_u32 v6, v4, 4, v3
    v_add_u32 v7, 0x5000, v6
    v_add_u32 v8, 0xa000, v6
    v_add_u32 v9, 0xf000, v6
    s_mul_i32 s50, s44, 4
    s_lshr_b32 s51, s50, 4
    s_and_b32 s52, s50, 15
    v_lshrrev_b32 v3, 5, v2
    s_add_u32 s53, s52, 0
    s_mul_i32 s53, s53, 2
    v_add_u32 v3, s53, v3
    v_and_b32 v4, 31, v2
    v_and_b32 v5, 3, v3
    v_lshrrev_b32 v30, 3, v3
    v_and_b32 v30, 1, v30
    v_lshl_or_b32 v5, v30, 2, v5
    v_lshlrev_b32 v5, 1, v5
    v_xor_b32 v4, v4, v5
    s_mov_b32 s60, 12288
    v_mul_lo_u32 v3, v3, s60
    v_lshl_add_u32 v3, v4, 4, v3
    s_mul_i32 s53, s47, 512
    v_add_u32 v10, s53, v3
    v_lshrrev_b32 v3, 5, v2
    s_add_u32 s53, s52, 1
    s_mul_i32 s53, s53, 2
    v_add_u32 v3, s53, v3
    v_and_b32 v4, 31, v2
    v_and_b32 v5, 3, v3
    v_lshrrev_b32 v30, 3, v3
    v_and_b32 v30, 1, v30
    v_lshl_or_b32 v5, v30, 2, v5
    v_lshlrev_b32 v5, 1, v5
    v_xor_b32 v4, v4, v5
    s_mov_b32 s60, 12288
    v_mul_lo_u32 v3, v3, s60
    v_lshl_add_u32 v3, v4, 4, v3
    s_mul_i32 s53, s47, 512
    v_add_u32 v11, s53, v3
    v_lshrrev_b32 v3, 5, v2
    s_add_u32 s53, s52, 2
    s_mul_i32 s53, s53, 2
    v_add_u32 v3, s53, v3
    v_and_b32 v4, 31, v2
    v_and_b32 v5, 3, v3
    v_lshrrev_b32 v30, 3, v3
    v_and_b32 v30, 1, v30
    v_lshl_or_b32 v5, v30, 2, v5
    v_lshlrev_b32 v5, 1, v5
    v_xor_b32 v4, v4, v5
    s_mov_b32 s60, 12288
    v_mul_lo_u32 v3, v3, s60
    v_lshl_add_u32 v3, v4, 4, v3
    s_mul_i32 s53, s47, 512
    v_add_u32 v12, s53, v3
    v_lshrrev_b32 v3, 5, v2
    s_add_u32 s53, s52, 3
    s_mul_i32 s53, s53, 2
    v_add_u32 v3, s53, v3
    v_and_b32 v4, 31, v2
    v_and_b32 v5, 3, v3
    v_lshrrev_b32 v30, 3, v3
    v_and_b32 v30, 1, v30
    v_lshl_or_b32 v5, v30, 2, v5
    v_lshlrev_b32 v5, 1, v5
    v_xor_b32 v4, v4, v5
    s_mov_b32 s60, 12288
    v_mul_lo_u32 v3, v3, s60
    v_lshl_add_u32 v3, v4, 4, v3
    s_mul_i32 s53, s47, 512
    v_add_u32 v13, s53, v3
    v_and_b32 v3, 15, v2
    v_lshrrev_b32 v4, 4, v2
    v_lshrrev_b32 v5, 3, v3
    v_lshlrev_b32 v5, 1, v5
    v_xor_b32 v5, v4, v5
    s_mul_i32 s53, s45, 128
    v_add_u32 v30, s53, v3
    v_lshlrev_b32 v30, 6, v30
    v_lshl_add_u32 v14, v5, 4, v30
    v_lshrrev_b32 v5, 2, v3
    v_and_b32 v30, 3, v2
    v_lshl_add_u32 v31, v4, 3, v5
    v_mul_u32_u24 v31, 512, v31
    v_lshl_add_u32 v31, v30, 3, v31
    v_add_u32 v31, 16384, v31
    v_and_b32 v30, 1, v4
    v_lshl_or_b32 v5, v30, 2, v5
    v_xor_b32 v30, 0, v5
    v_lshl_add_u32 v15, v30, 5, v31
    v_xor_b32 v30, 1, v5
    v_lshl_add_u32 v16, v30, 5, v31
    v_xor_b32 v30, 2, v5
    v_lshl_add_u32 v17, v30, 5, v31
    v_xor_b32 v30, 3, v5
    v_lshl_add_u32 v18, v30, 5, v31
    v_xor_b32 v30, 4, v5
    v_lshl_add_u32 v19, v30, 5, v31
    v_xor_b32 v30, 5, v5
    v_lshl_add_u32 v20, v30, 5, v31
    v_xor_b32 v30, 6, v5
    v_lshl_add_u32 v21, v30, 5, v31
    v_xor_b32 v30, 7, v5
    v_lshl_add_u32 v22, v30, 5, v31
    s_mul_i32 s53, s46, 256
    v_add_u32 v15, s53, v15
    v_add_u32 v16, s53, v16
    v_add_u32 v17, s53, v17
    v_add_u32 v18, s53, v18
    v_add_u32 v19, s53, v19
    v_add_u32 v20, s53, v20
    v_add_u32 v21, s53, v21
    v_add_u32 v22, s53, v22
    v_accvgpr_write_b32 a0, 0
    v_accvgpr_write_b32 a1, 0
    v_accvgpr_write_b32 a2, 0
    v_accvgpr_write_b32 a3, 0
    v_accvgpr_write_b32 a4, 0
    v_accvgpr_write_b32 a5, 0
    v_accvgpr_write_b32 a6, 0
    v_accvgpr_write_b32 a7, 0
    v_accvgpr_write_b32 a8, 0
    v_accvgpr_write_b32 a9, 0
    v_accvgpr_write_b32 a10, 0
    v_accvgpr_write_b32 a11, 0
    v_accvgpr_write_b32 a12, 0
    v_accvgpr_write_b32 a13, 0
    v_accvgpr_write_b32 a14, 0
    v_accvgpr_write_b32 a15, 0
    v_accvgpr_write_b32 a16, 0
    v_accvgpr_write_b32 a17, 0
    v_accvgpr_write_b32 a18, 0
    v_accvgpr_write_b32 a19, 0
    v_accvgpr_write_b32 a20, 0
    v_accvgpr_write_b32 a21, 0
    v_accvgpr_write_b32 a22, 0
    v_accvgpr_write_b32 a23, 0
    v_accvgpr_write_b32 a24, 0
    v_accvgpr_write_b32 a25, 0
    v_accvgpr_write_b32 a26, 0
    v_accvgpr_write_b32 a27, 0
    v_accvgpr_write_b32 a28, 0
    v_accvgpr_write_b32 a29, 0
    v_accvgpr_write_b32 a30, 0
    v_accvgpr_write_b32 a31, 0
    v_accvgpr_write_b32 a32, 0
    v_accvgpr_write_b32 a33, 0
    v_accvgpr_write_b32 a34, 0
    v_accvgpr_write_b32 a35, 0
    v_accvgpr_write_b32 a36, 0
    v_accvgpr_write_b32 a37, 0
    v_accvgpr_write_b32 a38, 0
    v_accvgpr_write_b32 a39, 0
    v_accvgpr_write_b32 a40, 0
    v_accvgpr_write_b32 a41, 0
    v_accvgpr_write_b32 a42, 0
    v_accvgpr_write_b32 a43, 0
    v_accvgpr_write_b32 a44, 0
    v_accvgpr_write_b32 a45, 0
    v_accvgpr_write_b32 a46, 0
    v_accvgpr_write_b32 a47, 0
    v_accvgpr_write_b32 a48, 0
    v_accvgpr_write_b32 a49, 0
    v_accvgpr_write_b32 a50, 0
    v_accvgpr_write_b32 a51, 0
    v_accvgpr_write_b32 a52, 0
    v_accvgpr_write_b32 a53, 0
    v_accvgpr_write_b32 a54, 0
    v_accvgpr_write_b32 a55, 0
    v_accvgpr_write_b32 a56, 0
    v_accvgpr_write_b32 a57, 0
    v_accvgpr_write_b32 a58, 0
    v_accvgpr_write_b32 a59, 0
    v_accvgpr_write_b32 a60, 0
    v_accvgpr_write_b32 a61, 0
    v_accvgpr_write_b32 a62, 0
    v_accvgpr_write_b32 a63, 0
    v_accvgpr_write_b32 a64, 0
    v_accvgpr_write_b32 a65, 0
    v_accvgpr_write_b32 a66, 0
    v_accvgpr_write_b32 a67, 0
    v_accvgpr_write_b32 a68, 0
    v_accvgpr_write_b32 a69, 0
    v_accvgpr_write_b32 a70, 0
    v_accvgpr_write_b32 a71, 0
    v_accvgpr_write_b32 a72, 0
    v_accvgpr_write_b32 a73, 0
    v_accvgpr_write_b32 a74, 0
    v_accvgpr_write_b32 a75, 0
    v_accvgpr_write_b32 a76, 0
    v_accvgpr_write_b32 a77, 0
    v_accvgpr_write_b32 a78, 0
    v_accvgpr_write_b32 a79, 0
    v_accvgpr_write_b32 a80, 0
    v_accvgpr_write_b32 a81, 0
    v_accvgpr_write_b32 a82, 0
    v_accvgpr_write_b32 a83, 0
    v_accvgpr_write_b32 a84, 0
    v_accvgpr_write_b32 a85, 0
    v_accvgpr_write_b32 a86, 0
    v_accvgpr_write_b32 a87, 0
    v_accvgpr_write_b32 a88, 0
    v_accvgpr_write_b32 a89, 0
    v_accvgpr_write_b32 a90, 0
    v_accvgpr_write_b32 a91, 0
    v_accvgpr_write_b32 a92, 0
    v_accvgpr_write_b32 a93, 0
    v_accvgpr_write_b32 a94, 0
    v_accvgpr_write_b32 a95, 0
    v_accvgpr_write_b32 a96, 0
    v_accvgpr_write_b32 a97, 0
    v_accvgpr_write_b32 a98, 0
    v_accvgpr_write_b32 a99, 0
    v_accvgpr_write_b32 a100, 0
    v_accvgpr_write_b32 a101, 0
    v_accvgpr_write_b32 a102, 0
    v_accvgpr_write_b32 a103, 0
    v_accvgpr_write_b32 a104, 0
    v_accvgpr_write_b32 a105, 0
    v_accvgpr_write_b32 a106, 0
    v_accvgpr_write_b32 a107, 0
    v_accvgpr_write_b32 a108, 0
    v_accvgpr_write_b32 a109, 0
    v_accvgpr_write_b32 a110, 0
    v_accvgpr_write_b32 a111, 0
    v_accvgpr_write_b32 a112, 0
    v_accvgpr_write_b32 a113, 0
    v_accvgpr_write_b32 a114, 0
    v_accvgpr_write_b32 a115, 0
    v_accvgpr_write_b32 a116, 0
    v_accvgpr_write_b32 a117, 0
    v_accvgpr_write_b32 a118, 0
    v_accvgpr_write_b32 a119, 0
    v_accvgpr_write_b32 a120, 0
    v_accvgpr_write_b32 a121, 0
    v_accvgpr_write_b32 a122, 0
    v_accvgpr_write_b32 a123, 0
    v_accvgpr_write_b32 a124, 0
    v_accvgpr_write_b32 a125, 0
    v_accvgpr_write_b32 a126, 0
    v_accvgpr_write_b32 a127, 0
    v_accvgpr_write_b32 a128, 0
    v_accvgpr_write_b32 a129, 0
    v_accvgpr_write_b32 a130, 0
    v_accvgpr_write_b32 a131, 0
    v_accvgpr_write_b32 a132, 0
    v_accvgpr_write_b32 a133, 0
    v_accvgpr_write_b32 a134, 0
    v_accvgpr_write_b32 a135, 0
    v_accvgpr_write_b32 a136, 0
    v_accvgpr_write_b32 a137, 0
    v_accvgpr_write_b32 a138, 0
    v_accvgpr_write_b32 a139, 0
    v_accvgpr_write_b32 a140, 0
    v_accvgpr_write_b32 a141, 0
    v_accvgpr_write_b32 a142, 0
    v_accvgpr_write_b32 a143, 0
    v_accvgpr_write_b32 a144, 0
    v_accvgpr_write_b32 a145, 0
    v_accvgpr_write_b32 a146, 0
    v_accvgpr_write_b32 a147, 0
    v_accvgpr_write_b32 a148, 0
    v_accvgpr_write_b32 a149, 0
    v_accvgpr_write_b32 a150, 0
    v_accvgpr_write_b32 a151, 0
    v_accvgpr_write_b32 a152, 0
    v_accvgpr_write_b32 a153, 0
    v_accvgpr_write_b32 a154, 0
    v_accvgpr_write_b32 a155, 0
    v_accvgpr_write_b32 a156, 0
    v_accvgpr_write_b32 a157, 0
    v_accvgpr_write_b32 a158, 0
    v_accvgpr_write_b32 a159, 0
    v_accvgpr_write_b32 a160, 0
    v_accvgpr_write_b32 a161, 0
    v_accvgpr_write_b32 a162, 0
    v_accvgpr_write_b32 a163, 0
    v_accvgpr_write_b32 a164, 0
    v_accvgpr_write_b32 a165, 0
    v_accvgpr_write_b32 a166, 0
    v_accvgpr_write_b32 a167, 0
    v_accvgpr_write_b32 a168, 0
    v_accvgpr_write_b32 a169, 0
    v_accvgpr_write_b32 a170, 0
    v_accvgpr_write_b32 a171, 0
    v_accvgpr_write_b32 a172, 0
    v_accvgpr_write_b32 a173, 0
    v_accvgpr_write_b32 a174, 0
    v_accvgpr_write_b32 a175, 0
    v_accvgpr_write_b32 a176, 0
    v_accvgpr_write_b32 a177, 0
    v_accvgpr_write_b32 a178, 0
    v_accvgpr_write_b32 a179, 0
    v_accvgpr_write_b32 a180, 0
    v_accvgpr_write_b32 a181, 0
    v_accvgpr_write_b32 a182, 0
    v_accvgpr_write_b32 a183, 0
    v_accvgpr_write_b32 a184, 0
    v_accvgpr_write_b32 a185, 0
    v_accvgpr_write_b32 a186, 0
    v_accvgpr_write_b32 a187, 0
    v_accvgpr_write_b32 a188, 0
    v_accvgpr_write_b32 a189, 0
    v_accvgpr_write_b32 a190, 0
    v_accvgpr_write_b32 a191, 0
    v_accvgpr_write_b32 a192, 0
    v_accvgpr_write_b32 a193, 0
    v_accvgpr_write_b32 a194, 0
    v_accvgpr_write_b32 a195, 0
    v_accvgpr_write_b32 a196, 0
    v_accvgpr_write_b32 a197, 0
    v_accvgpr_write_b32 a198, 0
    v_accvgpr_write_b32 a199, 0
    v_accvgpr_write_b32 a200, 0
    v_accvgpr_write_b32 a201, 0
    v_accvgpr_write_b32 a202, 0
    v_accvgpr_write_b32 a203, 0
    v_accvgpr_write_b32 a204, 0
    v_accvgpr_write_b32 a205, 0
    v_accvgpr_write_b32 a206, 0
    v_accvgpr_write_b32 a207, 0
    v_accvgpr_write_b32 a208, 0
    v_accvgpr_write_b32 a209, 0
    v_accvgpr_write_b32 a210, 0
    v_accvgpr_write_b32 a211, 0
    v_accvgpr_write_b32 a212, 0
    v_accvgpr_write_b32 a213, 0
    v_accvgpr_write_b32 a214, 0
    v_accvgpr_write_b32 a215, 0
    v_accvgpr_write_b32 a216, 0
    v_accvgpr_write_b32 a217, 0
    v_accvgpr_write_b32 a218, 0
    v_accvgpr_write_b32 a219, 0
    v_accvgpr_write_b32 a220, 0
    v_accvgpr_write_b32 a221, 0
    v_accvgpr_write_b32 a222, 0
    v_accvgpr_write_b32 a223, 0
    v_accvgpr_write_b32 a224, 0
    v_accvgpr_write_b32 a225, 0
    v_accvgpr_write_b32 a226, 0
    v_accvgpr_write_b32 a227, 0
    v_accvgpr_write_b32 a228, 0
    v_accvgpr_write_b32 a229, 0
    v_accvgpr_write_b32 a230, 0
    v_accvgpr_write_b32 a231, 0
    v_accvgpr_write_b32 a232, 0
    v_accvgpr_write_b32 a233, 0
    v_accvgpr_write_b32 a234, 0
    v_accvgpr_write_b32 a235, 0
    v_accvgpr_write_b32 a236, 0
    v_accvgpr_write_b32 a237, 0
    v_accvgpr_write_b32 a238, 0
    v_accvgpr_write_b32 a239, 0
    v_accvgpr_write_b32 a240, 0
    v_accvgpr_write_b32 a241, 0
    v_accvgpr_write_b32 a242, 0
    v_accvgpr_write_b32 a243, 0
    v_accvgpr_write_b32 a244, 0
    v_accvgpr_write_b32 a245, 0
    v_accvgpr_write_b32 a246, 0
    v_accvgpr_write_b32 a247, 0
    v_accvgpr_write_b32 a248, 0
    v_accvgpr_write_b32 a249, 0
    v_accvgpr_write_b32 a250, 0
    v_accvgpr_write_b32 a251, 0
    v_accvgpr_write_b32 a252, 0
    v_accvgpr_write_b32 a253, 0
    v_accvgpr_write_b32 a254, 0
    v_accvgpr_write_b32 a255, 0
    s_mul_i32 s56, s42, 0
    s_mul_i32 s57, s42, 0
    s_mov_b32 s58, 0
    s_mov_b32 s59, 0
    s_mul_i32 s63, s44, 4096
    s_mul_i32 s64, s44, 4096
    s_add_u32 s64, s64, 16384
    s_add_u32 s65, s58, s63
    s_add_u32 m0, s65, 0
    s_nop 0
    buffer_load_dwordx4 v6, s[12:15], s56 offen lds
    s_add_u32 s65, s58, s63
    s_add_u32 m0, s65, 1024
    s_nop 0
    buffer_load_dwordx4 v7, s[12:15], s56 offen lds
    s_add_u32 s65, s58, s63
    s_add_u32 m0, s65, 2048
    s_nop 0
    buffer_load_dwordx4 v8, s[12:15], s56 offen lds
    s_add_u32 s65, s58, s63
    s_add_u32 m0, s65, 3072
    s_nop 0
    buffer_load_dwordx4 v9, s[12:15], s56 offen lds
    s_add_u32 s65, s58, s64
    s_add_u32 m0, s65, 0
    s_nop 0
    buffer_load_dwordx4 v10, s[16:19], s57 offen lds
    s_add_u32 s65, s58, s64
    s_add_u32 m0, s65, 1024
    s_nop 0
    buffer_load_dwordx4 v11, s[16:19], s57 offen lds
    s_add_u32 s65, s58, s64
    s_add_u32 m0, s65, 2048
    s_nop 0
    buffer_load_dwordx4 v12, s[16:19], s57 offen lds
    s_add_u32 s65, s58, s64
    s_add_u32 m0, s65, 3072
    s_nop 0
    buffer_load_dwordx4 v13, s[16:19], s57 offen lds
    s_add_u32 s56, s56, 64
    s_add_u32 s57, s57, 393216
    s_add_u32 s58, s58, 32768
    s_cmp_ge_u32 s58, 98304
    s_cselect_b32 s58, 0, s58
    s_add_u32 s65, s58, s63
    s_add_u32 m0, s65, 0
    s_nop 0
    buffer_load_dwordx4 v6, s[12:15], s56 offen lds
    s_add_u32 s65, s58, s63
    s_add_u32 m0, s65, 1024
    s_nop 0
    buffer_load_dwordx4 v7, s[12:15], s56 offen lds
    s_add_u32 s65, s58, s63
    s_add_u32 m0, s65, 2048
    s_nop 0
    buffer_load_dwordx4 v8, s[12:15], s56 offen lds
    s_add_u32 s65, s58, s63
    s_add_u32 m0, s65, 3072
    s_nop 0
    buffer_load_dwordx4 v9, s[12:15], s56 offen lds
    s_add_u32 s65, s58, s64
    s_add_u32 m0, s65, 0
    s_nop 0
    buffer_load_dwordx4 v10, s[16:19], s57 offen lds
    s_add_u32 s65, s58, s64
    s_add_u32 m0, s65, 1024
    s_nop 0
    buffer_load_dwordx4 v11, s[16:19], s57 offen lds
    s_add_u32 s65, s58, s64
    s_add_u32 m0, s65, 2048
    s_nop 0
    buffer_load_dwordx4 v12, s[16:19], s57 offen lds
    s_add_u32 s65, s58, s64
    s_add_u32 m0, s65, 3072
    s_nop 0
    buffer_load_dwordx4 v13, s[16:19], s57 offen lds
    s_add_u32 s56, s56, 64
    s_add_u32 s57, s57, 393216
    s_add_u32 s58, s58, 32768
    s_cmp_ge_u32 s58, 98304
    s_cselect_b32 s58, 0, s58
    s_mov_b32 s62, 18
L_wk_loop:
    s_waitcnt vmcnt(8)
    s_barrier
    s_add_u32 s65, s58, s63
    s_add_u32 m0, s65, 0
    s_nop 0
    buffer_load_dwordx4 v6, s[12:15], s56 offen lds
    s_add_u32 s65, s58, s63
    s_add_u32 m0, s65, 1024
    s_nop 0
    buffer_load_dwordx4 v7, s[12:15], s56 offen lds
    s_add_u32 s65, s58, s63
    s_add_u32 m0, s65, 2048
    s_nop 0
    buffer_load_dwordx4 v8, s[12:15], s56 offen lds
    s_add_u32 s65, s58, s63
    s_add_u32 m0, s65, 3072
    s_nop 0
    buffer_load_dwordx4 v9, s[12:15], s56 offen lds
    s_add_u32 s65, s58, s64
    s_add_u32 m0, s65, 0
    s_nop 0
    buffer_load_dwordx4 v10, s[16:19], s57 offen lds
    s_add_u32 s65, s58, s64
    s_add_u32 m0, s65, 1024
    s_nop 0
    buffer_load_dwordx4 v11, s[16:19], s57 offen lds
    s_add_u32 s65, s58, s64
    s_add_u32 m0, s65, 2048
    s_nop 0
    buffer_load_dwordx4 v12, s[16:19], s57 offen lds
    s_add_u32 s65, s58, s64
    s_add_u32 m0, s65, 3072
    s_nop 0
    buffer_load_dwordx4 v13, s[16:19], s57 offen lds
    s_add_u32 s56, s56, 64
    s_add_u32 s57, s57, 393216
    s_add_u32 s58, s58, 32768
    s_cmp_ge_u32 s58, 98304
    s_cselect_b32 s58, 0, s58
    v_add_u32 v23, s59, v14
    v_add_u32 v24, s59, v15
    v_add_u32 v25, s59, v16
    v_add_u32 v26, s59, v17
    v_add_u32 v27, s59, v18
    v_add_u32 v28, s59, v19
    v_add_u32 v29, s59, v20
    v_add_u32 v30, s59, v21
    v_add_u32 v31, s59, v22
    ds_read_b128 v[32:35], v23 offset:0
    ds_read_b64_tr_b16 v[64:65], v24 offset:0
    ds_read_b64_tr_b16 v[66:67], v24 offset:2048
    ds_read_b64_tr_b16 v[68:69], v25 offset:0
    ds_read_b64_tr_b16 v[70:71], v25 offset:2048
    ds_read_b64_tr_b16 v[72:73], v26 offset:0
    ds_read_b64_tr_b16 v[74:75], v26 offset:2048
    ds_read_b64_tr_b16 v[76:77], v27 offset:0
    ds_read_b64_tr_b16 v[78:79], v27 offset:2048
    ds_read_b64_tr_b16 v[80:81], v28 offset:0
    s_waitcnt lgkmcnt(7)
    v_mfma_f32_16x16x32_bf16 a[0:3], v[64:67], v[32:35], a[0:3]
    ds_read_b64_tr_b16 v[82:83], v28 offset:2048
    ds_read_b64_tr_b16 v[84:85], v29 offset:0
    ds_read_b64_tr_b16 v[86:87], v29 offset:2048
    s_waitcnt lgkmcnt(8)
    v_mfma_f32_16x16x32_bf16 a[4:7], v[68:71], v[32:35], a[4:7]
    ds_read_b64_tr_b16 v[88:89], v30 offset:0
    ds_read_b64_tr_b16 v[90:91], v30 offset:2048
    s_waitcnt lgkmcnt(8)
    v_mfma_f32_16x16x32_bf16 a[8:11], v[72:75], v[32:35], a[8:11]
    ds_read_b64_tr_b16 v[92:93], v31 offset:0
    ds_read_b64_tr_b16 v[94:95], v31 offset:2048
    s_waitcnt lgkmcnt(8)
    v_mfma_f32_16x16x32_bf16 a[12:15], v[76:79], v[32:35], a[12:15]
    ds_read_b128 v[36:39], v23 offset:1024
    ds_read_b128 v[40:43], v23 offset:2048
    s_waitcnt lgkmcnt(8)
    v_mfma_f32_16x16x32_bf16 a[16:19], v[80:83], v[32:35], a[16:19]
    ds_read_b128 v[44:47], v23 offset:3072
    ds_read_b128 v[48:51], v23 offset:4096
    s_waitcnt lgkmcnt(8)
    v_mfma_f32_16x16x32_bf16 a[20:23], v[84:87], v[32:35], a[20:23]
    ds_read_b128 v[52:55], v23 offset:5120
    ds_read_b128 v[56:59], v23 offset:6144
    s_waitcnt lgkmcnt(8)
    v_mfma_f32_16x16x32_bf16 a[24:27], v[88:91], v[32:35], a[24:27]
    ds_read_b128 v[60:63], v23 offset:7168
    s_waitcnt lgkmcnt(7)
    v_mfma_f32_16x16x32_bf16 a[28:31], v[92:95], v[32:35], a[28:31]
    s_waitcnt lgkmcnt(6)
    v_mfma_f32_16x16x32_bf16 a[32:35], v[64:67], v[36:39], a[32:35]
    v_mfma_f32_16x16x32_bf16 a[36:39], v[68:71], v[36:39], a[36:39]
    v_mfma_f32_16x16x32_bf16 a[40:43], v[72:75], v[36:39], a[40:43]
    v_mfma_f32_16x16x32_bf16 a[44:47], v[76:79], v[36:39], a[44:47]
    v_mfma_f32_16x16x32_bf16 a[48:51], v[80:83], v[36:39], a[48:51]
    v_mfma_f32_16x16x32_bf16 a[52:55], v[84:87], v[36:39], a[52:55]
    v_mfma_f32_16x16x32_bf16 a[56:59], v[88:91], v[36:39], a[56:59]
    v_mfma_f32_16x16x32_bf16 a[60:63], v[92:95], v[36:39], a[60:63]
    s_waitcnt lgkmcnt(5)
    v_mfma_f32_16x16x32_bf16 a[64:67], v[64:67], v[40:43], a[64:67]
    v_mfma_f32_16x16x32_bf16 a[68:71], v[68:71], v[40:43], a[68:71]
    v_mfma_f32_16x16x32_bf16 a[72:75], v[72:75], v[40:43], a[72:75]
    v_mfma_f32_16x16x32_bf16 a[76:79], v[76:79], v[40:43], a[76:79]
    v_mfma_f32_16x16x32_bf16 a[80:83], v[80:83], v[40:43], a[80:83]
    v_mfma_f32_16x16x32_bf16 a[84:87], v[84:87], v[40:43], a[84:87]
    v_mfma_f32_16x16x32_bf16 a[88:91], v[88:91], v[40:43], a[88:91]
    v_mfma_f32_16x16x32_bf16 a[92:95], v[92:95], v[40:43], a[92:95]
    s_waitcnt lgkmcnt(4)
    v_mfma_f32_16x16x32_bf16 a[96:99], v[64:67], v[44:47], a[96:99]
    v_mfma_f32_16x16x32_bf16 a[100:103], v[68:71], v[44:47], a[100:103]
    v_mfma_f32_16x16x32_bf16 a[104:107], v[72:75], v[44:47], a[104:107]
    v_mfma_f32_16x16x32_bf16 a[108:111], v[76:79], v[44:47], a[108:111]
    v_mfma_f32_16x16x32_bf16 a[112:115], v[80:83], v[44:47], a[112:115]
    v_mfma_f32_16x16x32_bf16 a[116:119], v[84:87], v[44:47], a[116:119]
    v_mfma_f32_16x16x32_bf16 a[120:123], v[88:91], v[44:47], a[120:123]
    v_mfma_f32_16x16x32_bf16 a[124:127], v[92:95], v[44:47], a[124:127]
    s_waitcnt lgkmcnt(3)
    v_mfma_f32_16x16x32_bf16 a[128:131], v[64:67], v[48:51], a[128:131]
    v_mfma_f32_16x16x32_bf16 a[132:135], v[68:71], v[48:51], a[132:135]
    v_mfma_f32_16x16x32_bf16 a[136:139], v[72:75], v[48:51], a[136:139]
    v_mfma_f32_16x16x32_bf16 a[140:143], v[76:79], v[48:51], a[140:143]
    v_mfma_f32_16x16x32_bf16 a[144:147], v[80:83], v[48:51], a[144:147]
    v_mfma_f32_16x16x32_bf16 a[148:151], v[84:87], v[48:51], a[148:151]
    v_mfma_f32_16x16x32_bf16 a[152:155], v[88:91], v[48:51], a[152:155]
    v_mfma_f32_16x16x32_bf16 a[156:159], v[92:95], v[48:51], a[156:159]
    s_waitcnt lgkmcnt(2)
    v_mfma_f32_16x16x32_bf16 a[160:163], v[64:67], v[52:55], a[160:163]
    v_mfma_f32_16x16x32_bf16 a[164:167], v[68:71], v[52:55], a[164:167]
    v_mfma_f32_16x16x32_bf16 a[168:171], v[72:75], v[52:55], a[168:171]
    v_mfma_f32_16x16x32_bf16 a[172:175], v[76:79], v[52:55], a[172:175]
    v_mfma_f32_16x16x32_bf16 a[176:179], v[80:83], v[52:55], a[176:179]
    v_mfma_f32_16x16x32_bf16 a[180:183], v[84:87], v[52:55], a[180:183]
    v_mfma_f32_16x16x32_bf16 a[184:187], v[88:91], v[52:55], a[184:187]
    v_mfma_f32_16x16x32_bf16 a[188:191], v[92:95], v[52:55], a[188:191]
    s_waitcnt lgkmcnt(1)
    v_mfma_f32_16x16x32_bf16 a[192:195], v[64:67], v[56:59], a[192:195]
    v_mfma_f32_16x16x32_bf16 a[196:199], v[68:71], v[56:59], a[196:199]
    v_mfma_f32_16x16x32_bf16 a[200:203], v[72:75], v[56:59], a[200:203]
    v_mfma_f32_16x16x32_bf16 a[204:207], v[76:79], v[56:59], a[204:207]
    v_mfma_f32_16x16x32_bf16 a[208:211], v[80:83], v[56:59], a[208:211]
    v_mfma_f32_16x16x32_bf16 a[212:215], v[84:87], v[56:59], a[212:215]
    v_mfma_f32_16x16x32_bf16 a[216:219], v[88:91], v[56:59], a[216:219]
    v_mfma_f32_16x16x32_bf16 a[220:223], v[92:95], v[56:59], a[220:223]
    s_waitcnt lgkmcnt(0)
    v_mfma_f32_16x16x32_bf16 a[224:227], v[64:67], v[60:63], a[224:227]
    v_mfma_f32_16x16x32_bf16 a[228:231], v[68:71], v[60:63], a[228:231]
    v_mfma_f32_16x16x32_bf16 a[232:235], v[72:75], v[60:63], a[232:235]
    v_mfma_f32_16x16x32_bf16 a[236:239], v[76:79], v[60:63], a[236:239]
    v_mfma_f32_16x16x32_bf16 a[240:243], v[80:83], v[60:63], a[240:243]
    v_mfma_f32_16x16x32_bf16 a[244:247], v[84:87], v[60:63], a[244:247]
    v_mfma_f32_16x16x32_bf16 a[248:251], v[88:91], v[60:63], a[248:251]
    v_mfma_f32_16x16x32_bf16 a[252:255], v[92:95], v[60:63], a[252:255]
    s_add_u32 s59, s59, 32768
    s_cmp_ge_u32 s59, 98304
    s_cselect_b32 s59, 0, s59
    s_sub_u32 s62, s62, 1
    s_cmp_lg_u32 s62, 0
    s_cbranch_scc1 L_wk_loop
    s_waitcnt vmcnt(8)
    s_barrier
    v_add_u32 v23, s59, v14
    v_add_u32 v24, s59, v15
    v_add_u32 v25, s59, v16
    v_add_u32 v26, s59, v17
    v_add_u32 v27, s59, v18
    v_add_u32 v28, s59, v19
    v_add_u32 v29, s59, v20
    v_add_u32 v30, s59, v21
    v_add_u32 v31, s59, v22
    ds_read_b128 v[32:35], v23 offset:0
    ds_read_b64_tr_b16 v[64:65], v24 offset:0
    ds_read_b64_tr_b16 v[66:67], v24 offset:2048
    ds_read_b64_tr_b16 v[68:69], v25 offset:0
    ds_read_b64_tr_b16 v[70:71], v25 offset:2048
    ds_read_b64_tr_b16 v[72:73], v26 offset:0
    ds_read_b64_tr_b16 v[74:75], v26 offset:2048
    ds_read_b64_tr_b16 v[76:77], v27 offset:0
    ds_read_b64_tr_b16 v[78:79], v27 offset:2048
    ds_read_b64_tr_b16 v[80:81], v28 offset:0
    s_waitcnt lgkmcnt(7)
    v_mfma_f32_16x16x32_bf16 a[0:3], v[64:67], v[32:35], a[0:3]
    ds_read_b64_tr_b16 v[82:83], v28 offset:2048
    ds_read_b64_tr_b16 v[84:85], v29 offset:0
    ds_read_b64_tr_b16 v[86:87], v29 offset:2048
    s_waitcnt lgkmcnt(8)
    v_mfma_f32_16x16x32_bf16 a[4:7], v[68:71], v[32:35], a[4:7]
    ds_read_b64_tr_b16 v[88:89], v30 offset:0
    ds_read_b64_tr_b16 v[90:91], v30 offset:2048
    s_waitcnt lgkmcnt(8)
    v_mfma_f32_16x16x32_bf16 a[8:11], v[72:75], v[32:35], a[8:11]
    ds_read_b64_tr_b16 v[92:93], v31 offset:0
    ds_read_b64_tr_b16 v[94:95], v31 offset:2048
    s_waitcnt lgkmcnt(8)
    v_mfma_f32_16x16x32_bf16 a[12:15], v[76:79], v[32:35], a[12:15]
    ds_read_b128 v[36:39], v23 offset:1024
    ds_read_b128 v[40:43], v23 offset:2048
    s_waitcnt lgkmcnt(8)
    v_mfma_f32_16x16x32_bf16 a[16:19], v[80:83], v[32:35], a[16:19]
    ds_read_b128 v[44:47], v23 offset:3072
    ds_read_b128 v[48:51], v23 offset:4096
    s_waitcnt lgkmcnt(8)
    v_mfma_f32_16x16x32_bf16 a[20:23], v[84:87], v[32:35], a[20:23]
    ds_read_b128 v[52:55], v23 offset:5120
    ds_read_b128 v[56:59], v23 offset:6144
    s_waitcnt lgkmcnt(8)
    v_mfma_f32_16x16x32_bf16 a[24:27], v[88:91], v[32:35], a[24:27]
    ds_read_b128 v[60:63], v23 offset:7168
    s_waitcnt lgkmcnt(7)
    v_mfma_f32_16x16x32_bf16 a[28:31], v[92:95], v[32:35], a[28:31]
    s_waitcnt lgkmcnt(6)
    v_mfma_f32_16x16x32_bf16 a[32:35], v[64:67], v[36:39], a[32:35]
    v_mfma_f32_16x16x32_bf16 a[36:39], v[68:71], v[36:39], a[36:39]
    v_mfma_f32_16x16x32_bf16 a[40:43], v[72:75], v[36:39], a[40:43]
    v_mfma_f32_16x16x32_bf16 a[44:47], v[76:79], v[36:39], a[44:47]
    v_mfma_f32_16x16x32_bf16 a[48:51], v[80:83], v[36:39], a[48:51]
    v_mfma_f32_16x16x32_bf16 a[52:55], v[84:87], v[36:39], a[52:55]
    v_mfma_f32_16x16x32_bf16 a[56:59], v[88:91], v[36:39], a[56:59]
    v_mfma_f32_16x16x32_bf16 a[60:63], v[92:95], v[36:39], a[60:63]
    s_waitcnt lgkmcnt(5)
    v_mfma_f32_16x16x32_bf16 a[64:67], v[64:67], v[40:43], a[64:67]
    v_mfma_f32_16x16x32_bf16 a[68:71], v[68:71], v[40:43], a[68:71]
    v_mfma_f32_16x16x32_bf16 a[72:75], v[72:75], v[40:43], a[72:75]
    v_mfma_f32_16x16x32_bf16 a[76:79], v[76:79], v[40:43], a[76:79]
    v_mfma_f32_16x16x32_bf16 a[80:83], v[80:83], v[40:43], a[80:83]
    v_mfma_f32_16x16x32_bf16 a[84:87], v[84:87], v[40:43], a[84:87]
    v_mfma_f32_16x16x32_bf16 a[88:91], v[88:91], v[40:43], a[88:91]
    v_mfma_f32_16x16x32_bf16 a[92:95], v[92:95], v[40:43], a[92:95]
    s_waitcnt lgkmcnt(4)
    v_mfma_f32_16x16x32_bf16 a[96:99], v[64:67], v[44:47], a[96:99]
    v_mfma_f32_16x16x32_bf16 a[100:103], v[68:71], v[44:47], a[100:103]
    v_mfma_f32_16x16x32_bf16 a[104:107], v[72:75], v[44:47], a[104:107]
    v_mfma_f32_16x16x32_bf16 a[108:111], v[76:79], v[44:47], a[108:111]
    v_mfma_f32_16x16x32_bf16 a[112:115], v[80:83], v[44:47], a[112:115]
    v_mfma_f32_16x16x32_bf16 a[116:119], v[84:87], v[44:47], a[116:119]
    v_mfma_f32_16x16x32_bf16 a[120:123], v[88:91], v[44:47], a[120:123]
    v_mfma_f32_16x16x32_bf16 a[124:127], v[92:95], v[44:47], a[124:127]
    s_waitcnt lgkmcnt(3)
    v_mfma_f32_16x16x32_bf16 a[128:131], v[64:67], v[48:51], a[128:131]
    v_mfma_f32_16x16x32_bf16 a[132:135], v[68:71], v[48:51], a[132:135]
    v_mfma_f32_16x16x32_bf16 a[136:139], v[72:75], v[48:51], a[136:139]
    v_mfma_f32_16x16x32_bf16 a[140:143], v[76:79], v[48:51], a[140:143]
    v_mfma_f32_16x16x32_bf16 a[144:147], v[80:83], v[48:51], a[144:147]
    v_mfma_f32_16x16x32_bf16 a[148:151], v[84:87], v[48:51], a[148:151]
    v_mfma_f32_16x16x32_bf16 a[152:155], v[88:91], v[48:51], a[152:155]
    v_mfma_f32_16x16x32_bf16 a[156:159], v[92:95], v[48:51], a[156:159]
    s_waitcnt lgkmcnt(2)
    v_mfma_f32_16x16x32_bf16 a[160:163], v[64:67], v[52:55], a[160:163]
    v_mfma_f32_16x16x32_bf16 a[164:167], v[68:71], v[52:55], a[164:167]
    v_mfma_f32_16x16x32_bf16 a[168:171], v[72:75], v[52:55], a[168:171]
    v_mfma_f32_16x16x32_bf16 a[172:175], v[76:79], v[52:55], a[172:175]
    v_mfma_f32_16x16x32_bf16 a[176:179], v[80:83], v[52:55], a[176:179]
    v_mfma_f32_16x16x32_bf16 a[180:183], v[84:87], v[52:55], a[180:183]
    v_mfma_f32_16x16x32_bf16 a[184:187], v[88:91], v[52:55], a[184:187]
    v_mfma_f32_16x16x32_bf16 a[188:191], v[92:95], v[52:55], a[188:191]
    s_waitcnt lgkmcnt(1)
    v_mfma_f32_16x16x32_bf16 a[192:195], v[64:67], v[56:59], a[192:195]
    v_mfma_f32_16x16x32_bf16 a[196:199], v[68:71], v[56:59], a[196:199]
    v_mfma_f32_16x16x32_bf16 a[200:203], v[72:75], v[56:59], a[200:203]
    v_mfma_f32_16x16x32_bf16 a[204:207], v[76:79], v[56:59], a[204:207]
    v_mfma_f32_16x16x32_bf16 a[208:211], v[80:83], v[56:59], a[208:211]
    v_mfma_f32_16x16x32_bf16 a[212:215], v[84:87], v[56:59], a[212:215]
    v_mfma_f32_16x16x32_bf16 a[216:219], v[88:91], v[56:59], a[216:219]
    v_mfma_f32_16x16x32_bf16 a[220:223], v[92:95], v[56:59], a[220:223]
    s_waitcnt lgkmcnt(0)
    v_mfma_f32_16x16x32_bf16 a[224:227], v[64:67], v[60:63], a[224:227]
    v_mfma_f32_16x16x32_bf16 a[228:231], v[68:71], v[60:63], a[228:231]
    v_mfma_f32_16x16x32_bf16 a[232:235], v[72:75], v[60:63], a[232:235]
    v_mfma_f32_16x16x32_bf16 a[236:239], v[76:79], v[60:63], a[236:239]
    v_mfma_f32_16x16x32_bf16 a[240:243], v[80:83], v[60:63], a[240:243]
    v_mfma_f32_16x16x32_bf16 a[244:247], v[84:87], v[60:63], a[244:247]
    v_mfma_f32_16x16x32_bf16 a[248:251], v[88:91], v[60:63], a[248:251]
    v_mfma_f32_16x16x32_bf16 a[252:255], v[92:95], v[60:63], a[252:255]
    s_add_u32 s59, s59, 32768
    s_cmp_ge_u32 s59, 98304
    s_cselect_b32 s59, 0, s59
    s_waitcnt vmcnt(0)
    s_barrier
    v_add_u32 v23, s59, v14
    v_add_u32 v24, s59, v15
    v_add_u32 v25, s59, v16
    v_add_u32 v26, s59, v17
    v_add_u32 v27, s59, v18
    v_add_u32 v28, s59, v19
    v_add_u32 v29, s59, v20
    v_add_u32 v30, s59, v21
    v_add_u32 v31, s59, v22
    ds_read_b128 v[32:35], v23 offset:0
    ds_read_b64_tr_b16 v[64:65], v24 offset:0
    ds_read_b64_tr_b16 v[66:67], v24 offset:2048
    ds_read_b64_tr_b16 v[68:69], v25 offset:0
    ds_read_b64_tr_b16 v[70:71], v25 offset:2048
    ds_read_b64_tr_b16 v[72:73], v26 offset:0
    ds_read_b64_tr_b16 v[74:75], v26 offset:2048
    ds_read_b64_tr_b16 v[76:77], v27 offset:0
    ds_read_b64_tr_b16 v[78:79], v27 offset:2048
    ds_read_b64_tr_b16 v[80:81], v28 offset:0
    s_waitcnt lgkmcnt(7)
    v_mfma_f32_16x16x32_bf16 a[0:3], v[64:67], v[32:35], a[0:3]
    ds_read_b64_tr_b16 v[82:83], v28 offset:2048
    ds_read_b64_tr_b16 v[84:85], v29 offset:0
    ds_read_b64_tr_b16 v[86:87], v29 offset:2048
    s_waitcnt lgkmcnt(8)
    v_mfma_f32_16x16x32_bf16 a[4:7], v[68:71], v[32:35], a[4:7]
    ds_read_b64_tr_b16 v[88:89], v30 offset:0
    ds_read_b64_tr_b16 v[90:91], v30 offset:2048
    s_waitcnt lgkmcnt(8)
    v_mfma_f32_16x16x32_bf16 a[8:11], v[72:75], v[32:35], a[8:11]
    ds_read_b64_tr_b16 v[92:93], v31 offset:0
    ds_read_b64_tr_b16 v[94:95], v31 offset:2048
    s_waitcnt lgkmcnt(8)
    v_mfma_f32_16x16x32_bf16 a[12:15], v[76:79], v[32:35], a[12:15]
    ds_read_b128 v[36:39], v23 offset:1024
    ds_read_b128 v[40:43], v23 offset:2048
    s_waitcnt lgkmcnt(8)
    v_mfma_f32_16x16x32_bf16 a[16:19], v[80:83], v[32:35], a[16:19]
    ds_read_b128 v[44:47], v23 offset:3072
    ds_read_b128 v[48:51], v23 offset:4096
    s_waitcnt lgkmcnt(8)
    v_mfma_f32_16x16x32_bf16 a[20:23], v[84:87], v[32:35], a[20:23]
    ds_read_b128 v[52:55], v23 offset:5120
    ds_read_b128 v[56:59], v23 offset:6144
    s_waitcnt lgkmcnt(8)
    v_mfma_f32_16x16x32_bf16 a[24:27], v[88:91], v[32:35], a[24:27]
    ds_read_b128 v[60:63], v23 offset:7168
    s_waitcnt lgkmcnt(7)
    v_mfma_f32_16x16x32_bf16 a[28:31], v[92:95], v[32:35], a[28:31]
    s_waitcnt lgkmcnt(6)
    v_mfma_f32_16x16x32_bf16 a[32:35], v[64:67], v[36:39], a[32:35]
    v_mfma_f32_16x16x32_bf16 a[36:39], v[68:71], v[36:39], a[36:39]
    v_mfma_f32_16x16x32_bf16 a[40:43], v[72:75], v[36:39], a[40:43]
    v_mfma_f32_16x16x32_bf16 a[44:47], v[76:79], v[36:39], a[44:47]
    v_mfma_f32_16x16x32_bf16 a[48:51], v[80:83], v[36:39], a[48:51]
    v_mfma_f32_16x16x32_bf16 a[52:55], v[84:87], v[36:39], a[52:55]
    v_mfma_f32_16x16x32_bf16 a[56:59], v[88:91], v[36:39], a[56:59]
    v_mfma_f32_16x16x32_bf16 a[60:63], v[92:95], v[36:39], a[60:63]
    s_waitcnt lgkmcnt(5)
    v_mfma_f32_16x16x32_bf16 a[64:67], v[64:67], v[40:43], a[64:67]
    v_mfma_f32_16x16x32_bf16 a[68:71], v[68:71], v[40:43], a[68:71]
    v_mfma_f32_16x16x32_bf16 a[72:75], v[72:75], v[40:43], a[72:75]
    v_mfma_f32_16x16x32_bf16 a[76:79], v[76:79], v[40:43], a[76:79]
    v_mfma_f32_16x16x32_bf16 a[80:83], v[80:83], v[40:43], a[80:83]
    v_mfma_f32_16x16x32_bf16 a[84:87], v[84:87], v[40:43], a[84:87]
    v_mfma_f32_16x16x32_bf16 a[88:91], v[88:91], v[40:43], a[88:91]
    v_mfma_f32_16x16x32_bf16 a[92:95], v[92:95], v[40:43], a[92:95]
    s_waitcnt lgkmcnt(4)
    v_mfma_f32_16x16x32_bf16 a[96:99], v[64:67], v[44:47], a[96:99]
    v_mfma_f32_16x16x32_bf16 a[100:103], v[68:71], v[44:47], a[100:103]
    v_mfma_f32_16x16x32_bf16 a[104:107], v[72:75], v[44:47], a[104:107]
    v_mfma_f32_16x16x32_bf16 a[108:111], v[76:79], v[44:47], a[108:111]
    v_mfma_f32_16x16x32_bf16 a[112:115], v[80:83], v[44:47], a[112:115]
    v_mfma_f32_16x16x32_bf16 a[116:119], v[84:87], v[44:47], a[116:119]
    v_mfma_f32_16x16x32_bf16 a[120:123], v[88:91], v[44:47], a[120:123]
    v_mfma_f32_16x16x32_bf16 a[124:127], v[92:95], v[44:47], a[124:127]
    s_waitcnt lgkmcnt(3)
    v_mfma_f32_16x16x32_bf16 a[128:131], v[64:67], v[48:51], a[128:131]
    v_mfma_f32_16x16x32_bf16 a[132:135], v[68:71], v[48:51], a[132:135]
    v_mfma_f32_16x16x32_bf16 a[136:139], v[72:75], v[48:51], a[136:139]
    v_mfma_f32_16x16x32_bf16 a[140:143], v[76:79], v[48:51], a[140:143]
    v_mfma_f32_16x16x32_bf16 a[144:147], v[80:83], v[48:51], a[144:147]
    v_mfma_f32_16x16x32_bf16 a[148:151], v[84:87], v[48:51], a[148:151]
    v_mfma_f32_16x16x32_bf16 a[152:155], v[88:91], v[48:51], a[152:155]
    v_mfma_f32_16x16x32_bf16 a[156:159], v[92:95], v[48:51], a[156:159]
    s_waitcnt lgkmcnt(2)
    v_mfma_f32_16x16x32_bf16 a[160:163], v[64:67], v[52:55], a[160:163]
    v_mfma_f32_16x16x32_bf16 a[164:167], v[68:71], v[52:55], a[164:167]
    v_mfma_f32_16x16x32_bf16 a[168:171], v[72:75], v[52:55], a[168:171]
    v_mfma_f32_16x16x32_bf16 a[172:175], v[76:79], v[52:55], a[172:175]
    v_mfma_f32_16x16x32_bf16 a[176:179], v[80:83], v[52:55], a[176:179]
    v_mfma_f32_16x16x32_bf16 a[180:183], v[84:87], v[52:55], a[180:183]
    v_mfma_f32_16x16x32_bf16 a[184:187], v[88:91], v[52:55], a[184:187]
    v_mfma_f32_16x16x32_bf16 a[188:191], v[92:95], v[52:55], a[188:191]
    s_waitcnt lgkmcnt(1)
    v_mfma_f32_16x16x32_bf16 a[192:195], v[64:67], v[56:59], a[192:195]
    v_mfma_f32_16x16x32_bf16 a[196:199], v[68:71], v[56:59], a[196:199]
    v_mfma_f32_16x16x32_bf16 a[200:203], v[72:75], v[56:59], a[200:203]
    v_mfma_f32_16x16x32_bf16 a[204:207], v[76:79], v[56:59], a[204:207]
    v_mfma_f32_16x16x32_bf16 a[208:211], v[80:83], v[56:59], a[208:211]
    v_mfma_f32_16x16x32_bf16 a[212:215], v[84:87], v[56:59], a[212:215]
    v_mfma_f32_16x16x32_bf16 a[216:219], v[88:91], v[56:59], a[216:219]
    v_mfma_f32_16x16x32_bf16 a[220:223], v[92:95], v[56:59], a[220:223]
    s_waitcnt lgkmcnt(0)
    v_mfma_f32_16x16x32_bf16 a[224:227], v[64:67], v[60:63], a[224:227]
    v_mfma_f32_16x16x32_bf16 a[228:231], v[68:71], v[60:63], a[228:231]
    v_mfma_f32_16x16x32_bf16 a[232:235], v[72:75], v[60:63], a[232:235]
    v_mfma_f32_16x16x32_bf16 a[236:239], v[76:79], v[60:63], a[236:239]
    v_mfma_f32_16x16x32_bf16 a[240:243], v[80:83], v[60:63], a[240:243]
    v_mfma_f32_16x16x32_bf16 a[244:247], v[84:87], v[60:63], a[244:247]
    v_mfma_f32_16x16x32_bf16 a[248:251], v[88:91], v[60:63], a[248:251]
    v_mfma_f32_16x16x32_bf16 a[252:255], v[92:95], v[60:63], a[252:255]
    s_add_u32 s59, s59, 32768
    s_cmp_ge_u32 s59, 98304
    s_cselect_b32 s59, 0, s59
    s_nop 7
    s_nop 7
    s_add_u32 s28, s4, 0x1a80000
    s_addc_u32 s29, s5, 0
    s_mov_b32 s30, 0x1800000
    s_mov_b32 s31, 0x20000
    v_and_b32 v3, 15, v2
    v_lshrrev_b32 v4, 4, v2
    s_mul_i32 s53, s41, 256
    s_mul_i32 s54, s45, 128
    s_add_u32 s53, s53, s54
    v_add_u32 v3, s53, v3
    s_mov_b32 s60, 12288
    v_mul_lo_u32 v3, v3, s60
    s_mul_i32 s53, s47, 256
    s_mul_i32 s54, s46, 128
    s_add_u32 s53, s53, s54
    v_lshl_add_u32 v4, v4, 2, s53
    v_lshl_add_u32 v3, v4, 1, v3
    v_accvgpr_read_b32 v48, a0
    v_accvgpr_read_b32 v49, a1
    v_accvgpr_read_b32 v50, a2
    v_accvgpr_read_b32 v51, a3
    v_cvt_pk_bf16_f32 v32, v48, v49
    v_cvt_pk_bf16_f32 v33, v50, v51
    buffer_store_dwordx2 v[32:33], v3, s[28:31], 0 offen offset:0 sc1
    v_accvgpr_read_b32 v56, a4
    v_accvgpr_read_b32 v57, a5
    v_accvgpr_read_b32 v58, a6
    v_accvgpr_read_b32 v59, a7
    v_cvt_pk_bf16_f32 v36, v56, v57
    v_cvt_pk_bf16_f32 v37, v58, v59
    buffer_store_dwordx2 v[36:37], v3, s[28:31], 0 offen offset:32 sc1
    v_accvgpr_read_b32 v48, a8
    v_accvgpr_read_b32 v49, a9
    v_accvgpr_read_b32 v50, a10
    v_accvgpr_read_b32 v51, a11
    v_cvt_pk_bf16_f32 v40, v48, v49
    v_cvt_pk_bf16_f32 v41, v50, v51
    buffer_store_dwordx2 v[40:41], v3, s[28:31], 0 offen offset:64 sc1
    v_accvgpr_read_b32 v56, a12
    v_accvgpr_read_b32 v57, a13
    v_accvgpr_read_b32 v58, a14
    v_accvgpr_read_b32 v59, a15
    v_cvt_pk_bf16_f32 v44, v56, v57
    v_cvt_pk_bf16_f32 v45, v58, v59
    buffer_store_dwordx2 v[44:45], v3, s[28:31], 0 offen offset:96 sc1
    v_accvgpr_read_b32 v48, a16
    v_accvgpr_read_b32 v49, a17
    v_accvgpr_read_b32 v50, a18
    v_accvgpr_read_b32 v51, a19
    v_cvt_pk_bf16_f32 v32, v48, v49
    v_cvt_pk_bf16_f32 v33, v50, v51
    buffer_store_dwordx2 v[32:33], v3, s[28:31], 0 offen offset:128 sc1
    v_accvgpr_read_b32 v56, a20
    v_accvgpr_read_b32 v57, a21
    v_accvgpr_read_b32 v58, a22
    v_accvgpr_read_b32 v59, a23
    v_cvt_pk_bf16_f32 v36, v56, v57
    v_cvt_pk_bf16_f32 v37, v58, v59
    buffer_store_dwordx2 v[36:37], v3, s[28:31], 0 offen offset:160 sc1
    v_accvgpr_read_b32 v48, a24
    v_accvgpr_read_b32 v49, a25
    v_accvgpr_read_b32 v50, a26
    v_accvgpr_read_b32 v51, a27
    v_cvt_pk_bf16_f32 v40, v48, v49
    v_cvt_pk_bf16_f32 v41, v50, v51
    buffer_store_dwordx2 v[40:41], v3, s[28:31], 0 offen offset:192 sc1
    v_accvgpr_read_b32 v56, a28
    v_accvgpr_read_b32 v57, a29
    v_accvgpr_read_b32 v58, a30
    v_accvgpr_read_b32 v59, a31
    v_cvt_pk_bf16_f32 v44, v56, v57
    v_cvt_pk_bf16_f32 v45, v58, v59
    buffer_store_dwordx2 v[44:45], v3, s[28:31], 0 offen offset:224 sc1
    v_add_u32 v3, 0x30000, v3
    v_accvgpr_read_b32 v48, a32
    v_accvgpr_read_b32 v49, a33
    v_accvgpr_read_b32 v50, a34
    v_accvgpr_read_b32 v51, a35
    v_cvt_pk_bf16_f32 v32, v48, v49
    v_cvt_pk_bf16_f32 v33, v50, v51
    buffer_store_dwordx2 v[32:33], v3, s[28:31], 0 offen offset:0 sc1
    v_accvgpr_read_b32 v56, a36
    v_accvgpr_read_b32 v57, a37
    v_accvgpr_read_b32 v58, a38
    v_accvgpr_read_b32 v59, a39
    v_cvt_pk_bf16_f32 v36, v56, v57
    v_cvt_pk_bf16_f32 v37, v58, v59
    buffer_store_dwordx2 v[36:37], v3, s[28:31], 0 offen offset:32 sc1
    v_accvgpr_read_b32 v48, a40
    v_accvgpr_read_b32 v49, a41
    v_accvgpr_read_b32 v50, a42
    v_accvgpr_read_b32 v51, a43
    v_cvt_pk_bf16_f32 v40, v48, v49
    v_cvt_pk_bf16_f32 v41, v50, v51
    buffer_store_dwordx2 v[40:41], v3, s[28:31], 0 offen offset:64 sc1
    v_accvgpr_read_b32 v56, a44
    v_accvgpr_read_b32 v57, a45
    v_accvgpr_read_b32 v58, a46
    v_accvgpr_read_b32 v59, a47
    v_cvt_pk_bf16_f32 v44, v56, v57
    v_cvt_pk_bf16_f32 v45, v58, v59
    buffer_store_dwordx2 v[44:45], v3, s[28:31], 0 offen offset:96 sc1
    v_accvgpr_read_b32 v48, a48
    v_accvgpr_read_b32 v49, a49
    v_accvgpr_read_b32 v50, a50
    v_accvgpr_read_b32 v51, a51
    v_cvt_pk_bf16_f32 v32, v48, v49
    v_cvt_pk_bf16_f32 v33, v50, v51
    buffer_store_dwordx2 v[32:33], v3, s[28:31], 0 offen offset:128 sc1
    v_accvgpr_read_b32 v56, a52
    v_accvgpr_read_b32 v57, a53
    v_accvgpr_read_b32 v58, a54
    v_accvgpr_read_b32 v59, a55
    v_cvt_pk_bf16_f32 v36, v56, v57
    v_cvt_pk_bf16_f32 v37, v58, v59
    buffer_store_dwordx2 v[36:37], v3, s[28:31], 0 offen offset:160 sc1
    v_accvgpr_read_b32 v48, a56
    v_accvgpr_read_b32 v49, a57
    v_accvgpr_read_b32 v50, a58
    v_accvgpr_read_b32 v51, a59
    v_cvt_pk_bf16_f32 v40, v48, v49
    v_cvt_pk_bf16_f32 v41, v50, v51
    buffer_store_dwordx2 v[40:41], v3, s[28:31], 0 offen offset:192 sc1
    v_accvgpr_read_b32 v56, a60
    v_accvgpr_read_b32 v57, a61
    v_accvgpr_read_b32 v58, a62
    v_accvgpr_read_b32 v59, a63
    v_cvt_pk_bf16_f32 v44, v56, v57
    v_cvt_pk_bf16_f32 v45, v58, v59
    buffer_store_dwordx2 v[44:45], v3, s[28:31], 0 offen offset:224 sc1
    v_add_u32 v3, 0x30000, v3
    v_accvgpr_read_b32 v48, a64
    v_accvgpr_read_b32 v49, a65
    v_accvgpr_read_b32 v50, a66
    v_accvgpr_read_b32 v51, a67
    v_cvt_pk_bf16_f32 v32, v48, v49
    v_cvt_pk_bf16_f32 v33, v50, v51
    buffer_store_dwordx2 v[32:33], v3, s[28:31], 0 offen offset:0 sc1
    v_accvgpr_read_b32 v56, a68
    v_accvgpr_read_b32 v57, a69
    v_accvgpr_read_b32 v58, a70
    v_accvgpr_read_b32 v59, a71
    v_cvt_pk_bf16_f32 v36, v56, v57
    v_cvt_pk_bf16_f32 v37, v58, v59
    buffer_store_dwordx2 v[36:37], v3, s[28:31], 0 offen offset:32 sc1
    v_accvgpr_read_b32 v48, a72
    v_accvgpr_read_b32 v49, a73
    v_accvgpr_read_b32 v50, a74
    v_accvgpr_read_b32 v51, a75
    v_cvt_pk_bf16_f32 v40, v48, v49
    v_cvt_pk_bf16_f32 v41, v50, v51
    buffer_store_dwordx2 v[40:41], v3, s[28:31], 0 offen offset:64 sc1
    v_accvgpr_read_b32 v56, a76
    v_accvgpr_read_b32 v57, a77
    v_accvgpr_read_b32 v58, a78
    v_accvgpr_read_b32 v59, a79
    v_cvt_pk_bf16_f32 v44, v56, v57
    v_cvt_pk_bf16_f32 v45, v58, v59
    buffer_store_dwordx2 v[44:45], v3, s[28:31], 0 offen offset:96 sc1
    v_accvgpr_read_b32 v48, a80
    v_accvgpr_read_b32 v49, a81
    v_accvgpr_read_b32 v50, a82
    v_accvgpr_read_b32 v51, a83
    v_cvt_pk_bf16_f32 v32, v48, v49
    v_cvt_pk_bf16_f32 v33, v50, v51
    buffer_store_dwordx2 v[32:33], v3, s[28:31], 0 offen offset:128 sc1
    v_accvgpr_read_b32 v56, a84
    v_accvgpr_read_b32 v57, a85
    v_accvgpr_read_b32 v58, a86
    v_accvgpr_read_b32 v59, a87
    v_cvt_pk_bf16_f32 v36, v56, v57
    v_cvt_pk_bf16_f32 v37, v58, v59
    buffer_store_dwordx2 v[36:37], v3, s[28:31], 0 offen offset:160 sc1
    v_accvgpr_read_b32 v48, a88
    v_accvgpr_read_b32 v49, a89
    v_accvgpr_read_b32 v50, a90
    v_accvgpr_read_b32 v51, a91
    v_cvt_pk_bf16_f32 v40, v48, v49
    v_cvt_pk_bf16_f32 v41, v50, v51
    buffer_store_dwordx2 v[40:41], v3, s[28:31], 0 offen offset:192 sc1
    v_accvgpr_read_b32 v56, a92
    v_accvgpr_read_b32 v57, a93
    v_accvgpr_read_b32 v58, a94
    v_accvgpr_read_b32 v59, a95
    v_cvt_pk_bf16_f32 v44, v56, v57
    v_cvt_pk_bf16_f32 v45, v58, v59
    buffer_store_dwordx2 v[44:45], v3, s[28:31], 0 offen offset:224 sc1
    v_add_u32 v3, 0x30000, v3
    v_accvgpr_read_b32 v48, a96
    v_accvgpr_read_b32 v49, a97
    v_accvgpr_read_b32 v50, a98
    v_accvgpr_read_b32 v51, a99
    v_cvt_pk_bf16_f32 v32, v48, v49
    v_cvt_pk_bf16_f32 v33, v50, v51
    buffer_store_dwordx2 v[32:33], v3, s[28:31], 0 offen offset:0 sc1
    v_accvgpr_read_b32 v56, a100
    v_accvgpr_read_b32 v57, a101
    v_accvgpr_read_b32 v58, a102
    v_accvgpr_read_b32 v59, a103
    v_cvt_pk_bf16_f32 v36, v56, v57
    v_cvt_pk_bf16_f32 v37, v58, v59
    buffer_store_dwordx2 v[36:37], v3, s[28:31], 0 offen offset:32 sc1
    v_accvgpr_read_b32 v48, a104
    v_accvgpr_read_b32 v49, a105
    v_accvgpr_read_b32 v50, a106
    v_accvgpr_read_b32 v51, a107
    v_cvt_pk_bf16_f32 v40, v48, v49
    v_cvt_pk_bf16_f32 v41, v50, v51
    buffer_store_dwordx2 v[40:41], v3, s[28:31], 0 offen offset:64 sc1
    v_accvgpr_read_b32 v56, a108
    v_accvgpr_read_b32 v57, a109
    v_accvgpr_read_b32 v58, a110
    v_accvgpr_read_b32 v59, a111
    v_cvt_pk_bf16_f32 v44, v56, v57
    v_cvt_pk_bf16_f32 v45, v58, v59
    buffer_store_dwordx2 v[44:45], v3, s[28:31], 0 offen offset:96 sc1
    v_accvgpr_read_b32 v48, a112
    v_accvgpr_read_b32 v49, a113
    v_accvgpr_read_b32 v50, a114
    v_accvgpr_read_b32 v51, a115
    v_cvt_pk_bf16_f32 v32, v48, v49
    v_cvt_pk_bf16_f32 v33, v50, v51
    buffer_store_dwordx2 v[32:33], v3, s[28:31], 0 offen offset:128 sc1
    v_accvgpr_read_b32 v56, a116
    v_accvgpr_read_b32 v57, a117
    v_accvgpr_read_b32 v58, a118
    v_accvgpr_read_b32 v59, a119
    v_cvt_pk_bf16_f32 v36, v56, v57
    v_cvt_pk_bf16_f32 v37, v58, v59
    buffer_store_dwordx2 v[36:37], v3, s[28:31], 0 offen offset:160 sc1
    v_accvgpr_read_b32 v48, a120
    v_accvgpr_read_b32 v49, a121
    v_accvgpr_read_b32 v50, a122
    v_accvgpr_read_b32 v51, a123
    v_cvt_pk_bf16_f32 v40, v48, v49
    v_cvt_pk_bf16_f32 v41, v50, v51
    buffer_store_dwordx2 v[40:41], v3, s[28:31], 0 offen offset:192 sc1
    v_accvgpr_read_b32 v56, a124
    v_accvgpr_read_b32 v57, a125
    v_accvgpr_read_b32 v58, a126
    v_accvgpr_read_b32 v59, a127
    v_cvt_pk_bf16_f32 v44, v56, v57
    v_cvt_pk_bf16_f32 v45, v58, v59
    buffer_store_dwordx2 v[44:45], v3, s[28:31], 0 offen offset:224 sc1
    v_add_u32 v3, 0x30000, v3
    v_accvgpr_read_b32 v48, a128
    v_accvgpr_read_b32 v49, a129
    v_accvgpr_read_b32 v50, a130
    v_accvgpr_read_b32 v51, a131
    v_cvt_pk_bf16_f32 v32, v48, v49
    v_cvt_pk_bf16_f32 v33, v50, v51
    buffer_store_dwordx2 v[32:33], v3, s[28:31], 0 offen offset:0 sc1
    v_accvgpr_read_b32 v56, a132
    v_accvgpr_read_b32 v57, a133
    v_accvgpr_read_b32 v58, a134
    v_accvgpr_read_b32 v59, a135
    v_cvt_pk_bf16_f32 v36, v56, v57
    v_cvt_pk_bf16_f32 v37, v58, v59
    buffer_store_dwordx2 v[36:37], v3, s[28:31], 0 offen offset:32 sc1
    v_accvgpr_read_b32 v48, a136
    v_accvgpr_read_b32 v49, a137
    v_accvgpr_read_b32 v50, a138
    v_accvgpr_read_b32 v51, a139
    v_cvt_pk_bf16_f32 v40, v48, v49
    v_cvt_pk_bf16_f32 v41, v50, v51
    buffer_store_dwordx2 v[40:41], v3, s[28:31], 0 offen offset:64 sc1
    v_accvgpr_read_b32 v56, a140
    v_accvgpr_read_b32 v57, a141
    v_accvgpr_read_b32 v58, a142
    v_accvgpr_read_b32 v59, a143
    v_cvt_pk_bf16_f32 v44, v56, v57
    v_cvt_pk_bf16_f32 v45, v58, v59
    buffer_store_dwordx2 v[44:45], v3, s[28:31], 0 offen offset:96 sc1
    v_accvgpr_read_b32 v48, a144
    v_accvgpr_read_b32 v49, a145
    v_accvgpr_read_b32 v50, a146
    v_accvgpr_read_b32 v51, a147
    v_cvt_pk_bf16_f32 v32, v48, v49
    v_cvt_pk_bf16_f32 v33, v50, v51
    buffer_store_dwordx2 v[32:33], v3, s[28:31], 0 offen offset:128 sc1
    v_accvgpr_read_b32 v56, a148
    v_accvgpr_read_b32 v57, a149
    v_accvgpr_read_b32 v58, a150
    v_accvgpr_read_b32 v59, a151
    v_cvt_pk_bf16_f32 v36, v56, v57
    v_cvt_pk_bf16_f32 v37, v58, v59
    buffer_store_dwordx2 v[36:37], v3, s[28:31], 0 offen offset:160 sc1
    v_accvgpr_read_b32 v48, a152
    v_accvgpr_read_b32 v49, a153
    v_accvgpr_read_b32 v50, a154
    v_accvgpr_read_b32 v51, a155
    v_cvt_pk_bf16_f32 v40, v48, v49
    v_cvt_pk_bf16_f32 v41, v50, v51
    buffer_store_dwordx2 v[40:41], v3, s[28:31], 0 offen offset:192 sc1
    v_accvgpr_read_b32 v56, a156
    v_accvgpr_read_b32 v57, a157
    v_accvgpr_read_b32 v58, a158
    v_accvgpr_read_b32 v59, a159
    v_cvt_pk_bf16_f32 v44, v56, v57
    v_cvt_pk_bf16_f32 v45, v58, v59
    buffer_store_dwordx2 v[44:45], v3, s[28:31], 0 offen offset:224 sc1
    v_add_u32 v3, 0x30000, v3
    v_accvgpr_read_b32 v48, a160
    v_accvgpr_read_b32 v49, a161
    v_accvgpr_read_b32 v50, a162
    v_accvgpr_read_b32 v51, a163
    v_cvt_pk_bf16_f32 v32, v48, v49
    v_cvt_pk_bf16_f32 v33, v50, v51
    buffer_store_dwordx2 v[32:33], v3, s[28:31], 0 offen offset:0 sc1
    v_accvgpr_read_b32 v56, a164
    v_accvgpr_read_b32 v57, a165
    v_accvgpr_read_b32 v58, a166
    v_accvgpr_read_b32 v59, a167
    v_cvt_pk_bf16_f32 v36, v56, v57
    v_cvt_pk_bf16_f32 v37, v58, v59
    buffer_store_dwordx2 v[36:37], v3, s[28:31], 0 offen offset:32 sc1
    v_accvgpr_read_b32 v48, a168
    v_accvgpr_read_b32 v49, a169
    v_accvgpr_read_b32 v50, a170
    v_accvgpr_read_b32 v51, a171
    v_cvt_pk_bf16_f32 v40, v48, v49
    v_cvt_pk_bf16_f32 v41, v50, v51
    buffer_store_dwordx2 v[40:41], v3, s[28:31], 0 offen offset:64 sc1
    v_accvgpr_read_b32 v56, a172
    v_accvgpr_read_b32 v57, a173
    v_accvgpr_read_b32 v58, a174
    v_accvgpr_read_b32 v59, a175
    v_cvt_pk_bf16_f32 v44, v56, v57
    v_cvt_pk_bf16_f32 v45, v58, v59
    buffer_store_dwordx2 v[44:45], v3, s[28:31], 0 offen offset:96 sc1
    v_accvgpr_read_b32 v48, a176
    v_accvgpr_read_b32 v49, a177
    v_accvgpr_read_b32 v50, a178
    v_accvgpr_read_b32 v51, a179
    v_cvt_pk_bf16_f32 v32, v48, v49
    v_cvt_pk_bf16_f32 v33, v50, v51
    buffer_store_dwordx2 v[32:33], v3, s[28:31], 0 offen offset:128 sc1
    v_accvgpr_read_b32 v56, a180
    v_accvgpr_read_b32 v57, a181
    v_accvgpr_read_b32 v58, a182
    v_accvgpr_read_b32 v59, a183
    v_cvt_pk_bf16_f32 v36, v56, v57
    v_cvt_pk_bf16_f32 v37, v58, v59
    buffer_store_dwordx2 v[36:37], v3, s[28:31], 0 offen offset:160 sc1
    v_accvgpr_read_b32 v48, a184
    v_accvgpr_read_b32 v49, a185
    v_accvgpr_read_b32 v50, a186
    v_accvgpr_read_b32 v51, a187
    v_cvt_pk_bf16_f32 v40, v48, v49
    v_cvt_pk_bf16_f32 v41, v50, v51
    buffer_store_dwordx2 v[40:41], v3, s[28:31], 0 offen offset:192 sc1
    v_accvgpr_read_b32 v56, a188
    v_accvgpr_read_b32 v57, a189
    v_accvgpr_read_b32 v58, a190
    v_accvgpr_read_b32 v59, a191
    v_cvt_pk_bf16_f32 v44, v56, v57
    v_cvt_pk_bf16_f32 v45, v58, v59
    buffer_store_dwordx2 v[44:45], v3, s[28:31], 0 offen offset:224 sc1
    v_add_u32 v3, 0x30000, v3
    v_accvgpr_read_b32 v48, a192
    v_accvgpr_read_b32 v49, a193
    v_accvgpr_read_b32 v50, a194
    v_accvgpr_read_b32 v51, a195
    v_cvt_pk_bf16_f32 v32, v48, v49
    v_cvt_pk_bf16_f32 v33, v50, v51
    buffer_store_dwordx2 v[32:33], v3, s[28:31], 0 offen offset:0 sc1
    v_accvgpr_read_b32 v56, a196
    v_accvgpr_read_b32 v57, a197
    v_accvgpr_read_b32 v58, a198
    v_accvgpr_read_b32 v59, a199
    v_cvt_pk_bf16_f32 v36, v56, v57
    v_cvt_pk_bf16_f32 v37, v58, v59
    buffer_store_dwordx2 v[36:37], v3, s[28:31], 0 offen offset:32 sc1
    v_accvgpr_read_b32 v48, a200
    v_accvgpr_read_b32 v49, a201
    v_accvgpr_read_b32 v50, a202
    v_accvgpr_read_b32 v51, a203
    v_cvt_pk_bf16_f32 v40, v48, v49
    v_cvt_pk_bf16_f32 v41, v50, v51
    buffer_store_dwordx2 v[40:41], v3, s[28:31], 0 offen offset:64 sc1
    v_accvgpr_read_b32 v56, a204
    v_accvgpr_read_b32 v57, a205
    v_accvgpr_read_b32 v58, a206
    v_accvgpr_read_b32 v59, a207
    v_cvt_pk_bf16_f32 v44, v56, v57
    v_cvt_pk_bf16_f32 v45, v58, v59
    buffer_store_dwordx2 v[44:45], v3, s[28:31], 0 offen offset:96 sc1
    v_accvgpr_read_b32 v48, a208
    v_accvgpr_read_b32 v49, a209
    v_accvgpr_read_b32 v50, a210
    v_accvgpr_read_b32 v51, a211
    v_cvt_pk_bf16_f32 v32, v48, v49
    v_cvt_pk_bf16_f32 v33, v50, v51
    buffer_store_dwordx2 v[32:33], v3, s[28:31], 0 offen offset:128 sc1
    v_accvgpr_read_b32 v56, a212
    v_accvgpr_read_b32 v57, a213
    v_accvgpr_read_b32 v58, a214
    v_accvgpr_read_b32 v59, a215
    v_cvt_pk_bf16_f32 v36, v56, v57
    v_cvt_pk_bf16_f32 v37, v58, v59
    buffer_store_dwordx2 v[36:37], v3, s[28:31], 0 offen offset:160 sc1
    v_accvgpr_read_b32 v48, a216
    v_accvgpr_read_b32 v49, a217
    v_accvgpr_read_b32 v50, a218
    v_accvgpr_read_b32 v51, a219
    v_cvt_pk_bf16_f32 v40, v48, v49
    v_cvt_pk_bf16_f32 v41, v50, v51
    buffer_store_dwordx2 v[40:41], v3, s[28:31], 0 offen offset:192 sc1
    v_accvgpr_read_b32 v56, a220
    v_accvgpr_read_b32 v57, a221
    v_accvgpr_read_b32 v58, a222
    v_accvgpr_read_b32 v59, a223
    v_cvt_pk_bf16_f32 v44, v56, v57
    v_cvt_pk_bf16_f32 v45, v58, v59
    buffer_store_dwordx2 v[44:45], v3, s[28:31], 0 offen offset:224 sc1
    v_add_u32 v3, 0x30000, v3
    v_accvgpr_read_b32 v48, a224
    v_accvgpr_read_b32 v49, a225
    v_accvgpr_read_b32 v50, a226
    v_accvgpr_read_b32 v51, a227
    v_cvt_pk_bf16_f32 v32, v48, v49
    v_cvt_pk_bf16_f32 v33, v50, v51
    buffer_store_dwordx2 v[32:33], v3, s[28:31], 0 offen offset:0 sc1
    v_accvgpr_read_b32 v56, a228
    v_accvgpr_read_b32 v57, a229
    v_accvgpr_read_b32 v58, a230
    v_accvgpr_read_b32 v59, a231
    v_cvt_pk_bf16_f32 v36, v56, v57
    v_cvt_pk_bf16_f32 v37, v58, v59
    buffer_store_dwordx2 v[36:37], v3, s[28:31], 0 offen offset:32 sc1
    v_accvgpr_read_b32 v48, a232
    v_accvgpr_read_b32 v49, a233
    v_accvgpr_read_b32 v50, a234
    v_accvgpr_read_b32 v51, a235
    v_cvt_pk_bf16_f32 v40, v48, v49
    v_cvt_pk_bf16_f32 v41, v50, v51
    buffer_store_dwordx2 v[40:41], v3, s[28:31], 0 offen offset:64 sc1
    v_accvgpr_read_b32 v56, a236
    v_accvgpr_read_b32 v57, a237
    v_accvgpr_read_b32 v58, a238
    v_accvgpr_read_b32 v59, a239
    v_cvt_pk_bf16_f32 v44, v56, v57
    v_cvt_pk_bf16_f32 v45, v58, v59
    buffer_store_dwordx2 v[44:45], v3, s[28:31], 0 offen offset:96 sc1
    v_accvgpr_read_b32 v48, a240
    v_accvgpr_read_b32 v49, a241
    v_accvgpr_read_b32 v50, a242
    v_accvgpr_read_b32 v51, a243
    v_cvt_pk_bf16_f32 v32, v48, v49
    v_cvt_pk_bf16_f32 v33, v50, v51
    buffer_store_dwordx2 v[32:33], v3, s[28:31], 0 offen offset:128 sc1
    v_accvgpr_read_b32 v56, a244
    v_accvgpr_read_b32 v57, a245
    v_accvgpr_read_b32 v58, a246
    v_accvgpr_read_b32 v59, a247
    v_cvt_pk_bf16_f32 v36, v56, v57
    v_cvt_pk_bf16_f32 v37, v58, v59
    buffer_store_dwordx2 v[36:37], v3, s[28:31], 0 offen offset:160 sc1
    v_accvgpr_read_b32 v48, a248
    v_accvgpr_read_b32 v49, a249
    v_accvgpr_read_b32 v50, a250
    v_accvgpr_read_b32 v51, a251
    v_cvt_pk_bf16_f32 v40, v48, v49
    v_cvt_pk_bf16_f32 v41, v50, v51
    buffer_store_dwordx2 v[40:41], v3, s[28:31], 0 offen offset:192 sc1
    v_accvgpr_read_b32 v56, a252
    v_accvgpr_read_b32 v57, a253
    v_accvgpr_read_b32 v58, a254
    v_accvgpr_read_b32 v59, a255
    v_cvt_pk_bf16_f32 v44, v56, v57
    v_cvt_pk_bf16_f32 v45, v58, v59
    buffer_store_dwordx2 v[44:45], v3, s[28:31], 0 offen offset:224 sc1
    s_branch L_w_kvsig
L_w_v:
    s_sub_u32 s40, s40, 24
    s_mov_b32 s6, s100
    s_mov_b32 s7, s101
    s_lshr_b32 s45, s44, 1
    s_and_b32 s46, s44, 1
    s_mov_b32 s12, s4
    s_mov_b32 s13, s5
    s_mov_b32 s14, 0x280000
    s_mov_b32 s15, 0x20000
    s_mov_b32 s16, s6
    s_mov_b32 s17, s7
    s_mov_b32 s18, 0x780000
    s_mov_b32 s19, 0x20000
    s_mov_b32 s47, s40
    v_lshrrev_b32 v3, 2, v2
    v_and_b32 v4, 3, v2
    v_lshrrev_b32 v5, 3, v3
    v_lshlrev_b32 v5, 1, v5
    v_xor_b32 v4, v4, v5
    s_mul_i32 s48, s41, 256
    s_mul_i32 s49, s44, 64
    s_add_u32 s48, s48, s49
    v_add_u32 v3, s48, v3
    s_mov_b32 s60, 1280
    v_mul_lo_u32 v3, v3, s60
    v_lshl_add_u32 v6, v4, 4, v3
    v_add_u32 v7, 0x5000, v6
    v_add_u32 v8, 0xa000, v6
    v_add_u32 v9, 0xf000, v6
    s_mul_i32 s50, s44, 4
    s_lshr_b32 s51, s50, 4
    s_and_b32 s52, s50, 15
    v_lshrrev_b32 v3, 5, v2
    s_add_u32 s53, s52, 0
    s_mul_i32 s53, s53, 2
    v_add_u32 v3, s53, v3
    v_and_b32 v4, 31, v2
    v_and_b32 v5, 3, v3
    v_lshrrev_b32 v30, 3, v3
    v_and_b32 v30, 1, v30
    v_lshl_or_b32 v5, v30, 2, v5
    v_lshlrev_b32 v5, 1, v5
    v_xor_b32 v4, v4, v5
    s_mov_b32 s60, 12288
    v_mul_lo_u32 v3, v3, s60
    v_lshl_add_u32 v3, v4, 4, v3
    s_mul_i32 s53, s47, 512
    v_add_u32 v10, s53, v3
    v_lshrrev_b32 v3, 5, v2
    s_add_u32 s53, s52, 1
    s_mul_i32 s53, s53, 2
    v_add_u32 v3, s53, v3
    v_and_b32 v4, 31, v2
    v_and_b32 v5, 3, v3
    v_lshrrev_b32 v30, 3, v3
    v_and_b32 v30, 1, v30
    v_lshl_or_b32 v5, v30, 2, v5
    v_lshlrev_b32 v5, 1, v5
    v_xor_b32 v4, v4, v5
    s_mov_b32 s60, 12288
    v_mul_lo_u32 v3, v3, s60
    v_lshl_add_u32 v3, v4, 4, v3
    s_mul_i32 s53, s47, 512
    v_add_u32 v11, s53, v3
    v_lshrrev_b32 v3, 5, v2
    s_add_u32 s53, s52, 2
    s_mul_i32 s53, s53, 2
    v_add_u32 v3, s53, v3
    v_and_b32 v4, 31, v2
    v_and_b32 v5, 3, v3
    v_lshrrev_b32 v30, 3, v3
    v_and_b32 v30, 1, v30
    v_lshl_or_b32 v5, v30, 2, v5
    v_lshlrev_b32 v5, 1, v5
    v_xor_b32 v4, v4, v5
    s_mov_b32 s60, 12288
    v_mul_lo_u32 v3, v3, s60
    v_lshl_add_u32 v3, v4, 4, v3
    s_mul_i32 s53, s47, 512
    v_add_u32 v12, s53, v3
    v_lshrrev_b32 v3, 5, v2
    s_add_u32 s53, s52, 3
    s_mul_i32 s53, s53, 2
    v_add_u32 v3, s53, v3
    v_and_b32 v4, 31, v2
    v_and_b32 v5, 3, v3
    v_lshrrev_b32 v30, 3, v3
    v_and_b32 v30, 1, v30
    v_lshl_or_b32 v5, v30, 2, v5
    v_lshlrev_b32 v5, 1, v5
    v_xor_b32 v4, v4, v5
    s_mov_b32 s60, 12288
    v_mul_lo_u32 v3, v3, s60
    v_lshl_add_u32 v3, v4, 4, v3
    s_mul_i32 s53, s47, 512
    v_add_u32 v13, s53, v3
    v_and_b32 v3, 15, v2
    v_lshrrev_b32 v4, 4, v2
    v_lshrrev_b32 v5, 3, v3
    v_lshlrev_b32 v5, 1, v5
    v_xor_b32 v5, v4, v5
    s_mul_i32 s53, s45, 128
    v_add_u32 v30, s53, v3
    v_lshlrev_b32 v30, 6, v30
    v_lshl_add_u32 v14, v5, 4, v30
    v_lshrrev_b32 v5, 2, v3
    v_and_b32 v30, 3, v2
    v_lshl_add_u32 v31, v4, 3, v5
    v_mul_u32_u24 v31, 512, v31
    v_lshl_add_u32 v31, v30, 3, v31
    v_add_u32 v31, 16384, v31
    v_and_b32 v30, 1, v4
    v_lshl_or_b32 v5, v30, 2, v5
    v_xor_b32 v30, 0, v5
    v_lshl_add_u32 v15, v30, 5, v31
    v_xor_b32 v30, 1, v5
    v_lshl_add_u32 v16, v30, 5, v31
    v_xor_b32 v30, 2, v5
    v_lshl_add_u32 v17, v30, 5, v31
    v_xor_b32 v30, 3, v5
    v_lshl_add_u32 v18, v30, 5, v31
    v_xor_b32 v30, 4, v5
    v_lshl_add_u32 v19, v30, 5, v31
    v_xor_b32 v30, 5, v5
    v_lshl_add_u32 v20, v30, 5, v31
    v_xor_b32 v30, 6, v5
    v_lshl_add_u32 v21, v30, 5, v31
    v_xor_b32 v30, 7, v5
    v_lshl_add_u32 v22, v30, 5, v31
    s_mul_i32 s53, s46, 256
    v_add_u32 v15, s53, v15
    v_add_u32 v16, s53, v16
    v_add_u32 v17, s53, v17
    v_add_u32 v18, s53, v18
    v_add_u32 v19, s53, v19
    v_add_u32 v20, s53, v20
    v_add_u32 v21, s53, v21
    v_add_u32 v22, s53, v22
    v_accvgpr_write_b32 a0, 0
    v_accvgpr_write_b32 a1, 0
    v_accvgpr_write_b32 a2, 0
    v_accvgpr_write_b32 a3, 0
    v_accvgpr_write_b32 a4, 0
    v_accvgpr_write_b32 a5, 0
    v_accvgpr_write_b32 a6, 0
    v_accvgpr_write_b32 a7, 0
    v_accvgpr_write_b32 a8, 0
    v_accvgpr_write_b32 a9, 0
    v_accvgpr_write_b32 a10, 0
    v_accvgpr_write_b32 a11, 0
    v_accvgpr_write_b32 a12, 0
    v_accvgpr_write_b32 a13, 0
    v_accvgpr_write_b32 a14, 0
    v_accvgpr_write_b32 a15, 0
    v_accvgpr_write_b32 a16, 0
    v_accvgpr_write_b32 a17, 0
    v_accvgpr_write_b32 a18, 0
    v_accvgpr_write_b32 a19, 0
    v_accvgpr_write_b32 a20, 0
    v_accvgpr_write_b32 a21, 0
    v_accvgpr_write_b32 a22, 0
    v_accvgpr_write_b32 a23, 0
    v_accvgpr_write_b32 a24, 0
    v_accvgpr_write_b32 a25, 0
    v_accvgpr_write_b32 a26, 0
    v_accvgpr_write_b32 a27, 0
    v_accvgpr_write_b32 a28, 0
    v_accvgpr_write_b32 a29, 0
    v_accvgpr_write_b32 a30, 0
    v_accvgpr_write_b32 a31, 0
    v_accvgpr_write_b32 a32, 0
    v_accvgpr_write_b32 a33, 0
    v_accvgpr_write_b32 a34, 0
    v_accvgpr_write_b32 a35, 0
    v_accvgpr_write_b32 a36, 0
    v_accvgpr_write_b32 a37, 0
    v_accvgpr_write_b32 a38, 0
    v_accvgpr_write_b32 a39, 0
    v_accvgpr_write_b32 a40, 0
    v_accvgpr_write_b32 a41, 0
    v_accvgpr_write_b32 a42, 0
    v_accvgpr_write_b32 a43, 0
    v_accvgpr_write_b32 a44, 0
    v_accvgpr_write_b32 a45, 0
    v_accvgpr_write_b32 a46, 0
    v_accvgpr_write_b32 a47, 0
    v_accvgpr_write_b32 a48, 0
    v_accvgpr_write_b32 a49, 0
    v_accvgpr_write_b32 a50, 0
    v_accvgpr_write_b32 a51, 0
    v_accvgpr_write_b32 a52, 0
    v_accvgpr_write_b32 a53, 0
    v_accvgpr_write_b32 a54, 0
    v_accvgpr_write_b32 a55, 0
    v_accvgpr_write_b32 a56, 0
    v_accvgpr_write_b32 a57, 0
    v_accvgpr_write_b32 a58, 0
    v_accvgpr_write_b32 a59, 0
    v_accvgpr_write_b32 a60, 0
    v_accvgpr_write_b32 a61, 0
    v_accvgpr_write_b32 a62, 0
    v_accvgpr_write_b32 a63, 0
    v_accvgpr_write_b32 a64, 0
    v_accvgpr_write_b32 a65, 0
    v_accvgpr_write_b32 a66, 0
    v_accvgpr_write_b32 a67, 0
    v_accvgpr_write_b32 a68, 0
    v_accvgpr_write_b32 a69, 0
    v_accvgpr_write_b32 a70, 0
    v_accvgpr_write_b32 a71, 0
    v_accvgpr_write_b32 a72, 0
    v_accvgpr_write_b32 a73, 0
    v_accvgpr_write_b32 a74, 0
    v_accvgpr_write_b32 a75, 0
    v_accvgpr_write_b32 a76, 0
    v_accvgpr_write_b32 a77, 0
    v_accvgpr_write_b32 a78, 0
    v_accvgpr_write_b32 a79, 0
    v_accvgpr_write_b32 a80, 0
    v_accvgpr_write_b32 a81, 0
    v_accvgpr_write_b32 a82, 0
    v_accvgpr_write_b32 a83, 0
    v_accvgpr_write_b32 a84, 0
    v_accvgpr_write_b32 a85, 0
    v_accvgpr_write_b32 a86, 0
    v_accvgpr_write_b32 a87, 0
    v_accvgpr_write_b32 a88, 0
    v_accvgpr_write_b32 a89, 0
    v_accvgpr_write_b32 a90, 0
    v_accvgpr_write_b32 a91, 0
    v_accvgpr_write_b32 a92, 0
    v_accvgpr_write_b32 a93, 0
    v_accvgpr_write_b32 a94, 0
    v_accvgpr_write_b32 a95, 0
    v_accvgpr_write_b32 a96, 0
    v_accvgpr_write_b32 a97, 0
    v_accvgpr_write_b32 a98, 0
    v_accvgpr_write_b32 a99, 0
    v_accvgpr_write_b32 a100, 0
    v_accvgpr_write_b32 a101, 0
    v_accvgpr_write_b32 a102, 0
    v_accvgpr_write_b32 a103, 0
    v_accvgpr_write_b32 a104, 0
    v_accvgpr_write_b32 a105, 0
    v_accvgpr_write_b32 a106, 0
    v_accvgpr_write_b32 a107, 0
    v_accvgpr_write_b32 a108, 0
    v_accvgpr_write_b32 a109, 0
    v_accvgpr_write_b32 a110, 0
    v_accvgpr_write_b32 a111, 0
    v_accvgpr_write_b32 a112, 0
    v_accvgpr_write_b32 a113, 0
    v_accvgpr_write_b32 a114, 0
    v_accvgpr_write_b32 a115, 0
    v_accvgpr_write_b32 a116, 0
    v_accvgpr_write_b32 a117, 0
    v_accvgpr_write_b32 a118, 0
    v_accvgpr_write_b32 a119, 0
    v_accvgpr_write_b32 a120, 0
    v_accvgpr_write_b32 a121, 0
    v_accvgpr_write_b32 a122, 0
    v_accvgpr_write_b32 a123, 0
    v_accvgpr_write_b32 a124, 0
    v_accvgpr_write_b32 a125, 0
    v_accvgpr_write_b32 a126, 0
    v_accvgpr_write_b32 a127, 0
    v_accvgpr_write_b32 a128, 0
    v_accvgpr_write_b32 a129, 0
    v_accvgpr_write_b32 a130, 0
    v_accvgpr_write_b32 a131, 0
    v_accvgpr_write_b32 a132, 0
    v_accvgpr_write_b32 a133, 0
    v_accvgpr_write_b32 a134, 0
    v_accvgpr_write_b32 a135, 0
    v_accvgpr_write_b32 a136, 0
    v_accvgpr_write_b32 a137, 0
    v_accvgpr_write_b32 a138, 0
    v_accvgpr_write_b32 a139, 0
    v_accvgpr_write_b32 a140, 0
    v_accvgpr_write_b32 a141, 0
    v_accvgpr_write_b32 a142, 0
    v_accvgpr_write_b32 a143, 0
    v_accvgpr_write_b32 a144, 0
    v_accvgpr_write_b32 a145, 0
    v_accvgpr_write_b32 a146, 0
    v_accvgpr_write_b32 a147, 0
    v_accvgpr_write_b32 a148, 0
    v_accvgpr_write_b32 a149, 0
    v_accvgpr_write_b32 a150, 0
    v_accvgpr_write_b32 a151, 0
    v_accvgpr_write_b32 a152, 0
    v_accvgpr_write_b32 a153, 0
    v_accvgpr_write_b32 a154, 0
    v_accvgpr_write_b32 a155, 0
    v_accvgpr_write_b32 a156, 0
    v_accvgpr_write_b32 a157, 0
    v_accvgpr_write_b32 a158, 0
    v_accvgpr_write_b32 a159, 0
    v_accvgpr_write_b32 a160, 0
    v_accvgpr_write_b32 a161, 0
    v_accvgpr_write_b32 a162, 0
    v_accvgpr_write_b32 a163, 0
    v_accvgpr_write_b32 a164, 0
    v_accvgpr_write_b32 a165, 0
    v_accvgpr_write_b32 a166, 0
    v_accvgpr_write_b32 a167, 0
    v_accvgpr_write_b32 a168, 0
    v_accvgpr_write_b32 a169, 0
    v_accvgpr_write_b32 a170, 0
    v_accvgpr_write_b32 a171, 0
    v_accvgpr_write_b32 a172, 0
    v_accvgpr_write_b32 a173, 0
    v_accvgpr_write_b32 a174, 0
    v_accvgpr_write_b32 a175, 0
    v_accvgpr_write_b32 a176, 0
    v_accvgpr_write_b32 a177, 0
    v_accvgpr_write_b32 a178, 0
    v_accvgpr_write_b32 a179, 0
    v_accvgpr_write_b32 a180, 0
    v_accvgpr_write_b32 a181, 0
    v_accvgpr_write_b32 a182, 0
    v_accvgpr_write_b32 a183, 0
    v_accvgpr_write_b32 a184, 0
    v_accvgpr_write_b32 a185, 0
    v_accvgpr_write_b32 a186, 0
    v_accvgpr_write_b32 a187, 0
    v_accvgpr_write_b32 a188, 0
    v_accvgpr_write_b32 a189, 0
    v_accvgpr_write_b32 a190, 0
    v_accvgpr_write_b32 a191, 0
    v_accvgpr_write_b32 a192, 0
    v_accvgpr_write_b32 a193, 0
    v_accvgpr_write_b32 a194, 0
    v_accvgpr_write_b32 a195, 0
    v_accvgpr_write_b32 a196, 0
    v_accvgpr_write_b32 a197, 0
    v_accvgpr_write_b32 a198, 0
    v_accvgpr_write_b32 a199, 0
    v_accvgpr_write_b32 a200, 0
    v_accvgpr_write_b32 a201, 0
    v_accvgpr_write_b32 a202, 0
    v_accvgpr_write_b32 a203, 0
    v_accvgpr_write_b32 a204, 0
    v_accvgpr_write_b32 a205, 0
    v_accvgpr_write_b32 a206, 0
    v_accvgpr_write_b32 a207, 0
    v_accvgpr_write_b32 a208, 0
    v_accvgpr_write_b32 a209, 0
    v_accvgpr_write_b32 a210, 0
    v_accvgpr_write_b32 a211, 0
    v_accvgpr_write_b32 a212, 0
    v_accvgpr_write_b32 a213, 0
    v_accvgpr_write_b32 a214, 0
    v_accvgpr_write_b32 a215, 0
    v_accvgpr_write_b32 a216, 0
    v_accvgpr_write_b32 a217, 0
    v_accvgpr_write_b32 a218, 0
    v_accvgpr_write_b32 a219, 0
    v_accvgpr_write_b32 a220, 0
    v_accvgpr_write_b32 a221, 0
    v_accvgpr_write_b32 a222, 0
    v_accvgpr_write_b32 a223, 0
    v_accvgpr_write_b32 a224, 0
    v_accvgpr_write_b32 a225, 0
    v_accvgpr_write_b32 a226, 0
    v_accvgpr_write_b32 a227, 0
    v_accvgpr_write_b32 a228, 0
    v_accvgpr_write_b32 a229, 0
    v_accvgpr_write_b32 a230, 0
    v_accvgpr_write_b32 a231, 0
    v_accvgpr_write_b32 a232, 0
    v_accvgpr_write_b32 a233, 0
    v_accvgpr_write_b32 a234, 0
    v_accvgpr_write_b32 a235, 0
    v_accvgpr_write_b32 a236, 0
    v_accvgpr_write_b32 a237, 0
    v_accvgpr_write_b32 a238, 0
    v_accvgpr_write_b32 a239, 0
    v_accvgpr_write_b32 a240, 0
    v_accvgpr_write_b32 a241, 0
    v_accvgpr_write_b32 a242, 0
    v_accvgpr_write_b32 a243, 0
    v_accvgpr_write_b32 a244, 0
    v_accvgpr_write_b32 a245, 0
    v_accvgpr_write_b32 a246, 0
    v_accvgpr_write_b32 a247, 0
    v_accvgpr_write_b32 a248, 0
    v_accvgpr_write_b32 a249, 0
    v_accvgpr_write_b32 a250, 0
    v_accvgpr_write_b32 a251, 0
    v_accvgpr_write_b32 a252, 0
    v_accvgpr_write_b32 a253, 0
    v_accvgpr_write_b32 a254, 0
    v_accvgpr_write_b32 a255, 0
    s_mul_i32 s56, s42, 0
    s_mul_i32 s57, s42, 0
    s_mov_b32 s58, 0
    s_mov_b32 s59, 0
    s_mul_i32 s63, s44, 4096
    s_mul_i32 s64, s44, 4096
    s_add_u32 s64, s64, 16384
    s_add_u32 s65, s58, s63
    s_add_u32 m0, s65, 0
    s_nop 0
    buffer_load_dwordx4 v6, s[12:15], s56 offen lds
    s_add_u32 s65, s58, s63
    s_add_u32 m0, s65, 1024
    s_nop 0
    buffer_load_dwordx4 v7, s[12:15], s56 offen lds
    s_add_u32 s65, s58, s63
    s_add_u32 m0, s65, 2048
    s_nop 0
    buffer_load_dwordx4 v8, s[12:15], s56 offen lds
    s_add_u32 s65, s58, s63
    s_add_u32 m0, s65, 3072
    s_nop 0
    buffer_load_dwordx4 v9, s[12:15], s56 offen lds
    s_add_u32 s65, s58, s64
    s_add_u32 m0, s65, 0
    s_nop 0
    buffer_load_dwordx4 v10, s[16:19], s57 offen lds
    s_add_u32 s65, s58, s64
    s_add_u32 m0, s65, 1024
    s_nop 0
    buffer_load_dwordx4 v11, s[16:19], s57 offen lds
    s_add_u32 s65, s58, s64
    s_add_u32 m0, s65, 2048
    s_nop 0
    buffer_load_dwordx4 v12, s[16:19], s57 offen lds
    s_add_u32 s65, s58, s64
    s_add_u32 m0, s65, 3072
    s_nop 0
    buffer_load_dwordx4 v13, s[16:19], s57 offen lds
    s_add_u32 s56, s56, 64
    s_add_u32 s57, s57, 393216
    s_add_u32 s58, s58, 32768
    s_cmp_ge_u32 s58, 98304
    s_cselect_b32 s58, 0, s58
    s_add_u32 s65, s58, s63
    s_add_u32 m0, s65, 0
    s_nop 0
    buffer_load_dwordx4 v6, s[12:15], s56 offen lds
    s_add_u32 s65, s58, s63
    s_add_u32 m0, s65, 1024
    s_nop 0
    buffer_load_dwordx4 v7, s[12:15], s56 offen lds
    s_add_u32 s65, s58, s63
    s_add_u32 m0, s65, 2048
    s_nop 0
    buffer_load_dwordx4 v8, s[12:15], s56 offen lds
    s_add_u32 s65, s58, s63
    s_add_u32 m0, s65, 3072
    s_nop 0
    buffer_load_dwordx4 v9, s[12:15], s56 offen lds
    s_add_u32 s65, s58, s64
    s_add_u32 m0, s65, 0
    s_nop 0
    buffer_load_dwordx4 v10, s[16:19], s57 offen lds
    s_add_u32 s65, s58, s64
    s_add_u32 m0, s65, 1024
    s_nop 0
    buffer_load_dwordx4 v11, s[16:19], s57 offen lds
    s_add_u32 s65, s58, s64
    s_add_u32 m0, s65, 2048
    s_nop 0
    buffer_load_dwordx4 v12, s[16:19], s57 offen lds
    s_add_u32 s65, s58, s64
    s_add_u32 m0, s65, 3072
    s_nop 0
    buffer_load_dwordx4 v13, s[16:19], s57 offen lds
    s_add_u32 s56, s56, 64
    s_add_u32 s57, s57, 393216
    s_add_u32 s58, s58, 32768
    s_cmp_ge_u32 s58, 98304
    s_cselect_b32 s58, 0, s58
    s_mov_b32 s62, 18
L_wv_loop:
    s_waitcnt vmcnt(8)
    s_barrier
    s_add_u32 s65, s58, s63
    s_add_u32 m0, s65, 0
    s_nop 0
    buffer_load_dwordx4 v6, s[12:15], s56 offen lds
    s_add_u32 s65, s58, s63
    s_add_u32 m0, s65, 1024
    s_nop 0
    buffer_load_dwordx4 v7, s[12:15], s56 offen lds
    s_add_u32 s65, s58, s63
    s_add_u32 m0, s65, 2048
    s_nop 0
    buffer_load_dwordx4 v8, s[12:15], s56 offen lds
    s_add_u32 s65, s58, s63
    s_add_u32 m0, s65, 3072
    s_nop 0
    buffer_load_dwordx4 v9, s[12:15], s56 offen lds
    s_add_u32 s65, s58, s64
    s_add_u32 m0, s65, 0
    s_nop 0
    buffer_load_dwordx4 v10, s[16:19], s57 offen lds
    s_add_u32 s65, s58, s64
    s_add_u32 m0, s65, 1024
    s_nop 0
    buffer_load_dwordx4 v11, s[16:19], s57 offen lds
    s_add_u32 s65, s58, s64
    s_add_u32 m0, s65, 2048
    s_nop 0
    buffer_load_dwordx4 v12, s[16:19], s57 offen lds
    s_add_u32 s65, s58, s64
    s_add_u32 m0, s65, 3072
    s_nop 0
    buffer_load_dwordx4 v13, s[16:19], s57 offen lds
    s_add_u32 s56, s56, 64
    s_add_u32 s57, s57, 393216
    s_add_u32 s58, s58, 32768
    s_cmp_ge_u32 s58, 98304
    s_cselect_b32 s58, 0, s58
    v_add_u32 v23, s59, v14
    v_add_u32 v24, s59, v15
    v_add_u32 v25, s59, v16
    v_add_u32 v26, s59, v17
    v_add_u32 v27, s59, v18
    v_add_u32 v28, s59, v19
    v_add_u32 v29, s59, v20
    v_add_u32 v30, s59, v21
    v_add_u32 v31, s59, v22
    ds_read_b128 v[32:35], v23 offset:0
    ds_read_b64_tr_b16 v[64:65], v24 offset:0
    ds_read_b64_tr_b16 v[66:67], v24 offset:2048
    ds_read_b64_tr_b16 v[68:69], v25 offset:0
    ds_read_b64_tr_b16 v[70:71], v25 offset:2048
    ds_read_b64_tr_b16 v[72:73], v26 offset:0
    ds_read_b64_tr_b16 v[74:75], v26 offset:2048
    ds_read_b64_tr_b16 v[76:77], v27 offset:0
    ds_read_b64_tr_b16 v[78:79], v27 offset:2048
    ds_read_b64_tr_b16 v[80:81], v28 offset:0
    s_waitcnt lgkmcnt(7)
    v_mfma_f32_16x16x32_bf16 a[0:3], v[32:35], v[64:67], a[0:3]
    ds_read_b64_tr_b16 v[82:83], v28 offset:2048
    ds_read_b64_tr_b16 v[84:85], v29 offset:0
    ds_read_b64_tr_b16 v[86:87], v29 offset:2048
    s_waitcnt lgkmcnt(8)
    v_mfma_f32_16x16x32_bf16 a[4:7], v[32:35], v[68:71], a[4:7]
    ds_read_b64_tr_b16 v[88:89], v30 offset:0
    ds_read_b64_tr_b16 v[90:91], v30 offset:2048
    s_waitcnt lgkmcnt(8)
    v_mfma_f32_16x16x32_bf16 a[8:11], v[32:35], v[72:75], a[8:11]
    ds_read_b64_tr_b16 v[92:93], v31 offset:0
    ds_read_b64_tr_b16 v[94:95], v31 offset:2048
    s_waitcnt lgkmcnt(8)
    v_mfma_f32_16x16x32_bf16 a[12:15], v[32:35], v[76:79], a[12:15]
    ds_read_b128 v[36:39], v23 offset:1024
    ds_read_b128 v[40:43], v23 offset:2048
    s_waitcnt lgkmcnt(8)
    v_mfma_f32_16x16x32_bf16 a[16:19], v[32:35], v[80:83], a[16:19]
    ds_read_b128 v[44:47], v23 offset:3072
    ds_read_b128 v[48:51], v23 offset:4096
    s_waitcnt lgkmcnt(8)
    v_mfma_f32_16x16x32_bf16 a[20:23], v[32:35], v[84:87], a[20:23]
    ds_read_b128 v[52:55], v23 offset:5120
    ds_read_b128 v[56:59], v23 offset:6144
    s_waitcnt lgkmcnt(8)
    v_mfma_f32_16x16x32_bf16 a[24:27], v[32:35], v[88:91], a[24:27]
    ds_read_b128 v[60:63], v23 offset:7168
    s_waitcnt lgkmcnt(7)
    v_mfma_f32_16x16x32_bf16 a[28:31], v[32:35], v[92:95], a[28:31]
    s_waitcnt lgkmcnt(6)
    v_mfma_f32_16x16x32_bf16 a[32:35], v[36:39], v[64:67], a[32:35]
    v_mfma_f32_16x16x32_bf16 a[36:39], v[36:39], v[68:71], a[36:39]
    v_mfma_f32_16x16x32_bf16 a[40:43], v[36:39], v[72:75], a[40:43]
    v_mfma_f32_16x16x32_bf16 a[44:47], v[36:39], v[76:79], a[44:47]
    v_mfma_f32_16x16x32_bf16 a[48:51], v[36:39], v[80:83], a[48:51]
    v_mfma_f32_16x16x32_bf16 a[52:55], v[36:39], v[84:87], a[52:55]
    v_mfma_f32_16x16x32_bf16 a[56:59], v[36:39], v[88:91], a[56:59]
    v_mfma_f32_16x16x32_bf16 a[60:63], v[36:39], v[92:95], a[60:63]
    s_waitcnt lgkmcnt(5)
    v_mfma_f32_16x16x32_bf16 a[64:67], v[40:43], v[64:67], a[64:67]
    v_mfma_f32_16x16x32_bf16 a[68:71], v[40:43], v[68:71], a[68:71]
    v_mfma_f32_16x16x32_bf16 a[72:75], v[40:43], v[72:75], a[72:75]
    v_mfma_f32_16x16x32_bf16 a[76:79], v[40:43], v[76:79], a[76:79]
    v_mfma_f32_16x16x32_bf16 a[80:83], v[40:43], v[80:83], a[80:83]
    v_mfma_f32_16x16x32_bf16 a[84:87], v[40:43], v[84:87], a[84:87]
    v_mfma_f32_16x16x32_bf16 a[88:91], v[40:43], v[88:91], a[88:91]
    v_mfma_f32_16x16x32_bf16 a[92:95], v[40:43], v[92:95], a[92:95]
    s_waitcnt lgkmcnt(4)
    v_mfma_f32_16x16x32_bf16 a[96:99], v[44:47], v[64:67], a[96:99]
    v_mfma_f32_16x16x32_bf16 a[100:103], v[44:47], v[68:71], a[100:103]
    v_mfma_f32_16x16x32_bf16 a[104:107], v[44:47], v[72:75], a[104:107]
    v_mfma_f32_16x16x32_bf16 a[108:111], v[44:47], v[76:79], a[108:111]
    v_mfma_f32_16x16x32_bf16 a[112:115], v[44:47], v[80:83], a[112:115]
    v_mfma_f32_16x16x32_bf16 a[116:119], v[44:47], v[84:87], a[116:119]
    v_mfma_f32_16x16x32_bf16 a[120:123], v[44:47], v[88:91], a[120:123]
    v_mfma_f32_16x16x32_bf16 a[124:127], v[44:47], v[92:95], a[124:127]
    s_waitcnt lgkmcnt(3)
    v_mfma_f32_16x16x32_bf16 a[128:131], v[48:51], v[64:67], a[128:131]
    v_mfma_f32_16x16x32_bf16 a[132:135], v[48:51], v[68:71], a[132:135]
    v_mfma_f32_16x16x32_bf16 a[136:139], v[48:51], v[72:75], a[136:139]
    v_mfma_f32_16x16x32_bf16 a[140:143], v[48:51], v[76:79], a[140:143]
    v_mfma_f32_16x16x32_bf16 a[144:147], v[48:51], v[80:83], a[144:147]
    v_mfma_f32_16x16x32_bf16 a[148:151], v[48:51], v[84:87], a[148:151]
    v_mfma_f32_16x16x32_bf16 a[152:155], v[48:51], v[88:91], a[152:155]
    v_mfma_f32_16x16x32_bf16 a[156:159], v[48:51], v[92:95], a[156:159]
    s_waitcnt lgkmcnt(2)
    v_mfma_f32_16x16x32_bf16 a[160:163], v[52:55], v[64:67], a[160:163]
    v_mfma_f32_16x16x32_bf16 a[164:167], v[52:55], v[68:71], a[164:167]
    v_mfma_f32_16x16x32_bf16 a[168:171], v[52:55], v[72:75], a[168:171]
    v_mfma_f32_16x16x32_bf16 a[172:175], v[52:55], v[76:79], a[172:175]
    v_mfma_f32_16x16x32_bf16 a[176:179], v[52:55], v[80:83], a[176:179]
    v_mfma_f32_16x16x32_bf16 a[180:183], v[52:55], v[84:87], a[180:183]
    v_mfma_f32_16x16x32_bf16 a[184:187], v[52:55], v[88:91], a[184:187]
    v_mfma_f32_16x16x32_bf16 a[188:191], v[52:55], v[92:95], a[188:191]
    s_waitcnt lgkmcnt(1)
    v_mfma_f32_16x16x32_bf16 a[192:195], v[56:59], v[64:67], a[192:195]
    v_mfma_f32_16x16x32_bf16 a[196:199], v[56:59], v[68:71], a[196:199]
    v_mfma_f32_16x16x32_bf16 a[200:203], v[56:59], v[72:75], a[200:203]
    v_mfma_f32_16x16x32_bf16 a[204:207], v[56:59], v[76:79], a[204:207]
    v_mfma_f32_16x16x32_bf16 a[208:211], v[56:59], v[80:83], a[208:211]
    v_mfma_f32_16x16x32_bf16 a[212:215], v[56:59], v[84:87], a[212:215]
    v_mfma_f32_16x16x32_bf16 a[216:219], v[56:59], v[88:91], a[216:219]
    v_mfma_f32_16x16x32_bf16 a[220:223], v[56:59], v[92:95], a[220:223]
    s_waitcnt lgkmcnt(0)
    v_mfma_f32_16x16x32_bf16 a[224:227], v[60:63], v[64:67], a[224:227]
    v_mfma_f32_16x16x32_bf16 a[228:231], v[60:63], v[68:71], a[228:231]
    v_mfma_f32_16x16x32_bf16 a[232:235], v[60:63], v[72:75], a[232:235]
    v_mfma_f32_16x16x32_bf16 a[236:239], v[60:63], v[76:79], a[236:239]
    v_mfma_f32_16x16x32_bf16 a[240:243], v[60:63], v[80:83], a[240:243]
    v_mfma_f32_16x16x32_bf16 a[244:247], v[60:63], v[84:87], a[244:247]
    v_mfma_f32_16x16x32_bf16 a[248:251], v[60:63], v[88:91], a[248:251]
    v_mfma_f32_16x16x32_bf16 a[252:255], v[60:63], v[92:95], a[252:255]
    s_add_u32 s59, s59, 32768
    s_cmp_ge_u32 s59, 98304
    s_cselect_b32 s59, 0, s59
    s_sub_u32 s62, s62, 1
    s_cmp_lg_u32 s62, 0
    s_cbranch_scc1 L_wv_loop
    s_waitcnt vmcnt(8)
    s_barrier
    v_add_u32 v23, s59, v14
    v_add_u32 v24, s59, v15
    v_add_u32 v25, s59, v16
    v_add_u32 v26, s59, v17
    v_add_u32 v27, s59, v18
    v_add_u32 v28, s59, v19
    v_add_u32 v29, s59, v20
    v_add_u32 v30, s59, v21
    v_add_u32 v31, s59, v22
    ds_read_b128 v[32:35], v23 offset:0
    ds_read_b64_tr_b16 v[64:65], v24 offset:0
    ds_read_b64_tr_b16 v[66:67], v24 offset:2048
    ds_read_b64_tr_b16 v[68:69], v25 offset:0
    ds_read_b64_tr_b16 v[70:71], v25 offset:2048
    ds_read_b64_tr_b16 v[72:73], v26 offset:0
    ds_read_b64_tr_b16 v[74:75], v26 offset:2048
    ds_read_b64_tr_b16 v[76:77], v27 offset:0
    ds_read_b64_tr_b16 v[78:79], v27 offset:2048
    ds_read_b64_tr_b16 v[80:81], v28 offset:0
    s_waitcnt lgkmcnt(7)
    v_mfma_f32_16x16x32_bf16 a[0:3], v[32:35], v[64:67], a[0:3]
    ds_read_b64_tr_b16 v[82:83], v28 offset:2048
    ds_read_b64_tr_b16 v[84:85], v29 offset:0
    ds_read_b64_tr_b16 v[86:87], v29 offset:2048
    s_waitcnt lgkmcnt(8)
    v_mfma_f32_16x16x32_bf16 a[4:7], v[32:35], v[68:71], a[4:7]
    ds_read_b64_tr_b16 v[88:89], v30 offset:0
    ds_read_b64_tr_b16 v[90:91], v30 offset:2048
    s_waitcnt lgkmcnt(8)
    v_mfma_f32_16x16x32_bf16 a[8:11], v[32:35], v[72:75], a[8:11]
    ds_read_b64_tr_b16 v[92:93], v31 offset:0
    ds_read_b64_tr_b16 v[94:95], v31 offset:2048
    s_waitcnt lgkmcnt(8)
    v_mfma_f32_16x16x32_bf16 a[12:15], v[32:35], v[76:79], a[12:15]
    ds_read_b128 v[36:39], v23 offset:1024
    ds_read_b128 v[40:43], v23 offset:2048
    s_waitcnt lgkmcnt(8)
    v_mfma_f32_16x16x32_bf16 a[16:19], v[32:35], v[80:83], a[16:19]
    ds_read_b128 v[44:47], v23 offset:3072
    ds_read_b128 v[48:51], v23 offset:4096
    s_waitcnt lgkmcnt(8)
    v_mfma_f32_16x16x32_bf16 a[20:23], v[32:35], v[84:87], a[20:23]
    ds_read_b128 v[52:55], v23 offset:5120
    ds_read_b128 v[56:59], v23 offset:6144
    s_waitcnt lgkmcnt(8)
    v_mfma_f32_16x16x32_bf16 a[24:27], v[32:35], v[88:91], a[24:27]
    ds_read_b128 v[60:63], v23 offset:7168
    s_waitcnt lgkmcnt(7)
    v_mfma_f32_16x16x32_bf16 a[28:31], v[32:35], v[92:95], a[28:31]
    s_waitcnt lgkmcnt(6)
    v_mfma_f32_16x16x32_bf16 a[32:35], v[36:39], v[64:67], a[32:35]
    v_mfma_f32_16x16x32_bf16 a[36:39], v[36:39], v[68:71], a[36:39]
    v_mfma_f32_16x16x32_bf16 a[40:43], v[36:39], v[72:75], a[40:43]
    v_mfma_f32_16x16x32_bf16 a[44:47], v[36:39], v[76:79], a[44:47]
    v_mfma_f32_16x16x32_bf16 a[48:51], v[36:39], v[80:83], a[48:51]
    v_mfma_f32_16x16x32_bf16 a[52:55], v[36:39], v[84:87], a[52:55]
    v_mfma_f32_16x16x32_bf16 a[56:59], v[36:39], v[88:91], a[56:59]
    v_mfma_f32_16x16x32_bf16 a[60:63], v[36:39], v[92:95], a[60:63]
    s_waitcnt lgkmcnt(5)
    v_mfma_f32_16x16x32_bf16 a[64:67], v[40:43], v[64:67], a[64:67]
    v_mfma_f32_16x16x32_bf16 a[68:71], v[40:43], v[68:71], a[68:71]
    v_mfma_f32_16x16x32_bf16 a[72:75], v[40:43], v[72:75], a[72:75]
    v_mfma_f32_16x16x32_bf16 a[76:79], v[40:43], v[76:79], a[76:79]
    v_mfma_f32_16x16x32_bf16 a[80:83], v[40:43], v[80:83], a[80:83]
    v_mfma_f32_16x16x32_bf16 a[84:87], v[40:43], v[84:87], a[84:87]
    v_mfma_f32_16x16x32_bf16 a[88:91], v[40:43], v[88:91], a[88:91]
    v_mfma_f32_16x16x32_bf16 a[92:95], v[40:43], v[92:95], a[92:95]
    s_waitcnt lgkmcnt(4)
    v_mfma_f32_16x16x32_bf16 a[96:99], v[44:47], v[64:67], a[96:99]
    v_mfma_f32_16x16x32_bf16 a[100:103], v[44:47], v[68:71], a[100:103]
    v_mfma_f32_16x16x32_bf16 a[104:107], v[44:47], v[72:75], a[104:107]
    v_mfma_f32_16x16x32_bf16 a[108:111], v[44:47], v[76:79], a[108:111]
    v_mfma_f32_16x16x32_bf16 a[112:115], v[44:47], v[80:83], a[112:115]
    v_mfma_f32_16x16x32_bf16 a[116:119], v[44:47], v[84:87], a[116:119]
    v_mfma_f32_16x16x32_bf16 a[120:123], v[44:47], v[88:91], a[120:123]
    v_mfma_f32_16x16x32_bf16 a[124:127], v[44:47], v[92:95], a[124:127]
    s_waitcnt lgkmcnt(3)
    v_mfma_f32_16x16x32_bf16 a[128:131], v[48:51], v[64:67], a[128:131]
    v_mfma_f32_16x16x32_bf16 a[132:135], v[48:51], v[68:71], a[132:135]
    v_mfma_f32_16x16x32_bf16 a[136:139], v[48:51], v[72:75], a[136:139]
    v_mfma_f32_16x16x32_bf16 a[140:143], v[48:51], v[76:79], a[140:143]
    v_mfma_f32_16x16x32_bf16 a[144:147], v[48:51], v[80:83], a[144:147]
    v_mfma_f32_16x16x32_bf16 a[148:151], v[48:51], v[84:87], a[148:151]
    v_mfma_f32_16x16x32_bf16 a[152:155], v[48:51], v[88:91], a[152:155]
    v_mfma_f32_16x16x32_bf16 a[156:159], v[48:51], v[92:95], a[156:159]
    s_waitcnt lgkmcnt(2)
    v_mfma_f32_16x16x32_bf16 a[160:163], v[52:55], v[64:67], a[160:163]
    v_mfma_f32_16x16x32_bf16 a[164:167], v[52:55], v[68:71], a[164:167]
    v_mfma_f32_16x16x32_bf16 a[168:171], v[52:55], v[72:75], a[168:171]
    v_mfma_f32_16x16x32_bf16 a[172:175], v[52:55], v[76:79], a[172:175]
    v_mfma_f32_16x16x32_bf16 a[176:179], v[52:55], v[80:83], a[176:179]
    v_mfma_f32_16x16x32_bf16 a[180:183], v[52:55], v[84:87], a[180:183]
    v_mfma_f32_16x16x32_bf16 a[184:187], v[52:55], v[88:91], a[184:187]
    v_mfma_f32_16x16x32_bf16 a[188:191], v[52:55], v[92:95], a[188:191]
    s_waitcnt lgkmcnt(1)
    v_mfma_f32_16x16x32_bf16 a[192:195], v[56:59], v[64:67], a[192:195]
    v_mfma_f32_16x16x32_bf16 a[196:199], v[56:59], v[68:71], a[196:199]
    v_mfma_f32_16x16x32_bf16 a[200:203], v[56:59], v[72:75], a[200:203]
    v_mfma_f32_16x16x32_bf16 a[204:207], v[56:59], v[76:79], a[204:207]
    v_mfma_f32_16x16x32_bf16 a[208:211], v[56:59], v[80:83], a[208:211]
    v_mfma_f32_16x16x32_bf16 a[212:215], v[56:59], v[84:87], a[212:215]
    v_mfma_f32_16x16x32_bf16 a[216:219], v[56:59], v[88:91], a[216:219]
    v_mfma_f32_16x16x32_bf16 a[220:223], v[56:59], v[92:95], a[220:223]
    s_waitcnt lgkmcnt(0)
    v_mfma_f32_16x16x32_bf16 a[224:227], v[60:63], v[64:67], a[224:227]
    v_mfma_f32_16x16x32_bf16 a[228:231], v[60:63], v[68:71], a[228:231]
    v_mfma_f32_16x16x32_bf16 a[232:235], v[60:63], v[72:75], a[232:235]
    v_mfma_f32_16x16x32_bf16 a[236:239], v[60:63], v[76:79], a[236:239]
    v_mfma_f32_16x16x32_bf16 a[240:243], v[60:63], v[80:83], a[240:243]
    v_mfma_f32_16x16x32_bf16 a[244:247], v[60:63], v[84:87], a[244:247]
    v_mfma_f32_16x16x32_bf16 a[248:251], v[60:63], v[88:91], a[248:251]
    v_mfma_f32_16x16x32_bf16 a[252:255], v[60:63], v[92:95], a[252:255]
    s_add_u32 s59, s59, 32768
    s_cmp_ge_u32 s59, 98304
    s_cselect_b32 s59, 0, s59
    s_waitcnt vmcnt(0)
    s_barrier
    v_add_u32 v23, s59, v14
    v_add_u32 v24, s59, v15
    v_add_u32 v25, s59, v16
    v_add_u32 v26, s59, v17
    v_add_u32 v27, s59, v18
    v_add_u32 v28, s59, v19
    v_add_u32 v29, s59, v20
    v_add_u32 v30, s59, v21
    v_add_u32 v31, s59, v22
    ds_read_b128 v[32:35], v23 offset:0
    ds_read_b64_tr_b16 v[64:65], v24 offset:0
    ds_read_b64_tr_b16 v[66:67], v24 offset:2048
    ds_read_b64_tr_b16 v[68:69], v25 offset:0
    ds_read_b64_tr_b16 v[70:71], v25 offset:2048
    ds_read_b64_tr_b16 v[72:73], v26 offset:0
    ds_read_b64_tr_b16 v[74:75], v26 offset:2048
    ds_read_b64_tr_b16 v[76:77], v27 offset:0
    ds_read_b64_tr_b16 v[78:79], v27 offset:2048
    ds_read_b64_tr_b16 v[80:81], v28 offset:0
    s_waitcnt lgkmcnt(7)
    v_mfma_f32_16x16x32_bf16 a[0:3], v[32:35], v[64:67], a[0:3]
    ds_read_b64_tr_b16 v[82:83], v28 offset:2048
    ds_read_b64_tr_b16 v[84:85], v29 offset:0
    ds_read_b64_tr_b16 v[86:87], v29 offset:2048
    s_waitcnt lgkmcnt(8)
    v_mfma_f32_16x16x32_bf16 a[4:7], v[32:35], v[68:71], a[4:7]
    ds_read_b64_tr_b16 v[88:89], v30 offset:0
    ds_read_b64_tr_b16 v[90:91], v30 offset:2048
    s_waitcnt lgkmcnt(8)
    v_mfma_f32_16x16x32_bf16 a[8:11], v[32:35], v[72:75], a[8:11]
    ds_read_b64_tr_b16 v[92:93], v31 offset:0
    ds_read_b64_tr_b16 v[94:95], v31 offset:2048
    s_waitcnt lgkmcnt(8)
    v_mfma_f32_16x16x32_bf16 a[12:15], v[32:35], v[76:79], a[12:15]
    ds_read_b128 v[36:39], v23 offset:1024
    ds_read_b128 v[40:43], v23 offset:2048
    s_waitcnt lgkmcnt(8)
    v_mfma_f32_16x16x32_bf16 a[16:19], v[32:35], v[80:83], a[16:19]
    ds_read_b128 v[44:47], v23 offset:3072
    ds_read_b128 v[48:51], v23 offset:4096
    s_waitcnt lgkmcnt(8)
    v_mfma_f32_16x16x32_bf16 a[20:23], v[32:35], v[84:87], a[20:23]
    ds_read_b128 v[52:55], v23 offset:5120
    ds_read_b128 v[56:59], v23 offset:6144
    s_waitcnt lgkmcnt(8)
    v_mfma_f32_16x16x32_bf16 a[24:27], v[32:35], v[88:91], a[24:27]
    ds_read_b128 v[60:63], v23 offset:7168
    s_waitcnt lgkmcnt(7)
    v_mfma_f32_16x16x32_bf16 a[28:31], v[32:35], v[92:95], a[28:31]
    s_waitcnt lgkmcnt(6)
    v_mfma_f32_16x16x32_bf16 a[32:35], v[36:39], v[64:67], a[32:35]
    v_mfma_f32_16x16x32_bf16 a[36:39], v[36:39], v[68:71], a[36:39]
    v_mfma_f32_16x16x32_bf16 a[40:43], v[36:39], v[72:75], a[40:43]
    v_mfma_f32_16x16x32_bf16 a[44:47], v[36:39], v[76:79], a[44:47]
    v_mfma_f32_16x16x32_bf16 a[48:51], v[36:39], v[80:83], a[48:51]
    v_mfma_f32_16x16x32_bf16 a[52:55], v[36:39], v[84:87], a[52:55]
    v_mfma_f32_16x16x32_bf16 a[56:59], v[36:39], v[88:91], a[56:59]
    v_mfma_f32_16x16x32_bf16 a[60:63], v[36:39], v[92:95], a[60:63]
    s_waitcnt lgkmcnt(5)
    v_mfma_f32_16x16x32_bf16 a[64:67], v[40:43], v[64:67], a[64:67]
    v_mfma_f32_16x16x32_bf16 a[68:71], v[40:43], v[68:71], a[68:71]
    v_mfma_f32_16x16x32_bf16 a[72:75], v[40:43], v[72:75], a[72:75]
    v_mfma_f32_16x16x32_bf16 a[76:79], v[40:43], v[76:79], a[76:79]
    v_mfma_f32_16x16x32_bf16 a[80:83], v[40:43], v[80:83], a[80:83]
    v_mfma_f32_16x16x32_bf16 a[84:87], v[40:43], v[84:87], a[84:87]
    v_mfma_f32_16x16x32_bf16 a[88:91], v[40:43], v[88:91], a[88:91]
    v_mfma_f32_16x16x32_bf16 a[92:95], v[40:43], v[92:95], a[92:95]
    s_waitcnt lgkmcnt(4)
    v_mfma_f32_16x16x32_bf16 a[96:99], v[44:47], v[64:67], a[96:99]
    v_mfma_f32_16x16x32_bf16 a[100:103], v[44:47], v[68:71], a[100:103]
    v_mfma_f32_16x16x32_bf16 a[104:107], v[44:47], v[72:75], a[104:107]
    v_mfma_f32_16x16x32_bf16 a[108:111], v[44:47], v[76:79], a[108:111]
    v_mfma_f32_16x16x32_bf16 a[112:115], v[44:47], v[80:83], a[112:115]
    v_mfma_f32_16x16x32_bf16 a[116:119], v[44:47], v[84:87], a[116:119]
    v_mfma_f32_16x16x32_bf16 a[120:123], v[44:47], v[88:91], a[120:123]
    v_mfma_f32_16x16x32_bf16 a[124:127], v[44:47], v[92:95], a[124:127]
    s_waitcnt lgkmcnt(3)
    v_mfma_f32_16x16x32_bf16 a[128:131], v[48:51], v[64:67], a[128:131]
    v_mfma_f32_16x16x32_bf16 a[132:135], v[48:51], v[68:71], a[132:135]
    v_mfma_f32_16x16x32_bf16 a[136:139], v[48:51], v[72:75], a[136:139]
    v_mfma_f32_16x16x32_bf16 a[140:143], v[48:51], v[76:79], a[140:143]
    v_mfma_f32_16x16x32_bf16 a[144:147], v[48:51], v[80:83], a[144:147]
    v_mfma_f32_16x16x32_bf16 a[148:151], v[48:51], v[84:87], a[148:151]
    v_mfma_f32_16x16x32_bf16 a[152:155], v[48:51], v[88:91], a[152:155]
    v_mfma_f32_16x16x32_bf16 a[156:159], v[48:51], v[92:95], a[156:159]
    s_waitcnt lgkmcnt(2)
    v_mfma_f32_16x16x32_bf16 a[160:163], v[52:55], v[64:67], a[160:163]
    v_mfma_f32_16x16x32_bf16 a[164:167], v[52:55], v[68:71], a[164:167]
    v_mfma_f32_16x16x32_bf16 a[168:171], v[52:55], v[72:75], a[168:171]
    v_mfma_f32_16x16x32_bf16 a[172:175], v[52:55], v[76:79], a[172:175]
    v_mfma_f32_16x16x32_bf16 a[176:179], v[52:55], v[80:83], a[176:179]
    v_mfma_f32_16x16x32_bf16 a[180:183], v[52:55], v[84:87], a[180:183]
    v_mfma_f32_16x16x32_bf16 a[184:187], v[52:55], v[88:91], a[184:187]
    v_mfma_f32_16x16x32_bf16 a[188:191], v[52:55], v[92:95], a[188:191]
    s_waitcnt lgkmcnt(1)
    v_mfma_f32_16x16x32_bf16 a[192:195], v[56:59], v[64:67], a[192:195]
    v_mfma_f32_16x16x32_bf16 a[196:199], v[56:59], v[68:71], a[196:199]
    v_mfma_f32_16x16x32_bf16 a[200:203], v[56:59], v[72:75], a[200:203]
    v_mfma_f32_16x16x32_bf16 a[204:207], v[56:59], v[76:79], a[204:207]
    v_mfma_f32_16x16x32_bf16 a[208:211], v[56:59], v[80:83], a[208:211]
    v_mfma_f32_16x16x32_bf16 a[212:215], v[56:59], v[84:87], a[212:215]
    v_mfma_f32_16x16x32_bf16 a[216:219], v[56:59], v[88:91], a[216:219]
    v_mfma_f32_16x16x32_bf16 a[220:223], v[56:59], v[92:95], a[220:223]
    s_waitcnt lgkmcnt(0)
    v_mfma_f32_16x16x32_bf16 a[224:227], v[60:63], v[64:67], a[224:227]
    v_mfma_f32_16x16x32_bf16 a[228:231], v[60:63], v[68:71], a[228:231]
    v_mfma_f32_16x16x32_bf16 a[232:235], v[60:63], v[72:75], a[232:235]
    v_mfma_f32_16x16x32_bf16 a[236:239], v[60:63], v[76:79], a[236:239]
    v_mfma_f32_16x16x32_bf16 a[240:243], v[60:63], v[80:83], a[240:243]
    v_mfma_f32_16x16x32_bf16 a[244:247], v[60:63], v[84:87], a[244:247]
    v_mfma_f32_16x16x32_bf16 a[248:251], v[60:63], v[88:91], a[248:251]
    v_mfma_f32_16x16x32_bf16 a[252:255], v[60:63], v[92:95], a[252:255]
    s_add_u32 s59, s59, 32768
    s_cmp_ge_u32 s59, 98304
    s_cselect_b32 s59, 0, s59
    s_nop 7
    s_nop 7
    s_add_u32 s28, s4, 0x3280000
    s_addc_u32 s29, s5, 0
    s_mov_b32 s30, 0x1800000
    s_mov_b32 s31, 0x20000
    s_mul_i32 s53, s41, 8
    s_mul_i32 s54, s45, 4
    s_add_u32 s53, s53, s54
    s_mul_i32 s53, s53, 393216
    s_mul_i32 s54, s47, 16
    s_mul_i32 s55, s46, 8
    s_add_u32 s54, s54, s55
    s_lshl_b32 s54, s54, 10
    s_add_u32 s53, s53, s54
    v_lshlrev_b32 v3, 4, v2
    v_add_u32 v3, s53, v3
    v_add_u32 v4, 4096, v3
    v_accvgpr_read_b32 v48, a0
    v_accvgpr_read_b32 v49, a1
    v_accvgpr_read_b32 v50, a2
    v_accvgpr_read_b32 v51, a3
    v_accvgpr_read_b32 v52, a32
    v_accvgpr_read_b32 v53, a33
    v_accvgpr_read_b32 v54, a34
    v_accvgpr_read_b32 v55, a35
    v_cvt_pk_bf16_f32 v32, v48, v49
    v_cvt_pk_bf16_f32 v33, v50, v51
    v_cvt_pk_bf16_f32 v34, v52, v53
    v_cvt_pk_bf16_f32 v35, v54, v55
    buffer_store_dwordx4 v[32:35], v3, s[28:31], 0 offen offset:0 sc1
    v_accvgpr_read_b32 v56, a4
    v_accvgpr_read_b32 v57, a5
    v_accvgpr_read_b32 v58, a6
    v_accvgpr_read_b32 v59, a7
    v_accvgpr_read_b32 v60, a36
    v_accvgpr_read_b32 v61, a37
    v_accvgpr_read_b32 v62, a38
    v_accvgpr_read_b32 v63, a39
    v_cvt_pk_bf16_f32 v36, v56, v57
    v_cvt_pk_bf16_f32 v37, v58, v59
    v_cvt_pk_bf16_f32 v38, v60, v61
    v_cvt_pk_bf16_f32 v39, v62, v63
    buffer_store_dwordx4 v[36:39], v3, s[28:31], 0 offen offset:1024 sc1
    v_accvgpr_read_b32 v48, a8
    v_accvgpr_read_b32 v49, a9
    v_accvgpr_read_b32 v50, a10
    v_accvgpr_read_b32 v51, a11
    v_accvgpr_read_b32 v52, a40
    v_accvgpr_read_b32 v53, a41
    v_accvgpr_read_b32 v54, a42
    v_accvgpr_read_b32 v55, a43
    v_cvt_pk_bf16_f32 v40, v48, v49
    v_cvt_pk_bf16_f32 v41, v50, v51
    v_cvt_pk_bf16_f32 v42, v52, v53
    v_cvt_pk_bf16_f32 v43, v54, v55
    buffer_store_dwordx4 v[40:43], v3, s[28:31], 0 offen offset:2048 sc1
    v_accvgpr_read_b32 v56, a12
    v_accvgpr_read_b32 v57, a13
    v_accvgpr_read_b32 v58, a14
    v_accvgpr_read_b32 v59, a15
    v_accvgpr_read_b32 v60, a44
    v_accvgpr_read_b32 v61, a45
    v_accvgpr_read_b32 v62, a46
    v_accvgpr_read_b32 v63, a47
    v_cvt_pk_bf16_f32 v44, v56, v57
    v_cvt_pk_bf16_f32 v45, v58, v59
    v_cvt_pk_bf16_f32 v46, v60, v61
    v_cvt_pk_bf16_f32 v47, v62, v63
    buffer_store_dwordx4 v[44:47], v3, s[28:31], 0 offen offset:3072 sc1
    v_accvgpr_read_b32 v48, a16
    v_accvgpr_read_b32 v49, a17
    v_accvgpr_read_b32 v50, a18
    v_accvgpr_read_b32 v51, a19
    v_accvgpr_read_b32 v52, a48
    v_accvgpr_read_b32 v53, a49
    v_accvgpr_read_b32 v54, a50
    v_accvgpr_read_b32 v55, a51
    v_cvt_pk_bf16_f32 v32, v48, v49
    v_cvt_pk_bf16_f32 v33, v50, v51
    v_cvt_pk_bf16_f32 v34, v52, v53
    v_cvt_pk_bf16_f32 v35, v54, v55
    buffer_store_dwordx4 v[32:35], v4, s[28:31], 0 offen offset:0 sc1
    v_accvgpr_read_b32 v56, a20
    v_accvgpr_read_b32 v57, a21
    v_accvgpr_read_b32 v58, a22
    v_accvgpr_read_b32 v59, a23
    v_accvgpr_read_b32 v60, a52
    v_accvgpr_read_b32 v61, a53
    v_accvgpr_read_b32 v62, a54
    v_accvgpr_read_b32 v63, a55
    v_cvt_pk_bf16_f32 v36, v56, v57
    v_cvt_pk_bf16_f32 v37, v58, v59
    v_cvt_pk_bf16_f32 v38, v60, v61
    v_cvt_pk_bf16_f32 v39, v62, v63
    buffer_store_dwordx4 v[36:39], v4, s[28:31], 0 offen offset:1024 sc1
    v_accvgpr_read_b32 v48, a24
    v_accvgpr_read_b32 v49, a25
    v_accvgpr_read_b32 v50, a26
    v_accvgpr_read_b32 v51, a27
    v_accvgpr_read_b32 v52, a56
    v_accvgpr_read_b32 v53, a57
    v_accvgpr_read_b32 v54, a58
    v_accvgpr_read_b32 v55, a59
    v_cvt_pk_bf16_f32 v40, v48, v49
    v_cvt_pk_bf16_f32 v41, v50, v51
    v_cvt_pk_bf16_f32 v42, v52, v53
    v_cvt_pk_bf16_f32 v43, v54, v55
    buffer_store_dwordx4 v[40:43], v4, s[28:31], 0 offen offset:2048 sc1
    v_accvgpr_read_b32 v56, a28
    v_accvgpr_read_b32 v57, a29
    v_accvgpr_read_b32 v58, a30
    v_accvgpr_read_b32 v59, a31
    v_accvgpr_read_b32 v60, a60
    v_accvgpr_read_b32 v61, a61
    v_accvgpr_read_b32 v62, a62
    v_accvgpr_read_b32 v63, a63
    v_cvt_pk_bf16_f32 v44, v56, v57
    v_cvt_pk_bf16_f32 v45, v58, v59
    v_cvt_pk_bf16_f32 v46, v60, v61
    v_cvt_pk_bf16_f32 v47, v62, v63
    buffer_store_dwordx4 v[44:47], v4, s[28:31], 0 offen offset:3072 sc1
    v_add_u32 v3, 0x60000, v3
    v_add_u32 v4, 4096, v3
    v_accvgpr_read_b32 v48, a64
    v_accvgpr_read_b32 v49, a65
    v_accvgpr_read_b32 v50, a66
    v_accvgpr_read_b32 v51, a67
    v_accvgpr_read_b32 v52, a96
    v_accvgpr_read_b32 v53, a97
    v_accvgpr_read_b32 v54, a98
    v_accvgpr_read_b32 v55, a99
    v_cvt_pk_bf16_f32 v32, v48, v49
    v_cvt_pk_bf16_f32 v33, v50, v51
    v_cvt_pk_bf16_f32 v34, v52, v53
    v_cvt_pk_bf16_f32 v35, v54, v55
    buffer_store_dwordx4 v[32:35], v3, s[28:31], 0 offen offset:0 sc1
    v_accvgpr_read_b32 v56, a68
    v_accvgpr_read_b32 v57, a69
    v_accvgpr_read_b32 v58, a70
    v_accvgpr_read_b32 v59, a71
    v_accvgpr_read_b32 v60, a100
    v_accvgpr_read_b32 v61, a101
    v_accvgpr_read_b32 v62, a102
    v_accvgpr_read_b32 v63, a103
    v_cvt_pk_bf16_f32 v36, v56, v57
    v_cvt_pk_bf16_f32 v37, v58, v59
    v_cvt_pk_bf16_f32 v38, v60, v61
    v_cvt_pk_bf16_f32 v39, v62, v63
    buffer_store_dwordx4 v[36:39], v3, s[28:31], 0 offen offset:1024 sc1
    v_accvgpr_read_b32 v48, a72
    v_accvgpr_read_b32 v49, a73
    v_accvgpr_read_b32 v50, a74
    v_accvgpr_read_b32 v51, a75
    v_accvgpr_read_b32 v52, a104
    v_accvgpr_read_b32 v53, a105
    v_accvgpr_read_b32 v54, a106
    v_accvgpr_read_b32 v55, a107
    v_cvt_pk_bf16_f32 v40, v48, v49
    v_cvt_pk_bf16_f32 v41, v50, v51
    v_cvt_pk_bf16_f32 v42, v52, v53
    v_cvt_pk_bf16_f32 v43, v54, v55
    buffer_store_dwordx4 v[40:43], v3, s[28:31], 0 offen offset:2048 sc1
    v_accvgpr_read_b32 v56, a76
    v_accvgpr_read_b32 v57, a77
    v_accvgpr_read_b32 v58, a78
    v_accvgpr_read_b32 v59, a79
    v_accvgpr_read_b32 v60, a108
    v_accvgpr_read_b32 v61, a109
    v_accvgpr_read_b32 v62, a110
    v_accvgpr_read_b32 v63, a111
    v_cvt_pk_bf16_f32 v44, v56, v57
    v_cvt_pk_bf16_f32 v45, v58, v59
    v_cvt_pk_bf16_f32 v46, v60, v61
    v_cvt_pk_bf16_f32 v47, v62, v63
    buffer_store_dwordx4 v[44:47], v3, s[28:31], 0 offen offset:3072 sc1
    v_accvgpr_read_b32 v48, a80
    v_accvgpr_read_b32 v49, a81
    v_accvgpr_read_b32 v50, a82
    v_accvgpr_read_b32 v51, a83
    v_accvgpr_read_b32 v52, a112
    v_accvgpr_read_b32 v53, a113
    v_accvgpr_read_b32 v54, a114
    v_accvgpr_read_b32 v55, a115
    v_cvt_pk_bf16_f32 v32, v48, v49
    v_cvt_pk_bf16_f32 v33, v50, v51
    v_cvt_pk_bf16_f32 v34, v52, v53
    v_cvt_pk_bf16_f32 v35, v54, v55
    buffer_store_dwordx4 v[32:35], v4, s[28:31], 0 offen offset:0 sc1
    v_accvgpr_read_b32 v56, a84
    v_accvgpr_read_b32 v57, a85
    v_accvgpr_read_b32 v58, a86
    v_accvgpr_read_b32 v59, a87
    v_accvgpr_read_b32 v60, a116
    v_accvgpr_read_b32 v61, a117
    v_accvgpr_read_b32 v62, a118
    v_accvgpr_read_b32 v63, a119
    v_cvt_pk_bf16_f32 v36, v56, v57
    v_cvt_pk_bf16_f32 v37, v58, v59
    v_cvt_pk_bf16_f32 v38, v60, v61
    v_cvt_pk_bf16_f32 v39, v62, v63
    buffer_store_dwordx4 v[36:39], v4, s[28:31], 0 offen offset:1024 sc1
    v_accvgpr_read_b32 v48, a88
    v_accvgpr_read_b32 v49, a89
    v_accvgpr_read_b32 v50, a90
    v_accvgpr_read_b32 v51, a91
    v_accvgpr_read_b32 v52, a120
    v_accvgpr_read_b32 v53, a121
    v_accvgpr_read_b32 v54, a122
    v_accvgpr_read_b32 v55, a123
    v_cvt_pk_bf16_f32 v40, v48, v49
    v_cvt_pk_bf16_f32 v41, v50, v51
    v_cvt_pk_bf16_f32 v42, v52, v53
    v_cvt_pk_bf16_f32 v43, v54, v55
    buffer_store_dwordx4 v[40:43], v4, s[28:31], 0 offen offset:2048 sc1
    v_accvgpr_read_b32 v56, a92
    v_accvgpr_read_b32 v57, a93
    v_accvgpr_read_b32 v58, a94
    v_accvgpr_read_b32 v59, a95
    v_accvgpr_read_b32 v60, a124
    v_accvgpr_read_b32 v61, a125
    v_accvgpr_read_b32 v62, a126
    v_accvgpr_read_b32 v63, a127
    v_cvt_pk_bf16_f32 v44, v56, v57
    v_cvt_pk_bf16_f32 v45, v58, v59
    v_cvt_pk_bf16_f32 v46, v60, v61
    v_cvt_pk_bf16_f32 v47, v62, v63
    buffer_store_dwordx4 v[44:47], v4, s[28:31], 0 offen offset:3072 sc1
    v_add_u32 v3, 0x60000, v3
    v_add_u32 v4, 4096, v3
    v_accvgpr_read_b32 v48, a128
    v_accvgpr_read_b32 v49, a129
    v_accvgpr_read_b32 v50, a130
    v_accvgpr_read_b32 v51, a131
    v_accvgpr_read_b32 v52, a160
    v_accvgpr_read_b32 v53, a161
    v_accvgpr_read_b32 v54, a162
    v_accvgpr_read_b32 v55, a163
    v_cvt_pk_bf16_f32 v32, v48, v49
    v_cvt_pk_bf16_f32 v33, v50, v51
    v_cvt_pk_bf16_f32 v34, v52, v53
    v_cvt_pk_bf16_f32 v35, v54, v55
    buffer_store_dwordx4 v[32:35], v3, s[28:31], 0 offen offset:0 sc1
    v_accvgpr_read_b32 v56, a132
    v_accvgpr_read_b32 v57, a133
    v_accvgpr_read_b32 v58, a134
    v_accvgpr_read_b32 v59, a135
    v_accvgpr_read_b32 v60, a164
    v_accvgpr_read_b32 v61, a165
    v_accvgpr_read_b32 v62, a166
    v_accvgpr_read_b32 v63, a167
    v_cvt_pk_bf16_f32 v36, v56, v57
    v_cvt_pk_bf16_f32 v37, v58, v59
    v_cvt_pk_bf16_f32 v38, v60, v61
    v_cvt_pk_bf16_f32 v39, v62, v63
    buffer_store_dwordx4 v[36:39], v3, s[28:31], 0 offen offset:1024 sc1
    v_accvgpr_read_b32 v48, a136
    v_accvgpr_read_b32 v49, a137
    v_accvgpr_read_b32 v50, a138
    v_accvgpr_read_b32 v51, a139
    v_accvgpr_read_b32 v52, a168
    v_accvgpr_read_b32 v53, a169
    v_accvgpr_read_b32 v54, a170
    v_accvgpr_read_b32 v55, a171
    v_cvt_pk_bf16_f32 v40, v48, v49
    v_cvt_pk_bf16_f32 v41, v50, v51
    v_cvt_pk_bf16_f32 v42, v52, v53
    v_cvt_pk_bf16_f32 v43, v54, v55
    buffer_store_dwordx4 v[40:43], v3, s[28:31], 0 offen offset:2048 sc1
    v_accvgpr_read_b32 v56, a140
    v_accvgpr_read_b32 v57, a141
    v_accvgpr_read_b32 v58, a142
    v_accvgpr_read_b32 v59, a143
    v_accvgpr_read_b32 v60, a172
    v_accvgpr_read_b32 v61, a173
    v_accvgpr_read_b32 v62, a174
    v_accvgpr_read_b32 v63, a175
    v_cvt_pk_bf16_f32 v44, v56, v57
    v_cvt_pk_bf16_f32 v45, v58, v59
    v_cvt_pk_bf16_f32 v46, v60, v61
    v_cvt_pk_bf16_f32 v47, v62, v63
    buffer_store_dwordx4 v[44:47], v3, s[28:31], 0 offen offset:3072 sc1
    v_accvgpr_read_b32 v48, a144
    v_accvgpr_read_b32 v49, a145
    v_accvgpr_read_b32 v50, a146
    v_accvgpr_read_b32 v51, a147
    v_accvgpr_read_b32 v52, a176
    v_accvgpr_read_b32 v53, a177
    v_accvgpr_read_b32 v54, a178
    v_accvgpr_read_b32 v55, a179
    v_cvt_pk_bf16_f32 v32, v48, v49
    v_cvt_pk_bf16_f32 v33, v50, v51
    v_cvt_pk_bf16_f32 v34, v52, v53
    v_cvt_pk_bf16_f32 v35, v54, v55
    buffer_store_dwordx4 v[32:35], v4, s[28:31], 0 offen offset:0 sc1
    v_accvgpr_read_b32 v56, a148
    v_accvgpr_read_b32 v57, a149
    v_accvgpr_read_b32 v58, a150
    v_accvgpr_read_b32 v59, a151
    v_accvgpr_read_b32 v60, a180
    v_accvgpr_read_b32 v61, a181
    v_accvgpr_read_b32 v62, a182
    v_accvgpr_read_b32 v63, a183
    v_cvt_pk_bf16_f32 v36, v56, v57
    v_cvt_pk_bf16_f32 v37, v58, v59
    v_cvt_pk_bf16_f32 v38, v60, v61
    v_cvt_pk_bf16_f32 v39, v62, v63
    buffer_store_dwordx4 v[36:39], v4, s[28:31], 0 offen offset:1024 sc1
    v_accvgpr_read_b32 v48, a152
    v_accvgpr_read_b32 v49, a153
    v_accvgpr_read_b32 v50, a154
    v_accvgpr_read_b32 v51, a155
    v_accvgpr_read_b32 v52, a184
    v_accvgpr_read_b32 v53, a185
    v_accvgpr_read_b32 v54, a186
    v_accvgpr_read_b32 v55, a187
    v_cvt_pk_bf16_f32 v40, v48, v49
    v_cvt_pk_bf16_f32 v41, v50, v51
    v_cvt_pk_bf16_f32 v42, v52, v53
    v_cvt_pk_bf16_f32 v43, v54, v55
    buffer_store_dwordx4 v[40:43], v4, s[28:31], 0 offen offset:2048 sc1
    v_accvgpr_read_b32 v56, a156
    v_accvgpr_read_b32 v57, a157
    v_accvgpr_read_b32 v58, a158
    v_accvgpr_read_b32 v59, a159
    v_accvgpr_read_b32 v60, a188
    v_accvgpr_read_b32 v61, a189
    v_accvgpr_read_b32 v62, a190
    v_accvgpr_read_b32 v63, a191
    v_cvt_pk_bf16_f32 v44, v56, v57
    v_cvt_pk_bf16_f32 v45, v58, v59
    v_cvt_pk_bf16_f32 v46, v60, v61
    v_cvt_pk_bf16_f32 v47, v62, v63
    buffer_store_dwordx4 v[44:47], v4, s[28:31], 0 offen offset:3072 sc1
    v_add_u32 v3, 0x60000, v3
    v_add_u32 v4, 4096, v3
    v_accvgpr_read_b32 v48, a192
    v_accvgpr_read_b32 v49, a193
    v_accvgpr_read_b32 v50, a194
    v_accvgpr_read_b32 v51, a195
    v_accvgpr_read_b32 v52, a224
    v_accvgpr_read_b32 v53, a225
    v_accvgpr_read_b32 v54, a226
    v_accvgpr_read_b32 v55, a227
    v_cvt_pk_bf16_f32 v32, v48, v49
    v_cvt_pk_bf16_f32 v33, v50, v51
    v_cvt_pk_bf16_f32 v34, v52, v53
    v_cvt_pk_bf16_f32 v35, v54, v55
    buffer_store_dwordx4 v[32:35], v3, s[28:31], 0 offen offset:0 sc1
    v_accvgpr_read_b32 v56, a196
    v_accvgpr_read_b32 v57, a197
    v_accvgpr_read_b32 v58, a198
    v_accvgpr_read_b32 v59, a199
    v_accvgpr_read_b32 v60, a228
    v_accvgpr_read_b32 v61, a229
    v_accvgpr_read_b32 v62, a230
    v_accvgpr_read_b32 v63, a231
    v_cvt_pk_bf16_f32 v36, v56, v57
    v_cvt_pk_bf16_f32 v37, v58, v59
    v_cvt_pk_bf16_f32 v38, v60, v61
    v_cvt_pk_bf16_f32 v39, v62, v63
    buffer_store_dwordx4 v[36:39], v3, s[28:31], 0 offen offset:1024 sc1
    v_accvgpr_read_b32 v48, a200
    v_accvgpr_read_b32 v49, a201
    v_accvgpr_read_b32 v50, a202
    v_accvgpr_read_b32 v51, a203
    v_accvgpr_read_b32 v52, a232
    v_accvgpr_read_b32 v53, a233
    v_accvgpr_read_b32 v54, a234
    v_accvgpr_read_b32 v55, a235
    v_cvt_pk_bf16_f32 v40, v48, v49
    v_cvt_pk_bf16_f32 v41, v50, v51
    v_cvt_pk_bf16_f32 v42, v52, v53
    v_cvt_pk_bf16_f32 v43, v54, v55
    buffer_store_dwordx4 v[40:43], v3, s[28:31], 0 offen offset:2048 sc1
    v_accvgpr_read_b32 v56, a204
    v_accvgpr_read_b32 v57, a205
    v_accvgpr_read_b32 v58, a206
    v_accvgpr_read_b32 v59, a207
    v_accvgpr_read_b32 v60, a236
    v_accvgpr_read_b32 v61, a237
    v_accvgpr_read_b32 v62, a238
    v_accvgpr_read_b32 v63, a239
    v_cvt_pk_bf16_f32 v44, v56, v57
    v_cvt_pk_bf16_f32 v45, v58, v59
    v_cvt_pk_bf16_f32 v46, v60, v61
    v_cvt_pk_bf16_f32 v47, v62, v63
    buffer_store_dwordx4 v[44:47], v3, s[28:31], 0 offen offset:3072 sc1
    v_accvgpr_read_b32 v48, a208
    v_accvgpr_read_b32 v49, a209
    v_accvgpr_read_b32 v50, a210
    v_accvgpr_read_b32 v51, a211
    v_accvgpr_read_b32 v52, a240
    v_accvgpr_read_b32 v53, a241
    v_accvgpr_read_b32 v54, a242
    v_accvgpr_read_b32 v55, a243
    v_cvt_pk_bf16_f32 v32, v48, v49
    v_cvt_pk_bf16_f32 v33, v50, v51
    v_cvt_pk_bf16_f32 v34, v52, v53
    v_cvt_pk_bf16_f32 v35, v54, v55
    buffer_store_dwordx4 v[32:35], v4, s[28:31], 0 offen offset:0 sc1
    v_accvgpr_read_b32 v56, a212
    v_accvgpr_read_b32 v57, a213
    v_accvgpr_read_b32 v58, a214
    v_accvgpr_read_b32 v59, a215
    v_accvgpr_read_b32 v60, a244
    v_accvgpr_read_b32 v61, a245
    v_accvgpr_read_b32 v62, a246
    v_accvgpr_read_b32 v63, a247
    v_cvt_pk_bf16_f32 v36, v56, v57
    v_cvt_pk_bf16_f32 v37, v58, v59
    v_cvt_pk_bf16_f32 v38, v60, v61
    v_cvt_pk_bf16_f32 v39, v62, v63
    buffer_store_dwordx4 v[36:39], v4, s[28:31], 0 offen offset:1024 sc1
    v_accvgpr_read_b32 v48, a216
    v_accvgpr_read_b32 v49, a217
    v_accvgpr_read_b32 v50, a218
    v_accvgpr_read_b32 v51, a219
    v_accvgpr_read_b32 v52, a248
    v_accvgpr_read_b32 v53, a249
    v_accvgpr_read_b32 v54, a250
    v_accvgpr_read_b32 v55, a251
    v_cvt_pk_bf16_f32 v40, v48, v49
    v_cvt_pk_bf16_f32 v41, v50, v51
    v_cvt_pk_bf16_f32 v42, v52, v53
    v_cvt_pk_bf16_f32 v43, v54, v55
    buffer_store_dwordx4 v[40:43], v4, s[28:31], 0 offen offset:2048 sc1
    v_accvgpr_read_b32 v56, a220
    v_accvgpr_read_b32 v57, a221
    v_accvgpr_read_b32 v58, a222
    v_accvgpr_read_b32 v59, a223
    v_accvgpr_read_b32 v60, a252
    v_accvgpr_read_b32 v61, a253
    v_accvgpr_read_b32 v62, a254
    v_accvgpr_read_b32 v63, a255
    v_cvt_pk_bf16_f32 v44, v56, v57
    v_cvt_pk_bf16_f32 v45, v58, v59
    v_cvt_pk_bf16_f32 v46, v60, v61
    v_cvt_pk_bf16_f32 v47, v62, v63
    buffer_store_dwordx4 v[44:47], v4, s[28:31], 0 offen offset:3072 sc1
L_w_kvsig:
    s_waitcnt vmcnt(0)
    s_barrier
    s_cmp_lg_u32 s44, 0
    s_cbranch_scc1 L_w_nosig
    s_lshl_b32 s66, s41, 2
    v_mov_b32 v24, s66
    v_mov_b32 v25, 1
    s_mov_b64 exec, 1
    buffer_atomic_add v25, v24, s[92:95], 0 offen sc1
    s_mov_b64 exec, -1
L_w_nosig:
    s_add_u32 s91, s91, 127
    s_branch L_w_kv
L_w_q0:
    s_sub_u32 s91, s91, 336
L_w_q:
    s_cmp_ge_u32 s91, 192
    s_cbranch_scc1 L_w_f0
    s_mov_b32 s60, 0xaaaaaab
    s_mul_hi_u32 s41, s91, s60
    s_mul_i32 s61, s41, 24
    s_sub_u32 s40, s91, s61
    s_mov_b32 s6, s96
    s_mov_b32 s7, s97
    s_lshr_b32 s45, s44, 1
    s_and_b32 s46, s44, 1
    s_mov_b32 s12, s4
    s_mov_b32 s13, s5
    s_mov_b32 s14, 0x280000
    s_mov_b32 s15, 0x20000
    s_mov_b32 s16, s6
    s_mov_b32 s17, s7
    s_mov_b32 s18, 0x780000
    s_mov_b32 s19, 0x20000
    s_mov_b32 s47, s40
    v_lshrrev_b32 v3, 2, v2
    v_and_b32 v4, 3, v2
    v_lshrrev_b32 v5, 3, v3
    v_lshlrev_b32 v5, 1, v5
    v_xor_b32 v4, v4, v5
    s_mul_i32 s48, s41, 256
    s_mul_i32 s49, s44, 64
    s_add_u32 s48, s48, s49
    v_add_u32 v3, s48, v3
    s_mov_b32 s60, 1280
    v_mul_lo_u32 v3, v3, s60
    v_lshl_add_u32 v6, v4, 4, v3
    v_add_u32 v7, 0x5000, v6
    v_add_u32 v8, 0xa000, v6
    v_add_u32 v9, 0xf000, v6
    s_mul_i32 s50, s44, 4
    s_lshr_b32 s51, s50, 4
    s_and_b32 s52, s50, 15
    v_lshrrev_b32 v3, 5, v2
    s_add_u32 s53, s52, 0
    s_mul_i32 s53, s53, 2
    v_add_u32 v3, s53, v3
    v_and_b32 v4, 31, v2
    v_and_b32 v5, 3, v3
    v_lshrrev_b32 v30, 3, v3
    v_and_b32 v30, 1, v30
    v_lshl_or_b32 v5, v30, 2, v5
    v_lshlrev_b32 v5, 1, v5
    v_xor_b32 v4, v4, v5
    s_mov_b32 s60, 12288
    v_mul_lo_u32 v3, v3, s60
    v_lshl_add_u32 v3, v4, 4, v3
    s_mul_i32 s53, s47, 512
    v_add_u32 v10, s53, v3
    v_lshrrev_b32 v3, 5, v2
    s_add_u32 s53, s52, 1
    s_mul_i32 s53, s53, 2
    v_add_u32 v3, s53, v3
    v_and_b32 v4, 31, v2
    v_and_b32 v5, 3, v3
    v_lshrrev_b32 v30, 3, v3
    v_and_b32 v30, 1, v30
    v_lshl_or_b32 v5, v30, 2, v5
    v_lshlrev_b32 v5, 1, v5
    v_xor_b32 v4, v4, v5
    s_mov_b32 s60, 12288
    v_mul_lo_u32 v3, v3, s60
    v_lshl_add_u32 v3, v4, 4, v3
    s_mul_i32 s53, s47, 512
    v_add_u32 v11, s53, v3
    v_lshrrev_b32 v3, 5, v2
    s_add_u32 s53, s52, 2
    s_mul_i32 s53, s53, 2
    v_add_u32 v3, s53, v3
    v_and_b32 v4, 31, v2
    v_and_b32 v5, 3, v3
    v_lshrrev_b32 v30, 3, v3
    v_and_b32 v30, 1, v30
    v_lshl_or_b32 v5, v30, 2, v5
    v_lshlrev_b32 v5, 1, v5
    v_xor_b32 v4, v4, v5
    s_mov_b32 s60, 12288
    v_mul_lo_u32 v3, v3, s60
    v_lshl_add_u32 v3, v4, 4, v3
    s_mul_i32 s53, s47, 512
    v_add_u32 v12, s53, v3
    v_lshrrev_b32 v3, 5, v2
    s_add_u32 s53, s52, 3
    s_mul_i32 s53, s53, 2
    v_add_u32 v3, s53, v3
    v_and_b32 v4, 31, v2
    v_and_b32 v5, 3, v3
    v_lshrrev_b32 v30, 3, v3
    v_and_b32 v30, 1, v30
    v_lshl_or_b32 v5, v30, 2, v5
    v_lshlrev_b32 v5, 1, v5
    v_xor_b32 v4, v4, v5
    s_mov_b32 s60, 12288
    v_mul_lo_u32 v3, v3, s60
    v_lshl_add_u32 v3, v4, 4, v3
    s_mul_i32 s53, s47, 512
    v_add_u32 v13, s53, v3
    v_and_b32 v3, 15, v2
    v_lshrrev_b32 v4, 4, v2
    v_lshrrev_b32 v5, 3, v3
    v_lshlrev_b32 v5, 1, v5
    v_xor_b32 v5, v4, v5
    s_mul_i32 s53, s45, 128
    v_add_u32 v30, s53, v3
    v_lshlrev_b32 v30, 6, v30
    v_lshl_add_u32 v14, v5, 4, v30
    v_lshrrev_b32 v5, 2, v3
    v_and_b32 v30, 3, v2
    v_lshl_add_u32 v31, v4, 3, v5
    v_mul_u32_u24 v31, 512, v31
    v_lshl_add_u32 v31, v30, 3, v31
    v_add_u32 v31, 16384, v31
    v_and_b32 v30, 1, v4
    v_lshl_or_b32 v5, v30, 2, v5
    v_xor_b32 v30, 0, v5
    v_lshl_add_u32 v15, v30, 5, v31
    v_xor_b32 v30, 1, v5
    v_lshl_add_u32 v16, v30, 5, v31
    v_xor_b32 v30, 2, v5
    v_lshl_add_u32 v17, v30, 5, v31
    v_xor_b32 v30, 3, v5
    v_lshl_add_u32 v18, v30, 5, v31
    v_xor_b32 v30, 4, v5
    v_lshl_add_u32 v19, v30, 5, v31
    v_xor_b32 v30, 5, v5
    v_lshl_add_u32 v20, v30, 5, v31
    v_xor_b32 v30, 6, v5
    v_lshl_add_u32 v21, v30, 5, v31
    v_xor_b32 v30, 7, v5
    v_lshl_add_u32 v22, v30, 5, v31
    s_mul_i32 s53, s46, 256
    v_add_u32 v15, s53, v15
    v_add_u32 v16, s53, v16
    v_add_u32 v17, s53, v17
    v_add_u32 v18, s53, v18
    v_add_u32 v19, s53, v19
    v_add_u32 v20, s53, v20
    v_add_u32 v21, s53, v21
    v_add_u32 v22, s53, v22
    v_accvgpr_write_b32 a0, 0
    v_accvgpr_write_b32 a1, 0
    v_accvgpr_write_b32 a2, 0
    v_accvgpr_write_b32 a3, 0
    v_accvgpr_write_b32 a4, 0
    v_accvgpr_write_b32 a5, 0
    v_accvgpr_write_b32 a6, 0
    v_accvgpr_write_b32 a7, 0
    v_accvgpr_write_b32 a8, 0
    v_accvgpr_write_b32 a9, 0
    v_accvgpr_write_b32 a10, 0
    v_accvgpr_write_b32 a11, 0
    v_accvgpr_write_b32 a12, 0
    v_accvgpr_write_b32 a13, 0
    v_accvgpr_write_b32 a14, 0
    v_accvgpr_write_b32 a15, 0
    v_accvgpr_write_b32 a16, 0
    v_accvgpr_write_b32 a17, 0
    v_accvgpr_write_b32 a18, 0
    v_accvgpr_write_b32 a19, 0
    v_accvgpr_write_b32 a20, 0
    v_accvgpr_write_b32 a21, 0
    v_accvgpr_write_b32 a22, 0
    v_accvgpr_write_b32 a23, 0
    v_accvgpr_write_b32 a24, 0
    v_accvgpr_write_b32 a25, 0
    v_accvgpr_write_b32 a26, 0
    v_accvgpr_write_b32 a27, 0
    v_accvgpr_write_b32 a28, 0
    v_accvgpr_write_b32 a29, 0
    v_accvgpr_write_b32 a30, 0
    v_accvgpr_write_b32 a31, 0
    v_accvgpr_write_b32 a32, 0
    v_accvgpr_write_b32 a33, 0
    v_accvgpr_write_b32 a34, 0
    v_accvgpr_write_b32 a35, 0
    v_accvgpr_write_b32 a36, 0
    v_accvgpr_write_b32 a37, 0
    v_accvgpr_write_b32 a38, 0
    v_accvgpr_write_b32 a39, 0
    v_accvgpr_write_b32 a40, 0
    v_accvgpr_write_b32 a41, 0
    v_accvgpr_write_b32 a42, 0
    v_accvgpr_write_b32 a43, 0
    v_accvgpr_write_b32 a44, 0
    v_accvgpr_write_b32 a45, 0
    v_accvgpr_write_b32 a46, 0
    v_accvgpr_write_b32 a47, 0
    v_accvgpr_write_b32 a48, 0
    v_accvgpr_write_b32 a49, 0
    v_accvgpr_write_b32 a50, 0
    v_accvgpr_write_b32 a51, 0
    v_accvgpr_write_b32 a52, 0
    v_accvgpr_write_b32 a53, 0
    v_accvgpr_write_b32 a54, 0
    v_accvgpr_write_b32 a55, 0
    v_accvgpr_write_b32 a56, 0
    v_accvgpr_write_b32 a57, 0
    v_accvgpr_write_b32 a58, 0
    v_accvgpr_write_b32 a59, 0
    v_accvgpr_write_b32 a60, 0
    v_accvgpr_write_b32 a61, 0
    v_accvgpr_write_b32 a62, 0
    v_accvgpr_write_b32 a63, 0
    v_accvgpr_write_b32 a64, 0
    v_accvgpr_write_b32 a65, 0
    v_accvgpr_write_b32 a66, 0
    v_accvgpr_write_b32 a67, 0
    v_accvgpr_write_b32 a68, 0
    v_accvgpr_write_b32 a69, 0
    v_accvgpr_write_b32 a70, 0
    v_accvgpr_write_b32 a71, 0
    v_accvgpr_write_b32 a72, 0
    v_accvgpr_write_b32 a73, 0
    v_accvgpr_write_b32 a74, 0
    v_accvgpr_write_b32 a75, 0
    v_accvgpr_write_b32 a76, 0
    v_accvgpr_write_b32 a77, 0
    v_accvgpr_write_b32 a78, 0
    v_accvgpr_write_b32 a79, 0
    v_accvgpr_write_b32 a80, 0
    v_accvgpr_write_b32 a81, 0
    v_accvgpr_write_b32 a82, 0
    v_accvgpr_write_b32 a83, 0
    v_accvgpr_write_b32 a84, 0
    v_accvgpr_write_b32 a85, 0
    v_accvgpr_write_b32 a86, 0
    v_accvgpr_write_b32 a87, 0
    v_accvgpr_write_b32 a88, 0
    v_accvgpr_write_b32 a89, 0
    v_accvgpr_write_b32 a90, 0
    v_accvgpr_write_b32 a91, 0
    v_accvgpr_write_b32 a92, 0
    v_accvgpr_write_b32 a93, 0
    v_accvgpr_write_b32 a94, 0
    v_accvgpr_write_b32 a95, 0
    v_accvgpr_write_b32 a96, 0
    v_accvgpr_write_b32 a97, 0
    v_accvgpr_write_b32 a98, 0
    v_accvgpr_write_b32 a99, 0
    v_accvgpr_write_b32 a100, 0
    v_accvgpr_write_b32 a101, 0
    v_accvgpr_write_b32 a102, 0
    v_accvgpr_write_b32 a103, 0
    v_accvgpr_write_b32 a104, 0
    v_accvgpr_write_b32 a105, 0
    v_accvgpr_write_b32 a106, 0
    v_accvgpr_write_b32 a107, 0
    v_accvgpr_write_b32 a108, 0
    v_accvgpr_write_b32 a109, 0
    v_accvgpr_write_b32 a110, 0
    v_accvgpr_write_b32 a111, 0
    v_accvgpr_write_b32 a112, 0
    v_accvgpr_write_b32 a113, 0
    v_accvgpr_write_b32 a114, 0
    v_accvgpr_write_b32 a115, 0
    v_accvgpr_write_b32 a116, 0
    v_accvgpr_write_b32 a117, 0
    v_accvgpr_write_b32 a118, 0
    v_accvgpr_write_b32 a119, 0
    v_accvgpr_write_b32 a120, 0
    v_accvgpr_write_b32 a121, 0
    v_accvgpr_write_b32 a122, 0
    v_accvgpr_write_b32 a123, 0
    v_accvgpr_write_b32 a124, 0
    v_accvgpr_write_b32 a125, 0
    v_accvgpr_write_b32 a126, 0
    v_accvgpr_write_b32 a127, 0
    v_accvgpr_write_b32 a128, 0
    v_accvgpr_write_b32 a129, 0
    v_accvgpr_write_b32 a130, 0
    v_accvgpr_write_b32 a131, 0
    v_accvgpr_write_b32 a132, 0
    v_accvgpr_write_b32 a133, 0
    v_accvgpr_write_b32 a134, 0
    v_accvgpr_write_b32 a135, 0
    v_accvgpr_write_b32 a136, 0
    v_accvgpr_write_b32 a137, 0
    v_accvgpr_write_b32 a138, 0
    v_accvgpr_write_b32 a139, 0
    v_accvgpr_write_b32 a140, 0
    v_accvgpr_write_b32 a141, 0
    v_accvgpr_write_b32 a142, 0
    v_accvgpr_write_b32 a143, 0
    v_accvgpr_write_b32 a144, 0
    v_accvgpr_write_b32 a145, 0
    v_accvgpr_write_b32 a146, 0
    v_accvgpr_write_b32 a147, 0
    v_accvgpr_write_b32 a148, 0
    v_accvgpr_write_b32 a149, 0
    v_accvgpr_write_b32 a150, 0
    v_accvgpr_write_b32 a151, 0
    v_accvgpr_write_b32 a152, 0
    v_accvgpr_write_b32 a153, 0
    v_accvgpr_write_b32 a154, 0
    v_accvgpr_write_b32 a155, 0
    v_accvgpr_write_b32 a156, 0
    v_accvgpr_write_b32 a157, 0
    v_accvgpr_write_b32 a158, 0
    v_accvgpr_write_b32 a159, 0
    v_accvgpr_write_b32 a160, 0
    v_accvgpr_write_b32 a161, 0
    v_accvgpr_write_b32 a162, 0
    v_accvgpr_write_b32 a163, 0
    v_accvgpr_write_b32 a164, 0
    v_accvgpr_write_b32 a165, 0
    v_accvgpr_write_b32 a166, 0
    v_accvgpr_write_b32 a167, 0
    v_accvgpr_write_b32 a168, 0
    v_accvgpr_write_b32 a169, 0
    v_accvgpr_write_b32 a170, 0
    v_accvgpr_write_b32 a171, 0
    v_accvgpr_write_b32 a172, 0
    v_accvgpr_write_b32 a173, 0
    v_accvgpr_write_b32 a174, 0
    v_accvgpr_write_b32 a175, 0
    v_accvgpr_write_b32 a176, 0
    v_accvgpr_write_b32 a177, 0
    v_accvgpr_write_b32 a178, 0
    v_accvgpr_write_b32 a179, 0
    v_accvgpr_write_b32 a180, 0
    v_accvgpr_write_b32 a181, 0
    v_accvgpr_write_b32 a182, 0
    v_accvgpr_write_b32 a183, 0
    v_accvgpr_write_b32 a184, 0
    v_accvgpr_write_b32 a185, 0
    v_accvgpr_write_b32 a186, 0
    v_accvgpr_write_b32 a187, 0
    v_accvgpr_write_b32 a188, 0
    v_accvgpr_write_b32 a189, 0
    v_accvgpr_write_b32 a190, 0
    v_accvgpr_write_b32 a191, 0
    v_accvgpr_write_b32 a192, 0
    v_accvgpr_write_b32 a193, 0
    v_accvgpr_write_b32 a194, 0
    v_accvgpr_write_b32 a195, 0
    v_accvgpr_write_b32 a196, 0
    v_accvgpr_write_b32 a197, 0
    v_accvgpr_write_b32 a198, 0
    v_accvgpr_write_b32 a199, 0
    v_accvgpr_write_b32 a200, 0
    v_accvgpr_write_b32 a201, 0
    v_accvgpr_write_b32 a202, 0
    v_accvgpr_write_b32 a203, 0
    v_accvgpr_write_b32 a204, 0
    v_accvgpr_write_b32 a205, 0
    v_accvgpr_write_b32 a206, 0
    v_accvgpr_write_b32 a207, 0
    v_accvgpr_write_b32 a208, 0
    v_accvgpr_write_b32 a209, 0
    v_accvgpr_write_b32 a210, 0
    v_accvgpr_write_b32 a211, 0
    v_accvgpr_write_b32 a212, 0
    v_accvgpr_write_b32 a213, 0
    v_accvgpr_write_b32 a214, 0
    v_accvgpr_write_b32 a215, 0
    v_accvgpr_write_b32 a216, 0
    v_accvgpr_write_b32 a217, 0
    v_accvgpr_write_b32 a218, 0
    v_accvgpr_write_b32 a219, 0
    v_accvgpr_write_b32 a220, 0
    v_accvgpr_write_b32 a221, 0
    v_accvgpr_write_b32 a222, 0
    v_accvgpr_write_b32 a223, 0
    v_accvgpr_write_b32 a224, 0
    v_accvgpr_write_b32 a225, 0
    v_accvgpr_write_b32 a226, 0
    v_accvgpr_write_b32 a227, 0
    v_accvgpr_write_b32 a228, 0
    v_accvgpr_write_b32 a229, 0
    v_accvgpr_write_b32 a230, 0
    v_accvgpr_write_b32 a231, 0
    v_accvgpr_write_b32 a232, 0
    v_accvgpr_write_b32 a233, 0
    v_accvgpr_write_b32 a234, 0
    v_accvgpr_write_b32 a235, 0
    v_accvgpr_write_b32 a236, 0
    v_accvgpr_write_b32 a237, 0
    v_accvgpr_write_b32 a238, 0
    v_accvgpr_write_b32 a239, 0
    v_accvgpr_write_b32 a240, 0
    v_accvgpr_write_b32 a241, 0
    v_accvgpr_write_b32 a242, 0
    v_accvgpr_write_b32 a243, 0
    v_accvgpr_write_b32 a244, 0
    v_accvgpr_write_b32 a245, 0
    v_accvgpr_write_b32 a246, 0
    v_accvgpr_write_b32 a247, 0
    v_accvgpr_write_b32 a248, 0
    v_accvgpr_write_b32 a249, 0
    v_accvgpr_write_b32 a250, 0
    v_accvgpr_write_b32 a251, 0
    v_accvgpr_write_b32 a252, 0
    v_accvgpr_write_b32 a253, 0
    v_accvgpr_write_b32 a254, 0
    v_accvgpr_write_b32 a255, 0
    s_mul_i32 s56, s42, 0
    s_mul_i32 s57, s42, 0
    s_mov_b32 s58, 0
    s_mov_b32 s59, 0
    s_mul_i32 s63, s44, 4096
    s_mul_i32 s64, s44, 4096
    s_add_u32 s64, s64, 16384
    s_add_u32 s65, s58, s63
    s_add_u32 m0, s65, 0
    s_nop 0
    buffer_load_dwordx4 v6, s[12:15], s56 offen lds
    s_add_u32 s65, s58, s63
    s_add_u32 m0, s65, 1024
    s_nop 0
    buffer_load_dwordx4 v7, s[12:15], s56 offen lds
    s_add_u32 s65, s58, s63
    s_add_u32 m0, s65, 2048
    s_nop 0
    buffer_load_dwordx4 v8, s[12:15], s56 offen lds
    s_add_u32 s65, s58, s63
    s_add_u32 m0, s65, 3072
    s_nop 0
    buffer_load_dwordx4 v9, s[12:15], s56 offen lds
    s_add_u32 s65, s58, s64
    s_add_u32 m0, s65, 0
    s_nop 0
    buffer_load_dwordx4 v10, s[16:19], s57 offen lds
    s_add_u32 s65, s58, s64
    s_add_u32 m0, s65, 1024
    s_nop 0
    buffer_load_dwordx4 v11, s[16:19], s57 offen lds
    s_add_u32 s65, s58, s64
    s_add_u32 m0, s65, 2048
    s_nop 0
    buffer_load_dwordx4 v12, s[16:19], s57 offen lds
    s_add_u32 s65, s58, s64
    s_add_u32 m0, s65, 3072
    s_nop 0
    buffer_load_dwordx4 v13, s[16:19], s57 offen lds
    s_add_u32 s56, s56, 64
    s_add_u32 s57, s57, 393216
    s_add_u32 s58, s58, 32768
    s_cmp_ge_u32 s58, 98304
    s_cselect_b32 s58, 0, s58
    s_add_u32 s65, s58, s63
    s_add_u32 m0, s65, 0
    s_nop 0
    buffer_load_dwordx4 v6, s[12:15], s56 offen lds
    s_add_u32 s65, s58, s63
    s_add_u32 m0, s65, 1024
    s_nop 0
    buffer_load_dwordx4 v7, s[12:15], s56 offen lds
    s_add_u32 s65, s58, s63
    s_add_u32 m0, s65, 2048
    s_nop 0
    buffer_load_dwordx4 v8, s[12:15], s56 offen lds
    s_add_u32 s65, s58, s63
    s_add_u32 m0, s65, 3072
    s_nop 0
    buffer_load_dwordx4 v9, s[12:15], s56 offen lds
    s_add_u32 s65, s58, s64
    s_add_u32 m0, s65, 0
    s_nop 0
    buffer_load_dwordx4 v10, s[16:19], s57 offen lds
    s_add_u32 s65, s58, s64
    s_add_u32 m0, s65, 1024
    s_nop 0
    buffer_load_dwordx4 v11, s[16:19], s57 offen lds
    s_add_u32 s65, s58, s64
    s_add_u32 m0, s65, 2048
    s_nop 0
    buffer_load_dwordx4 v12, s[16:19], s57 offen lds
    s_add_u32 s65, s58, s64
    s_add_u32 m0, s65, 3072
    s_nop 0
    buffer_load_dwordx4 v13, s[16:19], s57 offen lds
    s_add_u32 s56, s56, 64
    s_add_u32 s57, s57, 393216
    s_add_u32 s58, s58, 32768
    s_cmp_ge_u32 s58, 98304
    s_cselect_b32 s58, 0, s58
    s_mov_b32 s62, 18
L_wq_loop:
    s_waitcnt vmcnt(8)
    s_barrier
    s_add_u32 s65, s58, s63
    s_add_u32 m0, s65, 0
    s_nop 0
    buffer_load_dwordx4 v6, s[12:15], s56 offen lds
    s_add_u32 s65, s58, s63
    s_add_u32 m0, s65, 1024
    s_nop 0
    buffer_load_dwordx4 v7, s[12:15], s56 offen lds
    s_add_u32 s65, s58, s63
    s_add_u32 m0, s65, 2048
    s_nop 0
    buffer_load_dwordx4 v8, s[12:15], s56 offen lds
    s_add_u32 s65, s58, s63
    s_add_u32 m0, s65, 3072
    s_nop 0
    buffer_load_dwordx4 v9, s[12:15], s56 offen lds
    s_add_u32 s65, s58, s64
    s_add_u32 m0, s65, 0
    s_nop 0
    buffer_load_dwordx4 v10, s[16:19], s57 offen lds
    s_add_u32 s65, s58, s64
    s_add_u32 m0, s65, 1024
    s_nop 0
    buffer_load_dwordx4 v11, s[16:19], s57 offen lds
    s_add_u32 s65, s58, s64
    s_add_u32 m0, s65, 2048
    s_nop 0
    buffer_load_dwordx4 v12, s[16:19], s57 offen lds
    s_add_u32 s65, s58, s64
    s_add_u32 m0, s65, 3072
    s_nop 0
    buffer_load_dwordx4 v13, s[16:19], s57 offen lds
    s_add_u32 s56, s56, 64
    s_add_u32 s57, s57, 393216
    s_add_u32 s58, s58, 32768
    s_cmp_ge_u32 s58, 98304
    s_cselect_b32 s58, 0, s58
    v_add_u32 v23, s59, v14
    v_add_u32 v24, s59, v15
    v_add_u32 v25, s59, v16
    v_add_u32 v26, s59, v17
    v_add_u32 v27, s59, v18
    v_add_u32 v28, s59, v19
    v_add_u32 v29, s59, v20
    v_add_u32 v30, s59, v21
    v_add_u32 v31, s59, v22
    ds_read_b128 v[32:35], v23 offset:0
    ds_read_b64_tr_b16 v[64:65], v24 offset:0
    ds_read_b64_tr_b16 v[66:67], v24 offset:2048
    ds_read_b64_tr_b16 v[68:69], v25 offset:0
    ds_read_b64_tr_b16 v[70:71], v25 offset:2048
    ds_read_b64_tr_b16 v[72:73], v26 offset:0
    ds_read_b64_tr_b16 v[74:75], v26 offset:2048
    ds_read_b64_tr_b16 v[76:77], v27 offset:0
    ds_read_b64_tr_b16 v[78:79], v27 offset:2048
    ds_read_b64_tr_b16 v[80:81], v28 offset:0
    s_waitcnt lgkmcnt(7)
    v_mfma_f32_16x16x32_bf16 a[0:3], v[64:67], v[32:35], a[0:3]
    ds_read_b64_tr_b16 v[82:83], v28 offset:2048
    ds_read_b64_tr_b16 v[84:85], v29 offset:0
    ds_read_b64_tr_b16 v[86:87], v29 offset:2048
    s_waitcnt lgkmcnt(8)
    v_mfma_f32_16x16x32_bf16 a[4:7], v[68:71], v[32:35], a[4:7]
    ds_read_b64_tr_b16 v[88:89], v30 offset:0
    ds_read_b64_tr_b16 v[90:91], v30 offset:2048
    s_waitcnt lgkmcnt(8)
    v_mfma_f32_16x16x32_bf16 a[8:11], v[72:75], v[32:35], a[8:11]
    ds_read_b64_tr_b16 v[92:93], v31 offset:0
    ds_read_b64_tr_b16 v[94:95], v31 offset:2048
    s_waitcnt lgkmcnt(8)
    v_mfma_f32_16x16x32_bf16 a[12:15], v[76:79], v[32:35], a[12:15]
    ds_read_b128 v[36:39], v23 offset:1024
    ds_read_b128 v[40:43], v23 offset:2048
    s_waitcnt lgkmcnt(8)
    v_mfma_f32_16x16x32_bf16 a[16:19], v[80:83], v[32:35], a[16:19]
    ds_read_b128 v[44:47], v23 offset:3072
    ds_read_b128 v[48:51], v23 offset:4096
    s_waitcnt lgkmcnt(8)
    v_mfma_f32_16x16x32_bf16 a[20:23], v[84:87], v[32:35], a[20:23]
    ds_read_b128 v[52:55], v23 offset:5120
    ds_read_b128 v[56:59], v23 offset:6144
    s_waitcnt lgkmcnt(8)
    v_mfma_f32_16x16x32_bf16 a[24:27], v[88:91], v[32:35], a[24:27]
    ds_read_b128 v[60:63], v23 offset:7168
    s_waitcnt lgkmcnt(7)
    v_mfma_f32_16x16x32_bf16 a[28:31], v[92:95], v[32:35], a[28:31]
    s_waitcnt lgkmcnt(6)
    v_mfma_f32_16x16x32_bf16 a[32:35], v[64:67], v[36:39], a[32:35]
    v_mfma_f32_16x16x32_bf16 a[36:39], v[68:71], v[36:39], a[36:39]
    v_mfma_f32_16x16x32_bf16 a[40:43], v[72:75], v[36:39], a[40:43]
    v_mfma_f32_16x16x32_bf16 a[44:47], v[76:79], v[36:39], a[44:47]
    v_mfma_f32_16x16x32_bf16 a[48:51], v[80:83], v[36:39], a[48:51]
    v_mfma_f32_16x16x32_bf16 a[52:55], v[84:87], v[36:39], a[52:55]
    v_mfma_f32_16x16x32_bf16 a[56:59], v[88:91], v[36:39], a[56:59]
    v_mfma_f32_16x16x32_bf16 a[60:63], v[92:95], v[36:39], a[60:63]
    s_waitcnt lgkmcnt(5)
    v_mfma_f32_16x16x32_bf16 a[64:67], v[64:67], v[40:43], a[64:67]
    v_mfma_f32_16x16x32_bf16 a[68:71], v[68:71], v[40:43], a[68:71]
    v_mfma_f32_16x16x32_bf16 a[72:75], v[72:75], v[40:43], a[72:75]
    v_mfma_f32_16x16x32_bf16 a[76:79], v[76:79], v[40:43], a[76:79]
    v_mfma_f32_16x16x32_bf16 a[80:83], v[80:83], v[40:43], a[80:83]
    v_mfma_f32_16x16x32_bf16 a[84:87], v[84:87], v[40:43], a[84:87]
    v_mfma_f32_16x16x32_bf16 a[88:91], v[88:91], v[40:43], a[88:91]
    v_mfma_f32_16x16x32_bf16 a[92:95], v[92:95], v[40:43], a[92:95]
    s_waitcnt lgkmcnt(4)
    v_mfma_f32_16x16x32_bf16 a[96:99], v[64:67], v[44:47], a[96:99]
    v_mfma_f32_16x16x32_bf16 a[100:103], v[68:71], v[44:47], a[100:103]
    v_mfma_f32_16x16x32_bf16 a[104:107], v[72:75], v[44:47], a[104:107]
    v_mfma_f32_16x16x32_bf16 a[108:111], v[76:79], v[44:47], a[108:111]
    v_mfma_f32_16x16x32_bf16 a[112:115], v[80:83], v[44:47], a[112:115]
    v_mfma_f32_16x16x32_bf16 a[116:119], v[84:87], v[44:47], a[116:119]
    v_mfma_f32_16x16x32_bf16 a[120:123], v[88:91], v[44:47], a[120:123]
    v_mfma_f32_16x16x32_bf16 a[124:127], v[92:95], v[44:47], a[124:127]
    s_waitcnt lgkmcnt(3)
    v_mfma_f32_16x16x32_bf16 a[128:131], v[64:67], v[48:51], a[128:131]
    v_mfma_f32_16x16x32_bf16 a[132:135], v[68:71], v[48:51], a[132:135]
    v_mfma_f32_16x16x32_bf16 a[136:139], v[72:75], v[48:51], a[136:139]
    v_mfma_f32_16x16x32_bf16 a[140:143], v[76:79], v[48:51], a[140:143]
    v_mfma_f32_16x16x32_bf16 a[144:147], v[80:83], v[48:51], a[144:147]
    v_mfma_f32_16x16x32_bf16 a[148:151], v[84:87], v[48:51], a[148:151]
    v_mfma_f32_16x16x32_bf16 a[152:155], v[88:91], v[48:51], a[152:155]
    v_mfma_f32_16x16x32_bf16 a[156:159], v[92:95], v[48:51], a[156:159]
    s_waitcnt lgkmcnt(2)
    v_mfma_f32_16x16x32_bf16 a[160:163], v[64:67], v[52:55], a[160:163]
    v_mfma_f32_16x16x32_bf16 a[164:167], v[68:71], v[52:55], a[164:167]
    v_mfma_f32_16x16x32_bf16 a[168:171], v[72:75], v[52:55], a[168:171]
    v_mfma_f32_16x16x32_bf16 a[172:175], v[76:79], v[52:55], a[172:175]
    v_mfma_f32_16x16x32_bf16 a[176:179], v[80:83], v[52:55], a[176:179]
    v_mfma_f32_16x16x32_bf16 a[180:183], v[84:87], v[52:55], a[180:183]
    v_mfma_f32_16x16x32_bf16 a[184:187], v[88:91], v[52:55], a[184:187]
    v_mfma_f32_16x16x32_bf16 a[188:191], v[92:95], v[52:55], a[188:191]
    s_waitcnt lgkmcnt(1)
    v_mfma_f32_16x16x32_bf16 a[192:195], v[64:67], v[56:59], a[192:195]
    v_mfma_f32_16x16x32_bf16 a[196:199], v[68:71], v[56:59], a[196:199]
    v_mfma_f32_16x16x32_bf16 a[200:203], v[72:75], v[56:59], a[200:203]
    v_mfma_f32_16x16x32_bf16 a[204:207], v[76:79], v[56:59], a[204:207]
    v_mfma_f32_16x16x32_bf16 a[208:211], v[80:83], v[56:59], a[208:211]
    v_mfma_f32_16x16x32_bf16 a[212:215], v[84:87], v[56:59], a[212:215]
    v_mfma_f32_16x16x32_bf16 a[216:219], v[88:91], v[56:59], a[216:219]
    v_mfma_f32_16x16x32_bf16 a[220:223], v[92:95], v[56:59], a[220:223]
    s_waitcnt lgkmcnt(0)
    v_mfma_f32_16x16x32_bf16 a[224:227], v[64:67], v[60:63], a[224:227]
    v_mfma_f32_16x16x32_bf16 a[228:231], v[68:71], v[60:63], a[228:231]
    v_mfma_f32_16x16x32_bf16 a[232:235], v[72:75], v[60:63], a[232:235]
    v_mfma_f32_16x16x32_bf16 a[236:239], v[76:79], v[60:63], a[236:239]
    v_mfma_f32_16x16x32_bf16 a[240:243], v[80:83], v[60:63], a[240:243]
    v_mfma_f32_16x16x32_bf16 a[244:247], v[84:87], v[60:63], a[244:247]
    v_mfma_f32_16x16x32_bf16 a[248:251], v[88:91], v[60:63], a[248:251]
    v_mfma_f32_16x16x32_bf16 a[252:255], v[92:95], v[60:63], a[252:255]
    s_add_u32 s59, s59, 32768
    s_cmp_ge_u32 s59, 98304
    s_cselect_b32 s59, 0, s59
    s_sub_u32 s62, s62, 1
    s_cmp_lg_u32 s62, 0
    s_cbranch_scc1 L_wq_loop
    s_waitcnt vmcnt(8)
    s_barrier
    v_add_u32 v23, s59, v14
    v_add_u32 v24, s59, v15
    v_add_u32 v25, s59, v16
    v_add_u32 v26, s59, v17
    v_add_u32 v27, s59, v18
    v_add_u32 v28, s59, v19
    v_add_u32 v29, s59, v20
    v_add_u32 v30, s59, v21
    v_add_u32 v31, s59, v22
    ds_read_b128 v[32:35], v23 offset:0
    ds_read_b64_tr_b16 v[64:65], v24 offset:0
    ds_read_b64_tr_b16 v[66:67], v24 offset:2048
    ds_read_b64_tr_b16 v[68:69], v25 offset:0
    ds_read_b64_tr_b16 v[70:71], v25 offset:2048
    ds_read_b64_tr_b16 v[72:73], v26 offset:0
    ds_read_b64_tr_b16 v[74:75], v26 offset:2048
    ds_read_b64_tr_b16 v[76:77], v27 offset:0
    ds_read_b64_tr_b16 v[78:79], v27 offset:2048
    ds_read_b64_tr_b16 v[80:81], v28 offset:0
    s_waitcnt lgkmcnt(7)
    v_mfma_f32_16x16x32_bf16 a[0:3], v[64:67], v[32:35], a[0:3]
    ds_read_b64_tr_b16 v[82:83], v28 offset:2048
    ds_read_b64_tr_b16 v[84:85], v29 offset:0
    ds_read_b64_tr_b16 v[86:87], v29 offset:2048
    s_waitcnt lgkmcnt(8)
    v_mfma_f32_16x16x32_bf16 a[4:7], v[68:71], v[32:35], a[4:7]
    ds_read_b64_tr_b16 v[88:89], v30 offset:0
    ds_read_b64_tr_b16 v[90:91], v30 offset:2048
    s_waitcnt lgkmcnt(8)
    v_mfma_f32_16x16x32_bf16 a[8:11], v[72:75], v[32:35], a[8:11]
    ds_read_b64_tr_b16 v[92:93], v31 offset:0
    ds_read_b64_tr_b16 v[94:95], v31 offset:2048
    s_waitcnt lgkmcnt(8)
    v_mfma_f32_16x16x32_bf16 a[12:15], v[76:79], v[32:35], a[12:15]
    ds_read_b128 v[36:39], v23 offset:1024
    ds_read_b128 v[40:43], v23 offset:2048
    s_waitcnt lgkmcnt(8)
    v_mfma_f32_16x16x32_bf16 a[16:19], v[80:83], v[32:35], a[16:19]
    ds_read_b128 v[44:47], v23 offset:3072
    ds_read_b128 v[48:51], v23 offset:4096
    s_waitcnt lgkmcnt(8)
    v_mfma_f32_16x16x32_bf16 a[20:23], v[84:87], v[32:35], a[20:23]
    ds_read_b128 v[52:55], v23 offset:5120
    ds_read_b128 v[56:59], v23 offset:6144
    s_waitcnt lgkmcnt(8)
    v_mfma_f32_16x16x32_bf16 a[24:27], v[88:91], v[32:35], a[24:27]
    ds_read_b128 v[60:63], v23 offset:7168
    s_waitcnt lgkmcnt(7)
    v_mfma_f32_16x16x32_bf16 a[28:31], v[92:95], v[32:35], a[28:31]
    s_waitcnt lgkmcnt(6)
    v_mfma_f32_16x16x32_bf16 a[32:35], v[64:67], v[36:39], a[32:35]
    v_mfma_f32_16x16x32_bf16 a[36:39], v[68:71], v[36:39], a[36:39]
    v_mfma_f32_16x16x32_bf16 a[40:43], v[72:75], v[36:39], a[40:43]
    v_mfma_f32_16x16x32_bf16 a[44:47], v[76:79], v[36:39], a[44:47]
    v_mfma_f32_16x16x32_bf16 a[48:51], v[80:83], v[36:39], a[48:51]
    v_mfma_f32_16x16x32_bf16 a[52:55], v[84:87], v[36:39], a[52:55]
    v_mfma_f32_16x16x32_bf16 a[56:59], v[88:91], v[36:39], a[56:59]
    v_mfma_f32_16x16x32_bf16 a[60:63], v[92:95], v[36:39], a[60:63]
    s_waitcnt lgkmcnt(5)
    v_mfma_f32_16x16x32_bf16 a[64:67], v[64:67], v[40:43], a[64:67]
    v_mfma_f32_16x16x32_bf16 a[68:71], v[68:71], v[40:43], a[68:71]
    v_mfma_f32_16x16x32_bf16 a[72:75], v[72:75], v[40:43], a[72:75]
    v_mfma_f32_16x16x32_bf16 a[76:79], v[76:79], v[40:43], a[76:79]
    v_mfma_f32_16x16x32_bf16 a[80:83], v[80:83], v[40:43], a[80:83]
    v_mfma_f32_16x16x32_bf16 a[84:87], v[84:87], v[40:43], a[84:87]
    v_mfma_f32_16x16x32_bf16 a[88:91], v[88:91], v[40:43], a[88:91]
    v_mfma_f32_16x16x32_bf16 a[92:95], v[92:95], v[40:43], a[92:95]
    s_waitcnt lgkmcnt(4)
    v_mfma_f32_16x16x32_bf16 a[96:99], v[64:67], v[44:47], a[96:99]
    v_mfma_f32_16x16x32_bf16 a[100:103], v[68:71], v[44:47], a[100:103]
    v_mfma_f32_16x16x32_bf16 a[104:107], v[72:75], v[44:47], a[104:107]
    v_mfma_f32_16x16x32_bf16 a[108:111], v[76:79], v[44:47], a[108:111]
    v_mfma_f32_16x16x32_bf16 a[112:115], v[80:83], v[44:47], a[112:115]
    v_mfma_f32_16x16x32_bf16 a[116:119], v[84:87], v[44:47], a[116:119]
    v_mfma_f32_16x16x32_bf16 a[120:123], v[88:91], v[44:47], a[120:123]
    v_mfma_f32_16x16x32_bf16 a[124:127], v[92:95], v[44:47], a[124:127]
    s_waitcnt lgkmcnt(3)
    v_mfma_f32_16x16x32_bf16 a[128:131], v[64:67], v[48:51], a[128:131]
    v_mfma_f32_16x16x32_bf16 a[132:135], v[68:71], v[48:51], a[132:135]
    v_mfma_f32_16x16x32_bf16 a[136:139], v[72:75], v[48:51], a[136:139]
    v_mfma_f32_16x16x32_bf16 a[140:143], v[76:79], v[48:51], a[140:143]
    v_mfma_f32_16x16x32_bf16 a[144:147], v[80:83], v[48:51], a[144:147]
    v_mfma_f32_16x16x32_bf16 a[148:151], v[84:87], v[48:51], a[148:151]
    v_mfma_f32_16x16x32_bf16 a[152:155], v[88:91], v[48:51], a[152:155]
    v_mfma_f32_16x16x32_bf16 a[156:159], v[92:95], v[48:51], a[156:159]
    s_waitcnt lgkmcnt(2)
    v_mfma_f32_16x16x32_bf16 a[160:163], v[64:67], v[52:55], a[160:163]
    v_mfma_f32_16x16x32_bf16 a[164:167], v[68:71], v[52:55], a[164:167]
    v_mfma_f32_16x16x32_bf16 a[168:171], v[72:75], v[52:55], a[168:171]
    v_mfma_f32_16x16x32_bf16 a[172:175], v[76:79], v[52:55], a[172:175]
    v_mfma_f32_16x16x32_bf16 a[176:179], v[80:83], v[52:55], a[176:179]
    v_mfma_f32_16x16x32_bf16 a[180:183], v[84:87], v[52:55], a[180:183]
    v_mfma_f32_16x16x32_bf16 a[184:187], v[88:91], v[52:55], a[184:187]
    v_mfma_f32_16x16x32_bf16 a[188:191], v[92:95], v[52:55], a[188:191]
    s_waitcnt lgkmcnt(1)
    v_mfma_f32_16x16x32_bf16 a[192:195], v[64:67], v[56:59], a[192:195]
    v_mfma_f32_16x16x32_bf16 a[196:199], v[68:71], v[56:59], a[196:199]
    v_mfma_f32_16x16x32_bf16 a[200:203], v[72:75], v[56:59], a[200:203]
    v_mfma_f32_16x16x32_bf16 a[204:207], v[76:79], v[56:59], a[204:207]
    v_mfma_f32_16x16x32_bf16 a[208:211], v[80:83], v[56:59], a[208:211]
    v_mfma_f32_16x16x32_bf16 a[212:215], v[84:87], v[56:59], a[212:215]
    v_mfma_f32_16x16x32_bf16 a[216:219], v[88:91], v[56:59], a[216:219]
    v_mfma_f32_16x16x32_bf16 a[220:223], v[92:95], v[56:59], a[220:223]
    s_waitcnt lgkmcnt(0)
    v_mfma_f32_16x16x32_bf16 a[224:227], v[64:67], v[60:63], a[224:227]
    v_mfma_f32_16x16x32_bf16 a[228:231], v[68:71], v[60:63], a[228:231]
    v_mfma_f32_16x16x32_bf16 a[232:235], v[72:75], v[60:63], a[232:235]
    v_mfma_f32_16x16x32_bf16 a[236:239], v[76:79], v[60:63], a[236:239]
    v_mfma_f32_16x16x32_bf16 a[240:243], v[80:83], v[60:63], a[240:243]
    v_mfma_f32_16x16x32_bf16 a[244:247], v[84:87], v[60:63], a[244:247]
    v_mfma_f32_16x16x32_bf16 a[248:251], v[88:91], v[60:63], a[248:251]
    v_mfma_f32_16x16x32_bf16 a[252:255], v[92:95], v[60:63], a[252:255]
    s_add_u32 s59, s59, 32768
    s_cmp_ge_u32 s59, 98304
    s_cselect_b32 s59, 0, s59
    s_waitcnt vmcnt(0)
    s_barrier
    v_add_u32 v23, s59, v14
    v_add_u32 v24, s59, v15
    v_add_u32 v25, s59, v16
    v_add_u32 v26, s59, v17
    v_add_u32 v27, s59, v18
    v_add_u32 v28, s59, v19
    v_add_u32 v29, s59, v20
    v_add_u32 v30, s59, v21
    v_add_u32 v31, s59, v22
    ds_read_b128 v[32:35], v23 offset:0
    ds_read_b64_tr_b16 v[64:65], v24 offset:0
    ds_read_b64_tr_b16 v[66:67], v24 offset:2048
    ds_read_b64_tr_b16 v[68:69], v25 offset:0
    ds_read_b64_tr_b16 v[70:71], v25 offset:2048
    ds_read_b64_tr_b16 v[72:73], v26 offset:0
    ds_read_b64_tr_b16 v[74:75], v26 offset:2048
    ds_read_b64_tr_b16 v[76:77], v27 offset:0
    ds_read_b64_tr_b16 v[78:79], v27 offset:2048
    ds_read_b64_tr_b16 v[80:81], v28 offset:0
    s_waitcnt lgkmcnt(7)
    v_mfma_f32_16x16x32_bf16 a[0:3], v[64:67], v[32:35], a[0:3]
    ds_read_b64_tr_b16 v[82:83], v28 offset:2048
    ds_read_b64_tr_b16 v[84:85], v29 offset:0
    ds_read_b64_tr_b16 v[86:87], v29 offset:2048
    s_waitcnt lgkmcnt(8)
    v_mfma_f32_16x16x32_bf16 a[4:7], v[68:71], v[32:35], a[4:7]
    ds_read_b64_tr_b16 v[88:89], v30 offset:0
    ds_read_b64_tr_b16 v[90:91], v30 offset:2048
    s_waitcnt lgkmcnt(8)
    v_mfma_f32_16x16x32_bf16 a[8:11], v[72:75], v[32:35], a[8:11]
    ds_read_b64_tr_b16 v[92:93], v31 offset:0
    ds_read_b64_tr_b16 v[94:95], v31 offset:2048
    s_waitcnt lgkmcnt(8)
    v_mfma_f32_16x16x32_bf16 a[12:15], v[76:79], v[32:35], a[12:15]
    ds_read_b128 v[36:39], v23 offset:1024
    ds_read_b128 v[40:43], v23 offset:2048
    s_waitcnt lgkmcnt(8)
    v_mfma_f32_16x16x32_bf16 a[16:19], v[80:83], v[32:35], a[16:19]
    ds_read_b128 v[44:47], v23 offset:3072
    ds_read_b128 v[48:51], v23 offset:4096
    s_waitcnt lgkmcnt(8)
    v_mfma_f32_16x16x32_bf16 a[20:23], v[84:87], v[32:35], a[20:23]
    ds_read_b128 v[52:55], v23 offset:5120
    ds_read_b128 v[56:59], v23 offset:6144
    s_waitcnt lgkmcnt(8)
    v_mfma_f32_16x16x32_bf16 a[24:27], v[88:91], v[32:35], a[24:27]
    ds_read_b128 v[60:63], v23 offset:7168
    s_waitcnt lgkmcnt(7)
    v_mfma_f32_16x16x32_bf16 a[28:31], v[92:95], v[32:35], a[28:31]
    s_waitcnt lgkmcnt(6)
    v_mfma_f32_16x16x32_bf16 a[32:35], v[64:67], v[36:39], a[32:35]
    v_mfma_f32_16x16x32_bf16 a[36:39], v[68:71], v[36:39], a[36:39]
    v_mfma_f32_16x16x32_bf16 a[40:43], v[72:75], v[36:39], a[40:43]
    v_mfma_f32_16x16x32_bf16 a[44:47], v[76:79], v[36:39], a[44:47]
    v_mfma_f32_16x16x32_bf16 a[48:51], v[80:83], v[36:39], a[48:51]
    v_mfma_f32_16x16x32_bf16 a[52:55], v[84:87], v[36:39], a[52:55]
    v_mfma_f32_16x16x32_bf16 a[56:59], v[88:91], v[36:39], a[56:59]
    v_mfma_f32_16x16x32_bf16 a[60:63], v[92:95], v[36:39], a[60:63]
    s_waitcnt lgkmcnt(5)
    v_mfma_f32_16x16x32_bf16 a[64:67], v[64:67], v[40:43], a[64:67]
    v_mfma_f32_16x16x32_bf16 a[68:71], v[68:71], v[40:43], a[68:71]
    v_mfma_f32_16x16x32_bf16 a[72:75], v[72:75], v[40:43], a[72:75]
    v_mfma_f32_16x16x32_bf16 a[76:79], v[76:79], v[40:43], a[76:79]
    v_mfma_f32_16x16x32_bf16 a[80:83], v[80:83], v[40:43], a[80:83]
    v_mfma_f32_16x16x32_bf16 a[84:87], v[84:87], v[40:43], a[84:87]
    v_mfma_f32_16x16x32_bf16 a[88:91], v[88:91], v[40:43], a[88:91]
    v_mfma_f32_16x16x32_bf16 a[92:95], v[92:95], v[40:43], a[92:95]
    s_waitcnt lgkmcnt(4)
    v_mfma_f32_16x16x32_bf16 a[96:99], v[64:67], v[44:47], a[96:99]
    v_mfma_f32_16x16x32_bf16 a[100:103], v[68:71], v[44:47], a[100:103]
    v_mfma_f32_16x16x32_bf16 a[104:107], v[72:75], v[44:47], a[104:107]
    v_mfma_f32_16x16x32_bf16 a[108:111], v[76:79], v[44:47], a[108:111]
    v_mfma_f32_16x16x32_bf16 a[112:115], v[80:83], v[44:47], a[112:115]
    v_mfma_f32_16x16x32_bf16 a[116:119], v[84:87], v[44:47], a[116:119]
    v_mfma_f32_16x16x32_bf16 a[120:123], v[88:91], v[44:47], a[120:123]
    v_mfma_f32_16x16x32_bf16 a[124:127], v[92:95], v[44:47], a[124:127]
    s_waitcnt lgkmcnt(3)
    v_mfma_f32_16x16x32_bf16 a[128:131], v[64:67], v[48:51], a[128:131]
    v_mfma_f32_16x16x32_bf16 a[132:135], v[68:71], v[48:51], a[132:135]
    v_mfma_f32_16x16x32_bf16 a[136:139], v[72:75], v[48:51], a[136:139]
    v_mfma_f32_16x16x32_bf16 a[140:143], v[76:79], v[48:51], a[140:143]
    v_mfma_f32_16x16x32_bf16 a[144:147], v[80:83], v[48:51], a[144:147]
    v_mfma_f32_16x16x32_bf16 a[148:151], v[84:87], v[48:51], a[148:151]
    v_mfma_f32_16x16x32_bf16 a[152:155], v[88:91], v[48:51], a[152:155]
    v_mfma_f32_16x16x32_bf16 a[156:159], v[92:95], v[48:51], a[156:159]
    s_waitcnt lgkmcnt(2)
    v_mfma_f32_16x16x32_bf16 a[160:163], v[64:67], v[52:55], a[160:163]
    v_mfma_f32_16x16x32_bf16 a[164:167], v[68:71], v[52:55], a[164:167]
    v_mfma_f32_16x16x32_bf16 a[168:171], v[72:75], v[52:55], a[168:171]
    v_mfma_f32_16x16x32_bf16 a[172:175], v[76:79], v[52:55], a[172:175]
    v_mfma_f32_16x16x32_bf16 a[176:179], v[80:83], v[52:55], a[176:179]
    v_mfma_f32_16x16x32_bf16 a[180:183], v[84:87], v[52:55], a[180:183]
    v_mfma_f32_16x16x32_bf16 a[184:187], v[88:91], v[52:55], a[184:187]
    v_mfma_f32_16x16x32_bf16 a[188:191], v[92:95], v[52:55], a[188:191]
    s_waitcnt lgkmcnt(1)
    v_mfma_f32_16x16x32_bf16 a[192:195], v[64:67], v[56:59], a[192:195]
    v_mfma_f32_16x16x32_bf16 a[196:199], v[68:71], v[56:59], a[196:199]
    v_mfma_f32_16x16x32_bf16 a[200:203], v[72:75], v[56:59], a[200:203]
    v_mfma_f32_16x16x32_bf16 a[204:207], v[76:79], v[56:59], a[204:207]
    v_mfma_f32_16x16x32_bf16 a[208:211], v[80:83], v[56:59], a[208:211]
    v_mfma_f32_16x16x32_bf16 a[212:215], v[84:87], v[56:59], a[212:215]
    v_mfma_f32_16x16x32_bf16 a[216:219], v[88:91], v[56:59], a[216:219]
    v_mfma_f32_16x16x32_bf16 a[220:223], v[92:95], v[56:59], a[220:223]
    s_waitcnt lgkmcnt(0)
    v_mfma_f32_16x16x32_bf16 a[224:227], v[64:67], v[60:63], a[224:227]
    v_mfma_f32_16x16x32_bf16 a[228:231], v[68:71], v[60:63], a[228:231]
    v_mfma_f32_16x16x32_bf16 a[232:235], v[72:75], v[60:63], a[232:235]
    v_mfma_f32_16x16x32_bf16 a[236:239], v[76:79], v[60:63], a[236:239]
    v_mfma_f32_16x16x32_bf16 a[240:243], v[80:83], v[60:63], a[240:243]
    v_mfma_f32_16x16x32_bf16 a[244:247], v[84:87], v[60:63], a[244:247]
    v_mfma_f32_16x16x32_bf16 a[248:251], v[88:91], v[60:63], a[248:251]
    v_mfma_f32_16x16x32_bf16 a[252:255], v[92:95], v[60:63], a[252:255]
    s_add_u32 s59, s59, 32768
    s_cmp_ge_u32 s59, 98304
    s_cselect_b32 s59, 0, s59
    s_nop 7
    s_nop 7
    s_add_u32 s28, s4, 0x280000
    s_addc_u32 s29, s5, 0
    s_mov_b32 s30, 0x1800000
    s_mov_b32 s31, 0x20000
    v_and_b32 v3, 15, v2
    v_lshrrev_b32 v4, 4, v2
    s_mul_i32 s53, s41, 256
    s_mul_i32 s54, s45, 128
    s_add_u32 s53, s53, s54
    v_add_u32 v3, s53, v3
    s_mov_b32 s60, 12288
    v_mul_lo_u32 v3, v3, s60
    s_mul_i32 s53, s47, 256
    s_mul_i32 s54, s46, 128
    s_add_u32 s53, s53, s54
    v_lshl_add_u32 v4, v4, 2, s53
    v_lshl_add_u32 v3, v4, 1, v3
    v_accvgpr_read_b32 v48, a0
    v_accvgpr_read_b32 v49, a1
    v_accvgpr_read_b32 v50, a2
    v_accvgpr_read_b32 v51, a3
    v_cvt_pk_bf16_f32 v32, v48, v49
    v_cvt_pk_bf16_f32 v33, v50, v51
    buffer_store_dwordx2 v[32:33], v3, s[28:31], 0 offen offset:0 sc1
    v_accvgpr_read_b32 v56, a4
    v_accvgpr_read_b32 v57, a5
    v_accvgpr_read_b32 v58, a6
    v_accvgpr_read_b32 v59, a7
    v_cvt_pk_bf16_f32 v36, v56, v57
    v_cvt_pk_bf16_f32 v37, v58, v59
    buffer_store_dwordx2 v[36:37], v3, s[28:31], 0 offen offset:32 sc1
    v_accvgpr_read_b32 v48, a8
    v_accvgpr_read_b32 v49, a9
    v_accvgpr_read_b32 v50, a10
    v_accvgpr_read_b32 v51, a11
    v_cvt_pk_bf16_f32 v40, v48, v49
    v_cvt_pk_bf16_f32 v41, v50, v51
    buffer_store_dwordx2 v[40:41], v3, s[28:31], 0 offen offset:64 sc1
    v_accvgpr_read_b32 v56, a12
    v_accvgpr_read_b32 v57, a13
    v_accvgpr_read_b32 v58, a14
    v_accvgpr_read_b32 v59, a15
    v_cvt_pk_bf16_f32 v44, v56, v57
    v_cvt_pk_bf16_f32 v45, v58, v59
    buffer_store_dwordx2 v[44:45], v3, s[28:31], 0 offen offset:96 sc1
    v_accvgpr_read_b32 v48, a16
    v_accvgpr_read_b32 v49, a17
    v_accvgpr_read_b32 v50, a18
    v_accvgpr_read_b32 v51, a19
    v_cvt_pk_bf16_f32 v32, v48, v49
    v_cvt_pk_bf16_f32 v33, v50, v51
    buffer_store_dwordx2 v[32:33], v3, s[28:31], 0 offen offset:128 sc1
    v_accvgpr_read_b32 v56, a20
    v_accvgpr_read_b32 v57, a21
    v_accvgpr_read_b32 v58, a22
    v_accvgpr_read_b32 v59, a23
    v_cvt_pk_bf16_f32 v36, v56, v57
    v_cvt_pk_bf16_f32 v37, v58, v59
    buffer_store_dwordx2 v[36:37], v3, s[28:31], 0 offen offset:160 sc1
    v_accvgpr_read_b32 v48, a24
    v_accvgpr_read_b32 v49, a25
    v_accvgpr_read_b32 v50, a26
    v_accvgpr_read_b32 v51, a27
    v_cvt_pk_bf16_f32 v40, v48, v49
    v_cvt_pk_bf16_f32 v41, v50, v51
    buffer_store_dwordx2 v[40:41], v3, s[28:31], 0 offen offset:192 sc1
    v_accvgpr_read_b32 v56, a28
    v_accvgpr_read_b32 v57, a29
    v_accvgpr_read_b32 v58, a30
    v_accvgpr_read_b32 v59, a31
    v_cvt_pk_bf16_f32 v44, v56, v57
    v_cvt_pk_bf16_f32 v45, v58, v59
    buffer_store_dwordx2 v[44:45], v3, s[28:31], 0 offen offset:224 sc1
    v_add_u32 v3, 0x30000, v3
    v_accvgpr_read_b32 v48, a32
    v_accvgpr_read_b32 v49, a33
    v_accvgpr_read_b32 v50, a34
    v_accvgpr_read_b32 v51, a35
    v_cvt_pk_bf16_f32 v32, v48, v49
    v_cvt_pk_bf16_f32 v33, v50, v51
    buffer_store_dwordx2 v[32:33], v3, s[28:31], 0 offen offset:0 sc1
    v_accvgpr_read_b32 v56, a36
    v_accvgpr_read_b32 v57, a37
    v_accvgpr_read_b32 v58, a38
    v_accvgpr_read_b32 v59, a39
    v_cvt_pk_bf16_f32 v36, v56, v57
    v_cvt_pk_bf16_f32 v37, v58, v59
    buffer_store_dwordx2 v[36:37], v3, s[28:31], 0 offen offset:32 sc1
    v_accvgpr_read_b32 v48, a40
    v_accvgpr_read_b32 v49, a41
    v_accvgpr_read_b32 v50, a42
    v_accvgpr_read_b32 v51, a43
    v_cvt_pk_bf16_f32 v40, v48, v49
    v_cvt_pk_bf16_f32 v41, v50, v51
    buffer_store_dwordx2 v[40:41], v3, s[28:31], 0 offen offset:64 sc1
    v_accvgpr_read_b32 v56, a44
    v_accvgpr_read_b32 v57, a45
    v_accvgpr_read_b32 v58, a46
    v_accvgpr_read_b32 v59, a47
    v_cvt_pk_bf16_f32 v44, v56, v57
    v_cvt_pk_bf16_f32 v45, v58, v59
    buffer_store_dwordx2 v[44:45], v3, s[28:31], 0 offen offset:96 sc1
    v_accvgpr_read_b32 v48, a48
    v_accvgpr_read_b32 v49, a49
    v_accvgpr_read_b32 v50, a50
    v_accvgpr_read_b32 v51, a51
    v_cvt_pk_bf16_f32 v32, v48, v49
    v_cvt_pk_bf16_f32 v33, v50, v51
    buffer_store_dwordx2 v[32:33], v3, s[28:31], 0 offen offset:128 sc1
    v_accvgpr_read_b32 v56, a52
    v_accvgpr_read_b32 v57, a53
    v_accvgpr_read_b32 v58, a54
    v_accvgpr_read_b32 v59, a55
    v_cvt_pk_bf16_f32 v36, v56, v57
    v_cvt_pk_bf16_f32 v37, v58, v59
    buffer_store_dwordx2 v[36:37], v3, s[28:31], 0 offen offset:160 sc1
    v_accvgpr_read_b32 v48, a56
    v_accvgpr_read_b32 v49, a57
    v_accvgpr_read_b32 v50, a58
    v_accvgpr_read_b32 v51, a59
    v_cvt_pk_bf16_f32 v40, v48, v49
    v_cvt_pk_bf16_f32 v41, v50, v51
    buffer_store_dwordx2 v[40:41], v3, s[28:31], 0 offen offset:192 sc1
    v_accvgpr_read_b32 v56, a60
    v_accvgpr_read_b32 v57, a61
    v_accvgpr_read_b32 v58, a62
    v_accvgpr_read_b32 v59, a63
    v_cvt_pk_bf16_f32 v44, v56, v57
    v_cvt_pk_bf16_f32 v45, v58, v59
    buffer_store_dwordx2 v[44:45], v3, s[28:31], 0 offen offset:224 sc1
    v_add_u32 v3, 0x30000, v3
    v_accvgpr_read_b32 v48, a64
    v_accvgpr_read_b32 v49, a65
    v_accvgpr_read_b32 v50, a66
    v_accvgpr_read_b32 v51, a67
    v_cvt_pk_bf16_f32 v32, v48, v49
    v_cvt_pk_bf16_f32 v33, v50, v51
    buffer_store_dwordx2 v[32:33], v3, s[28:31], 0 offen offset:0 sc1
    v_accvgpr_read_b32 v56, a68
    v_accvgpr_read_b32 v57, a69
    v_accvgpr_read_b32 v58, a70
    v_accvgpr_read_b32 v59, a71
    v_cvt_pk_bf16_f32 v36, v56, v57
    v_cvt_pk_bf16_f32 v37, v58, v59
    buffer_store_dwordx2 v[36:37], v3, s[28:31], 0 offen offset:32 sc1
    v_accvgpr_read_b32 v48, a72
    v_accvgpr_read_b32 v49, a73
    v_accvgpr_read_b32 v50, a74
    v_accvgpr_read_b32 v51, a75
    v_cvt_pk_bf16_f32 v40, v48, v49
    v_cvt_pk_bf16_f32 v41, v50, v51
    buffer_store_dwordx2 v[40:41], v3, s[28:31], 0 offen offset:64 sc1
    v_accvgpr_read_b32 v56, a76
    v_accvgpr_read_b32 v57, a77
    v_accvgpr_read_b32 v58, a78
    v_accvgpr_read_b32 v59, a79
    v_cvt_pk_bf16_f32 v44, v56, v57
    v_cvt_pk_bf16_f32 v45, v58, v59
    buffer_store_dwordx2 v[44:45], v3, s[28:31], 0 offen offset:96 sc1
    v_accvgpr_read_b32 v48, a80
    v_accvgpr_read_b32 v49, a81
    v_accvgpr_read_b32 v50, a82
    v_accvgpr_read_b32 v51, a83
    v_cvt_pk_bf16_f32 v32, v48, v49
    v_cvt_pk_bf16_f32 v33, v50, v51
    buffer_store_dwordx2 v[32:33], v3, s[28:31], 0 offen offset:128 sc1
    v_accvgpr_read_b32 v56, a84
    v_accvgpr_read_b32 v57, a85
    v_accvgpr_read_b32 v58, a86
    v_accvgpr_read_b32 v59, a87
    v_cvt_pk_bf16_f32 v36, v56, v57
    v_cvt_pk_bf16_f32 v37, v58, v59
    buffer_store_dwordx2 v[36:37], v3, s[28:31], 0 offen offset:160 sc1
    v_accvgpr_read_b32 v48, a88
    v_accvgpr_read_b32 v49, a89
    v_accvgpr_read_b32 v50, a90
    v_accvgpr_read_b32 v51, a91
    v_cvt_pk_bf16_f32 v40, v48, v49
    v_cvt_pk_bf16_f32 v41, v50, v51
    buffer_store_dwordx2 v[40:41], v3, s[28:31], 0 offen offset:192 sc1
    v_accvgpr_read_b32 v56, a92
    v_accvgpr_read_b32 v57, a93
    v_accvgpr_read_b32 v58, a94
    v_accvgpr_read_b32 v59, a95
    v_cvt_pk_bf16_f32 v44, v56, v57
    v_cvt_pk_bf16_f32 v45, v58, v59
    buffer_store_dwordx2 v[44:45], v3, s[28:31], 0 offen offset:224 sc1
    v_add_u32 v3, 0x30000, v3
    v_accvgpr_read_b32 v48, a96
    v_accvgpr_read_b32 v49, a97
    v_accvgpr_read_b32 v50, a98
    v_accvgpr_read_b32 v51, a99
    v_cvt_pk_bf16_f32 v32, v48, v49
    v_cvt_pk_bf16_f32 v33, v50, v51
    buffer_store_dwordx2 v[32:33], v3, s[28:31], 0 offen offset:0 sc1
    v_accvgpr_read_b32 v56, a100
    v_accvgpr_read_b32 v57, a101
    v_accvgpr_read_b32 v58, a102
    v_accvgpr_read_b32 v59, a103
    v_cvt_pk_bf16_f32 v36, v56, v57
    v_cvt_pk_bf16_f32 v37, v58, v59
    buffer_store_dwordx2 v[36:37], v3, s[28:31], 0 offen offset:32 sc1
    v_accvgpr_read_b32 v48, a104
    v_accvgpr_read_b32 v49, a105
    v_accvgpr_read_b32 v50, a106
    v_accvgpr_read_b32 v51, a107
    v_cvt_pk_bf16_f32 v40, v48, v49
    v_cvt_pk_bf16_f32 v41, v50, v51
    buffer_store_dwordx2 v[40:41], v3, s[28:31], 0 offen offset:64 sc1
    v_accvgpr_read_b32 v56, a108
    v_accvgpr_read_b32 v57, a109
    v_accvgpr_read_b32 v58, a110
    v_accvgpr_read_b32 v59, a111
    v_cvt_pk_bf16_f32 v44, v56, v57
    v_cvt_pk_bf16_f32 v45, v58, v59
    buffer_store_dwordx2 v[44:45], v3, s[28:31], 0 offen offset:96 sc1
    v_accvgpr_read_b32 v48, a112
    v_accvgpr_read_b32 v49, a113
    v_accvgpr_read_b32 v50, a114
    v_accvgpr_read_b32 v51, a115
    v_cvt_pk_bf16_f32 v32, v48, v49
    v_cvt_pk_bf16_f32 v33, v50, v51
    buffer_store_dwordx2 v[32:33], v3, s[28:31], 0 offen offset:128 sc1
    v_accvgpr_read_b32 v56, a116
    v_accvgpr_read_b32 v57, a117
    v_accvgpr_read_b32 v58, a118
    v_accvgpr_read_b32 v59, a119
    v_cvt_pk_bf16_f32 v36, v56, v57
    v_cvt_pk_bf16_f32 v37, v58, v59
    buffer_store_dwordx2 v[36:37], v3, s[28:31], 0 offen offset:160 sc1
    v_accvgpr_read_b32 v48, a120
    v_accvgpr_read_b32 v49, a121
    v_accvgpr_read_b32 v50, a122
    v_accvgpr_read_b32 v51, a123
    v_cvt_pk_bf16_f32 v40, v48, v49
    v_cvt_pk_bf16_f32 v41, v50, v51
    buffer_store_dwordx2 v[40:41], v3, s[28:31], 0 offen offset:192 sc1
    v_accvgpr_read_b32 v56, a124
    v_accvgpr_read_b32 v57, a125
    v_accvgpr_read_b32 v58, a126
    v_accvgpr_read_b32 v59, a127
    v_cvt_pk_bf16_f32 v44, v56, v57
    v_cvt_pk_bf16_f32 v45, v58, v59
    buffer_store_dwordx2 v[44:45], v3, s[28:31], 0 offen offset:224 sc1
    v_add_u32 v3, 0x30000, v3
    v_accvgpr_read_b32 v48, a128
    v_accvgpr_read_b32 v49, a129
    v_accvgpr_read_b32 v50, a130
    v_accvgpr_read_b32 v51, a131
    v_cvt_pk_bf16_f32 v32, v48, v49
    v_cvt_pk_bf16_f32 v33, v50, v51
    buffer_store_dwordx2 v[32:33], v3, s[28:31], 0 offen offset:0 sc1
    v_accvgpr_read_b32 v56, a132
    v_accvgpr_read_b32 v57, a133
    v_accvgpr_read_b32 v58, a134
    v_accvgpr_read_b32 v59, a135
    v_cvt_pk_bf16_f32 v36, v56, v57
    v_cvt_pk_bf16_f32 v37, v58, v59
    buffer_store_dwordx2 v[36:37], v3, s[28:31], 0 offen offset:32 sc1
    v_accvgpr_read_b32 v48, a136
    v_accvgpr_read_b32 v49, a137
    v_accvgpr_read_b32 v50, a138
    v_accvgpr_read_b32 v51, a139
    v_cvt_pk_bf16_f32 v40, v48, v49
    v_cvt_pk_bf16_f32 v41, v50, v51
    buffer_store_dwordx2 v[40:41], v3, s[28:31], 0 offen offset:64 sc1
    v_accvgpr_read_b32 v56, a140
    v_accvgpr_read_b32 v57, a141
    v_accvgpr_read_b32 v58, a142
    v_accvgpr_read_b32 v59, a143
    v_cvt_pk_bf16_f32 v44, v56, v57
    v_cvt_pk_bf16_f32 v45, v58, v59
    buffer_store_dwordx2 v[44:45], v3, s[28:31], 0 offen offset:96 sc1
    v_accvgpr_read_b32 v48, a144
    v_accvgpr_read_b32 v49, a145
    v_accvgpr_read_b32 v50, a146
    v_accvgpr_read_b32 v51, a147
    v_cvt_pk_bf16_f32 v32, v48, v49
    v_cvt_pk_bf16_f32 v33, v50, v51
    buffer_store_dwordx2 v[32:33], v3, s[28:31], 0 offen offset:128 sc1
    v_accvgpr_read_b32 v56, a148
    v_accvgpr_read_b32 v57, a149
    v_accvgpr_read_b32 v58, a150
    v_accvgpr_read_b32 v59, a151
    v_cvt_pk_bf16_f32 v36, v56, v57
    v_cvt_pk_bf16_f32 v37, v58, v59
    buffer_store_dwordx2 v[36:37], v3, s[28:31], 0 offen offset:160 sc1
    v_accvgpr_read_b32 v48, a152
    v_accvgpr_read_b32 v49, a153
    v_accvgpr_read_b32 v50, a154
    v_accvgpr_read_b32 v51, a155
    v_cvt_pk_bf16_f32 v40, v48, v49
    v_cvt_pk_bf16_f32 v41, v50, v51
    buffer_store_dwordx2 v[40:41], v3, s[28:31], 0 offen offset:192 sc1
    v_accvgpr_read_b32 v56, a156
    v_accvgpr_read_b32 v57, a157
    v_accvgpr_read_b32 v58, a158
    v_accvgpr_read_b32 v59, a159
    v_cvt_pk_bf16_f32 v44, v56, v57
    v_cvt_pk_bf16_f32 v45, v58, v59
    buffer_store_dwordx2 v[44:45], v3, s[28:31], 0 offen offset:224 sc1
    v_add_u32 v3, 0x30000, v3
    v_accvgpr_read_b32 v48, a160
    v_accvgpr_read_b32 v49, a161
    v_accvgpr_read_b32 v50, a162
    v_accvgpr_read_b32 v51, a163
    v_cvt_pk_bf16_f32 v32, v48, v49
    v_cvt_pk_bf16_f32 v33, v50, v51
    buffer_store_dwordx2 v[32:33], v3, s[28:31], 0 offen offset:0 sc1
    v_accvgpr_read_b32 v56, a164
    v_accvgpr_read_b32 v57, a165
    v_accvgpr_read_b32 v58, a166
    v_accvgpr_read_b32 v59, a167
    v_cvt_pk_bf16_f32 v36, v56, v57
    v_cvt_pk_bf16_f32 v37, v58, v59
    buffer_store_dwordx2 v[36:37], v3, s[28:31], 0 offen offset:32 sc1
    v_accvgpr_read_b32 v48, a168
    v_accvgpr_read_b32 v49, a169
    v_accvgpr_read_b32 v50, a170
    v_accvgpr_read_b32 v51, a171
    v_cvt_pk_bf16_f32 v40, v48, v49
    v_cvt_pk_bf16_f32 v41, v50, v51
    buffer_store_dwordx2 v[40:41], v3, s[28:31], 0 offen offset:64 sc1
    v_accvgpr_read_b32 v56, a172
    v_accvgpr_read_b32 v57, a173
    v_accvgpr_read_b32 v58, a174
    v_accvgpr_read_b32 v59, a175
    v_cvt_pk_bf16_f32 v44, v56, v57
    v_cvt_pk_bf16_f32 v45, v58, v59
    buffer_store_dwordx2 v[44:45], v3, s[28:31], 0 offen offset:96 sc1
    v_accvgpr_read_b32 v48, a176
    v_accvgpr_read_b32 v49, a177
    v_accvgpr_read_b32 v50, a178
    v_accvgpr_read_b32 v51, a179
    v_cvt_pk_bf16_f32 v32, v48, v49
    v_cvt_pk_bf16_f32 v33, v50, v51
    buffer_store_dwordx2 v[32:33], v3, s[28:31], 0 offen offset:128 sc1
    v_accvgpr_read_b32 v56, a180
    v_accvgpr_read_b32 v57, a181
    v_accvgpr_read_b32 v58, a182
    v_accvgpr_read_b32 v59, a183
    v_cvt_pk_bf16_f32 v36, v56, v57
    v_cvt_pk_bf16_f32 v37, v58, v59
    buffer_store_dwordx2 v[36:37], v3, s[28:31], 0 offen offset:160 sc1
    v_accvgpr_read_b32 v48, a184
    v_accvgpr_read_b32 v49, a185
    v_accvgpr_read_b32 v50, a186
    v_accvgpr_read_b32 v51, a187
    v_cvt_pk_bf16_f32 v40, v48, v49
    v_cvt_pk_bf16_f32 v41, v50, v51
    buffer_store_dwordx2 v[40:41], v3, s[28:31], 0 offen offset:192 sc1
    v_accvgpr_read_b32 v56, a188
    v_accvgpr_read_b32 v57, a189
    v_accvgpr_read_b32 v58, a190
    v_accvgpr_read_b32 v59, a191
    v_cvt_pk_bf16_f32 v44, v56, v57
    v_cvt_pk_bf16_f32 v45, v58, v59
    buffer_store_dwordx2 v[44:45], v3, s[28:31], 0 offen offset:224 sc1
    v_add_u32 v3, 0x30000, v3
    v_accvgpr_read_b32 v48, a192
    v_accvgpr_read_b32 v49, a193
    v_accvgpr_read_b32 v50, a194
    v_accvgpr_read_b32 v51, a195
    v_cvt_pk_bf16_f32 v32, v48, v49
    v_cvt_pk_bf16_f32 v33, v50, v51
    buffer_store_dwordx2 v[32:33], v3, s[28:31], 0 offen offset:0 sc1
    v_accvgpr_read_b32 v56, a196
    v_accvgpr_read_b32 v57, a197
    v_accvgpr_read_b32 v58, a198
    v_accvgpr_read_b32 v59, a199
    v_cvt_pk_bf16_f32 v36, v56, v57
    v_cvt_pk_bf16_f32 v37, v58, v59
    buffer_store_dwordx2 v[36:37], v3, s[28:31], 0 offen offset:32 sc1
    v_accvgpr_read_b32 v48, a200
    v_accvgpr_read_b32 v49, a201
    v_accvgpr_read_b32 v50, a202
    v_accvgpr_read_b32 v51, a203
    v_cvt_pk_bf16_f32 v40, v48, v49
    v_cvt_pk_bf16_f32 v41, v50, v51
    buffer_store_dwordx2 v[40:41], v3, s[28:31], 0 offen offset:64 sc1
    v_accvgpr_read_b32 v56, a204
    v_accvgpr_read_b32 v57, a205
    v_accvgpr_read_b32 v58, a206
    v_accvgpr_read_b32 v59, a207
    v_cvt_pk_bf16_f32 v44, v56, v57
    v_cvt_pk_bf16_f32 v45, v58, v59
    buffer_store_dwordx2 v[44:45], v3, s[28:31], 0 offen offset:96 sc1
    v_accvgpr_read_b32 v48, a208
    v_accvgpr_read_b32 v49, a209
    v_accvgpr_read_b32 v50, a210
    v_accvgpr_read_b32 v51, a211
    v_cvt_pk_bf16_f32 v32, v48, v49
    v_cvt_pk_bf16_f32 v33, v50, v51
    buffer_store_dwordx2 v[32:33], v3, s[28:31], 0 offen offset:128 sc1
    v_accvgpr_read_b32 v56, a212
    v_accvgpr_read_b32 v57, a213
    v_accvgpr_read_b32 v58, a214
    v_accvgpr_read_b32 v59, a215
    v_cvt_pk_bf16_f32 v36, v56, v57
    v_cvt_pk_bf16_f32 v37, v58, v59
    buffer_store_dwordx2 v[36:37], v3, s[28:31], 0 offen offset:160 sc1
    v_accvgpr_read_b32 v48, a216
    v_accvgpr_read_b32 v49, a217
    v_accvgpr_read_b32 v50, a218
    v_accvgpr_read_b32 v51, a219
    v_cvt_pk_bf16_f32 v40, v48, v49
    v_cvt_pk_bf16_f32 v41, v50, v51
    buffer_store_dwordx2 v[40:41], v3, s[28:31], 0 offen offset:192 sc1
    v_accvgpr_read_b32 v56, a220
    v_accvgpr_read_b32 v57, a221
    v_accvgpr_read_b32 v58, a222
    v_accvgpr_read_b32 v59, a223
    v_cvt_pk_bf16_f32 v44, v56, v57
    v_cvt_pk_bf16_f32 v45, v58, v59
    buffer_store_dwordx2 v[44:45], v3, s[28:31], 0 offen offset:224 sc1
    v_add_u32 v3, 0x30000, v3
    v_accvgpr_read_b32 v48, a224
    v_accvgpr_read_b32 v49, a225
    v_accvgpr_read_b32 v50, a226
    v_accvgpr_read_b32 v51, a227
    v_cvt_pk_bf16_f32 v32, v48, v49
    v_cvt_pk_bf16_f32 v33, v50, v51
    buffer_store_dwordx2 v[32:33], v3, s[28:31], 0 offen offset:0 sc1
    v_accvgpr_read_b32 v56, a228
    v_accvgpr_read_b32 v57, a229
    v_accvgpr_read_b32 v58, a230
    v_accvgpr_read_b32 v59, a231
    v_cvt_pk_bf16_f32 v36, v56, v57
    v_cvt_pk_bf16_f32 v37, v58, v59
    buffer_store_dwordx2 v[36:37], v3, s[28:31], 0 offen offset:32 sc1
    v_accvgpr_read_b32 v48, a232
    v_accvgpr_read_b32 v49, a233
    v_accvgpr_read_b32 v50, a234
    v_accvgpr_read_b32 v51, a235
    v_cvt_pk_bf16_f32 v40, v48, v49
    v_cvt_pk_bf16_f32 v41, v50, v51
    buffer_store_dwordx2 v[40:41], v3, s[28:31], 0 offen offset:64 sc1
    v_accvgpr_read_b32 v56, a236
    v_accvgpr_read_b32 v57, a237
    v_accvgpr_read_b32 v58, a238
    v_accvgpr_read_b32 v59, a239
    v_cvt_pk_bf16_f32 v44, v56, v57
    v_cvt_pk_bf16_f32 v45, v58, v59
    buffer_store_dwordx2 v[44:45], v3, s[28:31], 0 offen offset:96 sc1
    v_accvgpr_read_b32 v48, a240
    v_accvgpr_read_b32 v49, a241
    v_accvgpr_read_b32 v50, a242
    v_accvgpr_read_b32 v51, a243
    v_cvt_pk_bf16_f32 v32, v48, v49
    v_cvt_pk_bf16_f32 v33, v50, v51
    buffer_store_dwordx2 v[32:33], v3, s[28:31], 0 offen offset:128 sc1
    v_accvgpr_read_b32 v56, a244
    v_accvgpr_read_b32 v57, a245
    v_accvgpr_read_b32 v58, a246
    v_accvgpr_read_b32 v59, a247
    v_cvt_pk_bf16_f32 v36, v56, v57
    v_cvt_pk_bf16_f32 v37, v58, v59
    buffer_store_dwordx2 v[36:37], v3, s[28:31], 0 offen offset:160 sc1
    v_accvgpr_read_b32 v48, a248
    v_accvgpr_read_b32 v49, a249
    v_accvgpr_read_b32 v50, a250
    v_accvgpr_read_b32 v51, a251
    v_cvt_pk_bf16_f32 v40, v48, v49
    v_cvt_pk_bf16_f32 v41, v50, v51
    buffer_store_dwordx2 v[40:41], v3, s[28:31], 0 offen offset:192 sc1
    v_accvgpr_read_b32 v56, a252
    v_accvgpr_read_b32 v57, a253
    v_accvgpr_read_b32 v58, a254
    v_accvgpr_read_b32 v59, a255
    v_cvt_pk_bf16_f32 v44, v56, v57
    v_cvt_pk_bf16_f32 v45, v58, v59
    buffer_store_dwordx2 v[44:45], v3, s[28:31], 0 offen offset:224 sc1
    s_waitcnt vmcnt(0)
    s_barrier
    s_cmp_lg_u32 s44, 0
    s_cbranch_scc1 L_w_nsq
    s_lshl_b32 s66, s41, 2
    s_add_u32 s66, s66, 32
    v_mov_b32 v24, s66
    v_mov_b32 v25, 1
    s_mov_b64 exec, 1
    buffer_atomic_add v25, v24, s[92:95], 0 offen sc1
    s_mov_b64 exec, -1
L_w_nsq:
    s_add_u32 s91, s91, 127
    s_branch L_w_q
L_w_f0:
    s_sub_u32 s91, s91, 192
L_w_f:
    s_cmp_ge_u32 s91, 96
    s_cbranch_scc1 L_w_g0
    s_mov_b32 s60, 0x15555556
    s_mul_hi_u32 s41, s91, s60
    s_mul_i32 s61, s41, 12
    s_sub_u32 s40, s91, s61
    s_mov_b32 s6, s86
    s_mov_b32 s7, s87
    s_mov_b32 s8, s88
    s_mov_b32 s9, s89
    s_lshr_b32 s45, s44, 1
    s_and_b32 s46, s44, 1
    s_mov_b32 s12, s4
    s_mov_b32 s13, s5
    s_mov_b32 s14, 0x280000
    s_mov_b32 s15, 0x20000
    s_mov_b32 s16, s6
    s_mov_b32 s17, s7
    s_mov_b32 s18, 0x1e0000
    s_mov_b32 s19, 0x20000
    s_mov_b32 s47, s40
    s_mov_b32 s20, s8
    s_mov_b32 s21, s9
    s_mov_b32 s22, 0x1e0000
    s_mov_b32 s23, 0x20000
    v_lshrrev_b32 v3, 2, v2
    v_and_b32 v4, 3, v2
    v_lshrrev_b32 v5, 3, v3
    v_lshlrev_b32 v5, 1, v5
    v_xor_b32 v4, v4, v5
    s_mul_i32 s48, s41, 256
    s_mul_i32 s49, s44, 64
    s_add_u32 s48, s48, s49
    v_add_u32 v3, s48, v3
    s_mov_b32 s60, 1280
    v_mul_lo_u32 v3, v3, s60
    v_lshl_add_u32 v6, v4, 4, v3
    v_add_u32 v7, 0x5000, v6
    v_add_u32 v8, 0xa000, v6
    v_add_u32 v9, 0xf000, v6
    s_mul_i32 s50, s44, 4
    s_lshr_b32 s51, s50, 3
    s_and_b32 s52, s50, 7
    v_lshrrev_b32 v3, 4, v2
    s_add_u32 s53, s52, 0
    s_mul_i32 s53, s53, 4
    v_add_u32 v3, s53, v3
    v_and_b32 v4, 15, v2
    v_and_b32 v5, 3, v3
    v_lshrrev_b32 v30, 3, v3
    v_and_b32 v30, 1, v30
    v_lshl_or_b32 v5, v30, 2, v5
    v_lshlrev_b32 v5, 1, v5
    v_xor_b32 v4, v4, v5
    s_mov_b32 s60, 3072
    v_mul_lo_u32 v3, v3, s60
    v_lshl_add_u32 v3, v4, 4, v3
    s_mul_i32 s53, s47, 256
    v_add_u32 v10, s53, v3
    v_lshrrev_b32 v3, 4, v2
    s_add_u32 s53, s52, 1
    s_mul_i32 s53, s53, 4
    v_add_u32 v3, s53, v3
    v_and_b32 v4, 15, v2
    v_and_b32 v5, 3, v3
    v_lshrrev_b32 v30, 3, v3
    v_and_b32 v30, 1, v30
    v_lshl_or_b32 v5, v30, 2, v5
    v_lshlrev_b32 v5, 1, v5
    v_xor_b32 v4, v4, v5
    s_mov_b32 s60, 3072
    v_mul_lo_u32 v3, v3, s60
    v_lshl_add_u32 v3, v4, 4, v3
    s_mul_i32 s53, s47, 256
    v_add_u32 v11, s53, v3
    v_lshrrev_b32 v3, 4, v2
    s_add_u32 s53, s52, 2
    s_mul_i32 s53, s53, 4
    v_add_u32 v3, s53, v3
    v_and_b32 v4, 15, v2
    v_and_b32 v5, 3, v3
    v_lshrrev_b32 v30, 3, v3
    v_and_b32 v30, 1, v30
    v_lshl_or_b32 v5, v30, 2, v5
    v_lshlrev_b32 v5, 1, v5
    v_xor_b32 v4, v4, v5
    s_mov_b32 s60, 3072
    v_mul_lo_u32 v3, v3, s60
    v_lshl_add_u32 v3, v4, 4, v3
    s_mul_i32 s53, s47, 256
    v_add_u32 v12, s53, v3
    v_lshrrev_b32 v3, 4, v2
    s_add_u32 s53, s52, 3
    s_mul_i32 s53, s53, 4
    v_add_u32 v3, s53, v3
    v_and_b32 v4, 15, v2
    v_and_b32 v5, 3, v3
    v_lshrrev_b32 v30, 3, v3
    v_and_b32 v30, 1, v30
    v_lshl_or_b32 v5, v30, 2, v5
    v_lshlrev_b32 v5, 1, v5
    v_xor_b32 v4, v4, v5
    s_mov_b32 s60, 3072
    v_mul_lo_u32 v3, v3, s60
    v_lshl_add_u32 v3, v4, 4, v3
    s_mul_i32 s53, s47, 256
    v_add_u32 v13, s53, v3
    v_and_b32 v3, 15, v2
    v_lshrrev_b32 v4, 4, v2
    v_lshrrev_b32 v5, 3, v3
    v_lshlrev_b32 v5, 1, v5
    v_xor_b32 v5, v4, v5
    s_mul_i32 s53, s45, 128
    v_add_u32 v30, s53, v3
    v_lshlrev_b32 v30, 6, v30
    v_lshl_add_u32 v14, v5, 4, v30
    v_lshrrev_b32 v5, 2, v3
    v_and_b32 v30, 3, v2
    v_lshl_add_u32 v31, v4, 3, v5
    v_mul_u32_u24 v31, 256, v31
    v_lshl_add_u32 v31, v30, 3, v31
    v_add_u32 v31, 16384, v31
    v_and_b32 v30, 1, v4
    v_lshl_or_b32 v5, v30, 2, v5
    v_xor_b32 v30, 0, v5
    v_lshl_add_u32 v15, v30, 5, v31
    v_xor_b32 v30, 1, v5
    v_lshl_add_u32 v16, v30, 5, v31
    v_xor_b32 v30, 2, v5
    v_lshl_add_u32 v17, v30, 5, v31
    v_xor_b32 v30, 3, v5
    v_lshl_add_u32 v18, v30, 5, v31
    v_xor_b32 v30, 4, v5
    v_lshl_add_u32 v19, v30, 5, v31
    v_xor_b32 v30, 5, v5
    v_lshl_add_u32 v20, v30, 5, v31
    v_xor_b32 v30, 6, v5
    v_lshl_add_u32 v21, v30, 5, v31
    v_xor_b32 v30, 7, v5
    v_lshl_add_u32 v22, v30, 5, v31
    s_mul_i32 s53, s46, 4
    s_add_u32 s54, s53, 0
    v_xor_b32 v30, s54, v5
    v_lshl_add_u32 v15, v30, 5, v31
    s_add_u32 s54, s53, 1
    v_xor_b32 v30, s54, v5
    v_lshl_add_u32 v16, v30, 5, v31
    s_add_u32 s54, s53, 2
    v_xor_b32 v30, s54, v5
    v_lshl_add_u32 v17, v30, 5, v31
    s_add_u32 s54, s53, 3
    v_xor_b32 v30, s54, v5
    v_lshl_add_u32 v18, v30, 5, v31
    v_accvgpr_write_b32 a0, 0
    v_accvgpr_write_b32 a1, 0
    v_accvgpr_write_b32 a2, 0
    v_accvgpr_write_b32 a3, 0
    v_accvgpr_write_b32 a4, 0
    v_accvgpr_write_b32 a5, 0
    v_accvgpr_write_b32 a6, 0
    v_accvgpr_write_b32 a7, 0
    v_accvgpr_write_b32 a8, 0
    v_accvgpr_write_b32 a9, 0
    v_accvgpr_write_b32 a10, 0
    v_accvgpr_write_b32 a11, 0
    v_accvgpr_write_b32 a12, 0
    v_accvgpr_write_b32 a13, 0
    v_accvgpr_write_b32 a14, 0
    v_accvgpr_write_b32 a15, 0
    v_accvgpr_write_b32 a16, 0
    v_accvgpr_write_b32 a17, 0
    v_accvgpr_write_b32 a18, 0
    v_accvgpr_write_b32 a19, 0
    v_accvgpr_write_b32 a20, 0
    v_accvgpr_write_b32 a21, 0
    v_accvgpr_write_b32 a22, 0
    v_accvgpr_write_b32 a23, 0
    v_accvgpr_write_b32 a24, 0
    v_accvgpr_write_b32 a25, 0
    v_accvgpr_write_b32 a26, 0
    v_accvgpr_write_b32 a27, 0
    v_accvgpr_write_b32 a28, 0
    v_accvgpr_write_b32 a29, 0
    v_accvgpr_write_b32 a30, 0
    v_accvgpr_write_b32 a31, 0
    v_accvgpr_write_b32 a32, 0
    v_accvgpr_write_b32 a33, 0
    v_accvgpr_write_b32 a34, 0
    v_accvgpr_write_b32 a35, 0
    v_accvgpr_write_b32 a36, 0
    v_accvgpr_write_b32 a37, 0
    v_accvgpr_write_b32 a38, 0
    v_accvgpr_write_b32 a39, 0
    v_accvgpr_write_b32 a40, 0
    v_accvgpr_write_b32 a41, 0
    v_accvgpr_write_b32 a42, 0
    v_accvgpr_write_b32 a43, 0
    v_accvgpr_write_b32 a44, 0
    v_accvgpr_write_b32 a45, 0
    v_accvgpr_write_b32 a46, 0
    v_accvgpr_write_b32 a47, 0
    v_accvgpr_write_b32 a48, 0
    v_accvgpr_write_b32 a49, 0
    v_accvgpr_write_b32 a50, 0
    v_accvgpr_write_b32 a51, 0
    v_accvgpr_write_b32 a52, 0
    v_accvgpr_write_b32 a53, 0
    v_accvgpr_write_b32 a54, 0
    v_accvgpr_write_b32 a55, 0
    v_accvgpr_write_b32 a56, 0
    v_accvgpr_write_b32 a57, 0
    v_accvgpr_write_b32 a58, 0
    v_accvgpr_write_b32 a59, 0
    v_accvgpr_write_b32 a60, 0
    v_accvgpr_write_b32 a61, 0
    v_accvgpr_write_b32 a62, 0
    v_accvgpr_write_b32 a63, 0
    v_accvgpr_write_b32 a64, 0
    v_accvgpr_write_b32 a65, 0
    v_accvgpr_write_b32 a66, 0
    v_accvgpr_write_b32 a67, 0
    v_accvgpr_write_b32 a68, 0
    v_accvgpr_write_b32 a69, 0
    v_accvgpr_write_b32 a70, 0
    v_accvgpr_write_b32 a71, 0
    v_accvgpr_write_b32 a72, 0
    v_accvgpr_write_b32 a73, 0
    v_accvgpr_write_b32 a74, 0
    v_accvgpr_write_b32 a75, 0
    v_accvgpr_write_b32 a76, 0
    v_accvgpr_write_b32 a77, 0
    v_accvgpr_write_b32 a78, 0
    v_accvgpr_write_b32 a79, 0
    v_accvgpr_write_b32 a80, 0
    v_accvgpr_write_b32 a81, 0
    v_accvgpr_write_b32 a82, 0
    v_accvgpr_write_b32 a83, 0
    v_accvgpr_write_b32 a84, 0
    v_accvgpr_write_b32 a85, 0
    v_accvgpr_write_b32 a86, 0
    v_accvgpr_write_b32 a87, 0
    v_accvgpr_write_b32 a88, 0
    v_accvgpr_write_b32 a89, 0
    v_accvgpr_write_b32 a90, 0
    v_accvgpr_write_b32 a91, 0
    v_accvgpr_write_b32 a92, 0
    v_accvgpr_write_b32 a93, 0
    v_accvgpr_write_b32 a94, 0
    v_accvgpr_write_b32 a95, 0
    v_accvgpr_write_b32 a96, 0
    v_accvgpr_write_b32 a97, 0
    v_accvgpr_write_b32 a98, 0
    v_accvgpr_write_b32 a99, 0
    v_accvgpr_write_b32 a100, 0
    v_accvgpr_write_b32 a101, 0
    v_accvgpr_write_b32 a102, 0
    v_accvgpr_write_b32 a103, 0
    v_accvgpr_write_b32 a104, 0
    v_accvgpr_write_b32 a105, 0
    v_accvgpr_write_b32 a106, 0
    v_accvgpr_write_b32 a107, 0
    v_accvgpr_write_b32 a108, 0
    v_accvgpr_write_b32 a109, 0
    v_accvgpr_write_b32 a110, 0
    v_accvgpr_write_b32 a111, 0
    v_accvgpr_write_b32 a112, 0
    v_accvgpr_write_b32 a113, 0
    v_accvgpr_write_b32 a114, 0
    v_accvgpr_write_b32 a115, 0
    v_accvgpr_write_b32 a116, 0
    v_accvgpr_write_b32 a117, 0
    v_accvgpr_write_b32 a118, 0
    v_accvgpr_write_b32 a119, 0
    v_accvgpr_write_b32 a120, 0
    v_accvgpr_write_b32 a121, 0
    v_accvgpr_write_b32 a122, 0
    v_accvgpr_write_b32 a123, 0
    v_accvgpr_write_b32 a124, 0
    v_accvgpr_write_b32 a125, 0
    v_accvgpr_write_b32 a126, 0
    v_accvgpr_write_b32 a127, 0
    v_accvgpr_write_b32 a128, 0
    v_accvgpr_write_b32 a129, 0
    v_accvgpr_write_b32 a130, 0
    v_accvgpr_write_b32 a131, 0
    v_accvgpr_write_b32 a132, 0
    v_accvgpr_write_b32 a133, 0
    v_accvgpr_write_b32 a134, 0
    v_accvgpr_write_b32 a135, 0
    v_accvgpr_write_b32 a136, 0
    v_accvgpr_write_b32 a137, 0
    v_accvgpr_write_b32 a138, 0
    v_accvgpr_write_b32 a139, 0
    v_accvgpr_write_b32 a140, 0
    v_accvgpr_write_b32 a141, 0
    v_accvgpr_write_b32 a142, 0
    v_accvgpr_write_b32 a143, 0
    v_accvgpr_write_b32 a144, 0
    v_accvgpr_write_b32 a145, 0
    v_accvgpr_write_b32 a146, 0
    v_accvgpr_write_b32 a147, 0
    v_accvgpr_write_b32 a148, 0
    v_accvgpr_write_b32 a149, 0
    v_accvgpr_write_b32 a150, 0
    v_accvgpr_write_b32 a151, 0
    v_accvgpr_write_b32 a152, 0
    v_accvgpr_write_b32 a153, 0
    v_accvgpr_write_b32 a154, 0
    v_accvgpr_write_b32 a155, 0
    v_accvgpr_write_b32 a156, 0
    v_accvgpr_write_b32 a157, 0
    v_accvgpr_write_b32 a158, 0
    v_accvgpr_write_b32 a159, 0
    v_accvgpr_write_b32 a160, 0
    v_accvgpr_write_b32 a161, 0
    v_accvgpr_write_b32 a162, 0
    v_accvgpr_write_b32 a163, 0
    v_accvgpr_write_b32 a164, 0
    v_accvgpr_write_b32 a165, 0
    v_accvgpr_write_b32 a166, 0
    v_accvgpr_write_b32 a167, 0
    v_accvgpr_write_b32 a168, 0
    v_accvgpr_write_b32 a169, 0
    v_accvgpr_write_b32 a170, 0
    v_accvgpr_write_b32 a171, 0
    v_accvgpr_write_b32 a172, 0
    v_accvgpr_write_b32 a173, 0
    v_accvgpr_write_b32 a174, 0
    v_accvgpr_write_b32 a175, 0
    v_accvgpr_write_b32 a176, 0
    v_accvgpr_write_b32 a177, 0
    v_accvgpr_write_b32 a178, 0
    v_accvgpr_write_b32 a179, 0
    v_accvgpr_write_b32 a180, 0
    v_accvgpr_write_b32 a181, 0
    v_accvgpr_write_b32 a182, 0
    v_accvgpr_write_b32 a183, 0
    v_accvgpr_write_b32 a184, 0
    v_accvgpr_write_b32 a185, 0
    v_accvgpr_write_b32 a186, 0
    v_accvgpr_write_b32 a187, 0
    v_accvgpr_write_b32 a188, 0
    v_accvgpr_write_b32 a189, 0
    v_accvgpr_write_b32 a190, 0
    v_accvgpr_write_b32 a191, 0
    v_accvgpr_write_b32 a192, 0
    v_accvgpr_write_b32 a193, 0
    v_accvgpr_write_b32 a194, 0
    v_accvgpr_write_b32 a195, 0
    v_accvgpr_write_b32 a196, 0
    v_accvgpr_write_b32 a197, 0
    v_accvgpr_write_b32 a198, 0
    v_accvgpr_write_b32 a199, 0
    v_accvgpr_write_b32 a200, 0
    v_accvgpr_write_b32 a201, 0
    v_accvgpr_write_b32 a202, 0
    v_accvgpr_write_b32 a203, 0
    v_accvgpr_write_b32 a204, 0
    v_accvgpr_write_b32 a205, 0
    v_accvgpr_write_b32 a206, 0
    v_accvgpr_write_b32 a207, 0
    v_accvgpr_write_b32 a208, 0
    v_accvgpr_write_b32 a209, 0
    v_accvgpr_write_b32 a210, 0
    v_accvgpr_write_b32 a211, 0
    v_accvgpr_write_b32 a212, 0
    v_accvgpr_write_b32 a213, 0
    v_accvgpr_write_b32 a214, 0
    v_accvgpr_write_b32 a215, 0
    v_accvgpr_write_b32 a216, 0
    v_accvgpr_write_b32 a217, 0
    v_accvgpr_write_b32 a218, 0
    v_accvgpr_write_b32 a219, 0
    v_accvgpr_write_b32 a220, 0
    v_accvgpr_write_b32 a221, 0
    v_accvgpr_write_b32 a222, 0
    v_accvgpr_write_b32 a223, 0
    v_accvgpr_write_b32 a224, 0
    v_accvgpr_write_b32 a225, 0
    v_accvgpr_write_b32 a226, 0
    v_accvgpr_write_b32 a227, 0
    v_accvgpr_write_b32 a228, 0
    v_accvgpr_write_b32 a229, 0
    v_accvgpr_write_b32 a230, 0
    v_accvgpr_write_b32 a231, 0
    v_accvgpr_write_b32 a232, 0
    v_accvgpr_write_b32 a233, 0
    v_accvgpr_write_b32 a234, 0
    v_accvgpr_write_b32 a235, 0
    v_accvgpr_write_b32 a236, 0
    v_accvgpr_write_b32 a237, 0
    v_accvgpr_write_b32 a238, 0
    v_accvgpr_write_b32 a239, 0
    v_accvgpr_write_b32 a240, 0
    v_accvgpr_write_b32 a241, 0
    v_accvgpr_write_b32 a242, 0
    v_accvgpr_write_b32 a243, 0
    v_accvgpr_write_b32 a244, 0
    v_accvgpr_write_b32 a245, 0
    v_accvgpr_write_b32 a246, 0
    v_accvgpr_write_b32 a247, 0
    v_accvgpr_write_b32 a248, 0
    v_accvgpr_write_b32 a249, 0
    v_accvgpr_write_b32 a250, 0
    v_accvgpr_write_b32 a251, 0
    v_accvgpr_write_b32 a252, 0
    v_accvgpr_write_b32 a253, 0
    v_accvgpr_write_b32 a254, 0
    v_accvgpr_write_b32 a255, 0
    s_mul_i32 s56, s42, 0
    s_mul_i32 s57, s42, 0
    s_mov_b32 s58, 0
    s_mov_b32 s59, 0
    s_mul_i32 s63, s44, 4096
    s_mul_i32 s64, s44, 4096
    s_add_u32 s64, s64, 16384
    s_cmp_eq_u32 s51, 0
    s_cselect_b32 s24, s16, s20
    s_cselect_b32 s25, s17, s21
    s_mov_b32 s26, 0x1e0000
    s_mov_b32 s27, 0x20000
    s_add_u32 s65, s58, s63
    s_add_u32 m0, s65, 0
    s_nop 0
    buffer_load_dwordx4 v6, s[12:15], s56 offen lds
    s_add_u32 s65, s58, s63
    s_add_u32 m0, s65, 1024
    s_nop 0
    buffer_load_dwordx4 v7, s[12:15], s56 offen lds
    s_add_u32 s65, s58, s63
    s_add_u32 m0, s65, 2048
    s_nop 0
    buffer_load_dwordx4 v8, s[12:15], s56 offen lds
    s_add_u32 s65, s58, s63
    s_add_u32 m0, s65, 3072
    s_nop 0
    buffer_load_dwordx4 v9, s[12:15], s56 offen lds
    s_add_u32 s65, s58, s64
    s_add_u32 m0, s65, 0
    s_nop 0
    buffer_load_dwordx4 v10, s[24:27], s57 offen lds
    s_add_u32 s65, s58, s64
    s_add_u32 m0, s65, 1024
    s_nop 0
    buffer_load_dwordx4 v11, s[24:27], s57 offen lds
    s_add_u32 s65, s58, s64
    s_add_u32 m0, s65, 2048
    s_nop 0
    buffer_load_dwordx4 v12, s[24:27], s57 offen lds
    s_add_u32 s65, s58, s64
    s_add_u32 m0, s65, 3072
    s_nop 0
    buffer_load_dwordx4 v13, s[24:27], s57 offen lds
    s_add_u32 s56, s56, 64
    s_add_u32 s57, s57, 98304
    s_add_u32 s58, s58, 32768
    s_cmp_ge_u32 s58, 98304
    s_cselect_b32 s58, 0, s58
    s_add_u32 s65, s58, s63
    s_add_u32 m0, s65, 0
    s_nop 0
    buffer_load_dwordx4 v6, s[12:15], s56 offen lds
    s_add_u32 s65, s58, s63
    s_add_u32 m0, s65, 1024
    s_nop 0
    buffer_load_dwordx4 v7, s[12:15], s56 offen lds
    s_add_u32 s65, s58, s63
    s_add_u32 m0, s65, 2048
    s_nop 0
    buffer_load_dwordx4 v8, s[12:15], s56 offen lds
    s_add_u32 s65, s58, s63
    s_add_u32 m0, s65, 3072
    s_nop 0
    buffer_load_dwordx4 v9, s[12:15], s56 offen lds
    s_add_u32 s65, s58, s64
    s_add_u32 m0, s65, 0
    s_nop 0
    buffer_load_dwordx4 v10, s[24:27], s57 offen lds
    s_add_u32 s65, s58, s64
    s_add_u32 m0, s65, 1024
    s_nop 0
    buffer_load_dwordx4 v11, s[24:27], s57 offen lds
    s_add_u32 s65, s58, s64
    s_add_u32 m0, s65, 2048
    s_nop 0
    buffer_load_dwordx4 v12, s[24:27], s57 offen lds
    s_add_u32 s65, s58, s64
    s_add_u32 m0, s65, 3072
    s_nop 0
    buffer_load_dwordx4 v13, s[24:27], s57 offen lds
    s_add_u32 s56, s56, 64
    s_add_u32 s57, s57, 98304
    s_add_u32 s58, s58, 32768
    s_cmp_ge_u32 s58, 98304
    s_cselect_b32 s58, 0, s58
    s_mov_b32 s62, 18
L_wf_loop:
    s_waitcnt vmcnt(8)
    s_barrier
    s_add_u32 s65, s58, s63
    s_add_u32 m0, s65, 0
    s_nop 0
    buffer_load_dwordx4 v6, s[12:15], s56 offen lds
    s_add_u32 s65, s58, s63
    s_add_u32 m0, s65, 1024
    s_nop 0
    buffer_load_dwordx4 v7, s[12:15], s56 offen lds
    s_add_u32 s65, s58, s63
    s_add_u32 m0, s65, 2048
    s_nop 0
    buffer_load_dwordx4 v8, s[12:15], s56 offen lds
    s_add_u32 s65, s58, s63
    s_add_u32 m0, s65, 3072
    s_nop 0
    buffer_load_dwordx4 v9, s[12:15], s56 offen lds
    s_add_u32 s65, s58, s64
    s_add_u32 m0, s65, 0
    s_nop 0
    buffer_load_dwordx4 v10, s[24:27], s57 offen lds
    s_add_u32 s65, s58, s64
    s_add_u32 m0, s65, 1024
    s_nop 0
    buffer_load_dwordx4 v11, s[24:27], s57 offen lds
    s_add_u32 s65, s58, s64
    s_add_u32 m0, s65, 2048
    s_nop 0
    buffer_load_dwordx4 v12, s[24:27], s57 offen lds
    s_add_u32 s65, s58, s64
    s_add_u32 m0, s65, 3072
    s_nop 0
    buffer_load_dwordx4 v13, s[24:27], s57 offen lds
    s_add_u32 s56, s56, 64
    s_add_u32 s57, s57, 98304
    s_add_u32 s58, s58, 32768
    s_cmp_ge_u32 s58, 98304
    s_cselect_b32 s58, 0, s58
    v_add_u32 v23, s59, v14
    v_add_u32 v24, s59, v15
    v_add_u32 v25, s59, v16
    v_add_u32 v26, s59, v17
    v_add_u32 v27, s59, v18
    ds_read_b128 v[32:35], v23 offset:0
    ds_read_b64_tr_b16 v[64:65], v24 offset:0
    ds_read_b64_tr_b16 v[66:67], v24 offset:1024
    ds_read_b64_tr_b16 v[68:69], v25 offset:0
    ds_read_b64_tr_b16 v[70:71], v25 offset:1024
    ds_read_b64_tr_b16 v[72:73], v26 offset:0
    ds_read_b64_tr_b16 v[74:75], v26 offset:1024
    ds_read_b64_tr_b16 v[76:77], v27 offset:0
    ds_read_b64_tr_b16 v[78:79], v27 offset:1024
    ds_read_b64_tr_b16 v[80:81], v24 offset:8192
    s_waitcnt lgkmcnt(7)
    v_mfma_f32_16x16x32_bf16 a[0:3], v[64:67], v[32:35], a[0:3]
    ds_read_b64_tr_b16 v[82:83], v24 offset:9216
    ds_read_b64_tr_b16 v[84:85], v25 offset:8192
    ds_read_b64_tr_b16 v[86:87], v25 offset:9216
    s_waitcnt lgkmcnt(8)
    v_mfma_f32_16x16x32_bf16 a[4:7], v[68:71], v[32:35], a[4:7]
    ds_read_b64_tr_b16 v[88:89], v26 offset:8192
    ds_read_b64_tr_b16 v[90:91], v26 offset:9216
    s_waitcnt lgkmcnt(8)
    v_mfma_f32_16x16x32_bf16 a[8:11], v[72:75], v[32:35], a[8:11]
    ds_read_b64_tr_b16 v[92:93], v27 offset:8192
    ds_read_b64_tr_b16 v[94:95], v27 offset:9216
    s_waitcnt lgkmcnt(8)
    v_mfma_f32_16x16x32_bf16 a[12:15], v[76:79], v[32:35], a[12:15]
    ds_read_b128 v[36:39], v23 offset:1024
    ds_read_b128 v[40:43], v23 offset:2048
    s_waitcnt lgkmcnt(8)
    v_mfma_f32_16x16x32_bf16 a[16:19], v[80:83], v[32:35], a[16:19]
    ds_read_b128 v[44:47], v23 offset:3072
    ds_read_b128 v[48:51], v23 offset:4096
    s_waitcnt lgkmcnt(8)
    v_mfma_f32_16x16x32_bf16 a[20:23], v[84:87], v[32:35], a[20:23]
    ds_read_b128 v[52:55], v23 offset:5120
    ds_read_b128 v[56:59], v23 offset:6144
    s_waitcnt lgkmcnt(8)
    v_mfma_f32_16x16x32_bf16 a[24:27], v[88:91], v[32:35], a[24:27]
    ds_read_b128 v[60:63], v23 offset:7168
    s_waitcnt lgkmcnt(7)
    v_mfma_f32_16x16x32_bf16 a[28:31], v[92:95], v[32:35], a[28:31]
    s_waitcnt lgkmcnt(6)
    v_mfma_f32_16x16x32_bf16 a[32:35], v[64:67], v[36:39], a[32:35]
    v_mfma_f32_16x16x32_bf16 a[36:39], v[68:71], v[36:39], a[36:39]
    v_mfma_f32_16x16x32_bf16 a[40:43], v[72:75], v[36:39], a[40:43]
    v_mfma_f32_16x16x32_bf16 a[44:47], v[76:79], v[36:39], a[44:47]
    v_mfma_f32_16x16x32_bf16 a[48:51], v[80:83], v[36:39], a[48:51]
    v_mfma_f32_16x16x32_bf16 a[52:55], v[84:87], v[36:39], a[52:55]
    v_mfma_f32_16x16x32_bf16 a[56:59], v[88:91], v[36:39], a[56:59]
    v_mfma_f32_16x16x32_bf16 a[60:63], v[92:95], v[36:39], a[60:63]
    s_waitcnt lgkmcnt(5)
    v_mfma_f32_16x16x32_bf16 a[64:67], v[64:67], v[40:43], a[64:67]
    v_mfma_f32_16x16x32_bf16 a[68:71], v[68:71], v[40:43], a[68:71]
    v_mfma_f32_16x16x32_bf16 a[72:75], v[72:75], v[40:43], a[72:75]
    v_mfma_f32_16x16x32_bf16 a[76:79], v[76:79], v[40:43], a[76:79]
    v_mfma_f32_16x16x32_bf16 a[80:83], v[80:83], v[40:43], a[80:83]
    v_mfma_f32_16x16x32_bf16 a[84:87], v[84:87], v[40:43], a[84:87]
    v_mfma_f32_16x16x32_bf16 a[88:91], v[88:91], v[40:43], a[88:91]
    v_mfma_f32_16x16x32_bf16 a[92:95], v[92:95], v[40:43], a[92:95]
    s_waitcnt lgkmcnt(4)
    v_mfma_f32_16x16x32_bf16 a[96:99], v[64:67], v[44:47], a[96:99]
    v_mfma_f32_16x16x32_bf16 a[100:103], v[68:71], v[44:47], a[100:103]
    v_mfma_f32_16x16x32_bf16 a[104:107], v[72:75], v[44:47], a[104:107]
    v_mfma_f32_16x16x32_bf16 a[108:111], v[76:79], v[44:47], a[108:111]
    v_mfma_f32_16x16x32_bf16 a[112:115], v[80:83], v[44:47], a[112:115]
    v_mfma_f32_16x16x32_bf16 a[116:119], v[84:87], v[44:47], a[116:119]
    v_mfma_f32_16x16x32_bf16 a[120:123], v[88:91], v[44:47], a[120:123]
    v_mfma_f32_16x16x32_bf16 a[124:127], v[92:95], v[44:47], a[124:127]
    s_waitcnt lgkmcnt(3)
    v_mfma_f32_16x16x32_bf16 a[128:131], v[64:67], v[48:51], a[128:131]
    v_mfma_f32_16x16x32_bf16 a[132:135], v[68:71], v[48:51], a[132:135]
    v_mfma_f32_16x16x32_bf16 a[136:139], v[72:75], v[48:51], a[136:139]
    v_mfma_f32_16x16x32_bf16 a[140:143], v[76:79], v[48:51], a[140:143]
    v_mfma_f32_16x16x32_bf16 a[144:147], v[80:83], v[48:51], a[144:147]
    v_mfma_f32_16x16x32_bf16 a[148:151], v[84:87], v[48:51], a[148:151]
    v_mfma_f32_16x16x32_bf16 a[152:155], v[88:91], v[48:51], a[152:155]
    v_mfma_f32_16x16x32_bf16 a[156:159], v[92:95], v[48:51], a[156:159]
    s_waitcnt lgkmcnt(2)
    v_mfma_f32_16x16x32_bf16 a[160:163], v[64:67], v[52:55], a[160:163]
    v_mfma_f32_16x16x32_bf16 a[164:167], v[68:71], v[52:55], a[164:167]
    v_mfma_f32_16x16x32_bf16 a[168:171], v[72:75], v[52:55], a[168:171]
    v_mfma_f32_16x16x32_bf16 a[172:175], v[76:79], v[52:55], a[172:175]
    v_mfma_f32_16x16x32_bf16 a[176:179], v[80:83], v[52:55], a[176:179]
    v_mfma_f32_16x16x32_bf16 a[180:183], v[84:87], v[52:55], a[180:183]
    v_mfma_f32_16x16x32_bf16 a[184:187], v[88:91], v[52:55], a[184:187]
    v_mfma_f32_16x16x32_bf16 a[188:191], v[92:95], v[52:55], a[188:191]
    s_waitcnt lgkmcnt(1)
    v_mfma_f32_16x16x32_bf16 a[192:195], v[64:67], v[56:59], a[192:195]
    v_mfma_f32_16x16x32_bf16 a[196:199], v[68:71], v[56:59], a[196:199]
    v_mfma_f32_16x16x32_bf16 a[200:203], v[72:75], v[56:59], a[200:203]
    v_mfma_f32_16x16x32_bf16 a[204:207], v[76:79], v[56:59], a[204:207]
    v_mfma_f32_16x16x32_bf16 a[208:211], v[80:83], v[56:59], a[208:211]
    v_mfma_f32_16x16x32_bf16 a[212:215], v[84:87], v[56:59], a[212:215]
    v_mfma_f32_16x16x32_bf16 a[216:219], v[88:91], v[56:59], a[216:219]
    v_mfma_f32_16x16x32_bf16 a[220:223], v[92:95], v[56:59], a[220:223]
    s_waitcnt lgkmcnt(0)
    v_mfma_f32_16x16x32_bf16 a[224:227], v[64:67], v[60:63], a[224:227]
    v_mfma_f32_16x16x32_bf16 a[228:231], v[68:71], v[60:63], a[228:231]
    v_mfma_f32_16x16x32_bf16 a[232:235], v[72:75], v[60:63], a[232:235]
    v_mfma_f32_16x16x32_bf16 a[236:239], v[76:79], v[60:63], a[236:239]
    v_mfma_f32_16x16x32_bf16 a[240:243], v[80:83], v[60:63], a[240:243]
    v_mfma_f32_16x16x32_bf16 a[244:247], v[84:87], v[60:63], a[244:247]
    v_mfma_f32_16x16x32_bf16 a[248:251], v[88:91], v[60:63], a[248:251]
    v_mfma_f32_16x16x32_bf16 a[252:255], v[92:95], v[60:63], a[252:255]
    s_add_u32 s59, s59, 32768
    s_cmp_ge_u32 s59, 98304
    s_cselect_b32 s59, 0, s59
    s_sub_u32 s62, s62, 1
    s_cmp_lg_u32 s62, 0
    s_cbranch_scc1 L_wf_loop
    s_waitcnt vmcnt(8)
    s_barrier
    v_add_u32 v23, s59, v14
    v_add_u32 v24, s59, v15
    v_add_u32 v25, s59, v16
    v_add_u32 v26, s59, v17
    v_add_u32 v27, s59, v18
    ds_read_b128 v[32:35], v23 offset:0
    ds_read_b64_tr_b16 v[64:65], v24 offset:0
    ds_read_b64_tr_b16 v[66:67], v24 offset:1024
    ds_read_b64_tr_b16 v[68:69], v25 offset:0
    ds_read_b64_tr_b16 v[70:71], v25 offset:1024
    ds_read_b64_tr_b16 v[72:73], v26 offset:0
    ds_read_b64_tr_b16 v[74:75], v26 offset:1024
    ds_read_b64_tr_b16 v[76:77], v27 offset:0
    ds_read_b64_tr_b16 v[78:79], v27 offset:1024
    ds_read_b64_tr_b16 v[80:81], v24 offset:8192
    s_waitcnt lgkmcnt(7)
    v_mfma_f32_16x16x32_bf16 a[0:3], v[64:67], v[32:35], a[0:3]
    ds_read_b64_tr_b16 v[82:83], v24 offset:9216
    ds_read_b64_tr_b16 v[84:85], v25 offset:8192
    ds_read_b64_tr_b16 v[86:87], v25 offset:9216
    s_waitcnt lgkmcnt(8)
    v_mfma_f32_16x16x32_bf16 a[4:7], v[68:71], v[32:35], a[4:7]
    ds_read_b64_tr_b16 v[88:89], v26 offset:8192
    ds_read_b64_tr_b16 v[90:91], v26 offset:9216
    s_waitcnt lgkmcnt(8)
    v_mfma_f32_16x16x32_bf16 a[8:11], v[72:75], v[32:35], a[8:11]
    ds_read_b64_tr_b16 v[92:93], v27 offset:8192
    ds_read_b64_tr_b16 v[94:95], v27 offset:9216
    s_waitcnt lgkmcnt(8)
    v_mfma_f32_16x16x32_bf16 a[12:15], v[76:79], v[32:35], a[12:15]
    ds_read_b128 v[36:39], v23 offset:1024
    ds_read_b128 v[40:43], v23 offset:2048
    s_waitcnt lgkmcnt(8)
    v_mfma_f32_16x16x32_bf16 a[16:19], v[80:83], v[32:35], a[16:19]
    ds_read_b128 v[44:47], v23 offset:3072
    ds_read_b128 v[48:51], v23 offset:4096
    s_waitcnt lgkmcnt(8)
    v_mfma_f32_16x16x32_bf16 a[20:23], v[84:87], v[32:35], a[20:23]
    ds_read_b128 v[52:55], v23 offset:5120
    ds_read_b128 v[56:59], v23 offset:6144
    s_waitcnt lgkmcnt(8)
    v_mfma_f32_16x16x32_bf16 a[24:27], v[88:91], v[32:35], a[24:27]
    ds_read_b128 v[60:63], v23 offset:7168
    s_waitcnt lgkmcnt(7)
    v_mfma_f32_16x16x32_bf16 a[28:31], v[92:95], v[32:35], a[28:31]
    s_waitcnt lgkmcnt(6)
    v_mfma_f32_16x16x32_bf16 a[32:35], v[64:67], v[36:39], a[32:35]
    v_mfma_f32_16x16x32_bf16 a[36:39], v[68:71], v[36:39], a[36:39]
    v_mfma_f32_16x16x32_bf16 a[40:43], v[72:75], v[36:39], a[40:43]
    v_mfma_f32_16x16x32_bf16 a[44:47], v[76:79], v[36:39], a[44:47]
    v_mfma_f32_16x16x32_bf16 a[48:51], v[80:83], v[36:39], a[48:51]
    v_mfma_f32_16x16x32_bf16 a[52:55], v[84:87], v[36:39], a[52:55]
    v_mfma_f32_16x16x32_bf16 a[56:59], v[88:91], v[36:39], a[56:59]
    v_mfma_f32_16x16x32_bf16 a[60:63], v[92:95], v[36:39], a[60:63]
    s_waitcnt lgkmcnt(5)
    v_mfma_f32_16x16x32_bf16 a[64:67], v[64:67], v[40:43], a[64:67]
    v_mfma_f32_16x16x32_bf16 a[68:71], v[68:71], v[40:43], a[68:71]
    v_mfma_f32_16x16x32_bf16 a[72:75], v[72:75], v[40:43], a[72:75]
    v_mfma_f32_16x16x32_bf16 a[76:79], v[76:79], v[40:43], a[76:79]
    v_mfma_f32_16x16x32_bf16 a[80:83], v[80:83], v[40:43], a[80:83]
    v_mfma_f32_16x16x32_bf16 a[84:87], v[84:87], v[40:43], a[84:87]
    v_mfma_f32_16x16x32_bf16 a[88:91], v[88:91], v[40:43], a[88:91]
    v_mfma_f32_16x16x32_bf16 a[92:95], v[92:95], v[40:43], a[92:95]
    s_waitcnt lgkmcnt(4)
    v_mfma_f32_16x16x32_bf16 a[96:99], v[64:67], v[44:47], a[96:99]
    v_mfma_f32_16x16x32_bf16 a[100:103], v[68:71], v[44:47], a[100:103]
    v_mfma_f32_16x16x32_bf16 a[104:107], v[72:75], v[44:47], a[104:107]
    v_mfma_f32_16x16x32_bf16 a[108:111], v[76:79], v[44:47], a[108:111]
    v_mfma_f32_16x16x32_bf16 a[112:115], v[80:83], v[44:47], a[112:115]
    v_mfma_f32_16x16x32_bf16 a[116:119], v[84:87], v[44:47], a[116:119]
    v_mfma_f32_16x16x32_bf16 a[120:123], v[88:91], v[44:47], a[120:123]
    v_mfma_f32_16x16x32_bf16 a[124:127], v[92:95], v[44:47], a[124:127]
    s_waitcnt lgkmcnt(3)
    v_mfma_f32_16x16x32_bf16 a[128:131], v[64:67], v[48:51], a[128:131]
    v_mfma_f32_16x16x32_bf16 a[132:135], v[68:71], v[48:51], a[132:135]
    v_mfma_f32_16x16x32_bf16 a[136:139], v[72:75], v[48:51], a[136:139]
    v_mfma_f32_16x16x32_bf16 a[140:143], v[76:79], v[48:51], a[140:143]
    v_mfma_f32_16x16x32_bf16 a[144:147], v[80:83], v[48:51], a[144:147]
    v_mfma_f32_16x16x32_bf16 a[148:151], v[84:87], v[48:51], a[148:151]
    v_mfma_f32_16x16x32_bf16 a[152:155], v[88:91], v[48:51], a[152:155]
    v_mfma_f32_16x16x32_bf16 a[156:159], v[92:95], v[48:51], a[156:159]
    s_waitcnt lgkmcnt(2)
    v_mfma_f32_16x16x32_bf16 a[160:163], v[64:67], v[52:55], a[160:163]
    v_mfma_f32_16x16x32_bf16 a[164:167], v[68:71], v[52:55], a[164:167]
    v_mfma_f32_16x16x32_bf16 a[168:171], v[72:75], v[52:55], a[168:171]
    v_mfma_f32_16x16x32_bf16 a[172:175], v[76:79], v[52:55], a[172:175]
    v_mfma_f32_16x16x32_bf16 a[176:179], v[80:83], v[52:55], a[176:179]
    v_mfma_f32_16x16x32_bf16 a[180:183], v[84:87], v[52:55], a[180:183]
    v_mfma_f32_16x16x32_bf16 a[184:187], v[88:91], v[52:55], a[184:187]
    v_mfma_f32_16x16x32_bf16 a[188:191], v[92:95], v[52:55], a[188:191]
    s_waitcnt lgkmcnt(1)
    v_mfma_f32_16x16x32_bf16 a[192:195], v[64:67], v[56:59], a[192:195]
    v_mfma_f32_16x16x32_bf16 a[196:199], v[68:71], v[56:59], a[196:199]
    v_mfma_f32_16x16x32_bf16 a[200:203], v[72:75], v[56:59], a[200:203]
    v_mfma_f32_16x16x32_bf16 a[204:207], v[76:79], v[56:59], a[204:207]
    v_mfma_f32_16x16x32_bf16 a[208:211], v[80:83], v[56:59], a[208:211]
    v_mfma_f32_16x16x32_bf16 a[212:215], v[84:87], v[56:59], a[212:215]
    v_mfma_f32_16x16x32_bf16 a[216:219], v[88:91], v[56:59], a[216:219]
    v_mfma_f32_16x16x32_bf16 a[220:223], v[92:95], v[56:59], a[220:223]
    s_waitcnt lgkmcnt(0)
    v_mfma_f32_16x16x32_bf16 a[224:227], v[64:67], v[60:63], a[224:227]
    v_mfma_f32_16x16x32_bf16 a[228:231], v[68:71], v[60:63], a[228:231]
    v_mfma_f32_16x16x32_bf16 a[232:235], v[72:75], v[60:63], a[232:235]
    v_mfma_f32_16x16x32_bf16 a[236:239], v[76:79], v[60:63], a[236:239]
    v_mfma_f32_16x16x32_bf16 a[240:243], v[80:83], v[60:63], a[240:243]
    v_mfma_f32_16x16x32_bf16 a[244:247], v[84:87], v[60:63], a[244:247]
    v_mfma_f32_16x16x32_bf16 a[248:251], v[88:91], v[60:63], a[248:251]
    v_mfma_f32_16x16x32_bf16 a[252:255], v[92:95], v[60:63], a[252:255]
    s_add_u32 s59, s59, 32768
    s_cmp_ge_u32 s59, 98304
    s_cselect_b32 s59, 0, s59
    s_waitcnt vmcnt(0)
    s_barrier
    v_add_u32 v23, s59, v14
    v_add_u32 v24, s59, v15
    v_add_u32 v25, s59, v16
    v_add_u32 v26, s59, v17
    v_add_u32 v27, s59, v18
    ds_read_b128 v[32:35], v23 offset:0
    ds_read_b64_tr_b16 v[64:65], v24 offset:0
    ds_read_b64_tr_b16 v[66:67], v24 offset:1024
    ds_read_b64_tr_b16 v[68:69], v25 offset:0
    ds_read_b64_tr_b16 v[70:71], v25 offset:1024
    ds_read_b64_tr_b16 v[72:73], v26 offset:0
    ds_read_b64_tr_b16 v[74:75], v26 offset:1024
    ds_read_b64_tr_b16 v[76:77], v27 offset:0
    ds_read_b64_tr_b16 v[78:79], v27 offset:1024
    ds_read_b64_tr_b16 v[80:81], v24 offset:8192
    s_waitcnt lgkmcnt(7)
    v_mfma_f32_16x16x32_bf16 a[0:3], v[64:67], v[32:35], a[0:3]
    ds_read_b64_tr_b16 v[82:83], v24 offset:9216
    ds_read_b64_tr_b16 v[84:85], v25 offset:8192
    ds_read_b64_tr_b16 v[86:87], v25 offset:9216
    s_waitcnt lgkmcnt(8)
    v_mfma_f32_16x16x32_bf16 a[4:7], v[68:71], v[32:35], a[4:7]
    ds_read_b64_tr_b16 v[88:89], v26 offset:8192
    ds_read_b64_tr_b16 v[90:91], v26 offset:9216
    s_waitcnt lgkmcnt(8)
    v_mfma_f32_16x16x32_bf16 a[8:11], v[72:75], v[32:35], a[8:11]
    ds_read_b64_tr_b16 v[92:93], v27 offset:8192
    ds_read_b64_tr_b16 v[94:95], v27 offset:9216
    s_waitcnt lgkmcnt(8)
    v_mfma_f32_16x16x32_bf16 a[12:15], v[76:79], v[32:35], a[12:15]
    ds_read_b128 v[36:39], v23 offset:1024
    ds_read_b128 v[40:43], v23 offset:2048
    s_waitcnt lgkmcnt(8)
    v_mfma_f32_16x16x32_bf16 a[16:19], v[80:83], v[32:35], a[16:19]
    ds_read_b128 v[44:47], v23 offset:3072
    ds_read_b128 v[48:51], v23 offset:4096
    s_waitcnt lgkmcnt(8)
    v_mfma_f32_16x16x32_bf16 a[20:23], v[84:87], v[32:35], a[20:23]
    ds_read_b128 v[52:55], v23 offset:5120
    ds_read_b128 v[56:59], v23 offset:6144
    s_waitcnt lgkmcnt(8)
    v_mfma_f32_16x16x32_bf16 a[24:27], v[88:91], v[32:35], a[24:27]
    ds_read_b128 v[60:63], v23 offset:7168
    s_waitcnt lgkmcnt(7)
    v_mfma_f32_16x16x32_bf16 a[28:31], v[92:95], v[32:35], a[28:31]
    s_waitcnt lgkmcnt(6)
    v_mfma_f32_16x16x32_bf16 a[32:35], v[64:67], v[36:39], a[32:35]
    v_mfma_f32_16x16x32_bf16 a[36:39], v[68:71], v[36:39], a[36:39]
    v_mfma_f32_16x16x32_bf16 a[40:43], v[72:75], v[36:39], a[40:43]
    v_mfma_f32_16x16x32_bf16 a[44:47], v[76:79], v[36:39], a[44:47]
    v_mfma_f32_16x16x32_bf16 a[48:51], v[80:83], v[36:39], a[48:51]
    v_mfma_f32_16x16x32_bf16 a[52:55], v[84:87], v[36:39], a[52:55]
    v_mfma_f32_16x16x32_bf16 a[56:59], v[88:91], v[36:39], a[56:59]
    v_mfma_f32_16x16x32_bf16 a[60:63], v[92:95], v[36:39], a[60:63]
    s_waitcnt lgkmcnt(5)
    v_mfma_f32_16x16x32_bf16 a[64:67], v[64:67], v[40:43], a[64:67]
    v_mfma_f32_16x16x32_bf16 a[68:71], v[68:71], v[40:43], a[68:71]
    v_mfma_f32_16x16x32_bf16 a[72:75], v[72:75], v[40:43], a[72:75]
    v_mfma_f32_16x16x32_bf16 a[76:79], v[76:79], v[40:43], a[76:79]
    v_mfma_f32_16x16x32_bf16 a[80:83], v[80:83], v[40:43], a[80:83]
    v_mfma_f32_16x16x32_bf16 a[84:87], v[84:87], v[40:43], a[84:87]
    v_mfma_f32_16x16x32_bf16 a[88:91], v[88:91], v[40:43], a[88:91]
    v_mfma_f32_16x16x32_bf16 a[92:95], v[92:95], v[40:43], a[92:95]
    s_waitcnt lgkmcnt(4)
    v_mfma_f32_16x16x32_bf16 a[96:99], v[64:67], v[44:47], a[96:99]
    v_mfma_f32_16x16x32_bf16 a[100:103], v[68:71], v[44:47], a[100:103]
    v_mfma_f32_16x16x32_bf16 a[104:107], v[72:75], v[44:47], a[104:107]
    v_mfma_f32_16x16x32_bf16 a[108:111], v[76:79], v[44:47], a[108:111]
    v_mfma_f32_16x16x32_bf16 a[112:115], v[80:83], v[44:47], a[112:115]
    v_mfma_f32_16x16x32_bf16 a[116:119], v[84:87], v[44:47], a[116:119]
    v_mfma_f32_16x16x32_bf16 a[120:123], v[88:91], v[44:47], a[120:123]
    v_mfma_f32_16x16x32_bf16 a[124:127], v[92:95], v[44:47], a[124:127]
    s_waitcnt lgkmcnt(3)
    v_mfma_f32_16x16x32_bf16 a[128:131], v[64:67], v[48:51], a[128:131]
    v_mfma_f32_16x16x32_bf16 a[132:135], v[68:71], v[48:51], a[132:135]
    v_mfma_f32_16x16x32_bf16 a[136:139], v[72:75], v[48:51], a[136:139]
    v_mfma_f32_16x16x32_bf16 a[140:143], v[76:79], v[48:51], a[140:143]
    v_mfma_f32_16x16x32_bf16 a[144:147], v[80:83], v[48:51], a[144:147]
    v_mfma_f32_16x16x32_bf16 a[148:151], v[84:87], v[48:51], a[148:151]
    v_mfma_f32_16x16x32_bf16 a[152:155], v[88:91], v[48:51], a[152:155]
    v_mfma_f32_16x16x32_bf16 a[156:159], v[92:95], v[48:51], a[156:159]
    s_waitcnt lgkmcnt(2)
    v_mfma_f32_16x16x32_bf16 a[160:163], v[64:67], v[52:55], a[160:163]
    v_mfma_f32_16x16x32_bf16 a[164:167], v[68:71], v[52:55], a[164:167]
    v_mfma_f32_16x16x32_bf16 a[168:171], v[72:75], v[52:55], a[168:171]
    v_mfma_f32_16x16x32_bf16 a[172:175], v[76:79], v[52:55], a[172:175]
    v_mfma_f32_16x16x32_bf16 a[176:179], v[80:83], v[52:55], a[176:179]
    v_mfma_f32_16x16x32_bf16 a[180:183], v[84:87], v[52:55], a[180:183]
    v_mfma_f32_16x16x32_bf16 a[184:187], v[88:91], v[52:55], a[184:187]
    v_mfma_f32_16x16x32_bf16 a[188:191], v[92:95], v[52:55], a[188:191]
    s_waitcnt lgkmcnt(1)
    v_mfma_f32_16x16x32_bf16 a[192:195], v[64:67], v[56:59], a[192:195]
    v_mfma_f32_16x16x32_bf16 a[196:199], v[68:71], v[56:59], a[196:199]
    v_mfma_f32_16x16x32_bf16 a[200:203], v[72:75], v[56:59], a[200:203]
    v_mfma_f32_16x16x32_bf16 a[204:207], v[76:79], v[56:59], a[204:207]
    v_mfma_f32_16x16x32_bf16 a[208:211], v[80:83], v[56:59], a[208:211]
    v_mfma_f32_16x16x32_bf16 a[212:215], v[84:87], v[56:59], a[212:215]
    v_mfma_f32_16x16x32_bf16 a[216:219], v[88:91], v[56:59], a[216:219]
    v_mfma_f32_16x16x32_bf16 a[220:223], v[92:95], v[56:59], a[220:223]
    s_waitcnt lgkmcnt(0)
    v_mfma_f32_16x16x32_bf16 a[224:227], v[64:67], v[60:63], a[224:227]
    v_mfma_f32_16x16x32_bf16 a[228:231], v[68:71], v[60:63], a[228:231]
    v_mfma_f32_16x16x32_bf16 a[232:235], v[72:75], v[60:63], a[232:235]
    v_mfma_f32_16x16x32_bf16 a[236:239], v[76:79], v[60:63], a[236:239]
    v_mfma_f32_16x16x32_bf16 a[240:243], v[80:83], v[60:63], a[240:243]
    v_mfma_f32_16x16x32_bf16 a[244:247], v[84:87], v[60:63], a[244:247]
    v_mfma_f32_16x16x32_bf16 a[248:251], v[88:91], v[60:63], a[248:251]
    v_mfma_f32_16x16x32_bf16 a[252:255], v[92:95], v[60:63], a[252:255]
    s_add_u32 s59, s59, 32768
    s_cmp_ge_u32 s59, 98304
    s_cselect_b32 s59, 0, s59
    s_nop 7
    s_nop 7
    s_add_u32 s28, s4, 0x4a80000
    s_addc_u32 s29, s5, 0
    s_mov_b32 s30, 0x600000
    s_mov_b32 s31, 0x20000
    v_and_b32 v3, 15, v2
    v_lshrrev_b32 v4, 4, v2
    s_mul_i32 s53, s41, 256
    s_mul_i32 s54, s45, 128
    s_add_u32 s53, s53, s54
    v_add_u32 v3, s53, v3
    s_mov_b32 s60, 3072
    v_mul_lo_u32 v3, v3, s60
    s_mul_i32 s53, s47, 128
    s_mul_i32 s54, s46, 64
    s_add_u32 s53, s53, s54
    v_lshl_add_u32 v4, v4, 2, s53
    v_lshl_add_u32 v3, v4, 1, v3
    v_accvgpr_read_b32 v48, a0
    v_accvgpr_read_b32 v49, a1
    v_accvgpr_read_b32 v50, a2
    v_accvgpr_read_b32 v51, a3
    v_accvgpr_read_b32 v52, a16
    v_accvgpr_read_b32 v53, a17
    v_accvgpr_read_b32 v54, a18
    v_accvgpr_read_b32 v55, a19
    v_cvt_pk_bf16_f32 v48, v48, v48
    v_lshlrev_b32 v48, 16, v48
    v_cvt_pk_bf16_f32 v52, v52, v52
    v_lshlrev_b32 v52, 16, v52
    v_cmp_lt_f32 vcc, 0, v48
    s_nop 1
    v_cndmask_b32 v34, 0, 1.0, vcc
    v_mul_f32 v48, v48, v34
    v_mul_f32 v48, v48, v52
    v_cvt_pk_bf16_f32 v49, v49, v49
    v_lshlrev_b32 v49, 16, v49
    v_cvt_pk_bf16_f32 v53, v53, v53
    v_lshlrev_b32 v53, 16, v53
    v_cmp_lt_f32 vcc, 0, v49
    s_nop 1
    v_cndmask_b32 v34, 0, 1.0, vcc
    v_mul_f32 v49, v49, v34
    v_mul_f32 v49, v49, v53
    v_cvt_pk_bf16_f32 v50, v50, v50
    v_lshlrev_b32 v50, 16, v50
    v_cvt_pk_bf16_f32 v54, v54, v54
    v_lshlrev_b32 v54, 16, v54
    v_cmp_lt_f32 vcc, 0, v50
    s_nop 1
    v_cndmask_b32 v34, 0, 1.0, vcc
    v_mul_f32 v50, v50, v34
    v_mul_f32 v50, v50, v54
    v_cvt_pk_bf16_f32 v51, v51, v51
    v_lshlrev_b32 v51, 16, v51
    v_cvt_pk_bf16_f32 v55, v55, v55
    v_lshlrev_b32 v55, 16, v55
    v_cmp_lt_f32 vcc, 0, v51
    s_nop 1
    v_cndmask_b32 v34, 0, 1.0, vcc
    v_mul_f32 v51, v51, v34
    v_mul_f32 v51, v51, v55
    v_cvt_pk_bf16_f32 v32, v48, v49
    v_cvt_pk_bf16_f32 v33, v50, v51
    buffer_store_dwordx2 v[32:33], v3, s[28:31], 0 offen offset:0 sc1
    v_accvgpr_read_b32 v56, a4
    v_accvgpr_read_b32 v57, a5
    v_accvgpr_read_b32 v58, a6
    v_accvgpr_read_b32 v59, a7
    v_accvgpr_read_b32 v60, a20
    v_accvgpr_read_b32 v61, a21
    v_accvgpr_read_b32 v62, a22
    v_accvgpr_read_b32 v63, a23
    v_cvt_pk_bf16_f32 v56, v56, v56
    v_lshlrev_b32 v56, 16, v56
    v_cvt_pk_bf16_f32 v60, v60, v60
    v_lshlrev_b32 v60, 16, v60
    v_cmp_lt_f32 vcc, 0, v56
    s_nop 1
    v_cndmask_b32 v38, 0, 1.0, vcc
    v_mul_f32 v56, v56, v38
    v_mul_f32 v56, v56, v60
    v_cvt_pk_bf16_f32 v57, v57, v57
    v_lshlrev_b32 v57, 16, v57
    v_cvt_pk_bf16_f32 v61, v61, v61
    v_lshlrev_b32 v61, 16, v61
    v_cmp_lt_f32 vcc, 0, v57
    s_nop 1
    v_cndmask_b32 v38, 0, 1.0, vcc
    v_mul_f32 v57, v57, v38
    v_mul_f32 v57, v57, v61
    v_cvt_pk_bf16_f32 v58, v58, v58
    v_lshlrev_b32 v58, 16, v58
    v_cvt_pk_bf16_f32 v62, v62, v62
    v_lshlrev_b32 v62, 16, v62
    v_cmp_lt_f32 vcc, 0, v58
    s_nop 1
    v_cndmask_b32 v38, 0, 1.0, vcc
    v_mul_f32 v58, v58, v38
    v_mul_f32 v58, v58, v62
    v_cvt_pk_bf16_f32 v59, v59, v59
    v_lshlrev_b32 v59, 16, v59
    v_cvt_pk_bf16_f32 v63, v63, v63
    v_lshlrev_b32 v63, 16, v63
    v_cmp_lt_f32 vcc, 0, v59
    s_nop 1
    v_cndmask_b32 v38, 0, 1.0, vcc
    v_mul_f32 v59, v59, v38
    v_mul_f32 v59, v59, v63
    v_cvt_pk_bf16_f32 v36, v56, v57
    v_cvt_pk_bf16_f32 v37, v58, v59
    buffer_store_dwordx2 v[36:37], v3, s[28:31], 0 offen offset:32 sc1
    v_accvgpr_read_b32 v48, a8
    v_accvgpr_read_b32 v49, a9
    v_accvgpr_read_b32 v50, a10
    v_accvgpr_read_b32 v51, a11
    v_accvgpr_read_b32 v52, a24
    v_accvgpr_read_b32 v53, a25
    v_accvgpr_read_b32 v54, a26
    v_accvgpr_read_b32 v55, a27
    v_cvt_pk_bf16_f32 v48, v48, v48
    v_lshlrev_b32 v48, 16, v48
    v_cvt_pk_bf16_f32 v52, v52, v52
    v_lshlrev_b32 v52, 16, v52
    v_cmp_lt_f32 vcc, 0, v48
    s_nop 1
    v_cndmask_b32 v42, 0, 1.0, vcc
    v_mul_f32 v48, v48, v42
    v_mul_f32 v48, v48, v52
    v_cvt_pk_bf16_f32 v49, v49, v49
    v_lshlrev_b32 v49, 16, v49
    v_cvt_pk_bf16_f32 v53, v53, v53
    v_lshlrev_b32 v53, 16, v53
    v_cmp_lt_f32 vcc, 0, v49
    s_nop 1
    v_cndmask_b32 v42, 0, 1.0, vcc
    v_mul_f32 v49, v49, v42
    v_mul_f32 v49, v49, v53
    v_cvt_pk_bf16_f32 v50, v50, v50
    v_lshlrev_b32 v50, 16, v50
    v_cvt_pk_bf16_f32 v54, v54, v54
    v_lshlrev_b32 v54, 16, v54
    v_cmp_lt_f32 vcc, 0, v50
    s_nop 1
    v_cndmask_b32 v42, 0, 1.0, vcc
    v_mul_f32 v50, v50, v42
    v_mul_f32 v50, v50, v54
    v_cvt_pk_bf16_f32 v51, v51, v51
    v_lshlrev_b32 v51, 16, v51
    v_cvt_pk_bf16_f32 v55, v55, v55
    v_lshlrev_b32 v55, 16, v55
    v_cmp_lt_f32 vcc, 0, v51
    s_nop 1
    v_cndmask_b32 v42, 0, 1.0, vcc
    v_mul_f32 v51, v51, v42
    v_mul_f32 v51, v51, v55
    v_cvt_pk_bf16_f32 v40, v48, v49
    v_cvt_pk_bf16_f32 v41, v50, v51
    buffer_store_dwordx2 v[40:41], v3, s[28:31], 0 offen offset:64 sc1
    v_accvgpr_read_b32 v56, a12
    v_accvgpr_read_b32 v57, a13
    v_accvgpr_read_b32 v58, a14
    v_accvgpr_read_b32 v59, a15
    v_accvgpr_read_b32 v60, a28
    v_accvgpr_read_b32 v61, a29
    v_accvgpr_read_b32 v62, a30
    v_accvgpr_read_b32 v63, a31
    v_cvt_pk_bf16_f32 v56, v56, v56
    v_lshlrev_b32 v56, 16, v56
    v_cvt_pk_bf16_f32 v60, v60, v60
    v_lshlrev_b32 v60, 16, v60
    v_cmp_lt_f32 vcc, 0, v56
    s_nop 1
    v_cndmask_b32 v46, 0, 1.0, vcc
    v_mul_f32 v56, v56, v46
    v_mul_f32 v56, v56, v60
    v_cvt_pk_bf16_f32 v57, v57, v57
    v_lshlrev_b32 v57, 16, v57
    v_cvt_pk_bf16_f32 v61, v61, v61
    v_lshlrev_b32 v61, 16, v61
    v_cmp_lt_f32 vcc, 0, v57
    s_nop 1
    v_cndmask_b32 v46, 0, 1.0, vcc
    v_mul_f32 v57, v57, v46
    v_mul_f32 v57, v57, v61
    v_cvt_pk_bf16_f32 v58, v58, v58
    v_lshlrev_b32 v58, 16, v58
    v_cvt_pk_bf16_f32 v62, v62, v62
    v_lshlrev_b32 v62, 16, v62
    v_cmp_lt_f32 vcc, 0, v58
    s_nop 1
    v_cndmask_b32 v46, 0, 1.0, vcc
    v_mul_f32 v58, v58, v46
    v_mul_f32 v58, v58, v62
    v_cvt_pk_bf16_f32 v59, v59, v59
    v_lshlrev_b32 v59, 16, v59
    v_cvt_pk_bf16_f32 v63, v63, v63
    v_lshlrev_b32 v63, 16, v63
    v_cmp_lt_f32 vcc, 0, v59
    s_nop 1
    v_cndmask_b32 v46, 0, 1.0, vcc
    v_mul_f32 v59, v59, v46
    v_mul_f32 v59, v59, v63
    v_cvt_pk_bf16_f32 v44, v56, v57
    v_cvt_pk_bf16_f32 v45, v58, v59
    buffer_store_dwordx2 v[44:45], v3, s[28:31], 0 offen offset:96 sc1
    v_add_u32 v3, 0xc000, v3
    v_accvgpr_read_b32 v48, a32
    v_accvgpr_read_b32 v49, a33
    v_accvgpr_read_b32 v50, a34
    v_accvgpr_read_b32 v51, a35
    v_accvgpr_read_b32 v52, a48
    v_accvgpr_read_b32 v53, a49
    v_accvgpr_read_b32 v54, a50
    v_accvgpr_read_b32 v55, a51
    v_cvt_pk_bf16_f32 v48, v48, v48
    v_lshlrev_b32 v48, 16, v48
    v_cvt_pk_bf16_f32 v52, v52, v52
    v_lshlrev_b32 v52, 16, v52
    v_cmp_lt_f32 vcc, 0, v48
    s_nop 1
    v_cndmask_b32 v34, 0, 1.0, vcc
    v_mul_f32 v48, v48, v34
    v_mul_f32 v48, v48, v52
    v_cvt_pk_bf16_f32 v49, v49, v49
    v_lshlrev_b32 v49, 16, v49
    v_cvt_pk_bf16_f32 v53, v53, v53
    v_lshlrev_b32 v53, 16, v53
    v_cmp_lt_f32 vcc, 0, v49
    s_nop 1
    v_cndmask_b32 v34, 0, 1.0, vcc
    v_mul_f32 v49, v49, v34
    v_mul_f32 v49, v49, v53
    v_cvt_pk_bf16_f32 v50, v50, v50
    v_lshlrev_b32 v50, 16, v50
    v_cvt_pk_bf16_f32 v54, v54, v54
    v_lshlrev_b32 v54, 16, v54
    v_cmp_lt_f32 vcc, 0, v50
    s_nop 1
    v_cndmask_b32 v34, 0, 1.0, vcc
    v_mul_f32 v50, v50, v34
    v_mul_f32 v50, v50, v54
    v_cvt_pk_bf16_f32 v51, v51, v51
    v_lshlrev_b32 v51, 16, v51
    v_cvt_pk_bf16_f32 v55, v55, v55
    v_lshlrev_b32 v55, 16, v55
    v_cmp_lt_f32 vcc, 0, v51
    s_nop 1
    v_cndmask_b32 v34, 0, 1.0, vcc
    v_mul_f32 v51, v51, v34
    v_mul_f32 v51, v51, v55
    v_cvt_pk_bf16_f32 v32, v48, v49
    v_cvt_pk_bf16_f32 v33, v50, v51
    buffer_store_dwordx2 v[32:33], v3, s[28:31], 0 offen offset:0 sc1
    v_accvgpr_read_b32 v56, a36
    v_accvgpr_read_b32 v57, a37
    v_accvgpr_read_b32 v58, a38
    v_accvgpr_read_b32 v59, a39
    v_accvgpr_read_b32 v60, a52
    v_accvgpr_read_b32 v61, a53
    v_accvgpr_read_b32 v62, a54
    v_accvgpr_read_b32 v63, a55
    v_cvt_pk_bf16_f32 v56, v56, v56
    v_lshlrev_b32 v56, 16, v56
    v_cvt_pk_bf16_f32 v60, v60, v60
    v_lshlrev_b32 v60, 16, v60
    v_cmp_lt_f32 vcc, 0, v56
    s_nop 1
    v_cndmask_b32 v38, 0, 1.0, vcc
    v_mul_f32 v56, v56, v38
    v_mul_f32 v56, v56, v60
    v_cvt_pk_bf16_f32 v57, v57, v57
    v_lshlrev_b32 v57, 16, v57
    v_cvt_pk_bf16_f32 v61, v61, v61
    v_lshlrev_b32 v61, 16, v61
    v_cmp_lt_f32 vcc, 0, v57
    s_nop 1
    v_cndmask_b32 v38, 0, 1.0, vcc
    v_mul_f32 v57, v57, v38
    v_mul_f32 v57, v57, v61
    v_cvt_pk_bf16_f32 v58, v58, v58
    v_lshlrev_b32 v58, 16, v58
    v_cvt_pk_bf16_f32 v62, v62, v62
    v_lshlrev_b32 v62, 16, v62
    v_cmp_lt_f32 vcc, 0, v58
    s_nop 1
    v_cndmask_b32 v38, 0, 1.0, vcc
    v_mul_f32 v58, v58, v38
    v_mul_f32 v58, v58, v62
    v_cvt_pk_bf16_f32 v59, v59, v59
    v_lshlrev_b32 v59, 16, v59
    v_cvt_pk_bf16_f32 v63, v63, v63
    v_lshlrev_b32 v63, 16, v63
    v_cmp_lt_f32 vcc, 0, v59
    s_nop 1
    v_cndmask_b32 v38, 0, 1.0, vcc
    v_mul_f32 v59, v59, v38
    v_mul_f32 v59, v59, v63
    v_cvt_pk_bf16_f32 v36, v56, v57
    v_cvt_pk_bf16_f32 v37, v58, v59
    buffer_store_dwordx2 v[36:37], v3, s[28:31], 0 offen offset:32 sc1
    v_accvgpr_read_b32 v48, a40
    v_accvgpr_read_b32 v49, a41
    v_accvgpr_read_b32 v50, a42
    v_accvgpr_read_b32 v51, a43
    v_accvgpr_read_b32 v52, a56
    v_accvgpr_read_b32 v53, a57
    v_accvgpr_read_b32 v54, a58
    v_accvgpr_read_b32 v55, a59
    v_cvt_pk_bf16_f32 v48, v48, v48
    v_lshlrev_b32 v48, 16, v48
    v_cvt_pk_bf16_f32 v52, v52, v52
    v_lshlrev_b32 v52, 16, v52
    v_cmp_lt_f32 vcc, 0, v48
    s_nop 1
    v_cndmask_b32 v42, 0, 1.0, vcc
    v_mul_f32 v48, v48, v42
    v_mul_f32 v48, v48, v52
    v_cvt_pk_bf16_f32 v49, v49, v49
    v_lshlrev_b32 v49, 16, v49
    v_cvt_pk_bf16_f32 v53, v53, v53
    v_lshlrev_b32 v53, 16, v53
    v_cmp_lt_f32 vcc, 0, v49
    s_nop 1
    v_cndmask_b32 v42, 0, 1.0, vcc
    v_mul_f32 v49, v49, v42
    v_mul_f32 v49, v49, v53
    v_cvt_pk_bf16_f32 v50, v50, v50
    v_lshlrev_b32 v50, 16, v50
    v_cvt_pk_bf16_f32 v54, v54, v54
    v_lshlrev_b32 v54, 16, v54
    v_cmp_lt_f32 vcc, 0, v50
    s_nop 1
    v_cndmask_b32 v42, 0, 1.0, vcc
    v_mul_f32 v50, v50, v42
    v_mul_f32 v50, v50, v54
    v_cvt_pk_bf16_f32 v51, v51, v51
    v_lshlrev_b32 v51, 16, v51
    v_cvt_pk_bf16_f32 v55, v55, v55
    v_lshlrev_b32 v55, 16, v55
    v_cmp_lt_f32 vcc, 0, v51
    s_nop 1
    v_cndmask_b32 v42, 0, 1.0, vcc
    v_mul_f32 v51, v51, v42
    v_mul_f32 v51, v51, v55
    v_cvt_pk_bf16_f32 v40, v48, v49
    v_cvt_pk_bf16_f32 v41, v50, v51
    buffer_store_dwordx2 v[40:41], v3, s[28:31], 0 offen offset:64 sc1
    v_accvgpr_read_b32 v56, a44
    v_accvgpr_read_b32 v57, a45
    v_accvgpr_read_b32 v58, a46
    v_accvgpr_read_b32 v59, a47
    v_accvgpr_read_b32 v60, a60
    v_accvgpr_read_b32 v61, a61
    v_accvgpr_read_b32 v62, a62
    v_accvgpr_read_b32 v63, a63
    v_cvt_pk_bf16_f32 v56, v56, v56
    v_lshlrev_b32 v56, 16, v56
    v_cvt_pk_bf16_f32 v60, v60, v60
    v_lshlrev_b32 v60, 16, v60
    v_cmp_lt_f32 vcc, 0, v56
    s_nop 1
    v_cndmask_b32 v46, 0, 1.0, vcc
    v_mul_f32 v56, v56, v46
    v_mul_f32 v56, v56, v60
    v_cvt_pk_bf16_f32 v57, v57, v57
    v_lshlrev_b32 v57, 16, v57
    v_cvt_pk_bf16_f32 v61, v61, v61
    v_lshlrev_b32 v61, 16, v61
    v_cmp_lt_f32 vcc, 0, v57
    s_nop 1
    v_cndmask_b32 v46, 0, 1.0, vcc
    v_mul_f32 v57, v57, v46
    v_mul_f32 v57, v57, v61
    v_cvt_pk_bf16_f32 v58, v58, v58
    v_lshlrev_b32 v58, 16, v58
    v_cvt_pk_bf16_f32 v62, v62, v62
    v_lshlrev_b32 v62, 16, v62
    v_cmp_lt_f32 vcc, 0, v58
    s_nop 1
    v_cndmask_b32 v46, 0, 1.0, vcc
    v_mul_f32 v58, v58, v46
    v_mul_f32 v58, v58, v62
    v_cvt_pk_bf16_f32 v59, v59, v59
    v_lshlrev_b32 v59, 16, v59
    v_cvt_pk_bf16_f32 v63, v63, v63
    v_lshlrev_b32 v63, 16, v63
    v_cmp_lt_f32 vcc, 0, v59
    s_nop 1
    v_cndmask_b32 v46, 0, 1.0, vcc
    v_mul_f32 v59, v59, v46
    v_mul_f32 v59, v59, v63
    v_cvt_pk_bf16_f32 v44, v56, v57
    v_cvt_pk_bf16_f32 v45, v58, v59
    buffer_store_dwordx2 v[44:45], v3, s[28:31], 0 offen offset:96 sc1
    v_add_u32 v3, 0xc000, v3
    v_accvgpr_read_b32 v48, a64
    v_accvgpr_read_b32 v49, a65
    v_accvgpr_read_b32 v50, a66
    v_accvgpr_read_b32 v51, a67
    v_accvgpr_read_b32 v52, a80
    v_accvgpr_read_b32 v53, a81
    v_accvgpr_read_b32 v54, a82
    v_accvgpr_read_b32 v55, a83
    v_cvt_pk_bf16_f32 v48, v48, v48
    v_lshlrev_b32 v48, 16, v48
    v_cvt_pk_bf16_f32 v52, v52, v52
    v_lshlrev_b32 v52, 16, v52
    v_cmp_lt_f32 vcc, 0, v48
    s_nop 1
    v_cndmask_b32 v34, 0, 1.0, vcc
    v_mul_f32 v48, v48, v34
    v_mul_f32 v48, v48, v52
    v_cvt_pk_bf16_f32 v49, v49, v49
    v_lshlrev_b32 v49, 16, v49
    v_cvt_pk_bf16_f32 v53, v53, v53
    v_lshlrev_b32 v53, 16, v53
    v_cmp_lt_f32 vcc, 0, v49
    s_nop 1
    v_cndmask_b32 v34, 0, 1.0, vcc
    v_mul_f32 v49, v49, v34
    v_mul_f32 v49, v49, v53
    v_cvt_pk_bf16_f32 v50, v50, v50
    v_lshlrev_b32 v50, 16, v50
    v_cvt_pk_bf16_f32 v54, v54, v54
    v_lshlrev_b32 v54, 16, v54
    v_cmp_lt_f32 vcc, 0, v50
    s_nop 1
    v_cndmask_b32 v34, 0, 1.0, vcc
    v_mul_f32 v50, v50, v34
    v_mul_f32 v50, v50, v54
    v_cvt_pk_bf16_f32 v51, v51, v51
    v_lshlrev_b32 v51, 16, v51
    v_cvt_pk_bf16_f32 v55, v55, v55
    v_lshlrev_b32 v55, 16, v55
    v_cmp_lt_f32 vcc, 0, v51
    s_nop 1
    v_cndmask_b32 v34, 0, 1.0, vcc
    v_mul_f32 v51, v51, v34
    v_mul_f32 v51, v51, v55
    v_cvt_pk_bf16_f32 v32, v48, v49
    v_cvt_pk_bf16_f32 v33, v50, v51
    buffer_store_dwordx2 v[32:33], v3, s[28:31], 0 offen offset:0 sc1
    v_accvgpr_read_b32 v56, a68
    v_accvgpr_read_b32 v57, a69
    v_accvgpr_read_b32 v58, a70
    v_accvgpr_read_b32 v59, a71
    v_accvgpr_read_b32 v60, a84
    v_accvgpr_read_b32 v61, a85
    v_accvgpr_read_b32 v62, a86
    v_accvgpr_read_b32 v63, a87
    v_cvt_pk_bf16_f32 v56, v56, v56
    v_lshlrev_b32 v56, 16, v56
    v_cvt_pk_bf16_f32 v60, v60, v60
    v_lshlrev_b32 v60, 16, v60
    v_cmp_lt_f32 vcc, 0, v56
    s_nop 1
    v_cndmask_b32 v38, 0, 1.0, vcc
    v_mul_f32 v56, v56, v38
    v_mul_f32 v56, v56, v60
    v_cvt_pk_bf16_f32 v57, v57, v57
    v_lshlrev_b32 v57, 16, v57
    v_cvt_pk_bf16_f32 v61, v61, v61
    v_lshlrev_b32 v61, 16, v61
    v_cmp_lt_f32 vcc, 0, v57
    s_nop 1
    v_cndmask_b32 v38, 0, 1.0, vcc
    v_mul_f32 v57, v57, v38
    v_mul_f32 v57, v57, v61
    v_cvt_pk_bf16_f32 v58, v58, v58
    v_lshlrev_b32 v58, 16, v58
    v_cvt_pk_bf16_f32 v62, v62, v62
    v_lshlrev_b32 v62, 16, v62
    v_cmp_lt_f32 vcc, 0, v58
    s_nop 1
    v_cndmask_b32 v38, 0, 1.0, vcc
    v_mul_f32 v58, v58, v38
    v_mul_f32 v58, v58, v62
    v_cvt_pk_bf16_f32 v59, v59, v59
    v_lshlrev_b32 v59, 16, v59
    v_cvt_pk_bf16_f32 v63, v63, v63
    v_lshlrev_b32 v63, 16, v63
    v_cmp_lt_f32 vcc, 0, v59
    s_nop 1
    v_cndmask_b32 v38, 0, 1.0, vcc
    v_mul_f32 v59, v59, v38
    v_mul_f32 v59, v59, v63
    v_cvt_pk_bf16_f32 v36, v56, v57
    v_cvt_pk_bf16_f32 v37, v58, v59
    buffer_store_dwordx2 v[36:37], v3, s[28:31], 0 offen offset:32 sc1
    v_accvgpr_read_b32 v48, a72
    v_accvgpr_read_b32 v49, a73
    v_accvgpr_read_b32 v50, a74
    v_accvgpr_read_b32 v51, a75
    v_accvgpr_read_b32 v52, a88
    v_accvgpr_read_b32 v53, a89
    v_accvgpr_read_b32 v54, a90
    v_accvgpr_read_b32 v55, a91
    v_cvt_pk_bf16_f32 v48, v48, v48
    v_lshlrev_b32 v48, 16, v48
    v_cvt_pk_bf16_f32 v52, v52, v52
    v_lshlrev_b32 v52, 16, v52
    v_cmp_lt_f32 vcc, 0, v48
    s_nop 1
    v_cndmask_b32 v42, 0, 1.0, vcc
    v_mul_f32 v48, v48, v42
    v_mul_f32 v48, v48, v52
    v_cvt_pk_bf16_f32 v49, v49, v49
    v_lshlrev_b32 v49, 16, v49
    v_cvt_pk_bf16_f32 v53, v53, v53
    v_lshlrev_b32 v53, 16, v53
    v_cmp_lt_f32 vcc, 0, v49
    s_nop 1
    v_cndmask_b32 v42, 0, 1.0, vcc
    v_mul_f32 v49, v49, v42
    v_mul_f32 v49, v49, v53
    v_cvt_pk_bf16_f32 v50, v50, v50
    v_lshlrev_b32 v50, 16, v50
    v_cvt_pk_bf16_f32 v54, v54, v54
    v_lshlrev_b32 v54, 16, v54
    v_cmp_lt_f32 vcc, 0, v50
    s_nop 1
    v_cndmask_b32 v42, 0, 1.0, vcc
    v_mul_f32 v50, v50, v42
    v_mul_f32 v50, v50, v54
    v_cvt_pk_bf16_f32 v51, v51, v51
    v_lshlrev_b32 v51, 16, v51
    v_cvt_pk_bf16_f32 v55, v55, v55
    v_lshlrev_b32 v55, 16, v55
    v_cmp_lt_f32 vcc, 0, v51
    s_nop 1
    v_cndmask_b32 v42, 0, 1.0, vcc
    v_mul_f32 v51, v51, v42
    v_mul_f32 v51, v51, v55
    v_cvt_pk_bf16_f32 v40, v48, v49
    v_cvt_pk_bf16_f32 v41, v50, v51
    buffer_store_dwordx2 v[40:41], v3, s[28:31], 0 offen offset:64 sc1
    v_accvgpr_read_b32 v56, a76
    v_accvgpr_read_b32 v57, a77
    v_accvgpr_read_b32 v58, a78
    v_accvgpr_read_b32 v59, a79
    v_accvgpr_read_b32 v60, a92
    v_accvgpr_read_b32 v61, a93
    v_accvgpr_read_b32 v62, a94
    v_accvgpr_read_b32 v63, a95
    v_cvt_pk_bf16_f32 v56, v56, v56
    v_lshlrev_b32 v56, 16, v56
    v_cvt_pk_bf16_f32 v60, v60, v60
    v_lshlrev_b32 v60, 16, v60
    v_cmp_lt_f32 vcc, 0, v56
    s_nop 1
    v_cndmask_b32 v46, 0, 1.0, vcc
    v_mul_f32 v56, v56, v46
    v_mul_f32 v56, v56, v60
    v_cvt_pk_bf16_f32 v57, v57, v57
    v_lshlrev_b32 v57, 16, v57
    v_cvt_pk_bf16_f32 v61, v61, v61
    v_lshlrev_b32 v61, 16, v61
    v_cmp_lt_f32 vcc, 0, v57
    s_nop 1
    v_cndmask_b32 v46, 0, 1.0, vcc
    v_mul_f32 v57, v57, v46
    v_mul_f32 v57, v57, v61
    v_cvt_pk_bf16_f32 v58, v58, v58
    v_lshlrev_b32 v58, 16, v58
    v_cvt_pk_bf16_f32 v62, v62, v62
    v_lshlrev_b32 v62, 16, v62
    v_cmp_lt_f32 vcc, 0, v58
    s_nop 1
    v_cndmask_b32 v46, 0, 1.0, vcc
    v_mul_f32 v58, v58, v46
    v_mul_f32 v58, v58, v62
    v_cvt_pk_bf16_f32 v59, v59, v59
    v_lshlrev_b32 v59, 16, v59
    v_cvt_pk_bf16_f32 v63, v63, v63
    v_lshlrev_b32 v63, 16, v63
    v_cmp_lt_f32 vcc, 0, v59
    s_nop 1
    v_cndmask_b32 v46, 0, 1.0, vcc
    v_mul_f32 v59, v59, v46
    v_mul_f32 v59, v59, v63
    v_cvt_pk_bf16_f32 v44, v56, v57
    v_cvt_pk_bf16_f32 v45, v58, v59
    buffer_store_dwordx2 v[44:45], v3, s[28:31], 0 offen offset:96 sc1
    v_add_u32 v3, 0xc000, v3
    v_accvgpr_read_b32 v48, a96
    v_accvgpr_read_b32 v49, a97
    v_accvgpr_read_b32 v50, a98
    v_accvgpr_read_b32 v51, a99
    v_accvgpr_read_b32 v52, a112
    v_accvgpr_read_b32 v53, a113
    v_accvgpr_read_b32 v54, a114
    v_accvgpr_read_b32 v55, a115
    v_cvt_pk_bf16_f32 v48, v48, v48
    v_lshlrev_b32 v48, 16, v48
    v_cvt_pk_bf16_f32 v52, v52, v52
    v_lshlrev_b32 v52, 16, v52
    v_cmp_lt_f32 vcc, 0, v48
    s_nop 1
    v_cndmask_b32 v34, 0, 1.0, vcc
    v_mul_f32 v48, v48, v34
    v_mul_f32 v48, v48, v52
    v_cvt_pk_bf16_f32 v49, v49, v49
    v_lshlrev_b32 v49, 16, v49
    v_cvt_pk_bf16_f32 v53, v53, v53
    v_lshlrev_b32 v53, 16, v53
    v_cmp_lt_f32 vcc, 0, v49
    s_nop 1
    v_cndmask_b32 v34, 0, 1.0, vcc
    v_mul_f32 v49, v49, v34
    v_mul_f32 v49, v49, v53
    v_cvt_pk_bf16_f32 v50, v50, v50
    v_lshlrev_b32 v50, 16, v50
    v_cvt_pk_bf16_f32 v54, v54, v54
    v_lshlrev_b32 v54, 16, v54
    v_cmp_lt_f32 vcc, 0, v50
    s_nop 1
    v_cndmask_b32 v34, 0, 1.0, vcc
    v_mul_f32 v50, v50, v34
    v_mul_f32 v50, v50, v54
    v_cvt_pk_bf16_f32 v51, v51, v51
    v_lshlrev_b32 v51, 16, v51
    v_cvt_pk_bf16_f32 v55, v55, v55
    v_lshlrev_b32 v55, 16, v55
    v_cmp_lt_f32 vcc, 0, v51
    s_nop 1
    v_cndmask_b32 v34, 0, 1.0, vcc
    v_mul_f32 v51, v51, v34
    v_mul_f32 v51, v51, v55
    v_cvt_pk_bf16_f32 v32, v48, v49
    v_cvt_pk_bf16_f32 v33, v50, v51
    buffer_store_dwordx2 v[32:33], v3, s[28:31], 0 offen offset:0 sc1
    v_accvgpr_read_b32 v56, a100
    v_accvgpr_read_b32 v57, a101
    v_accvgpr_read_b32 v58, a102
    v_accvgpr_read_b32 v59, a103
    v_accvgpr_read_b32 v60, a116
    v_accvgpr_read_b32 v61, a117
    v_accvgpr_read_b32 v62, a118
    v_accvgpr_read_b32 v63, a119
    v_cvt_pk_bf16_f32 v56, v56, v56
    v_lshlrev_b32 v56, 16, v56
    v_cvt_pk_bf16_f32 v60, v60, v60
    v_lshlrev_b32 v60, 16, v60
    v_cmp_lt_f32 vcc, 0, v56
    s_nop 1
    v_cndmask_b32 v38, 0, 1.0, vcc
    v_mul_f32 v56, v56, v38
    v_mul_f32 v56, v56, v60
    v_cvt_pk_bf16_f32 v57, v57, v57
    v_lshlrev_b32 v57, 16, v57
    v_cvt_pk_bf16_f32 v61, v61, v61
    v_lshlrev_b32 v61, 16, v61
    v_cmp_lt_f32 vcc, 0, v57
    s_nop 1
    v_cndmask_b32 v38, 0, 1.0, vcc
    v_mul_f32 v57, v57, v38
    v_mul_f32 v57, v57, v61
    v_cvt_pk_bf16_f32 v58, v58, v58
    v_lshlrev_b32 v58, 16, v58
    v_cvt_pk_bf16_f32 v62, v62, v62
    v_lshlrev_b32 v62, 16, v62
    v_cmp_lt_f32 vcc, 0, v58
    s_nop 1
    v_cndmask_b32 v38, 0, 1.0, vcc
    v_mul_f32 v58, v58, v38
    v_mul_f32 v58, v58, v62
    v_cvt_pk_bf16_f32 v59, v59, v59
    v_lshlrev_b32 v59, 16, v59
    v_cvt_pk_bf16_f32 v63, v63, v63
    v_lshlrev_b32 v63, 16, v63
    v_cmp_lt_f32 vcc, 0, v59
    s_nop 1
    v_cndmask_b32 v38, 0, 1.0, vcc
    v_mul_f32 v59, v59, v38
    v_mul_f32 v59, v59, v63
    v_cvt_pk_bf16_f32 v36, v56, v57
    v_cvt_pk_bf16_f32 v37, v58, v59
    buffer_store_dwordx2 v[36:37], v3, s[28:31], 0 offen offset:32 sc1
    v_accvgpr_read_b32 v48, a104
    v_accvgpr_read_b32 v49, a105
    v_accvgpr_read_b32 v50, a106
    v_accvgpr_read_b32 v51, a107
    v_accvgpr_read_b32 v52, a120
    v_accvgpr_read_b32 v53, a121
    v_accvgpr_read_b32 v54, a122
    v_accvgpr_read_b32 v55, a123
    v_cvt_pk_bf16_f32 v48, v48, v48
    v_lshlrev_b32 v48, 16, v48
    v_cvt_pk_bf16_f32 v52, v52, v52
    v_lshlrev_b32 v52, 16, v52
    v_cmp_lt_f32 vcc, 0, v48
    s_nop 1
    v_cndmask_b32 v42, 0, 1.0, vcc
    v_mul_f32 v48, v48, v42
    v_mul_f32 v48, v48, v52
    v_cvt_pk_bf16_f32 v49, v49, v49
    v_lshlrev_b32 v49, 16, v49
    v_cvt_pk_bf16_f32 v53, v53, v53
    v_lshlrev_b32 v53, 16, v53
    v_cmp_lt_f32 vcc, 0, v49
    s_nop 1
    v_cndmask_b32 v42, 0, 1.0, vcc
    v_mul_f32 v49, v49, v42
    v_mul_f32 v49, v49, v53
    v_cvt_pk_bf16_f32 v50, v50, v50
    v_lshlrev_b32 v50, 16, v50
    v_cvt_pk_bf16_f32 v54, v54, v54
    v_lshlrev_b32 v54, 16, v54
    v_cmp_lt_f32 vcc, 0, v50
    s_nop 1
    v_cndmask_b32 v42, 0, 1.0, vcc
    v_mul_f32 v50, v50, v42
    v_mul_f32 v50, v50, v54
    v_cvt_pk_bf16_f32 v51, v51, v51
    v_lshlrev_b32 v51, 16, v51
    v_cvt_pk_bf16_f32 v55, v55, v55
    v_lshlrev_b32 v55, 16, v55
    v_cmp_lt_f32 vcc, 0, v51
    s_nop 1
    v_cndmask_b32 v42, 0, 1.0, vcc
    v_mul_f32 v51, v51, v42
    v_mul_f32 v51, v51, v55
    v_cvt_pk_bf16_f32 v40, v48, v49
    v_cvt_pk_bf16_f32 v41, v50, v51
    buffer_store_dwordx2 v[40:41], v3, s[28:31], 0 offen offset:64 sc1
    v_accvgpr_read_b32 v56, a108
    v_accvgpr_read_b32 v57, a109
    v_accvgpr_read_b32 v58, a110
    v_accvgpr_read_b32 v59, a111
    v_accvgpr_read_b32 v60, a124
    v_accvgpr_read_b32 v61, a125
    v_accvgpr_read_b32 v62, a126
    v_accvgpr_read_b32 v63, a127
    v_cvt_pk_bf16_f32 v56, v56, v56
    v_lshlrev_b32 v56, 16, v56
    v_cvt_pk_bf16_f32 v60, v60, v60
    v_lshlrev_b32 v60, 16, v60
    v_cmp_lt_f32 vcc, 0, v56
    s_nop 1
    v_cndmask_b32 v46, 0, 1.0, vcc
    v_mul_f32 v56, v56, v46
    v_mul_f32 v56, v56, v60
    v_cvt_pk_bf16_f32 v57, v57, v57
    v_lshlrev_b32 v57, 16, v57
    v_cvt_pk_bf16_f32 v61, v61, v61
    v_lshlrev_b32 v61, 16, v61
    v_cmp_lt_f32 vcc, 0, v57
    s_nop 1
    v_cndmask_b32 v46, 0, 1.0, vcc
    v_mul_f32 v57, v57, v46
    v_mul_f32 v57, v57, v61
    v_cvt_pk_bf16_f32 v58, v58, v58
    v_lshlrev_b32 v58, 16, v58
    v_cvt_pk_bf16_f32 v62, v62, v62
    v_lshlrev_b32 v62, 16, v62
    v_cmp_lt_f32 vcc, 0, v58
    s_nop 1
    v_cndmask_b32 v46, 0, 1.0, vcc
    v_mul_f32 v58, v58, v46
    v_mul_f32 v58, v58, v62
    v_cvt_pk_bf16_f32 v59, v59, v59
    v_lshlrev_b32 v59, 16, v59
    v_cvt_pk_bf16_f32 v63, v63, v63
    v_lshlrev_b32 v63, 16, v63
    v_cmp_lt_f32 vcc, 0, v59
    s_nop 1
    v_cndmask_b32 v46, 0, 1.0, vcc
    v_mul_f32 v59, v59, v46
    v_mul_f32 v59, v59, v63
    v_cvt_pk_bf16_f32 v44, v56, v57
    v_cvt_pk_bf16_f32 v45, v58, v59
    buffer_store_dwordx2 v[44:45], v3, s[28:31], 0 offen offset:96 sc1
    v_add_u32 v3, 0xc000, v3
    v_accvgpr_read_b32 v48, a128
    v_accvgpr_read_b32 v49, a129
    v_accvgpr_read_b32 v50, a130
    v_accvgpr_read_b32 v51, a131
    v_accvgpr_read_b32 v52, a144
    v_accvgpr_read_b32 v53, a145
    v_accvgpr_read_b32 v54, a146
    v_accvgpr_read_b32 v55, a147
    v_cvt_pk_bf16_f32 v48, v48, v48
    v_lshlrev_b32 v48, 16, v48
    v_cvt_pk_bf16_f32 v52, v52, v52
    v_lshlrev_b32 v52, 16, v52
    v_cmp_lt_f32 vcc, 0, v48
    s_nop 1
    v_cndmask_b32 v34, 0, 1.0, vcc
    v_mul_f32 v48, v48, v34
    v_mul_f32 v48, v48, v52
    v_cvt_pk_bf16_f32 v49, v49, v49
    v_lshlrev_b32 v49, 16, v49
    v_cvt_pk_bf16_f32 v53, v53, v53
    v_lshlrev_b32 v53, 16, v53
    v_cmp_lt_f32 vcc, 0, v49
    s_nop 1
    v_cndmask_b32 v34, 0, 1.0, vcc
    v_mul_f32 v49, v49, v34
    v_mul_f32 v49, v49, v53
    v_cvt_pk_bf16_f32 v50, v50, v50
    v_lshlrev_b32 v50, 16, v50
    v_cvt_pk_bf16_f32 v54, v54, v54
    v_lshlrev_b32 v54, 16, v54
    v_cmp_lt_f32 vcc, 0, v50
    s_nop 1
    v_cndmask_b32 v34, 0, 1.0, vcc
    v_mul_f32 v50, v50, v34
    v_mul_f32 v50, v50, v54
    v_cvt_pk_bf16_f32 v51, v51, v51
    v_lshlrev_b32 v51, 16, v51
    v_cvt_pk_bf16_f32 v55, v55, v55
    v_lshlrev_b32 v55, 16, v55
    v_cmp_lt_f32 vcc, 0, v51
    s_nop 1
    v_cndmask_b32 v34, 0, 1.0, vcc
    v_mul_f32 v51, v51, v34
    v_mul_f32 v51, v51, v55
    v_cvt_pk_bf16_f32 v32, v48, v49
    v_cvt_pk_bf16_f32 v33, v50, v51
    buffer_store_dwordx2 v[32:33], v3, s[28:31], 0 offen offset:0 sc1
    v_accvgpr_read_b32 v56, a132
    v_accvgpr_read_b32 v57, a133
    v_accvgpr_read_b32 v58, a134
    v_accvgpr_read_b32 v59, a135
    v_accvgpr_read_b32 v60, a148
    v_accvgpr_read_b32 v61, a149
    v_accvgpr_read_b32 v62, a150
    v_accvgpr_read_b32 v63, a151
    v_cvt_pk_bf16_f32 v56, v56, v56
    v_lshlrev_b32 v56, 16, v56
    v_cvt_pk_bf16_f32 v60, v60, v60
    v_lshlrev_b32 v60, 16, v60
    v_cmp_lt_f32 vcc, 0, v56
    s_nop 1
    v_cndmask_b32 v38, 0, 1.0, vcc
    v_mul_f32 v56, v56, v38
    v_mul_f32 v56, v56, v60
    v_cvt_pk_bf16_f32 v57, v57, v57
    v_lshlrev_b32 v57, 16, v57
    v_cvt_pk_bf16_f32 v61, v61, v61
    v_lshlrev_b32 v61, 16, v61
    v_cmp_lt_f32 vcc, 0, v57
    s_nop 1
    v_cndmask_b32 v38, 0, 1.0, vcc
    v_mul_f32 v57, v57, v38
    v_mul_f32 v57, v57, v61
    v_cvt_pk_bf16_f32 v58, v58, v58
    v_lshlrev_b32 v58, 16, v58
    v_cvt_pk_bf16_f32 v62, v62, v62
    v_lshlrev_b32 v62, 16, v62
    v_cmp_lt_f32 vcc, 0, v58
    s_nop 1
    v_cndmask_b32 v38, 0, 1.0, vcc
    v_mul_f32 v58, v58, v38
    v_mul_f32 v58, v58, v62
    v_cvt_pk_bf16_f32 v59, v59, v59
    v_lshlrev_b32 v59, 16, v59
    v_cvt_pk_bf16_f32 v63, v63, v63
    v_lshlrev_b32 v63, 16, v63
    v_cmp_lt_f32 vcc, 0, v59
    s_nop 1
    v_cndmask_b32 v38, 0, 1.0, vcc
    v_mul_f32 v59, v59, v38
    v_mul_f32 v59, v59, v63
    v_cvt_pk_bf16_f32 v36, v56, v57
    v_cvt_pk_bf16_f32 v37, v58, v59
    buffer_store_dwordx2 v[36:37], v3, s[28:31], 0 offen offset:32 sc1
    v_accvgpr_read_b32 v48, a136
    v_accvgpr_read_b32 v49, a137
    v_accvgpr_read_b32 v50, a138
    v_accvgpr_read_b32 v51, a139
    v_accvgpr_read_b32 v52, a152
    v_accvgpr_read_b32 v53, a153
    v_accvgpr_read_b32 v54, a154
    v_accvgpr_read_b32 v55, a155
    v_cvt_pk_bf16_f32 v48, v48, v48
    v_lshlrev_b32 v48, 16, v48
    v_cvt_pk_bf16_f32 v52, v52, v52
    v_lshlrev_b32 v52, 16, v52
    v_cmp_lt_f32 vcc, 0, v48
    s_nop 1
    v_cndmask_b32 v42, 0, 1.0, vcc
    v_mul_f32 v48, v48, v42
    v_mul_f32 v48, v48, v52
    v_cvt_pk_bf16_f32 v49, v49, v49
    v_lshlrev_b32 v49, 16, v49
    v_cvt_pk_bf16_f32 v53, v53, v53
    v_lshlrev_b32 v53, 16, v53
    v_cmp_lt_f32 vcc, 0, v49
    s_nop 1
    v_cndmask_b32 v42, 0, 1.0, vcc
    v_mul_f32 v49, v49, v42
    v_mul_f32 v49, v49, v53
    v_cvt_pk_bf16_f32 v50, v50, v50
    v_lshlrev_b32 v50, 16, v50
    v_cvt_pk_bf16_f32 v54, v54, v54
    v_lshlrev_b32 v54, 16, v54
    v_cmp_lt_f32 vcc, 0, v50
    s_nop 1
    v_cndmask_b32 v42, 0, 1.0, vcc
    v_mul_f32 v50, v50, v42
    v_mul_f32 v50, v50, v54
    v_cvt_pk_bf16_f32 v51, v51, v51
    v_lshlrev_b32 v51, 16, v51
    v_cvt_pk_bf16_f32 v55, v55, v55
    v_lshlrev_b32 v55, 16, v55
    v_cmp_lt_f32 vcc, 0, v51
    s_nop 1
    v_cndmask_b32 v42, 0, 1.0, vcc
    v_mul_f32 v51, v51, v42
    v_mul_f32 v51, v51, v55
    v_cvt_pk_bf16_f32 v40, v48, v49
    v_cvt_pk_bf16_f32 v41, v50, v51
    buffer_store_dwordx2 v[40:41], v3, s[28:31], 0 offen offset:64 sc1
    v_accvgpr_read_b32 v56, a140
    v_accvgpr_read_b32 v57, a141
    v_accvgpr_read_b32 v58, a142
    v_accvgpr_read_b32 v59, a143
    v_accvgpr_read_b32 v60, a156
    v_accvgpr_read_b32 v61, a157
    v_accvgpr_read_b32 v62, a158
    v_accvgpr_read_b32 v63, a159
    v_cvt_pk_bf16_f32 v56, v56, v56
    v_lshlrev_b32 v56, 16, v56
    v_cvt_pk_bf16_f32 v60, v60, v60
    v_lshlrev_b32 v60, 16, v60
    v_cmp_lt_f32 vcc, 0, v56
    s_nop 1
    v_cndmask_b32 v46, 0, 1.0, vcc
    v_mul_f32 v56, v56, v46
    v_mul_f32 v56, v56, v60
    v_cvt_pk_bf16_f32 v57, v57, v57
    v_lshlrev_b32 v57, 16, v57
    v_cvt_pk_bf16_f32 v61, v61, v61
    v_lshlrev_b32 v61, 16, v61
    v_cmp_lt_f32 vcc, 0, v57
    s_nop 1
    v_cndmask_b32 v46, 0, 1.0, vcc
    v_mul_f32 v57, v57, v46
    v_mul_f32 v57, v57, v61
    v_cvt_pk_bf16_f32 v58, v58, v58
    v_lshlrev_b32 v58, 16, v58
    v_cvt_pk_bf16_f32 v62, v62, v62
    v_lshlrev_b32 v62, 16, v62
    v_cmp_lt_f32 vcc, 0, v58
    s_nop 1
    v_cndmask_b32 v46, 0, 1.0, vcc
    v_mul_f32 v58, v58, v46
    v_mul_f32 v58, v58, v62
    v_cvt_pk_bf16_f32 v59, v59, v59
    v_lshlrev_b32 v59, 16, v59
    v_cvt_pk_bf16_f32 v63, v63, v63
    v_lshlrev_b32 v63, 16, v63
    v_cmp_lt_f32 vcc, 0, v59
    s_nop 1
    v_cndmask_b32 v46, 0, 1.0, vcc
    v_mul_f32 v59, v59, v46
    v_mul_f32 v59, v59, v63
    v_cvt_pk_bf16_f32 v44, v56, v57
    v_cvt_pk_bf16_f32 v45, v58, v59
    buffer_store_dwordx2 v[44:45], v3, s[28:31], 0 offen offset:96 sc1
    v_add_u32 v3, 0xc000, v3
    v_accvgpr_read_b32 v48, a160
    v_accvgpr_read_b32 v49, a161
    v_accvgpr_read_b32 v50, a162
    v_accvgpr_read_b32 v51, a163
    v_accvgpr_read_b32 v52, a176
    v_accvgpr_read_b32 v53, a177
    v_accvgpr_read_b32 v54, a178
    v_accvgpr_read_b32 v55, a179
    v_cvt_pk_bf16_f32 v48, v48, v48
    v_lshlrev_b32 v48, 16, v48
    v_cvt_pk_bf16_f32 v52, v52, v52
    v_lshlrev_b32 v52, 16, v52
    v_cmp_lt_f32 vcc, 0, v48
    s_nop 1
    v_cndmask_b32 v34, 0, 1.0, vcc
    v_mul_f32 v48, v48, v34
    v_mul_f32 v48, v48, v52
    v_cvt_pk_bf16_f32 v49, v49, v49
    v_lshlrev_b32 v49, 16, v49
    v_cvt_pk_bf16_f32 v53, v53, v53
    v_lshlrev_b32 v53, 16, v53
    v_cmp_lt_f32 vcc, 0, v49
    s_nop 1
    v_cndmask_b32 v34, 0, 1.0, vcc
    v_mul_f32 v49, v49, v34
    v_mul_f32 v49, v49, v53
    v_cvt_pk_bf16_f32 v50, v50, v50
    v_lshlrev_b32 v50, 16, v50
    v_cvt_pk_bf16_f32 v54, v54, v54
    v_lshlrev_b32 v54, 16, v54
    v_cmp_lt_f32 vcc, 0, v50
    s_nop 1
    v_cndmask_b32 v34, 0, 1.0, vcc
    v_mul_f32 v50, v50, v34
    v_mul_f32 v50, v50, v54
    v_cvt_pk_bf16_f32 v51, v51, v51
    v_lshlrev_b32 v51, 16, v51
    v_cvt_pk_bf16_f32 v55, v55, v55
    v_lshlrev_b32 v55, 16, v55
    v_cmp_lt_f32 vcc, 0, v51
    s_nop 1
    v_cndmask_b32 v34, 0, 1.0, vcc
    v_mul_f32 v51, v51, v34
    v_mul_f32 v51, v51, v55
    v_cvt_pk_bf16_f32 v32, v48, v49
    v_cvt_pk_bf16_f32 v33, v50, v51
    buffer_store_dwordx2 v[32:33], v3, s[28:31], 0 offen offset:0 sc1
    v_accvgpr_read_b32 v56, a164
    v_accvgpr_read_b32 v57, a165
    v_accvgpr_read_b32 v58, a166
    v_accvgpr_read_b32 v59, a167
    v_accvgpr_read_b32 v60, a180
    v_accvgpr_read_b32 v61, a181
    v_accvgpr_read_b32 v62, a182
    v_accvgpr_read_b32 v63, a183
    v_cvt_pk_bf16_f32 v56, v56, v56
    v_lshlrev_b32 v56, 16, v56
    v_cvt_pk_bf16_f32 v60, v60, v60
    v_lshlrev_b32 v60, 16, v60
    v_cmp_lt_f32 vcc, 0, v56
    s_nop 1
    v_cndmask_b32 v38, 0, 1.0, vcc
    v_mul_f32 v56, v56, v38
    v_mul_f32 v56, v56, v60
    v_cvt_pk_bf16_f32 v57, v57, v57
    v_lshlrev_b32 v57, 16, v57
    v_cvt_pk_bf16_f32 v61, v61, v61
    v_lshlrev_b32 v61, 16, v61
    v_cmp_lt_f32 vcc, 0, v57
    s_nop 1
    v_cndmask_b32 v38, 0, 1.0, vcc
    v_mul_f32 v57, v57, v38
    v_mul_f32 v57, v57, v61
    v_cvt_pk_bf16_f32 v58, v58, v58
    v_lshlrev_b32 v58, 16, v58
    v_cvt_pk_bf16_f32 v62, v62, v62
    v_lshlrev_b32 v62, 16, v62
    v_cmp_lt_f32 vcc, 0, v58
    s_nop 1
    v_cndmask_b32 v38, 0, 1.0, vcc
    v_mul_f32 v58, v58, v38
    v_mul_f32 v58, v58, v62
    v_cvt_pk_bf16_f32 v59, v59, v59
    v_lshlrev_b32 v59, 16, v59
    v_cvt_pk_bf16_f32 v63, v63, v63
    v_lshlrev_b32 v63, 16, v63
    v_cmp_lt_f32 vcc, 0, v59
    s_nop 1
    v_cndmask_b32 v38, 0, 1.0, vcc
    v_mul_f32 v59, v59, v38
    v_mul_f32 v59, v59, v63
    v_cvt_pk_bf16_f32 v36, v56, v57
    v_cvt_pk_bf16_f32 v37, v58, v59
    buffer_store_dwordx2 v[36:37], v3, s[28:31], 0 offen offset:32 sc1
    v_accvgpr_read_b32 v48, a168
    v_accvgpr_read_b32 v49, a169
    v_accvgpr_read_b32 v50, a170
    v_accvgpr_read_b32 v51, a171
    v_accvgpr_read_b32 v52, a184
    v_accvgpr_read_b32 v53, a185
    v_accvgpr_read_b32 v54, a186
    v_accvgpr_read_b32 v55, a187
    v_cvt_pk_bf16_f32 v48, v48, v48
    v_lshlrev_b32 v48, 16, v48
    v_cvt_pk_bf16_f32 v52, v52, v52
    v_lshlrev_b32 v52, 16, v52
    v_cmp_lt_f32 vcc, 0, v48
    s_nop 1
    v_cndmask_b32 v42, 0, 1.0, vcc
    v_mul_f32 v48, v48, v42
    v_mul_f32 v48, v48, v52
    v_cvt_pk_bf16_f32 v49, v49, v49
    v_lshlrev_b32 v49, 16, v49
    v_cvt_pk_bf16_f32 v53, v53, v53
    v_lshlrev_b32 v53, 16, v53
    v_cmp_lt_f32 vcc, 0, v49
    s_nop 1
    v_cndmask_b32 v42, 0, 1.0, vcc
    v_mul_f32 v49, v49, v42
    v_mul_f32 v49, v49, v53
    v_cvt_pk_bf16_f32 v50, v50, v50
    v_lshlrev_b32 v50, 16, v50
    v_cvt_pk_bf16_f32 v54, v54, v54
    v_lshlrev_b32 v54, 16, v54
    v_cmp_lt_f32 vcc, 0, v50
    s_nop 1
    v_cndmask_b32 v42, 0, 1.0, vcc
    v_mul_f32 v50, v50, v42
    v_mul_f32 v50, v50, v54
    v_cvt_pk_bf16_f32 v51, v51, v51
    v_lshlrev_b32 v51, 16, v51
    v_cvt_pk_bf16_f32 v55, v55, v55
    v_lshlrev_b32 v55, 16, v55
    v_cmp_lt_f32 vcc, 0, v51
    s_nop 1
    v_cndmask_b32 v42, 0, 1.0, vcc
    v_mul_f32 v51, v51, v42
    v_mul_f32 v51, v51, v55
    v_cvt_pk_bf16_f32 v40, v48, v49
    v_cvt_pk_bf16_f32 v41, v50, v51
    buffer_store_dwordx2 v[40:41], v3, s[28:31], 0 offen offset:64 sc1
    v_accvgpr_read_b32 v56, a172
    v_accvgpr_read_b32 v57, a173
    v_accvgpr_read_b32 v58, a174
    v_accvgpr_read_b32 v59, a175
    v_accvgpr_read_b32 v60, a188
    v_accvgpr_read_b32 v61, a189
    v_accvgpr_read_b32 v62, a190
    v_accvgpr_read_b32 v63, a191
    v_cvt_pk_bf16_f32 v56, v56, v56
    v_lshlrev_b32 v56, 16, v56
    v_cvt_pk_bf16_f32 v60, v60, v60
    v_lshlrev_b32 v60, 16, v60
    v_cmp_lt_f32 vcc, 0, v56
    s_nop 1
    v_cndmask_b32 v46, 0, 1.0, vcc
    v_mul_f32 v56, v56, v46
    v_mul_f32 v56, v56, v60
    v_cvt_pk_bf16_f32 v57, v57, v57
    v_lshlrev_b32 v57, 16, v57
    v_cvt_pk_bf16_f32 v61, v61, v61
    v_lshlrev_b32 v61, 16, v61
    v_cmp_lt_f32 vcc, 0, v57
    s_nop 1
    v_cndmask_b32 v46, 0, 1.0, vcc
    v_mul_f32 v57, v57, v46
    v_mul_f32 v57, v57, v61
    v_cvt_pk_bf16_f32 v58, v58, v58
    v_lshlrev_b32 v58, 16, v58
    v_cvt_pk_bf16_f32 v62, v62, v62
    v_lshlrev_b32 v62, 16, v62
    v_cmp_lt_f32 vcc, 0, v58
    s_nop 1
    v_cndmask_b32 v46, 0, 1.0, vcc
    v_mul_f32 v58, v58, v46
    v_mul_f32 v58, v58, v62
    v_cvt_pk_bf16_f32 v59, v59, v59
    v_lshlrev_b32 v59, 16, v59
    v_cvt_pk_bf16_f32 v63, v63, v63
    v_lshlrev_b32 v63, 16, v63
    v_cmp_lt_f32 vcc, 0, v59
    s_nop 1
    v_cndmask_b32 v46, 0, 1.0, vcc
    v_mul_f32 v59, v59, v46
    v_mul_f32 v59, v59, v63
    v_cvt_pk_bf16_f32 v44, v56, v57
    v_cvt_pk_bf16_f32 v45, v58, v59
    buffer_store_dwordx2 v[44:45], v3, s[28:31], 0 offen offset:96 sc1
    v_add_u32 v3, 0xc000, v3
    v_accvgpr_read_b32 v48, a192
    v_accvgpr_read_b32 v49, a193
    v_accvgpr_read_b32 v50, a194
    v_accvgpr_read_b32 v51, a195
    v_accvgpr_read_b32 v52, a208
    v_accvgpr_read_b32 v53, a209
    v_accvgpr_read_b32 v54, a210
    v_accvgpr_read_b32 v55, a211
    v_cvt_pk_bf16_f32 v48, v48, v48
    v_lshlrev_b32 v48, 16, v48
    v_cvt_pk_bf16_f32 v52, v52, v52
    v_lshlrev_b32 v52, 16, v52
    v_cmp_lt_f32 vcc, 0, v48
    s_nop 1
    v_cndmask_b32 v34, 0, 1.0, vcc
    v_mul_f32 v48, v48, v34
    v_mul_f32 v48, v48, v52
    v_cvt_pk_bf16_f32 v49, v49, v49
    v_lshlrev_b32 v49, 16, v49
    v_cvt_pk_bf16_f32 v53, v53, v53
    v_lshlrev_b32 v53, 16, v53
    v_cmp_lt_f32 vcc, 0, v49
    s_nop 1
    v_cndmask_b32 v34, 0, 1.0, vcc
    v_mul_f32 v49, v49, v34
    v_mul_f32 v49, v49, v53
    v_cvt_pk_bf16_f32 v50, v50, v50
    v_lshlrev_b32 v50, 16, v50
    v_cvt_pk_bf16_f32 v54, v54, v54
    v_lshlrev_b32 v54, 16, v54
    v_cmp_lt_f32 vcc, 0, v50
    s_nop 1
    v_cndmask_b32 v34, 0, 1.0, vcc
    v_mul_f32 v50, v50, v34
    v_mul_f32 v50, v50, v54
    v_cvt_pk_bf16_f32 v51, v51, v51
    v_lshlrev_b32 v51, 16, v51
    v_cvt_pk_bf16_f32 v55, v55, v55
    v_lshlrev_b32 v55, 16, v55
    v_cmp_lt_f32 vcc, 0, v51
    s_nop 1
    v_cndmask_b32 v34, 0, 1.0, vcc
    v_mul_f32 v51, v51, v34
    v_mul_f32 v51, v51, v55
    v_cvt_pk_bf16_f32 v32, v48, v49
    v_cvt_pk_bf16_f32 v33, v50, v51
    buffer_store_dwordx2 v[32:33], v3, s[28:31], 0 offen offset:0 sc1
    v_accvgpr_read_b32 v56, a196
    v_accvgpr_read_b32 v57, a197
    v_accvgpr_read_b32 v58, a198
    v_accvgpr_read_b32 v59, a199
    v_accvgpr_read_b32 v60, a212
    v_accvgpr_read_b32 v61, a213
    v_accvgpr_read_b32 v62, a214
    v_accvgpr_read_b32 v63, a215
    v_cvt_pk_bf16_f32 v56, v56, v56
    v_lshlrev_b32 v56, 16, v56
    v_cvt_pk_bf16_f32 v60, v60, v60
    v_lshlrev_b32 v60, 16, v60
    v_cmp_lt_f32 vcc, 0, v56
    s_nop 1
    v_cndmask_b32 v38, 0, 1.0, vcc
    v_mul_f32 v56, v56, v38
    v_mul_f32 v56, v56, v60
    v_cvt_pk_bf16_f32 v57, v57, v57
    v_lshlrev_b32 v57, 16, v57
    v_cvt_pk_bf16_f32 v61, v61, v61
    v_lshlrev_b32 v61, 16, v61
    v_cmp_lt_f32 vcc, 0, v57
    s_nop 1
    v_cndmask_b32 v38, 0, 1.0, vcc
    v_mul_f32 v57, v57, v38
    v_mul_f32 v57, v57, v61
    v_cvt_pk_bf16_f32 v58, v58, v58
    v_lshlrev_b32 v58, 16, v58
    v_cvt_pk_bf16_f32 v62, v62, v62
    v_lshlrev_b32 v62, 16, v62
    v_cmp_lt_f32 vcc, 0, v58
    s_nop 1
    v_cndmask_b32 v38, 0, 1.0, vcc
    v_mul_f32 v58, v58, v38
    v_mul_f32 v58, v58, v62
    v_cvt_pk_bf16_f32 v59, v59, v59
    v_lshlrev_b32 v59, 16, v59
    v_cvt_pk_bf16_f32 v63, v63, v63
    v_lshlrev_b32 v63, 16, v63
    v_cmp_lt_f32 vcc, 0, v59
    s_nop 1
    v_cndmask_b32 v38, 0, 1.0, vcc
    v_mul_f32 v59, v59, v38
    v_mul_f32 v59, v59, v63
    v_cvt_pk_bf16_f32 v36, v56, v57
    v_cvt_pk_bf16_f32 v37, v58, v59
    buffer_store_dwordx2 v[36:37], v3, s[28:31], 0 offen offset:32 sc1
    v_accvgpr_read_b32 v48, a200
    v_accvgpr_read_b32 v49, a201
    v_accvgpr_read_b32 v50, a202
    v_accvgpr_read_b32 v51, a203
    v_accvgpr_read_b32 v52, a216
    v_accvgpr_read_b32 v53, a217
    v_accvgpr_read_b32 v54, a218
    v_accvgpr_read_b32 v55, a219
    v_cvt_pk_bf16_f32 v48, v48, v48
    v_lshlrev_b32 v48, 16, v48
    v_cvt_pk_bf16_f32 v52, v52, v52
    v_lshlrev_b32 v52, 16, v52
    v_cmp_lt_f32 vcc, 0, v48
    s_nop 1
    v_cndmask_b32 v42, 0, 1.0, vcc
    v_mul_f32 v48, v48, v42
    v_mul_f32 v48, v48, v52
    v_cvt_pk_bf16_f32 v49, v49, v49
    v_lshlrev_b32 v49, 16, v49
    v_cvt_pk_bf16_f32 v53, v53, v53
    v_lshlrev_b32 v53, 16, v53
    v_cmp_lt_f32 vcc, 0, v49
    s_nop 1
    v_cndmask_b32 v42, 0, 1.0, vcc
    v_mul_f32 v49, v49, v42
    v_mul_f32 v49, v49, v53
    v_cvt_pk_bf16_f32 v50, v50, v50
    v_lshlrev_b32 v50, 16, v50
    v_cvt_pk_bf16_f32 v54, v54, v54
    v_lshlrev_b32 v54, 16, v54
    v_cmp_lt_f32 vcc, 0, v50
    s_nop 1
    v_cndmask_b32 v42, 0, 1.0, vcc
    v_mul_f32 v50, v50, v42
    v_mul_f32 v50, v50, v54
    v_cvt_pk_bf16_f32 v51, v51, v51
    v_lshlrev_b32 v51, 16, v51
    v_cvt_pk_bf16_f32 v55, v55, v55
    v_lshlrev_b32 v55, 16, v55
    v_cmp_lt_f32 vcc, 0, v51
    s_nop 1
    v_cndmask_b32 v42, 0, 1.0, vcc
    v_mul_f32 v51, v51, v42
    v_mul_f32 v51, v51, v55
    v_cvt_pk_bf16_f32 v40, v48, v49
    v_cvt_pk_bf16_f32 v41, v50, v51
    buffer_store_dwordx2 v[40:41], v3, s[28:31], 0 offen offset:64 sc1
    v_accvgpr_read_b32 v56, a204
    v_accvgpr_read_b32 v57, a205
    v_accvgpr_read_b32 v58, a206
    v_accvgpr_read_b32 v59, a207
    v_accvgpr_read_b32 v60, a220
    v_accvgpr_read_b32 v61, a221
    v_accvgpr_read_b32 v62, a222
    v_accvgpr_read_b32 v63, a223
    v_cvt_pk_bf16_f32 v56, v56, v56
    v_lshlrev_b32 v56, 16, v56
    v_cvt_pk_bf16_f32 v60, v60, v60
    v_lshlrev_b32 v60, 16, v60
    v_cmp_lt_f32 vcc, 0, v56
    s_nop 1
    v_cndmask_b32 v46, 0, 1.0, vcc
    v_mul_f32 v56, v56, v46
    v_mul_f32 v56, v56, v60
    v_cvt_pk_bf16_f32 v57, v57, v57
    v_lshlrev_b32 v57, 16, v57
    v_cvt_pk_bf16_f32 v61, v61, v61
    v_lshlrev_b32 v61, 16, v61
    v_cmp_lt_f32 vcc, 0, v57
    s_nop 1
    v_cndmask_b32 v46, 0, 1.0, vcc
    v_mul_f32 v57, v57, v46
    v_mul_f32 v57, v57, v61
    v_cvt_pk_bf16_f32 v58, v58, v58
    v_lshlrev_b32 v58, 16, v58
    v_cvt_pk_bf16_f32 v62, v62, v62
    v_lshlrev_b32 v62, 16, v62
    v_cmp_lt_f32 vcc, 0, v58
    s_nop 1
    v_cndmask_b32 v46, 0, 1.0, vcc
    v_mul_f32 v58, v58, v46
    v_mul_f32 v58, v58, v62
    v_cvt_pk_bf16_f32 v59, v59, v59
    v_lshlrev_b32 v59, 16, v59
    v_cvt_pk_bf16_f32 v63, v63, v63
    v_lshlrev_b32 v63, 16, v63
    v_cmp_lt_f32 vcc, 0, v59
    s_nop 1
    v_cndmask_b32 v46, 0, 1.0, vcc
    v_mul_f32 v59, v59, v46
    v_mul_f32 v59, v59, v63
    v_cvt_pk_bf16_f32 v44, v56, v57
    v_cvt_pk_bf16_f32 v45, v58, v59
    buffer_store_dwordx2 v[44:45], v3, s[28:31], 0 offen offset:96 sc1
    v_add_u32 v3, 0xc000, v3
    v_accvgpr_read_b32 v48, a224
    v_accvgpr_read_b32 v49, a225
    v_accvgpr_read_b32 v50, a226
    v_accvgpr_read_b32 v51, a227
    v_accvgpr_read_b32 v52, a240
    v_accvgpr_read_b32 v53, a241
    v_accvgpr_read_b32 v54, a242
    v_accvgpr_read_b32 v55, a243
    v_cvt_pk_bf16_f32 v48, v48, v48
    v_lshlrev_b32 v48, 16, v48
    v_cvt_pk_bf16_f32 v52, v52, v52
    v_lshlrev_b32 v52, 16, v52
    v_cmp_lt_f32 vcc, 0, v48
    s_nop 1
    v_cndmask_b32 v34, 0, 1.0, vcc
    v_mul_f32 v48, v48, v34
    v_mul_f32 v48, v48, v52
    v_cvt_pk_bf16_f32 v49, v49, v49
    v_lshlrev_b32 v49, 16, v49
    v_cvt_pk_bf16_f32 v53, v53, v53
    v_lshlrev_b32 v53, 16, v53
    v_cmp_lt_f32 vcc, 0, v49
    s_nop 1
    v_cndmask_b32 v34, 0, 1.0, vcc
    v_mul_f32 v49, v49, v34
    v_mul_f32 v49, v49, v53
    v_cvt_pk_bf16_f32 v50, v50, v50
    v_lshlrev_b32 v50, 16, v50
    v_cvt_pk_bf16_f32 v54, v54, v54
    v_lshlrev_b32 v54, 16, v54
    v_cmp_lt_f32 vcc, 0, v50
    s_nop 1
    v_cndmask_b32 v34, 0, 1.0, vcc
    v_mul_f32 v50, v50, v34
    v_mul_f32 v50, v50, v54
    v_cvt_pk_bf16_f32 v51, v51, v51
    v_lshlrev_b32 v51, 16, v51
    v_cvt_pk_bf16_f32 v55, v55, v55
    v_lshlrev_b32 v55, 16, v55
    v_cmp_lt_f32 vcc, 0, v51
    s_nop 1
    v_cndmask_b32 v34, 0, 1.0, vcc
    v_mul_f32 v51, v51, v34
    v_mul_f32 v51, v51, v55
    v_cvt_pk_bf16_f32 v32, v48, v49
    v_cvt_pk_bf16_f32 v33, v50, v51
    buffer_store_dwordx2 v[32:33], v3, s[28:31], 0 offen offset:0 sc1
    v_accvgpr_read_b32 v56, a228
    v_accvgpr_read_b32 v57, a229
    v_accvgpr_read_b32 v58, a230
    v_accvgpr_read_b32 v59, a231
    v_accvgpr_read_b32 v60, a244
    v_accvgpr_read_b32 v61, a245
    v_accvgpr_read_b32 v62, a246
    v_accvgpr_read_b32 v63, a247
    v_cvt_pk_bf16_f32 v56, v56, v56
    v_lshlrev_b32 v56, 16, v56
    v_cvt_pk_bf16_f32 v60, v60, v60
    v_lshlrev_b32 v60, 16, v60
    v_cmp_lt_f32 vcc, 0, v56
    s_nop 1
    v_cndmask_b32 v38, 0, 1.0, vcc
    v_mul_f32 v56, v56, v38
    v_mul_f32 v56, v56, v60
    v_cvt_pk_bf16_f32 v57, v57, v57
    v_lshlrev_b32 v57, 16, v57
    v_cvt_pk_bf16_f32 v61, v61, v61
    v_lshlrev_b32 v61, 16, v61
    v_cmp_lt_f32 vcc, 0, v57
    s_nop 1
    v_cndmask_b32 v38, 0, 1.0, vcc
    v_mul_f32 v57, v57, v38
    v_mul_f32 v57, v57, v61
    v_cvt_pk_bf16_f32 v58, v58, v58
    v_lshlrev_b32 v58, 16, v58
    v_cvt_pk_bf16_f32 v62, v62, v62
    v_lshlrev_b32 v62, 16, v62
    v_cmp_lt_f32 vcc, 0, v58
    s_nop 1
    v_cndmask_b32 v38, 0, 1.0, vcc
    v_mul_f32 v58, v58, v38
    v_mul_f32 v58, v58, v62
    v_cvt_pk_bf16_f32 v59, v59, v59
    v_lshlrev_b32 v59, 16, v59
    v_cvt_pk_bf16_f32 v63, v63, v63
    v_lshlrev_b32 v63, 16, v63
    v_cmp_lt_f32 vcc, 0, v59
    s_nop 1
    v_cndmask_b32 v38, 0, 1.0, vcc
    v_mul_f32 v59, v59, v38
    v_mul_f32 v59, v59, v63
    v_cvt_pk_bf16_f32 v36, v56, v57
    v_cvt_pk_bf16_f32 v37, v58, v59
    buffer_store_dwordx2 v[36:37], v3, s[28:31], 0 offen offset:32 sc1
    v_accvgpr_read_b32 v48, a232
    v_accvgpr_read_b32 v49, a233
    v_accvgpr_read_b32 v50, a234
    v_accvgpr_read_b32 v51, a235
    v_accvgpr_read_b32 v52, a248
    v_accvgpr_read_b32 v53, a249
    v_accvgpr_read_b32 v54, a250
    v_accvgpr_read_b32 v55, a251
    v_cvt_pk_bf16_f32 v48, v48, v48
    v_lshlrev_b32 v48, 16, v48
    v_cvt_pk_bf16_f32 v52, v52, v52
    v_lshlrev_b32 v52, 16, v52
    v_cmp_lt_f32 vcc, 0, v48
    s_nop 1
    v_cndmask_b32 v42, 0, 1.0, vcc
    v_mul_f32 v48, v48, v42
    v_mul_f32 v48, v48, v52
    v_cvt_pk_bf16_f32 v49, v49, v49
    v_lshlrev_b32 v49, 16, v49
    v_cvt_pk_bf16_f32 v53, v53, v53
    v_lshlrev_b32 v53, 16, v53
    v_cmp_lt_f32 vcc, 0, v49
    s_nop 1
    v_cndmask_b32 v42, 0, 1.0, vcc
    v_mul_f32 v49, v49, v42
    v_mul_f32 v49, v49, v53
    v_cvt_pk_bf16_f32 v50, v50, v50
    v_lshlrev_b32 v50, 16, v50
    v_cvt_pk_bf16_f32 v54, v54, v54
    v_lshlrev_b32 v54, 16, v54
    v_cmp_lt_f32 vcc, 0, v50
    s_nop 1
    v_cndmask_b32 v42, 0, 1.0, vcc
    v_mul_f32 v50, v50, v42
    v_mul_f32 v50, v50, v54
    v_cvt_pk_bf16_f32 v51, v51, v51
    v_lshlrev_b32 v51, 16, v51
    v_cvt_pk_bf16_f32 v55, v55, v55
    v_lshlrev_b32 v55, 16, v55
    v_cmp_lt_f32 vcc, 0, v51
    s_nop 1
    v_cndmask_b32 v42, 0, 1.0, vcc
    v_mul_f32 v51, v51, v42
    v_mul_f32 v51, v51, v55
    v_cvt_pk_bf16_f32 v40, v48, v49
    v_cvt_pk_bf16_f32 v41, v50, v51
    buffer_store_dwordx2 v[40:41], v3, s[28:31], 0 offen offset:64 sc1
    v_accvgpr_read_b32 v56, a236
    v_accvgpr_read_b32 v57, a237
    v_accvgpr_read_b32 v58, a238
    v_accvgpr_read_b32 v59, a239
    v_accvgpr_read_b32 v60, a252
    v_accvgpr_read_b32 v61, a253
    v_accvgpr_read_b32 v62, a254
    v_accvgpr_read_b32 v63, a255
    v_cvt_pk_bf16_f32 v56, v56, v56
    v_lshlrev_b32 v56, 16, v56
    v_cvt_pk_bf16_f32 v60, v60, v60
    v_lshlrev_b32 v60, 16, v60
    v_cmp_lt_f32 vcc, 0, v56
    s_nop 1
    v_cndmask_b32 v46, 0, 1.0, vcc
    v_mul_f32 v56, v56, v46
    v_mul_f32 v56, v56, v60
    v_cvt_pk_bf16_f32 v57, v57, v57
    v_lshlrev_b32 v57, 16, v57
    v_cvt_pk_bf16_f32 v61, v61, v61
    v_lshlrev_b32 v61, 16, v61
    v_cmp_lt_f32 vcc, 0, v57
    s_nop 1
    v_cndmask_b32 v46, 0, 1.0, vcc
    v_mul_f32 v57, v57, v46
    v_mul_f32 v57, v57, v61
    v_cvt_pk_bf16_f32 v58, v58, v58
    v_lshlrev_b32 v58, 16, v58
    v_cvt_pk_bf16_f32 v62, v62, v62
    v_lshlrev_b32 v62, 16, v62
    v_cmp_lt_f32 vcc, 0, v58
    s_nop 1
    v_cndmask_b32 v46, 0, 1.0, vcc
    v_mul_f32 v58, v58, v46
    v_mul_f32 v58, v58, v62
    v_cvt_pk_bf16_f32 v59, v59, v59
    v_lshlrev_b32 v59, 16, v59
    v_cvt_pk_bf16_f32 v63, v63, v63
    v_lshlrev_b32 v63, 16, v63
    v_cmp_lt_f32 vcc, 0, v59
    s_nop 1
    v_cndmask_b32 v46, 0, 1.0, vcc
    v_mul_f32 v59, v59, v46
    v_mul_f32 v59, v59, v63
    v_cvt_pk_bf16_f32 v44, v56, v57
    v_cvt_pk_bf16_f32 v45, v58, v59
    buffer_store_dwordx2 v[44:45], v3, s[28:31], 0 offen offset:96 sc1
    s_waitcnt vmcnt(0)
    s_barrier
    s_cmp_lg_u32 s44, 0
    s_cbranch_scc1 L_w_nsf
    s_lshl_b32 s66, s41, 2
    s_add_u32 s66, s66, 64
    v_mov_b32 v24, s66
    v_mov_b32 v25, 1
    s_mov_b64 exec, 1
    buffer_atomic_add v25, v24, s[92:95], 0 offen sc1
    s_mov_b64 exec, -1
L_w_nsf:
    s_add_u32 s91, s91, 127
    s_branch L_w_f
L_w_g0:
    s_sub_u32 s91, s91, 96
L_w_g:
    s_cmp_ge_u32 s91, 80
    s_cbranch_scc1 L_w_a0
    s_mov_b32 s60, 0x33333334
    s_mul_hi_u32 s41, s91, s60
    s_mul_i32 s61, s41, 5
    s_sub_u32 s40, s91, s61
    s_lshr_b32 s90, s41, 1
    s_cmp_lg_u32 s80, 0
    s_cbranch_scc1 L_w_okg
    s_lshl_b32 s66, s90, 2
    s_add_u32 s66, s66, 64
    v_mov_b32 v24, s66
    s_mov_b32 s74, 0
L_w_wtg:
    buffer_load_dword v25, v24, s[92:95], 0 offen sc1
    s_waitcnt vmcnt(0)
    v_readfirstlane_b32 s66, v25
    s_add_u32 s74, s74, 1
    s_cmp_ge_u32 s74, 1048576
    s_cbranch_scc1 L_ch_done
    s_cmp_ge_u32 s66, 12
    s_cbranch_scc1 L_w_okg
    s_sleep 32
    s_branch L_w_wtg
L_w_okg:
    s_barrier
    s_mov_b32 s6, s76
    s_mov_b32 s7, s77
    s_mov_b32 s42, 0
    s_lshr_b32 s45, s44, 1
    s_and_b32 s46, s44, 1
    s_add_u32 s12, s4, 0x4a80000
    s_addc_u32 s13, s5, 0
    s_mov_b32 s14, 0x600000
    s_mov_b32 s15, 0x20000
    s_mov_b32 s16, s6
    s_mov_b32 s17, s7
    s_mov_b32 s18, 0x1e0000
    s_mov_b32 s19, 0x20000
    s_mov_b32 s47, s40
    v_lshrrev_b32 v3, 2, v2
    v_and_b32 v4, 3, v2
    v_lshrrev_b32 v5, 3, v3
    v_lshlrev_b32 v5, 1, v5
    v_xor_b32 v4, v4, v5
    s_mul_i32 s48, s41, 128
    s_mul_i32 s49, s44, 32
    s_add_u32 s48, s48, s49
    v_add_u32 v3, s48, v3
    s_mov_b32 s60, 3072
    v_mul_lo_u32 v3, v3, s60
    v_lshl_add_u32 v6, v4, 4, v3
    v_add_u32 v7, 0xc000, v6
    s_mul_i32 s50, s44, 2
    s_lshr_b32 s51, s50, 3
    s_and_b32 s52, s50, 7
    v_lshrrev_b32 v3, 4, v2
    s_add_u32 s53, s52, 0
    s_mul_i32 s53, s53, 4
    v_add_u32 v3, s53, v3
    v_and_b32 v4, 15, v2
    v_and_b32 v5, 3, v3
    v_lshrrev_b32 v30, 3, v3
    v_and_b32 v30, 1, v30
    v_lshl_or_b32 v5, v30, 2, v5
    v_lshlrev_b32 v5, 1, v5
    v_xor_b32 v4, v4, v5
    s_mov_b32 s60, 1280
    v_mul_lo_u32 v3, v3, s60
    v_lshl_add_u32 v3, v4, 4, v3
    s_mul_i32 s53, s47, 256
    v_add_u32 v8, s53, v3
    v_lshrrev_b32 v3, 4, v2
    s_add_u32 s53, s52, 1
    s_mul_i32 s53, s53, 4
    v_add_u32 v3, s53, v3
    v_and_b32 v4, 15, v2
    v_and_b32 v5, 3, v3
    v_lshrrev_b32 v30, 3, v3
    v_and_b32 v30, 1, v30
    v_lshl_or_b32 v5, v30, 2, v5
    v_lshlrev_b32 v5, 1, v5
    v_xor_b32 v4, v4, v5
    s_mov_b32 s60, 1280
    v_mul_lo_u32 v3, v3, s60
    v_lshl_add_u32 v3, v4, 4, v3
    s_mul_i32 s53, s47, 256
    v_add_u32 v9, s53, v3
    v_and_b32 v3, 15, v2
    v_lshrrev_b32 v4, 4, v2
    v_lshrrev_b32 v5, 3, v3
    v_lshlrev_b32 v5, 1, v5
    v_xor_b32 v5, v4, v5
    s_mul_i32 s53, s45, 64
    v_add_u32 v30, s53, v3
    v_lshlrev_b32 v30, 6, v30
    v_lshl_add_u32 v10, v5, 4, v30
    v_lshrrev_b32 v5, 2, v3
    v_and_b32 v30, 3, v2
    v_lshl_add_u32 v31, v4, 3, v5
    v_mul_u32_u24 v31, 256, v31
    v_lshl_add_u32 v31, v30, 3, v31
    v_add_u32 v31, 8192, v31
    v_and_b32 v30, 1, v4
    v_lshl_or_b32 v5, v30, 2, v5
    v_xor_b32 v30, 0, v5
    v_lshl_add_u32 v11, v30, 5, v31
    v_xor_b32 v30, 1, v5
    v_lshl_add_u32 v12, v30, 5, v31
    v_xor_b32 v30, 2, v5
    v_lshl_add_u32 v13, v30, 5, v31
    v_xor_b32 v30, 3, v5
    v_lshl_add_u32 v14, v30, 5, v31
    v_xor_b32 v30, 4, v5
    v_lshl_add_u32 v15, v30, 5, v31
    v_xor_b32 v30, 5, v5
    v_lshl_add_u32 v16, v30, 5, v31
    v_xor_b32 v30, 6, v5
    v_lshl_add_u32 v17, v30, 5, v31
    v_xor_b32 v30, 7, v5
    v_lshl_add_u32 v18, v30, 5, v31
    s_mul_i32 s53, s46, 4
    s_add_u32 s54, s53, 0
    v_xor_b32 v30, s54, v5
    v_lshl_add_u32 v11, v30, 5, v31
    s_add_u32 s54, s53, 1
    v_xor_b32 v30, s54, v5
    v_lshl_add_u32 v12, v30, 5, v31
    s_add_u32 s54, s53, 2
    v_xor_b32 v30, s54, v5
    v_lshl_add_u32 v13, v30, 5, v31
    s_add_u32 s54, s53, 3
    v_xor_b32 v30, s54, v5
    v_lshl_add_u32 v14, v30, 5, v31
    v_mov_b32 v60, 0
    v_mov_b32 v61, 0
    v_mov_b32 v62, 0
    v_mov_b32 v63, 0
    v_mov_b32 v64, 0
    v_mov_b32 v65, 0
    v_mov_b32 v66, 0
    v_mov_b32 v67, 0
    v_mov_b32 v68, 0
    v_mov_b32 v69, 0
    v_mov_b32 v70, 0
    v_mov_b32 v71, 0
    v_mov_b32 v72, 0
    v_mov_b32 v73, 0
    v_mov_b32 v74, 0
    v_mov_b32 v75, 0
    v_mov_b32 v76, 0
    v_mov_b32 v77, 0
    v_mov_b32 v78, 0
    v_mov_b32 v79, 0
    v_mov_b32 v80, 0
    v_mov_b32 v81, 0
    v_mov_b32 v82, 0
    v_mov_b32 v83, 0
    v_mov_b32 v84, 0
    v_mov_b32 v85, 0
    v_mov_b32 v86, 0
    v_mov_b32 v87, 0
    v_mov_b32 v88, 0
    v_mov_b32 v89, 0
    v_mov_b32 v90, 0
    v_mov_b32 v91, 0
    v_mov_b32 v92, 0
    v_mov_b32 v93, 0
    v_mov_b32 v94, 0
    v_mov_b32 v95, 0
    v_mov_b32 v96, 0
    v_mov_b32 v97, 0
    v_mov_b32 v98, 0
    v_mov_b32 v99, 0
    v_mov_b32 v100, 0
    v_mov_b32 v101, 0
    v_mov_b32 v102, 0
    v_mov_b32 v103, 0
    v_mov_b32 v104, 0
    v_mov_b32 v105, 0
    v_mov_b32 v106, 0
    v_mov_b32 v107, 0
    v_mov_b32 v108, 0
    v_mov_b32 v109, 0
    v_mov_b32 v110, 0
    v_mov_b32 v111, 0
    v_mov_b32 v112, 0
    v_mov_b32 v113, 0
    v_mov_b32 v114, 0
    v_mov_b32 v115, 0
    v_mov_b32 v116, 0
    v_mov_b32 v117, 0
    v_mov_b32 v118, 0
    v_mov_b32 v119, 0
    v_mov_b32 v120, 0
    v_mov_b32 v121, 0
    v_mov_b32 v122, 0
    v_mov_b32 v123, 0
    s_mul_i32 s56, s42, 0
    s_mul_i32 s57, s42, 0
    s_mov_b32 s58, 0
    s_mov_b32 s59, 0
    s_mul_i32 s63, s44, 2048
    s_mul_i32 s64, s44, 2048
    s_add_u32 s64, s64, 8192
    s_add_u32 s65, s58, s63
    s_add_u32 m0, s65, 0
    s_nop 0
    buffer_load_dwordx4 v6, s[12:15], s56 offen sc1 lds
    s_add_u32 s65, s58, s63
    s_add_u32 m0, s65, 1024
    s_nop 0
    buffer_load_dwordx4 v7, s[12:15], s56 offen sc1 lds
    s_add_u32 s65, s58, s64
    s_add_u32 m0, s65, 0
    s_nop 0
    buffer_load_dwordx4 v8, s[16:19], s57 offen lds
    s_add_u32 s65, s58, s64
    s_add_u32 m0, s65, 1024
    s_nop 0
    buffer_load_dwordx4 v9, s[16:19], s57 offen lds
    s_add_u32 s56, s56, 64
    s_add_u32 s57, s57, 40960
    s_add_u32 s58, s58, 16384
    s_cmp_ge_u32 s58, 131072
    s_cselect_b32 s58, 0, s58
    s_add_u32 s65, s58, s63
    s_add_u32 m0, s65, 0
    s_nop 0
    buffer_load_dwordx4 v6, s[12:15], s56 offen sc1 lds
    s_add_u32 s65, s58, s63
    s_add_u32 m0, s65, 1024
    s_nop 0
    buffer_load_dwordx4 v7, s[12:15], s56 offen sc1 lds
    s_add_u32 s65, s58, s64
    s_add_u32 m0, s65, 0
    s_nop 0
    buffer_load_dwordx4 v8, s[16:19], s57 offen lds
    s_add_u32 s65, s58, s64
    s_add_u32 m0, s65, 1024
    s_nop 0
    buffer_load_dwordx4 v9, s[16:19], s57 offen lds
    s_add_u32 s56, s56, 64
    s_add_u32 s57, s57, 40960
    s_add_u32 s58, s58, 16384
    s_cmp_ge_u32 s58, 131072
    s_cselect_b32 s58, 0, s58
    s_add_u32 s65, s58, s63
    s_add_u32 m0, s65, 0
    s_nop 0
    buffer_load_dwordx4 v6, s[12:15], s56 offen sc1 lds
    s_add_u32 s65, s58, s63
    s_add_u32 m0, s65, 1024
    s_nop 0
    buffer_load_dwordx4 v7, s[12:15], s56 offen sc1 lds
    s_add_u32 s65, s58, s64
    s_add_u32 m0, s65, 0
    s_nop 0
    buffer_load_dwordx4 v8, s[16:19], s57 offen lds
    s_add_u32 s65, s58, s64
    s_add_u32 m0, s65, 1024
    s_nop 0
    buffer_load_dwordx4 v9, s[16:19], s57 offen lds
    s_add_u32 s56, s56, 64
    s_add_u32 s57, s57, 40960
    s_add_u32 s58, s58, 16384
    s_cmp_ge_u32 s58, 131072
    s_cselect_b32 s58, 0, s58
    s_add_u32 s65, s58, s63
    s_add_u32 m0, s65, 0
    s_nop 0
    buffer_load_dwordx4 v6, s[12:15], s56 offen sc1 lds
    s_add_u32 s65, s58, s63
    s_add_u32 m0, s65, 1024
    s_nop 0
    buffer_load_dwordx4 v7, s[12:15], s56 offen sc1 lds
    s_add_u32 s65, s58, s64
    s_add_u32 m0, s65, 0
    s_nop 0
    buffer_load_dwordx4 v8, s[16:19], s57 offen lds
    s_add_u32 s65, s58, s64
    s_add_u32 m0, s65, 1024
    s_nop 0
    buffer_load_dwordx4 v9, s[16:19], s57 offen lds
    s_add_u32 s56, s56, 64
    s_add_u32 s57, s57, 40960
    s_add_u32 s58, s58, 16384
    s_cmp_ge_u32 s58, 131072
    s_cselect_b32 s58, 0, s58
    s_add_u32 s65, s58, s63
    s_add_u32 m0, s65, 0
    s_nop 0
    buffer_load_dwordx4 v6, s[12:15], s56 offen sc1 lds
    s_add_u32 s65, s58, s63
    s_add_u32 m0, s65, 1024
    s_nop 0
    buffer_load_dwordx4 v7, s[12:15], s56 offen sc1 lds
    s_add_u32 s65, s58, s64
    s_add_u32 m0, s65, 0
    s_nop 0
    buffer_load_dwordx4 v8, s[16:19], s57 offen lds
    s_add_u32 s65, s58, s64
    s_add_u32 m0, s65, 1024
    s_nop 0
    buffer_load_dwordx4 v9, s[16:19], s57 offen lds
    s_add_u32 s56, s56, 64
    s_add_u32 s57, s57, 40960
    s_add_u32 s58, s58, 16384
    s_cmp_ge_u32 s58, 131072
    s_cselect_b32 s58, 0, s58
    s_add_u32 s65, s58, s63
    s_add_u32 m0, s65, 0
    s_nop 0
    buffer_load_dwordx4 v6, s[12:15], s56 offen sc1 lds
    s_add_u32 s65, s58, s63
    s_add_u32 m0, s65, 1024
    s_nop 0
    buffer_load_dwordx4 v7, s[12:15], s56 offen sc1 lds
    s_add_u32 s65, s58, s64
    s_add_u32 m0, s65, 0
    s_nop 0
    buffer_load_dwordx4 v8, s[16:19], s57 offen lds
    s_add_u32 s65, s58, s64
    s_add_u32 m0, s65, 1024
    s_nop 0
    buffer_load_dwordx4 v9, s[16:19], s57 offen lds
    s_add_u32 s56, s56, 64
    s_add_u32 s57, s57, 40960
    s_add_u32 s58, s58, 16384
    s_cmp_ge_u32 s58, 131072
    s_cselect_b32 s58, 0, s58
    s_add_u32 s65, s58, s63
    s_add_u32 m0, s65, 0
    s_nop 0
    buffer_load_dwordx4 v6, s[12:15], s56 offen sc1 lds
    s_add_u32 s65, s58, s63
    s_add_u32 m0, s65, 1024
    s_nop 0
    buffer_load_dwordx4 v7, s[12:15], s56 offen sc1 lds
    s_add_u32 s65, s58, s64
    s_add_u32 m0, s65, 0
    s_nop 0
    buffer_load_dwordx4 v8, s[16:19], s57 offen lds
    s_add_u32 s65, s58, s64
    s_add_u32 m0, s65, 1024
    s_nop 0
    buffer_load_dwordx4 v9, s[16:19], s57 offen lds
    s_add_u32 s56, s56, 64
    s_add_u32 s57, s57, 40960
    s_add_u32 s58, s58, 16384
    s_cmp_ge_u32 s58, 131072
    s_cselect_b32 s58, 0, s58
    s_mov_b32 s62, 41
L_wg_loop:
    s_waitcnt vmcnt(24)
    s_barrier
    s_add_u32 s65, s58, s63
    s_add_u32 m0, s65, 0
    s_nop 0
    buffer_load_dwordx4 v6, s[12:15], s56 offen sc1 lds
    s_add_u32 s65, s58, s63
    s_add_u32 m0, s65, 1024
    s_nop 0
    buffer_load_dwordx4 v7, s[12:15], s56 offen sc1 lds
    s_add_u32 s65, s58, s64
    s_add_u32 m0, s65, 0
    s_nop 0
    buffer_load_dwordx4 v8, s[16:19], s57 offen lds
    s_add_u32 s65, s58, s64
    s_add_u32 m0, s65, 1024
    s_nop 0
    buffer_load_dwordx4 v9, s[16:19], s57 offen lds
    s_add_u32 s56, s56, 64
    s_add_u32 s57, s57, 40960
    s_add_u32 s58, s58, 16384
    s_cmp_ge_u32 s58, 131072
    s_cselect_b32 s58, 0, s58
    v_add_u32 v19, s59, v10
    v_add_u32 v20, s59, v11
    v_add_u32 v21, s59, v12
    v_add_u32 v22, s59, v13
    v_add_u32 v23, s59, v14
    ds_read_b128 v[28:31], v19 offset:0
    ds_read_b64_tr_b16 v[44:45], v20 offset:0
    ds_read_b64_tr_b16 v[46:47], v20 offset:1024
    ds_read_b64_tr_b16 v[48:49], v21 offset:0
    ds_read_b64_tr_b16 v[50:51], v21 offset:1024
    ds_read_b64_tr_b16 v[52:53], v22 offset:0
    ds_read_b64_tr_b16 v[54:55], v22 offset:1024
    ds_read_b64_tr_b16 v[56:57], v23 offset:0
    ds_read_b64_tr_b16 v[58:59], v23 offset:1024
    ds_read_b128 v[32:35], v19 offset:1024
    s_waitcnt lgkmcnt(7)
    v_mfma_f32_16x16x32_bf16 v[60:63], v[44:47], v[28:31], v[60:63]
    ds_read_b128 v[36:39], v19 offset:2048
    ds_read_b128 v[40:43], v19 offset:3072
    s_waitcnt lgkmcnt(7)
    v_mfma_f32_16x16x32_bf16 v[64:67], v[48:51], v[28:31], v[64:67]
    s_waitcnt lgkmcnt(5)
    v_mfma_f32_16x16x32_bf16 v[68:71], v[52:55], v[28:31], v[68:71]
    s_waitcnt lgkmcnt(3)
    v_mfma_f32_16x16x32_bf16 v[72:75], v[56:59], v[28:31], v[72:75]
    s_waitcnt lgkmcnt(2)
    v_mfma_f32_16x16x32_bf16 v[76:79], v[44:47], v[32:35], v[76:79]
    v_mfma_f32_16x16x32_bf16 v[80:83], v[48:51], v[32:35], v[80:83]
    v_mfma_f32_16x16x32_bf16 v[84:87], v[52:55], v[32:35], v[84:87]
    v_mfma_f32_16x16x32_bf16 v[88:91], v[56:59], v[32:35], v[88:91]
    s_waitcnt lgkmcnt(1)
    v_mfma_f32_16x16x32_bf16 v[92:95], v[44:47], v[36:39], v[92:95]
    v_mfma_f32_16x16x32_bf16 v[96:99], v[48:51], v[36:39], v[96:99]
    v_mfma_f32_16x16x32_bf16 v[100:103], v[52:55], v[36:39], v[100:103]
    v_mfma_f32_16x16x32_bf16 v[104:107], v[56:59], v[36:39], v[104:107]
    s_waitcnt lgkmcnt(0)
    v_mfma_f32_16x16x32_bf16 v[108:111], v[44:47], v[40:43], v[108:111]
    v_mfma_f32_16x16x32_bf16 v[112:115], v[48:51], v[40:43], v[112:115]
    v_mfma_f32_16x16x32_bf16 v[116:119], v[52:55], v[40:43], v[116:119]
    v_mfma_f32_16x16x32_bf16 v[120:123], v[56:59], v[40:43], v[120:123]
    s_add_u32 s59, s59, 16384
    s_cmp_ge_u32 s59, 131072
    s_cselect_b32 s59, 0, s59
    s_sub_u32 s62, s62, 1
    s_cmp_lg_u32 s62, 0
    s_cbranch_scc1 L_wg_loop
    s_waitcnt vmcnt(24)
    s_barrier
    v_add_u32 v19, s59, v10
    v_add_u32 v20, s59, v11
    v_add_u32 v21, s59, v12
    v_add_u32 v22, s59, v13
    v_add_u32 v23, s59, v14
    ds_read_b128 v[28:31], v19 offset:0
    ds_read_b64_tr_b16 v[44:45], v20 offset:0
    ds_read_b64_tr_b16 v[46:47], v20 offset:1024
    ds_read_b64_tr_b16 v[48:49], v21 offset:0
    ds_read_b64_tr_b16 v[50:51], v21 offset:1024
    ds_read_b64_tr_b16 v[52:53], v22 offset:0
    ds_read_b64_tr_b16 v[54:55], v22 offset:1024
    ds_read_b64_tr_b16 v[56:57], v23 offset:0
    ds_read_b64_tr_b16 v[58:59], v23 offset:1024
    ds_read_b128 v[32:35], v19 offset:1024
    s_waitcnt lgkmcnt(7)
    v_mfma_f32_16x16x32_bf16 v[60:63], v[44:47], v[28:31], v[60:63]
    ds_read_b128 v[36:39], v19 offset:2048
    ds_read_b128 v[40:43], v19 offset:3072
    s_waitcnt lgkmcnt(7)
    v_mfma_f32_16x16x32_bf16 v[64:67], v[48:51], v[28:31], v[64:67]
    s_waitcnt lgkmcnt(5)
    v_mfma_f32_16x16x32_bf16 v[68:71], v[52:55], v[28:31], v[68:71]
    s_waitcnt lgkmcnt(3)
    v_mfma_f32_16x16x32_bf16 v[72:75], v[56:59], v[28:31], v[72:75]
    s_waitcnt lgkmcnt(2)
    v_mfma_f32_16x16x32_bf16 v[76:79], v[44:47], v[32:35], v[76:79]
    v_mfma_f32_16x16x32_bf16 v[80:83], v[48:51], v[32:35], v[80:83]
    v_mfma_f32_16x16x32_bf16 v[84:87], v[52:55], v[32:35], v[84:87]
    v_mfma_f32_16x16x32_bf16 v[88:91], v[56:59], v[32:35], v[88:91]
    s_waitcnt lgkmcnt(1)
    v_mfma_f32_16x16x32_bf16 v[92:95], v[44:47], v[36:39], v[92:95]
    v_mfma_f32_16x16x32_bf16 v[96:99], v[48:51], v[36:39], v[96:99]
    v_mfma_f32_16x16x32_bf16 v[100:103], v[52:55], v[36:39], v[100:103]
    v_mfma_f32_16x16x32_bf16 v[104:107], v[56:59], v[36:39], v[104:107]
    s_waitcnt lgkmcnt(0)
    v_mfma_f32_16x16x32_bf16 v[108:111], v[44:47], v[40:43], v[108:111]
    v_mfma_f32_16x16x32_bf16 v[112:115], v[48:51], v[40:43], v[112:115]
    v_mfma_f32_16x16x32_bf16 v[116:119], v[52:55], v[40:43], v[116:119]
    v_mfma_f32_16x16x32_bf16 v[120:123], v[56:59], v[40:43], v[120:123]
    s_add_u32 s59, s59, 16384
    s_cmp_ge_u32 s59, 131072
    s_cselect_b32 s59, 0, s59
    s_waitcnt vmcnt(20)
    s_barrier
    v_add_u32 v19, s59, v10
    v_add_u32 v20, s59, v11
    v_add_u32 v21, s59, v12
    v_add_u32 v22, s59, v13
    v_add_u32 v23, s59, v14
    ds_read_b128 v[28:31], v19 offset:0
    ds_read_b64_tr_b16 v[44:45], v20 offset:0
    ds_read_b64_tr_b16 v[46:47], v20 offset:1024
    ds_read_b64_tr_b16 v[48:49], v21 offset:0
    ds_read_b64_tr_b16 v[50:51], v21 offset:1024
    ds_read_b64_tr_b16 v[52:53], v22 offset:0
    ds_read_b64_tr_b16 v[54:55], v22 offset:1024
    ds_read_b64_tr_b16 v[56:57], v23 offset:0
    ds_read_b64_tr_b16 v[58:59], v23 offset:1024
    ds_read_b128 v[32:35], v19 offset:1024
    s_waitcnt lgkmcnt(7)
    v_mfma_f32_16x16x32_bf16 v[60:63], v[44:47], v[28:31], v[60:63]
    ds_read_b128 v[36:39], v19 offset:2048
    ds_read_b128 v[40:43], v19 offset:3072
    s_waitcnt lgkmcnt(7)
    v_mfma_f32_16x16x32_bf16 v[64:67], v[48:51], v[28:31], v[64:67]
    s_waitcnt lgkmcnt(5)
    v_mfma_f32_16x16x32_bf16 v[68:71], v[52:55], v[28:31], v[68:71]
    s_waitcnt lgkmcnt(3)
    v_mfma_f32_16x16x32_bf16 v[72:75], v[56:59], v[28:31], v[72:75]
    s_waitcnt lgkmcnt(2)
    v_mfma_f32_16x16x32_bf16 v[76:79], v[44:47], v[32:35], v[76:79]
    v_mfma_f32_16x16x32_bf16 v[80:83], v[48:51], v[32:35], v[80:83]
    v_mfma_f32_16x16x32_bf16 v[84:87], v[52:55], v[32:35], v[84:87]
    v_mfma_f32_16x16x32_bf16 v[88:91], v[56:59], v[32:35], v[88:91]
    s_waitcnt lgkmcnt(1)
    v_mfma_f32_16x16x32_bf16 v[92:95], v[44:47], v[36:39], v[92:95]
    v_mfma_f32_16x16x32_bf16 v[96:99], v[48:51], v[36:39], v[96:99]
    v_mfma_f32_16x16x32_bf16 v[100:103], v[52:55], v[36:39], v[100:103]
    v_mfma_f32_16x16x32_bf16 v[104:107], v[56:59], v[36:39], v[104:107]
    s_waitcnt lgkmcnt(0)
    v_mfma_f32_16x16x32_bf16 v[108:111], v[44:47], v[40:43], v[108:111]
    v_mfma_f32_16x16x32_bf16 v[112:115], v[48:51], v[40:43], v[112:115]
    v_mfma_f32_16x16x32_bf16 v[116:119], v[52:55], v[40:43], v[116:119]
    v_mfma_f32_16x16x32_bf16 v[120:123], v[56:59], v[40:43], v[120:123]
    s_add_u32 s59, s59, 16384
    s_cmp_ge_u32 s59, 131072
    s_cselect_b32 s59, 0, s59
    s_waitcnt vmcnt(16)
    s_barrier
    v_add_u32 v19, s59, v10
    v_add_u32 v20, s59, v11
    v_add_u32 v21, s59, v12
    v_add_u32 v22, s59, v13
    v_add_u32 v23, s59, v14
    ds_read_b128 v[28:31], v19 offset:0
    ds_read_b64_tr_b16 v[44:45], v20 offset:0
    ds_read_b64_tr_b16 v[46:47], v20 offset:1024
    ds_read_b64_tr_b16 v[48:49], v21 offset:0
    ds_read_b64_tr_b16 v[50:51], v21 offset:1024
    ds_read_b64_tr_b16 v[52:53], v22 offset:0
    ds_read_b64_tr_b16 v[54:55], v22 offset:1024
    ds_read_b64_tr_b16 v[56:57], v23 offset:0
    ds_read_b64_tr_b16 v[58:59], v23 offset:1024
    ds_read_b128 v[32:35], v19 offset:1024
    s_waitcnt lgkmcnt(7)
    v_mfma_f32_16x16x32_bf16 v[60:63], v[44:47], v[28:31], v[60:63]
    ds_read_b128 v[36:39], v19 offset:2048
    ds_read_b128 v[40:43], v19 offset:3072
    s_waitcnt lgkmcnt(7)
    v_mfma_f32_16x16x32_bf16 v[64:67], v[48:51], v[28:31], v[64:67]
    s_waitcnt lgkmcnt(5)
    v_mfma_f32_16x16x32_bf16 v[68:71], v[52:55], v[28:31], v[68:71]
    s_waitcnt lgkmcnt(3)
    v_mfma_f32_16x16x32_bf16 v[72:75], v[56:59], v[28:31], v[72:75]
    s_waitcnt lgkmcnt(2)
    v_mfma_f32_16x16x32_bf16 v[76:79], v[44:47], v[32:35], v[76:79]
    v_mfma_f32_16x16x32_bf16 v[80:83], v[48:51], v[32:35], v[80:83]
    v_mfma_f32_16x16x32_bf16 v[84:87], v[52:55], v[32:35], v[84:87]
    v_mfma_f32_16x16x32_bf16 v[88:91], v[56:59], v[32:35], v[88:91]
    s_waitcnt lgkmcnt(1)
    v_mfma_f32_16x16x32_bf16 v[92:95], v[44:47], v[36:39], v[92:95]
    v_mfma_f32_16x16x32_bf16 v[96:99], v[48:51], v[36:39], v[96:99]
    v_mfma_f32_16x16x32_bf16 v[100:103], v[52:55], v[36:39], v[100:103]
    v_mfma_f32_16x16x32_bf16 v[104:107], v[56:59], v[36:39], v[104:107]
    s_waitcnt lgkmcnt(0)
    v_mfma_f32_16x16x32_bf16 v[108:111], v[44:47], v[40:43], v[108:111]
    v_mfma_f32_16x16x32_bf16 v[112:115], v[48:51], v[40:43], v[112:115]
    v_mfma_f32_16x16x32_bf16 v[116:119], v[52:55], v[40:43], v[116:119]
    v_mfma_f32_16x16x32_bf16 v[120:123], v[56:59], v[40:43], v[120:123]
    s_add_u32 s59, s59, 16384
    s_cmp_ge_u32 s59, 131072
    s_cselect_b32 s59, 0, s59
    s_waitcnt vmcnt(12)
    s_barrier
    v_add_u32 v19, s59, v10
    v_add_u32 v20, s59, v11
    v_add_u32 v21, s59, v12
    v_add_u32 v22, s59, v13
    v_add_u32 v23, s59, v14
    ds_read_b128 v[28:31], v19 offset:0
    ds_read_b64_tr_b16 v[44:45], v20 offset:0
    ds_read_b64_tr_b16 v[46:47], v20 offset:1024
    ds_read_b64_tr_b16 v[48:49], v21 offset:0
    ds_read_b64_tr_b16 v[50:51], v21 offset:1024
    ds_read_b64_tr_b16 v[52:53], v22 offset:0
    ds_read_b64_tr_b16 v[54:55], v22 offset:1024
    ds_read_b64_tr_b16 v[56:57], v23 offset:0
    ds_read_b64_tr_b16 v[58:59], v23 offset:1024
    ds_read_b128 v[32:35], v19 offset:1024
    s_waitcnt lgkmcnt(7)
    v_mfma_f32_16x16x32_bf16 v[60:63], v[44:47], v[28:31], v[60:63]
    ds_read_b128 v[36:39], v19 offset:2048
    ds_read_b128 v[40:43], v19 offset:3072
    s_waitcnt lgkmcnt(7)
    v_mfma_f32_16x16x32_bf16 v[64:67], v[48:51], v[28:31], v[64:67]
    s_waitcnt lgkmcnt(5)
    v_mfma_f32_16x16x32_bf16 v[68:71], v[52:55], v[28:31], v[68:71]
    s_waitcnt lgkmcnt(3)
    v_mfma_f32_16x16x32_bf16 v[72:75], v[56:59], v[28:31], v[72:75]
    s_waitcnt lgkmcnt(2)
    v_mfma_f32_16x16x32_bf16 v[76:79], v[44:47], v[32:35], v[76:79]
    v_mfma_f32_16x16x32_bf16 v[80:83], v[48:51], v[32:35], v[80:83]
    v_mfma_f32_16x16x32_bf16 v[84:87], v[52:55], v[32:35], v[84:87]
    v_mfma_f32_16x16x32_bf16 v[88:91], v[56:59], v[32:35], v[88:91]
    s_waitcnt lgkmcnt(1)
    v_mfma_f32_16x16x32_bf16 v[92:95], v[44:47], v[36:39], v[92:95]
    v_mfma_f32_16x16x32_bf16 v[96:99], v[48:51], v[36:39], v[96:99]
    v_mfma_f32_16x16x32_bf16 v[100:103], v[52:55], v[36:39], v[100:103]
    v_mfma_f32_16x16x32_bf16 v[104:107], v[56:59], v[36:39], v[104:107]
    s_waitcnt lgkmcnt(0)
    v_mfma_f32_16x16x32_bf16 v[108:111], v[44:47], v[40:43], v[108:111]
    v_mfma_f32_16x16x32_bf16 v[112:115], v[48:51], v[40:43], v[112:115]
    v_mfma_f32_16x16x32_bf16 v[116:119], v[52:55], v[40:43], v[116:119]
    v_mfma_f32_16x16x32_bf16 v[120:123], v[56:59], v[40:43], v[120:123]
    s_add_u32 s59, s59, 16384
    s_cmp_ge_u32 s59, 131072
    s_cselect_b32 s59, 0, s59
    s_waitcnt vmcnt(8)
    s_barrier
    v_add_u32 v19, s59, v10
    v_add_u32 v20, s59, v11
    v_add_u32 v21, s59, v12
    v_add_u32 v22, s59, v13
    v_add_u32 v23, s59, v14
    ds_read_b128 v[28:31], v19 offset:0
    ds_read_b64_tr_b16 v[44:45], v20 offset:0
    ds_read_b64_tr_b16 v[46:47], v20 offset:1024
    ds_read_b64_tr_b16 v[48:49], v21 offset:0
    ds_read_b64_tr_b16 v[50:51], v21 offset:1024
    ds_read_b64_tr_b16 v[52:53], v22 offset:0
    ds_read_b64_tr_b16 v[54:55], v22 offset:1024
    ds_read_b64_tr_b16 v[56:57], v23 offset:0
    ds_read_b64_tr_b16 v[58:59], v23 offset:1024
    ds_read_b128 v[32:35], v19 offset:1024
    s_waitcnt lgkmcnt(7)
    v_mfma_f32_16x16x32_bf16 v[60:63], v[44:47], v[28:31], v[60:63]
    ds_read_b128 v[36:39], v19 offset:2048
    ds_read_b128 v[40:43], v19 offset:3072
    s_waitcnt lgkmcnt(7)
    v_mfma_f32_16x16x32_bf16 v[64:67], v[48:51], v[28:31], v[64:67]
    s_waitcnt lgkmcnt(5)
    v_mfma_f32_16x16x32_bf16 v[68:71], v[52:55], v[28:31], v[68:71]
    s_waitcnt lgkmcnt(3)
    v_mfma_f32_16x16x32_bf16 v[72:75], v[56:59], v[28:31], v[72:75]
    s_waitcnt lgkmcnt(2)
    v_mfma_f32_16x16x32_bf16 v[76:79], v[44:47], v[32:35], v[76:79]
    v_mfma_f32_16x16x32_bf16 v[80:83], v[48:51], v[32:35], v[80:83]
    v_mfma_f32_16x16x32_bf16 v[84:87], v[52:55], v[32:35], v[84:87]
    v_mfma_f32_16x16x32_bf16 v[88:91], v[56:59], v[32:35], v[88:91]
    s_waitcnt lgkmcnt(1)
    v_mfma_f32_16x16x32_bf16 v[92:95], v[44:47], v[36:39], v[92:95]
    v_mfma_f32_16x16x32_bf16 v[96:99], v[48:51], v[36:39], v[96:99]
    v_mfma_f32_16x16x32_bf16 v[100:103], v[52:55], v[36:39], v[100:103]
    v_mfma_f32_16x16x32_bf16 v[104:107], v[56:59], v[36:39], v[104:107]
    s_waitcnt lgkmcnt(0)
    v_mfma_f32_16x16x32_bf16 v[108:111], v[44:47], v[40:43], v[108:111]
    v_mfma_f32_16x16x32_bf16 v[112:115], v[48:51], v[40:43], v[112:115]
    v_mfma_f32_16x16x32_bf16 v[116:119], v[52:55], v[40:43], v[116:119]
    v_mfma_f32_16x16x32_bf16 v[120:123], v[56:59], v[40:43], v[120:123]
    s_add_u32 s59, s59, 16384
    s_cmp_ge_u32 s59, 131072
    s_cselect_b32 s59, 0, s59
    s_waitcnt vmcnt(4)
    s_barrier
    v_add_u32 v19, s59, v10
    v_add_u32 v20, s59, v11
    v_add_u32 v21, s59, v12
    v_add_u32 v22, s59, v13
    v_add_u32 v23, s59, v14
    ds_read_b128 v[28:31], v19 offset:0
    ds_read_b64_tr_b16 v[44:45], v20 offset:0
    ds_read_b64_tr_b16 v[46:47], v20 offset:1024
    ds_read_b64_tr_b16 v[48:49], v21 offset:0
    ds_read_b64_tr_b16 v[50:51], v21 offset:1024
    ds_read_b64_tr_b16 v[52:53], v22 offset:0
    ds_read_b64_tr_b16 v[54:55], v22 offset:1024
    ds_read_b64_tr_b16 v[56:57], v23 offset:0
    ds_read_b64_tr_b16 v[58:59], v23 offset:1024
    ds_read_b128 v[32:35], v19 offset:1024
    s_waitcnt lgkmcnt(7)
    v_mfma_f32_16x16x32_bf16 v[60:63], v[44:47], v[28:31], v[60:63]
    ds_read_b128 v[36:39], v19 offset:2048
    ds_read_b128 v[40:43], v19 offset:3072
    s_waitcnt lgkmcnt(7)
    v_mfma_f32_16x16x32_bf16 v[64:67], v[48:51], v[28:31], v[64:67]
    s_waitcnt lgkmcnt(5)
    v_mfma_f32_16x16x32_bf16 v[68:71], v[52:55], v[28:31], v[68:71]
    s_waitcnt lgkmcnt(3)
    v_mfma_f32_16x16x32_bf16 v[72:75], v[56:59], v[28:31], v[72:75]
    s_waitcnt lgkmcnt(2)
    v_mfma_f32_16x16x32_bf16 v[76:79], v[44:47], v[32:35], v[76:79]
    v_mfma_f32_16x16x32_bf16 v[80:83], v[48:51], v[32:35], v[80:83]
    v_mfma_f32_16x16x32_bf16 v[84:87], v[52:55], v[32:35], v[84:87]
    v_mfma_f32_16x16x32_bf16 v[88:91], v[56:59], v[32:35], v[88:91]
    s_waitcnt lgkmcnt(1)
    v_mfma_f32_16x16x32_bf16 v[92:95], v[44:47], v[36:39], v[92:95]
    v_mfma_f32_16x16x32_bf16 v[96:99], v[48:51], v[36:39], v[96:99]
    v_mfma_f32_16x16x32_bf16 v[100:103], v[52:55], v[36:39], v[100:103]
    v_mfma_f32_16x16x32_bf16 v[104:107], v[56:59], v[36:39], v[104:107]
    s_waitcnt lgkmcnt(0)
    v_mfma_f32_16x16x32_bf16 v[108:111], v[44:47], v[40:43], v[108:111]
    v_mfma_f32_16x16x32_bf16 v[112:115], v[48:51], v[40:43], v[112:115]
    v_mfma_f32_16x16x32_bf16 v[116:119], v[52:55], v[40:43], v[116:119]
    v_mfma_f32_16x16x32_bf16 v[120:123], v[56:59], v[40:43], v[120:123]
    s_add_u32 s59, s59, 16384
    s_cmp_ge_u32 s59, 131072
    s_cselect_b32 s59, 0, s59
    s_waitcnt vmcnt(0)
    s_barrier
    v_add_u32 v19, s59, v10
    v_add_u32 v20, s59, v11
    v_add_u32 v21, s59, v12
    v_add_u32 v22, s59, v13
    v_add_u32 v23, s59, v14
    ds_read_b128 v[28:31], v19 offset:0
    ds_read_b64_tr_b16 v[44:45], v20 offset:0
    ds_read_b64_tr_b16 v[46:47], v20 offset:1024
    ds_read_b64_tr_b16 v[48:49], v21 offset:0
    ds_read_b64_tr_b16 v[50:51], v21 offset:1024
    ds_read_b64_tr_b16 v[52:53], v22 offset:0
    ds_read_b64_tr_b16 v[54:55], v22 offset:1024
    ds_read_b64_tr_b16 v[56:57], v23 offset:0
    ds_read_b64_tr_b16 v[58:59], v23 offset:1024
    ds_read_b128 v[32:35], v19 offset:1024
    s_waitcnt lgkmcnt(7)
    v_mfma_f32_16x16x32_bf16 v[60:63], v[44:47], v[28:31], v[60:63]
    ds_read_b128 v[36:39], v19 offset:2048
    ds_read_b128 v[40:43], v19 offset:3072
    s_waitcnt lgkmcnt(7)
    v_mfma_f32_16x16x32_bf16 v[64:67], v[48:51], v[28:31], v[64:67]
    s_waitcnt lgkmcnt(5)
    v_mfma_f32_16x16x32_bf16 v[68:71], v[52:55], v[28:31], v[68:71]
    s_waitcnt lgkmcnt(3)
    v_mfma_f32_16x16x32_bf16 v[72:75], v[56:59], v[28:31], v[72:75]
    s_waitcnt lgkmcnt(2)
    v_mfma_f32_16x16x32_bf16 v[76:79], v[44:47], v[32:35], v[76:79]
    v_mfma_f32_16x16x32_bf16 v[80:83], v[48:51], v[32:35], v[80:83]
    v_mfma_f32_16x16x32_bf16 v[84:87], v[52:55], v[32:35], v[84:87]
    v_mfma_f32_16x16x32_bf16 v[88:91], v[56:59], v[32:35], v[88:91]
    s_waitcnt lgkmcnt(1)
    v_mfma_f32_16x16x32_bf16 v[92:95], v[44:47], v[36:39], v[92:95]
    v_mfma_f32_16x16x32_bf16 v[96:99], v[48:51], v[36:39], v[96:99]
    v_mfma_f32_16x16x32_bf16 v[100:103], v[52:55], v[36:39], v[100:103]
    v_mfma_f32_16x16x32_bf16 v[104:107], v[56:59], v[36:39], v[104:107]
    s_waitcnt lgkmcnt(0)
    v_mfma_f32_16x16x32_bf16 v[108:111], v[44:47], v[40:43], v[108:111]
    v_mfma_f32_16x16x32_bf16 v[112:115], v[48:51], v[40:43], v[112:115]
    v_mfma_f32_16x16x32_bf16 v[116:119], v[52:55], v[40:43], v[116:119]
    v_mfma_f32_16x16x32_bf16 v[120:123], v[56:59], v[40:43], v[120:123]
    s_add_u32 s59, s59, 16384
    s_cmp_ge_u32 s59, 131072
    s_cselect_b32 s59, 0, s59
    s_nop 7
    s_nop 7
    s_add_u32 s28, s4, 0x5080000
    s_addc_u32 s29, s5, 0
    s_mov_b32 s30, 0x280000
    s_mov_b32 s31, 0x20000
    v_and_b32 v3, 15, v2
    v_lshrrev_b32 v4, 4, v2
    s_mul_i32 s53, s41, 128
    s_mul_i32 s54, s45, 64
    s_add_u32 s53, s53, s54
    v_add_u32 v3, s53, v3
    s_mov_b32 s60, 1280
    v_mul_lo_u32 v3, v3, s60
    s_mul_i32 s53, s47, 128
    s_mul_i32 s54, s46, 64
    s_add_u32 s53, s53, s54
    v_lshl_add_u32 v4, v4, 2, s53
    v_lshl_add_u32 v3, v4, 1, v3
    v_cvt_pk_bf16_f32 v28, v60, v61
    v_cvt_pk_bf16_f32 v29, v62, v63
    buffer_store_dwordx2 v[28:29], v3, s[28:31], 0 offen offset:0
    v_cvt_pk_bf16_f32 v32, v64, v65
    v_cvt_pk_bf16_f32 v33, v66, v67
    buffer_store_dwordx2 v[32:33], v3, s[28:31], 0 offen offset:32
    v_cvt_pk_bf16_f32 v36, v68, v69
    v_cvt_pk_bf16_f32 v37, v70, v71
    buffer_store_dwordx2 v[36:37], v3, s[28:31], 0 offen offset:64
    v_cvt_pk_bf16_f32 v40, v72, v73
    v_cvt_pk_bf16_f32 v41, v74, v75
    buffer_store_dwordx2 v[40:41], v3, s[28:31], 0 offen offset:96
    v_add_u32 v3, 0x5000, v3
    v_cvt_pk_bf16_f32 v28, v76, v77
    v_cvt_pk_bf16_f32 v29, v78, v79
    buffer_store_dwordx2 v[28:29], v3, s[28:31], 0 offen offset:0
    v_cvt_pk_bf16_f32 v32, v80, v81
    v_cvt_pk_bf16_f32 v33, v82, v83
    buffer_store_dwordx2 v[32:33], v3, s[28:31], 0 offen offset:32
    v_cvt_pk_bf16_f32 v36, v84, v85
    v_cvt_pk_bf16_f32 v37, v86, v87
    buffer_store_dwordx2 v[36:37], v3, s[28:31], 0 offen offset:64
    v_cvt_pk_bf16_f32 v40, v88, v89
    v_cvt_pk_bf16_f32 v41, v90, v91
    buffer_store_dwordx2 v[40:41], v3, s[28:31], 0 offen offset:96
    v_add_u32 v3, 0x5000, v3
    v_cvt_pk_bf16_f32 v28, v92, v93
    v_cvt_pk_bf16_f32 v29, v94, v95
    buffer_store_dwordx2 v[28:29], v3, s[28:31], 0 offen offset:0
    v_cvt_pk_bf16_f32 v32, v96, v97
    v_cvt_pk_bf16_f32 v33, v98, v99
    buffer_store_dwordx2 v[32:33], v3, s[28:31], 0 offen offset:32
    v_cvt_pk_bf16_f32 v36, v100, v101
    v_cvt_pk_bf16_f32 v37, v102, v103
    buffer_store_dwordx2 v[36:37], v3, s[28:31], 0 offen offset:64
    v_cvt_pk_bf16_f32 v40, v104, v105
    v_cvt_pk_bf16_f32 v41, v106, v107
    buffer_store_dwordx2 v[40:41], v3, s[28:31], 0 offen offset:96
    v_add_u32 v3, 0x5000, v3
    v_cvt_pk_bf16_f32 v28, v108, v109
    v_cvt_pk_bf16_f32 v29, v110, v111
    buffer_store_dwordx2 v[28:29], v3, s[28:31], 0 offen offset:0
    v_cvt_pk_bf16_f32 v32, v112, v113
    v_cvt_pk_bf16_f32 v33, v114, v115
    buffer_store_dwordx2 v[32:33], v3, s[28:31], 0 offen offset:32
    v_cvt_pk_bf16_f32 v36, v116, v117
    v_cvt_pk_bf16_f32 v37, v118, v119
    buffer_store_dwordx2 v[36:37], v3, s[28:31], 0 offen offset:64
    v_cvt_pk_bf16_f32 v40, v120, v121
    v_cvt_pk_bf16_f32 v41, v122, v123
    buffer_store_dwordx2 v[40:41], v3, s[28:31], 0 offen offset:96
    s_barrier
    s_add_u32 s91, s91, 127
    s_branch L_w_g
L_w_a0:
    s_sub_u32 s91, s91, 80
L_w_a:
    s_cmp_ge_u32 s91, 992
    s_cbranch_scc1 L_ch_done
    s_mov_b32 s60, 0x4210843
    s_mul_hi_u32 s82, s91, s60
    s_mul_i32 s61, s82, 62
    s_sub_u32 s83, s91, s61
    s_cmp_ge_u32 s83, 32
    s_cbranch_scc1 L_w_o
    s_lshr_b32 s41, s83, 3
    s_lshl_b32 s90, s82, 2
    s_add_u32 s41, s41, s90
    s_and_b32 s42, s83, 7
    s_lshl_b32 s42, s42, 2
    s_add_u32 s42, s42, s44
    s_lshr_b32 s90, s82, 1
    s_cmp_lg_u32 s80, 0
    s_cbranch_scc1 L_w_okaq
    s_lshl_b32 s66, s90, 2
    s_add_u32 s66, s66, 32
    v_mov_b32 v24, s66
    s_mov_b32 s74, 0
L_w_wtaq:
    buffer_load_dword v25, v24, s[92:95], 0 offen sc1
    s_waitcnt vmcnt(0)
    v_readfirstlane_b32 s66, v25
    s_add_u32 s74, s74, 1
    s_cmp_ge_u32 s74, 1048576
    s_cbranch_scc1 L_ch_done
    s_cmp_ge_u32 s66, 24
    s_cbranch_scc1 L_w_okaq
    s_sleep 32
    s_branch L_w_wtaq
L_w_okaq:
    s_barrier
    s_cmp_lg_u32 s80, 0
    s_cbranch_scc1 L_w_okas
    v_mov_b32 v24, 120
    s_mov_b32 s74, 0
L_w_wtas:
    buffer_load_dword v25, v24, s[92:95], 0 offen sc1
    s_waitcnt vmcnt(0)
    v_readfirstlane_b32 s66, v25
    s_add_u32 s74, s74, 1
    s_cmp_ge_u32 s74, 1048576
    s_cbranch_scc1 L_ch_done
    s_cmp_gt_u32 s66, s41
    s_cbranch_scc1 L_w_okas
    s_sleep 32
    s_branch L_w_wtas
L_w_okas:
    s_barrier
    s_add_u32 s12, s4, 0x280000
    s_addc_u32 s13, s5, 0
    s_mov_b32 s14, 0x1800000
    s_mov_b32 s15, 0x20000
    s_add_u32 s16, s4, 0x1a80000
    s_addc_u32 s17, s5, 0
    s_mov_b32 s18, 0x1800000
    s_mov_b32 s19, 0x20000
    s_add_u32 s20, s4, 0x3280000
    s_addc_u32 s21, s5, 0
    s_mov_b32 s22, 0x1800000
    s_mov_b32 s23, 0x20000
    s_add_u32 s24, s4, 0x6b00000
    s_addc_u32 s25, s5, 0
    s_mov_b32 s26, 0xc00000
    s_mov_b32 s27, 0x20000
    s_add_u32 s28, s4, 0x5300000
    s_addc_u32 s29, s5, 0
    s_mov_b32 s30, 0x1800000
    s_mov_b32 s31, 0x20000
    v_and_b32 v3, 15, v2
    v_lshrrev_b32 v4, 4, v2
    s_lshl_b32 s43, s41, 5
    v_add_u32 v5, s43, v3
    s_mov_b32 s60, 12288
    v_mul_lo_u32 v5, v5, s60
    s_mul_i32 s43, s42, 384
    v_add_u32 v5, s43, v5
    v_lshl_add_u32 v5, v4, 4, v5
    v_add_u32 v6, 0x30000, v5
    s_lshl_b32 s43, s41, 5
    s_add_u32 s43, s43, s42
    s_mul_i32 s44, s43, 6144
    v_and_b32 v7, 7, v2
    v_lshl_add_u32 v7, v4, 3, v7
    v_lshlrev_b32 v7, 4, v7
    v_add_u32 v7, s44, v7
    v_and_b32 v8, 1, v4
    v_lshlrev_b32 v8, 3, v8
    v_lshl_add_u32 v8, v3, 4, v8
    v_add_u32 v8, s44, v8
    v_add_u32 v8, 3072, v8
    s_mul_i32 s43, s41, 384
    s_mul_i32 s45, s42, 12
    s_add_u32 s43, s43, s45
    s_lshl_b32 s43, s43, 10
    v_lshlrev_b32 v9, 4, v2
    v_add_u32 v9, s43, v9
    v_add_u32 v10, 4096, v9
    v_add_u32 v11, 8192, v9
    buffer_load_dwordx4 v[32:35], v5, s[12:15], 0 offen offset:0 sc1
    buffer_load_dwordx4 v[36:39], v5, s[12:15], 0 offen offset:64 sc1
    buffer_load_dwordx4 v[40:43], v5, s[12:15], 0 offen offset:128 sc1
    buffer_load_dwordx4 v[44:47], v5, s[12:15], 0 offen offset:192 sc1
    buffer_load_dwordx4 v[48:51], v5, s[12:15], 0 offen offset:256 sc1
    buffer_load_dwordx4 v[52:55], v5, s[12:15], 0 offen offset:320 sc1
    buffer_load_dwordx4 v[56:59], v6, s[12:15], 0 offen offset:0 sc1
    buffer_load_dwordx4 v[60:63], v6, s[12:15], 0 offen offset:64 sc1
    buffer_load_dwordx4 v[64:67], v6, s[12:15], 0 offen offset:128 sc1
    buffer_load_dwordx4 v[68:71], v6, s[12:15], 0 offen offset:192 sc1
    buffer_load_dwordx4 v[72:75], v6, s[12:15], 0 offen offset:256 sc1
    buffer_load_dwordx4 v[76:79], v6, s[12:15], 0 offen offset:320 sc1
    buffer_load_dwordx4 v[80:83], v5, s[16:19], 0 offen offset:0 sc1
    buffer_load_dwordx4 v[84:87], v5, s[16:19], 0 offen offset:64 sc1
    buffer_load_dwordx4 v[88:91], v5, s[16:19], 0 offen offset:128 sc1
    buffer_load_dwordx4 v[92:95], v5, s[16:19], 0 offen offset:192 sc1
    buffer_load_dwordx4 v[96:99], v5, s[16:19], 0 offen offset:256 sc1
    buffer_load_dwordx4 v[100:103], v5, s[16:19], 0 offen offset:320 sc1
    buffer_load_dwordx4 v[104:107], v6, s[16:19], 0 offen offset:0 sc1
    buffer_load_dwordx4 v[108:111], v6, s[16:19], 0 offen offset:64 sc1
    buffer_load_dwordx4 v[112:115], v6, s[16:19], 0 offen offset:128 sc1
    buffer_load_dwordx4 v[116:119], v6, s[16:19], 0 offen offset:192 sc1
    buffer_load_dwordx4 v[120:123], v6, s[16:19], 0 offen offset:256 sc1
    buffer_load_dwordx4 v[124:127], v6, s[16:19], 0 offen offset:320 sc1
    buffer_load_dwordx4 v[128:131], v7, s[24:27], 0 offen offset:0 sc1
    buffer_load_dwordx4 v[132:135], v7, s[24:27], 0 offen offset:512 sc1
    buffer_load_dwordx4 v[136:139], v7, s[24:27], 0 offen offset:1024 sc1
    buffer_load_dwordx4 v[140:143], v7, s[24:27], 0 offen offset:1536 sc1
    buffer_load_dwordx4 v[144:147], v7, s[24:27], 0 offen offset:2048 sc1
    buffer_load_dwordx4 v[148:151], v7, s[24:27], 0 offen offset:2560 sc1
    buffer_load_dwordx4 v[152:155], v9, s[20:23], 0 offen offset:0 sc1
    buffer_load_dwordx4 v[156:159], v9, s[20:23], 0 offen offset:1024 sc1
    buffer_load_dwordx4 v[160:163], v9, s[20:23], 0 offen offset:2048 sc1
    buffer_load_dwordx4 v[164:167], v9, s[20:23], 0 offen offset:3072 sc1
    buffer_load_dwordx4 v[168:171], v10, s[20:23], 0 offen offset:0 sc1
    buffer_load_dwordx4 v[172:175], v10, s[20:23], 0 offen offset:1024 sc1
    buffer_load_dwordx4 v[176:179], v10, s[20:23], 0 offen offset:2048 sc1
    buffer_load_dwordx4 v[180:183], v10, s[20:23], 0 offen offset:3072 sc1
    buffer_load_dwordx4 v[184:187], v11, s[20:23], 0 offen offset:0 sc1
    buffer_load_dwordx4 v[188:191], v11, s[20:23], 0 offen offset:1024 sc1
    buffer_load_dwordx4 v[192:195], v11, s[20:23], 0 offen offset:2048 sc1
    buffer_load_dwordx4 v[196:199], v11, s[20:23], 0 offen offset:3072 sc1
    buffer_load_dwordx2 v[200:201], v8, s[24:27], 0 offen offset:0 sc1
    buffer_load_dwordx2 v[202:203], v8, s[24:27], 0 offen offset:256 sc1
    buffer_load_dwordx2 v[204:205], v8, s[24:27], 0 offen offset:512 sc1
    buffer_load_dwordx2 v[206:207], v8, s[24:27], 0 offen offset:768 sc1
    buffer_load_dwordx2 v[208:209], v8, s[24:27], 0 offen offset:1024 sc1
    buffer_load_dwordx2 v[210:211], v8, s[24:27], 0 offen offset:1280 sc1
    buffer_load_dwordx2 v[212:213], v8, s[24:27], 0 offen offset:1536 sc1
    buffer_load_dwordx2 v[214:215], v8, s[24:27], 0 offen offset:1792 sc1
    buffer_load_dwordx2 v[216:217], v8, s[24:27], 0 offen offset:2048 sc1
    buffer_load_dwordx2 v[218:219], v8, s[24:27], 0 offen offset:2304 sc1
    buffer_load_dwordx2 v[220:221], v8, s[24:27], 0 offen offset:2560 sc1
    buffer_load_dwordx2 v[222:223], v8, s[24:27], 0 offen offset:2816 sc1
    v_cmp_gt_u32 s[46:47], 2, v4
    v_lshl_add_u32 v12, v4, 2, 0
    v_cmp_le_u32 s[48:49], v12, v3
    v_lshl_add_u32 v12, v4, 2, 1
    v_cmp_le_u32 s[50:51], v12, v3
    v_lshl_add_u32 v12, v4, 2, 2
    v_cmp_le_u32 s[52:53], v12, v3
    v_lshl_add_u32 v12, v4, 2, 3
    v_cmp_le_u32 s[54:55], v12, v3
    s_mov_b32 s56, 0.07216878364870322
    v_mov_b32 v13, 0xce6e6b28
    v_mov_b32 v224, 0
    v_mov_b32 v225, 0
    v_mov_b32 v226, 0
    v_mov_b32 v227, 0
    v_mov_b32 v228, 0
    v_mov_b32 v229, 0
    v_mov_b32 v230, 0
    v_mov_b32 v231, 0
    v_mov_b32 v232, 0
    v_mov_b32 v233, 0
    v_mov_b32 v234, 0
    v_mov_b32 v235, 0
    v_mov_b32 v236, 0
    v_mov_b32 v237, 0
    v_mov_b32 v238, 0
    v_mov_b32 v239, 0
    v_mov_b32 v240, 0
    v_mov_b32 v241, 0
    v_mov_b32 v242, 0
    v_mov_b32 v243, 0
    v_mov_b32 v244, 0
    v_mov_b32 v245, 0
    v_mov_b32 v246, 0
    v_mov_b32 v247, 0
    s_waitcnt vmcnt(24)
    v_mfma_f32_16x16x32_bf16 v[224:227], v[128:131], v[32:35], v[224:227]
    v_mfma_f32_16x16x32_bf16 v[228:231], v[80:83], v[32:35], v[228:231]
    v_mfma_f32_16x16x32_bf16 v[224:227], v[132:135], v[36:39], v[224:227]
    v_mfma_f32_16x16x32_bf16 v[228:231], v[84:87], v[36:39], v[228:231]
    v_mfma_f32_16x16x32_bf16 v[224:227], v[136:139], v[40:43], v[224:227]
    v_mfma_f32_16x16x32_bf16 v[228:231], v[88:91], v[40:43], v[228:231]
    v_mfma_f32_16x16x32_bf16 v[224:227], v[140:143], v[44:47], v[224:227]
    v_mfma_f32_16x16x32_bf16 v[228:231], v[92:95], v[44:47], v[228:231]
    v_mfma_f32_16x16x32_bf16 v[224:227], v[144:147], v[48:51], v[224:227]
    v_mfma_f32_16x16x32_bf16 v[228:231], v[96:99], v[48:51], v[228:231]
    v_mfma_f32_16x16x32_bf16 v[224:227], v[148:151], v[52:55], v[224:227]
    v_mfma_f32_16x16x32_bf16 v[228:231], v[100:103], v[52:55], v[228:231]
    v_mfma_f32_16x16x32_bf16 v[236:239], v[128:131], v[56:59], v[236:239]
    v_mfma_f32_16x16x32_bf16 v[240:243], v[80:83], v[56:59], v[240:243]
    v_mfma_f32_16x16x32_bf16 v[244:247], v[104:107], v[56:59], v[244:247]
    v_mfma_f32_16x16x32_bf16 v[236:239], v[132:135], v[60:63], v[236:239]
    v_mfma_f32_16x16x32_bf16 v[240:243], v[84:87], v[60:63], v[240:243]
    v_mfma_f32_16x16x32_bf16 v[244:247], v[108:111], v[60:63], v[244:247]
    v_mfma_f32_16x16x32_bf16 v[236:239], v[136:139], v[64:67], v[236:239]
    v_mfma_f32_16x16x32_bf16 v[240:243], v[88:91], v[64:67], v[240:243]
    v_mfma_f32_16x16x32_bf16 v[244:247], v[112:115], v[64:67], v[244:247]
    v_mfma_f32_16x16x32_bf16 v[236:239], v[140:143], v[68:71], v[236:239]
    v_mfma_f32_16x16x32_bf16 v[240:243], v[92:95], v[68:71], v[240:243]
    v_mfma_f32_16x16x32_bf16 v[244:247], v[116:119], v[68:71], v[244:247]
    v_mfma_f32_16x16x32_bf16 v[236:239], v[144:147], v[72:75], v[236:239]
    v_mfma_f32_16x16x32_bf16 v[240:243], v[96:99], v[72:75], v[240:243]
    v_mfma_f32_16x16x32_bf16 v[244:247], v[120:123], v[72:75], v[244:247]
    v_mfma_f32_16x16x32_bf16 v[236:239], v[148:151], v[76:79], v[236:239]
    v_mfma_f32_16x16x32_bf16 v[240:243], v[100:103], v[76:79], v[240:243]
    v_mfma_f32_16x16x32_bf16 v[244:247], v[124:127], v[76:79], v[244:247]
    s_nop 7
    s_nop 1
    v_cvt_pk_bf16_f32 v224, v224, v225
    v_cvt_pk_bf16_f32 v226, v226, v227
    v_cvt_pk_bf16_f32 v228, v228, v229
    v_cvt_pk_bf16_f32 v230, v230, v231
    v_and_b32 v225, 0xffff0000, v224
    v_and_b32 v227, 0xffff0000, v226
    v_and_b32 v229, 0xffff0000, v228
    v_and_b32 v231, 0xffff0000, v230
    v_lshlrev_b32 v224, 16, v224
    v_lshlrev_b32 v226, 16, v226
    v_lshlrev_b32 v228, 16, v228
    v_lshlrev_b32 v230, 16, v230
    v_mul_f32 v224, s56, v224
    v_mul_f32 v225, s56, v225
    v_mul_f32 v226, s56, v226
    v_mul_f32 v227, s56, v227
    v_mul_f32 v228, s56, v228
    v_mul_f32 v229, s56, v229
    v_mul_f32 v230, s56, v230
    v_mul_f32 v231, s56, v231
    v_cvt_pk_bf16_f32 v224, v224, v225
    v_cvt_pk_bf16_f32 v226, v226, v227
    v_cvt_pk_bf16_f32 v228, v228, v229
    v_cvt_pk_bf16_f32 v230, v230, v231
    v_and_b32 v225, 0xffff0000, v224
    v_and_b32 v227, 0xffff0000, v226
    v_and_b32 v229, 0xffff0000, v228
    v_and_b32 v231, 0xffff0000, v230
    v_lshlrev_b32 v224, 16, v224
    v_lshlrev_b32 v226, 16, v226
    v_lshlrev_b32 v228, 16, v228
    v_lshlrev_b32 v230, 16, v230
    v_cndmask_b32 v224, v13, v224, s[46:47]
    v_cndmask_b32 v225, v13, v225, s[46:47]
    v_cndmask_b32 v226, v13, v226, s[46:47]
    v_cndmask_b32 v227, v13, v227, s[46:47]
    v_cndmask_b32 v228, v13, v228, s[48:49]
    v_cndmask_b32 v229, v13, v229, s[50:51]
    v_cndmask_b32 v230, v13, v230, s[52:53]
    v_cndmask_b32 v231, v13, v231, s[54:55]
    v_max3_f32 v14, v224, v225, v226
    v_max3_f32 v15, v227, v228, v229
    v_max3_f32 v14, v14, v230, v231
    v_max_f32 v15, v15, v14
    v_mov_b32 v14, v15
    s_nop 1
    v_permlane32_swap_b32 v15, v14
    s_nop 1
    v_max_f32 v15, v15, v14
    v_mov_b32 v14, v15
    s_nop 1
    v_permlane16_swap_b32 v15, v14
    s_nop 1
    v_max_f32 v15, v15, v14
    v_mul_f32 v15, -1.4426950408889634, v15
    v_mov_b32 v14, 1.4426950408889634
    v_fma_f32 v224, v224, v14, v15
    v_fma_f32 v225, v225, v14, v15
    v_fma_f32 v226, v226, v14, v15
    v_fma_f32 v227, v227, v14, v15
    v_fma_f32 v228, v228, v14, v15
    v_fma_f32 v229, v229, v14, v15
    v_fma_f32 v230, v230, v14, v15
    v_fma_f32 v231, v231, v14, v15
    v_exp_f32 v224, v224
    v_exp_f32 v225, v225
    v_exp_f32 v226, v226
    v_exp_f32 v227, v227
    v_exp_f32 v228, v228
    v_exp_f32 v229, v229
    v_exp_f32 v230, v230
    v_exp_f32 v231, v231
    s_nop 0
    v_add_f32 v15, v224, v225
    v_add_f32 v14, v226, v227
    v_add_f32 v15, v15, v228
    v_add_f32 v14, v14, v229
    v_add_f32 v15, v15, v230
    v_add_f32 v14, v14, v231
    v_add_f32 v15, v15, v14
    v_mov_b32 v14, v15
    s_nop 1
    v_permlane32_swap_b32 v15, v14
    s_nop 1
    v_add_f32 v15, v15, v14
    v_mov_b32 v14, v15
    s_nop 1
    v_permlane16_swap_b32 v15, v14
    s_nop 1
    v_add_f32 v15, v15, v14
    v_rcp_f32 v15, v15
    s_nop 0
    v_mul_f32 v224, v224, v15
    v_mul_f32 v225, v225, v15
    v_mul_f32 v226, v226, v15
    v_mul_f32 v227, v227, v15
    v_mul_f32 v228, v228, v15
    v_mul_f32 v229, v229, v15
    v_mul_f32 v230, v230, v15
    v_mul_f32 v231, v231, v15
    v_cvt_pk_bf16_f32 v80, v228, v229
    v_cvt_pk_bf16_f32 v81, v230, v231
    v_mov_b32 v82, 0
    v_mov_b32 v83, 0
    v_cvt_pk_bf16_f32 v84, v224, v225
    v_cvt_pk_bf16_f32 v85, v226, v227
    v_cvt_pk_bf16_f32 v236, v236, v237
    v_cvt_pk_bf16_f32 v238, v238, v239
    v_cvt_pk_bf16_f32 v240, v240, v241
    v_cvt_pk_bf16_f32 v242, v242, v243
    v_cvt_pk_bf16_f32 v244, v244, v245
    v_cvt_pk_bf16_f32 v246, v246, v247
    v_and_b32 v237, 0xffff0000, v236
    v_and_b32 v239, 0xffff0000, v238
    v_and_b32 v241, 0xffff0000, v240
    v_and_b32 v243, 0xffff0000, v242
    v_and_b32 v245, 0xffff0000, v244
    v_and_b32 v247, 0xffff0000, v246
    v_lshlrev_b32 v236, 16, v236
    v_lshlrev_b32 v238, 16, v238
    v_lshlrev_b32 v240, 16, v240
    v_lshlrev_b32 v242, 16, v242
    v_lshlrev_b32 v244, 16, v244
    v_lshlrev_b32 v246, 16, v246
    v_mul_f32 v236, s56, v236
    v_mul_f32 v237, s56, v237
    v_mul_f32 v238, s56, v238
    v_mul_f32 v239, s56, v239
    v_mul_f32 v240, s56, v240
    v_mul_f32 v241, s56, v241
    v_mul_f32 v242, s56, v242
    v_mul_f32 v243, s56, v243
    v_mul_f32 v244, s56, v244
    v_mul_f32 v245, s56, v245
    v_mul_f32 v246, s56, v246
    v_mul_f32 v247, s56, v247
    v_cvt_pk_bf16_f32 v236, v236, v237
    v_cvt_pk_bf16_f32 v238, v238, v239
    v_cvt_pk_bf16_f32 v240, v240, v241
    v_cvt_pk_bf16_f32 v242, v242, v243
    v_cvt_pk_bf16_f32 v244, v244, v245
    v_cvt_pk_bf16_f32 v246, v246, v247
    v_and_b32 v237, 0xffff0000, v236
    v_and_b32 v239, 0xffff0000, v238
    v_and_b32 v241, 0xffff0000, v240
    v_and_b32 v243, 0xffff0000, v242
    v_and_b32 v245, 0xffff0000, v244
    v_and_b32 v247, 0xffff0000, v246
    v_lshlrev_b32 v236, 16, v236
    v_lshlrev_b32 v238, 16, v238
    v_lshlrev_b32 v240, 16, v240
    v_lshlrev_b32 v242, 16, v242
    v_lshlrev_b32 v244, 16, v244
    v_lshlrev_b32 v246, 16, v246
    v_cndmask_b32 v236, v13, v236, s[46:47]
    v_cndmask_b32 v237, v13, v237, s[46:47]
    v_cndmask_b32 v238, v13, v238, s[46:47]
    v_cndmask_b32 v239, v13, v239, s[46:47]
    v_cndmask_b32 v244, v13, v244, s[48:49]
    v_cndmask_b32 v245, v13, v245, s[50:51]
    v_cndmask_b32 v246, v13, v246, s[52:53]
    v_cndmask_b32 v247, v13, v247, s[54:55]
    v_max3_f32 v14, v236, v237, v238
    v_max3_f32 v15, v239, v240, v241
    v_max3_f32 v14, v14, v242, v243
    v_max3_f32 v15, v15, v244, v245
    v_max3_f32 v14, v14, v246, v247
    v_max_f32 v15, v15, v14
    v_mov_b32 v14, v15
    s_nop 1
    v_permlane32_swap_b32 v15, v14
    s_nop 1
    v_max_f32 v15, v15, v14
    v_mov_b32 v14, v15
    s_nop 1
    v_permlane16_swap_b32 v15, v14
    s_nop 1
    v_max_f32 v15, v15, v14
    v_mul_f32 v15, -1.4426950408889634, v15
    v_mov_b32 v14, 1.4426950408889634
    v_fma_f32 v236, v236, v14, v15
    v_fma_f32 v237, v237, v14, v15
    v_fma_f32 v238, v238, v14, v15
    v_fma_f32 v239, v239, v14, v15
    v_fma_f32 v240, v240, v14, v15
    v_fma_f32 v241, v241, v14, v15
    v_fma_f32 v242, v242, v14, v15
    v_fma_f32 v243, v243, v14, v15
    v_fma_f32 v244, v244, v14, v15
    v_fma_f32 v245, v245, v14, v15
    v_fma_f32 v246, v246, v14, v15
    v_fma_f32 v247, v247, v14, v15
    v_exp_f32 v236, v236
    v_exp_f32 v237, v237
    v_exp_f32 v238, v238
    v_exp_f32 v239, v239
    v_exp_f32 v240, v240
    v_exp_f32 v241, v241
    v_exp_f32 v242, v242
    v_exp_f32 v243, v243
    v_exp_f32 v244, v244
    v_exp_f32 v245, v245
    v_exp_f32 v246, v246
    v_exp_f32 v247, v247
    s_nop 0
    v_add_f32 v15, v236, v237
    v_add_f32 v14, v238, v239
    v_add_f32 v15, v15, v240
    v_add_f32 v14, v14, v241
    v_add_f32 v15, v15, v242
    v_add_f32 v14, v14, v243
    v_add_f32 v15, v15, v244
    v_add_f32 v14, v14, v245
    v_add_f32 v15, v15, v246
    v_add_f32 v14, v14, v247
    v_add_f32 v15, v15, v14
    v_mov_b32 v14, v15
    s_nop 1
    v_permlane32_swap_b32 v15, v14
    s_nop 1
    v_add_f32 v15, v15, v14
    v_mov_b32 v14, v15
    s_nop 1
    v_permlane16_swap_b32 v15, v14
    s_nop 1
    v_add_f32 v15, v15, v14
    v_rcp_f32 v15, v15
    s_nop 0
    v_mul_f32 v236, v236, v15
    v_mul_f32 v237, v237, v15
    v_mul_f32 v238, v238, v15
    v_mul_f32 v239, v239, v15
    v_mul_f32 v240, v240, v15
    v_mul_f32 v241, v241, v15
    v_mul_f32 v242, v242, v15
    v_mul_f32 v243, v243, v15
    v_mul_f32 v244, v244, v15
    v_mul_f32 v245, v245, v15
    v_mul_f32 v246, v246, v15
    v_mul_f32 v247, v247, v15
    v_cvt_pk_bf16_f32 v86, v240, v241
    v_cvt_pk_bf16_f32 v87, v242, v243
    v_cvt_pk_bf16_f32 v88, v244, v245
    v_cvt_pk_bf16_f32 v89, v246, v247
    v_cvt_pk_bf16_f32 v90, v236, v237
    v_cvt_pk_bf16_f32 v91, v238, v239
    s_waitcnt vmcnt(0)
    v_lshlrev_b32 v16, 3, v4
    v_sub_u32 v17, v5, v16
    v_sub_u32 v18, v6, v16
    v_mov_b32 v32, 0
    v_mov_b32 v33, 0
    v_mov_b32 v34, 0
    v_mov_b32 v35, 0
    v_mov_b32 v36, 0
    v_mov_b32 v37, 0
    v_mov_b32 v38, 0
    v_mov_b32 v39, 0
    v_mov_b32 v40, 0
    v_mov_b32 v41, 0
    v_mov_b32 v42, 0
    v_mov_b32 v43, 0
    v_mov_b32 v44, 0
    v_mov_b32 v45, 0
    v_mov_b32 v46, 0
    v_mov_b32 v47, 0
    v_mov_b32 v48, 0
    v_mov_b32 v49, 0
    v_mov_b32 v50, 0
    v_mov_b32 v51, 0
    v_mov_b32 v52, 0
    v_mov_b32 v53, 0
    v_mov_b32 v54, 0
    v_mov_b32 v55, 0
    v_mov_b32 v56, 0
    v_mov_b32 v57, 0
    v_mov_b32 v58, 0
    v_mov_b32 v59, 0
    v_mov_b32 v60, 0
    v_mov_b32 v61, 0
    v_mov_b32 v62, 0
    v_mov_b32 v63, 0
    v_mov_b32 v64, 0
    v_mov_b32 v65, 0
    v_mov_b32 v66, 0
    v_mov_b32 v67, 0
    v_mov_b32 v68, 0
    v_mov_b32 v69, 0
    v_mov_b32 v70, 0
    v_mov_b32 v71, 0
    v_mov_b32 v72, 0
    v_mov_b32 v73, 0
    v_mov_b32 v74, 0
    v_mov_b32 v75, 0
    v_mov_b32 v76, 0
    v_mov_b32 v77, 0
    v_mov_b32 v78, 0
    v_mov_b32 v79, 0
    s_nop 1
    v_mfma_f32_16x16x32_bf16 v[32:35], v[152:155], v[80:83], v[32:35]
    v_mfma_f32_16x16x32_bf16 v[36:39], v[156:159], v[80:83], v[36:39]
    v_mfma_f32_16x16x32_bf16 v[40:43], v[160:163], v[80:83], v[40:43]
    v_mfma_f32_16x16x32_bf16 v[44:47], v[164:167], v[80:83], v[44:47]
    v_mfma_f32_16x16x32_bf16 v[48:51], v[168:171], v[80:83], v[48:51]
    v_mfma_f32_16x16x32_bf16 v[52:55], v[172:175], v[80:83], v[52:55]
    v_mfma_f32_16x16x32_bf16 v[56:59], v[176:179], v[80:83], v[56:59]
    v_mfma_f32_16x16x32_bf16 v[60:63], v[180:183], v[80:83], v[60:63]
    v_mfma_f32_16x16x32_bf16 v[64:67], v[184:187], v[80:83], v[64:67]
    v_mfma_f32_16x16x32_bf16 v[68:71], v[188:191], v[80:83], v[68:71]
    v_mfma_f32_16x16x32_bf16 v[72:75], v[192:195], v[80:83], v[72:75]
    v_mfma_f32_16x16x32_bf16 v[76:79], v[196:199], v[80:83], v[76:79]
    v_mfma_f32_16x16x16_bf16 v[32:35], v[200:201], v[84:85], v[32:35]
    v_mfma_f32_16x16x16_bf16 v[36:39], v[202:203], v[84:85], v[36:39]
    v_mfma_f32_16x16x16_bf16 v[40:43], v[204:205], v[84:85], v[40:43]
    v_mfma_f32_16x16x16_bf16 v[44:47], v[206:207], v[84:85], v[44:47]
    v_mfma_f32_16x16x16_bf16 v[48:51], v[208:209], v[84:85], v[48:51]
    v_mfma_f32_16x16x16_bf16 v[52:55], v[210:211], v[84:85], v[52:55]
    v_mfma_f32_16x16x16_bf16 v[56:59], v[212:213], v[84:85], v[56:59]
    v_mfma_f32_16x16x16_bf16 v[60:63], v[214:215], v[84:85], v[60:63]
    v_mfma_f32_16x16x16_bf16 v[64:67], v[216:217], v[84:85], v[64:67]
    v_mfma_f32_16x16x16_bf16 v[68:71], v[218:219], v[84:85], v[68:71]
    v_mfma_f32_16x16x16_bf16 v[72:75], v[220:221], v[84:85], v[72:75]
    v_mfma_f32_16x16x16_bf16 v[76:79], v[222:223], v[84:85], v[76:79]
    s_nop 7
    s_nop 1
    v_cvt_pk_bf16_f32 v24, v32, v33
    v_cvt_pk_bf16_f32 v25, v34, v35
    buffer_store_dwordx2 v[24:25], v17, s[28:31], 0 offen offset:0 sc1
    v_cvt_pk_bf16_f32 v26, v36, v37
    v_cvt_pk_bf16_f32 v27, v38, v39
    buffer_store_dwordx2 v[26:27], v17, s[28:31], 0 offen offset:32 sc1
    v_cvt_pk_bf16_f32 v28, v40, v41
    v_cvt_pk_bf16_f32 v29, v42, v43
    buffer_store_dwordx2 v[28:29], v17, s[28:31], 0 offen offset:64 sc1
    v_cvt_pk_bf16_f32 v30, v44, v45
    v_cvt_pk_bf16_f32 v31, v46, v47
    buffer_store_dwordx2 v[30:31], v17, s[28:31], 0 offen offset:96 sc1
    v_cvt_pk_bf16_f32 v24, v48, v49
    v_cvt_pk_bf16_f32 v25, v50, v51
    buffer_store_dwordx2 v[24:25], v17, s[28:31], 0 offen offset:128 sc1
    v_cvt_pk_bf16_f32 v26, v52, v53
    v_cvt_pk_bf16_f32 v27, v54, v55
    buffer_store_dwordx2 v[26:27], v17, s[28:31], 0 offen offset:160 sc1
    v_cvt_pk_bf16_f32 v28, v56, v57
    v_cvt_pk_bf16_f32 v29, v58, v59
    buffer_store_dwordx2 v[28:29], v17, s[28:31], 0 offen offset:192 sc1
    v_cvt_pk_bf16_f32 v30, v60, v61
    v_cvt_pk_bf16_f32 v31, v62, v63
    buffer_store_dwordx2 v[30:31], v17, s[28:31], 0 offen offset:224 sc1
    v_cvt_pk_bf16_f32 v24, v64, v65
    v_cvt_pk_bf16_f32 v25, v66, v67
    buffer_store_dwordx2 v[24:25], v17, s[28:31], 0 offen offset:256 sc1
    v_cvt_pk_bf16_f32 v26, v68, v69
    v_cvt_pk_bf16_f32 v27, v70, v71
    buffer_store_dwordx2 v[26:27], v17, s[28:31], 0 offen offset:288 sc1
    v_cvt_pk_bf16_f32 v28, v72, v73
    v_cvt_pk_bf16_f32 v29, v74, v75
    buffer_store_dwordx2 v[28:29], v17, s[28:31], 0 offen offset:320 sc1
    v_cvt_pk_bf16_f32 v30, v76, v77
    v_cvt_pk_bf16_f32 v31, v78, v79
    buffer_store_dwordx2 v[30:31], v17, s[28:31], 0 offen offset:352 sc1
    s_nop 1
    v_mov_b32 v32, 0
    v_mov_b32 v33, 0
    v_mov_b32 v34, 0
    v_mov_b32 v35, 0
    v_mov_b32 v36, 0
    v_mov_b32 v37, 0
    v_mov_b32 v38, 0
    v_mov_b32 v39, 0
    v_mov_b32 v40, 0
    v_mov_b32 v41, 0
    v_mov_b32 v42, 0
    v_mov_b32 v43, 0
    v_mov_b32 v44, 0
    v_mov_b32 v45, 0
    v_mov_b32 v46, 0
    v_mov_b32 v47, 0
    v_mov_b32 v48, 0
    v_mov_b32 v49, 0
    v_mov_b32 v50, 0
    v_mov_b32 v51, 0
    v_mov_b32 v52, 0
    v_mov_b32 v53, 0
    v_mov_b32 v54, 0
    v_mov_b32 v55, 0
    v_mov_b32 v56, 0
    v_mov_b32 v57, 0
    v_mov_b32 v58, 0
    v_mov_b32 v59, 0
    v_mov_b32 v60, 0
    v_mov_b32 v61, 0
    v_mov_b32 v62, 0
    v_mov_b32 v63, 0
    v_mov_b32 v64, 0
    v_mov_b32 v65, 0
    v_mov_b32 v66, 0
    v_mov_b32 v67, 0
    v_mov_b32 v68, 0
    v_mov_b32 v69, 0
    v_mov_b32 v70, 0
    v_mov_b32 v71, 0
    v_mov_b32 v72, 0
    v_mov_b32 v73, 0
    v_mov_b32 v74, 0
    v_mov_b32 v75, 0
    v_mov_b32 v76, 0
    v_mov_b32 v77, 0
    v_mov_b32 v78, 0
    v_mov_b32 v79, 0
    s_nop 1
    v_mfma_f32_16x16x32_bf16 v[32:35], v[152:155], v[86:89], v[32:35]
    v_mfma_f32_16x16x32_bf16 v[36:39], v[156:159], v[86:89], v[36:39]
    v_mfma_f32_16x16x32_bf16 v[40:43], v[160:163], v[86:89], v[40:43]
    v_mfma_f32_16x16x32_bf16 v[44:47], v[164:167], v[86:89], v[44:47]
    v_mfma_f32_16x16x32_bf16 v[48:51], v[168:171], v[86:89], v[48:51]
    v_mfma_f32_16x16x32_bf16 v[52:55], v[172:175], v[86:89], v[52:55]
    v_mfma_f32_16x16x32_bf16 v[56:59], v[176:179], v[86:89], v[56:59]
    v_mfma_f32_16x16x32_bf16 v[60:63], v[180:183], v[86:89], v[60:63]
    v_mfma_f32_16x16x32_bf16 v[64:67], v[184:187], v[86:89], v[64:67]
    v_mfma_f32_16x16x32_bf16 v[68:71], v[188:191], v[86:89], v[68:71]
    v_mfma_f32_16x16x32_bf16 v[72:75], v[192:195], v[86:89], v[72:75]
    v_mfma_f32_16x16x32_bf16 v[76:79], v[196:199], v[86:89], v[76:79]
    v_mfma_f32_16x16x16_bf16 v[32:35], v[200:201], v[90:91], v[32:35]
    v_mfma_f32_16x16x16_bf16 v[36:39], v[202:203], v[90:91], v[36:39]
    v_mfma_f32_16x16x16_bf16 v[40:43], v[204:205], v[90:91], v[40:43]
    v_mfma_f32_16x16x16_bf16 v[44:47], v[206:207], v[90:91], v[44:47]
    v_mfma_f32_16x16x16_bf16 v[48:51], v[208:209], v[90:91], v[48:51]
    v_mfma_f32_16x16x16_bf16 v[52:55], v[210:211], v[90:91], v[52:55]
    v_mfma_f32_16x16x16_bf16 v[56:59], v[212:213], v[90:91], v[56:59]
    v_mfma_f32_16x16x16_bf16 v[60:63], v[214:215], v[90:91], v[60:63]
    v_mfma_f32_16x16x16_bf16 v[64:67], v[216:217], v[90:91], v[64:67]
    v_mfma_f32_16x16x16_bf16 v[68:71], v[218:219], v[90:91], v[68:71]
    v_mfma_f32_16x16x16_bf16 v[72:75], v[220:221], v[90:91], v[72:75]
    v_mfma_f32_16x16x16_bf16 v[76:79], v[222:223], v[90:91], v[76:79]
    s_nop 7
    s_nop 1
    v_cvt_pk_bf16_f32 v24, v32, v33
    v_cvt_pk_bf16_f32 v25, v34, v35
    buffer_store_dwordx2 v[24:25], v18, s[28:31], 0 offen offset:0 sc1
    v_cvt_pk_bf16_f32 v26, v36, v37
    v_cvt_pk_bf16_f32 v27, v38, v39
    buffer_store_dwordx2 v[26:27], v18, s[28:31], 0 offen offset:32 sc1
    v_cvt_pk_bf16_f32 v28, v40, v41
    v_cvt_pk_bf16_f32 v29, v42, v43
    buffer_store_dwordx2 v[28:29], v18, s[28:31], 0 offen offset:64 sc1
    v_cvt_pk_bf16_f32 v30, v44, v45
    v_cvt_pk_bf16_f32 v31, v46, v47
    buffer_store_dwordx2 v[30:31], v18, s[28:31], 0 offen offset:96 sc1
    v_cvt_pk_bf16_f32 v24, v48, v49
    v_cvt_pk_bf16_f32 v25, v50, v51
    buffer_store_dwordx2 v[24:25], v18, s[28:31], 0 offen offset:128 sc1
    v_cvt_pk_bf16_f32 v26, v52, v53
    v_cvt_pk_bf16_f32 v27, v54, v55
    buffer_store_dwordx2 v[26:27], v18, s[28:31], 0 offen offset:160 sc1
    v_cvt_pk_bf16_f32 v28, v56, v57
    v_cvt_pk_bf16_f32 v29, v58, v59
    buffer_store_dwordx2 v[28:29], v18, s[28:31], 0 offen offset:192 sc1
    v_cvt_pk_bf16_f32 v30, v60, v61
    v_cvt_pk_bf16_f32 v31, v62, v63
    buffer_store_dwordx2 v[30:31], v18, s[28:31], 0 offen offset:224 sc1
    v_cvt_pk_bf16_f32 v24, v64, v65
    v_cvt_pk_bf16_f32 v25, v66, v67
    buffer_store_dwordx2 v[24:25], v18, s[28:31], 0 offen offset:256 sc1
    v_cvt_pk_bf16_f32 v26, v68, v69
    v_cvt_pk_bf16_f32 v27, v70, v71
    buffer_store_dwordx2 v[26:27], v18, s[28:31], 0 offen offset:288 sc1
    v_cvt_pk_bf16_f32 v28, v72, v73
    v_cvt_pk_bf16_f32 v29, v74, v75
    buffer_store_dwordx2 v[28:29], v18, s[28:31], 0 offen offset:320 sc1
    v_cvt_pk_bf16_f32 v30, v76, v77
    v_cvt_pk_bf16_f32 v31, v78, v79
    buffer_store_dwordx2 v[30:31], v18, s[28:31], 0 offen offset:352 sc1
    s_nop 1
    s_mov_b32 s44, s80
    s_waitcnt vmcnt(0)
    s_barrier
    s_cmp_lg_u32 s44, 0
    s_cbranch_scc1 L_w_nsa
    s_lshl_b32 s66, s82, 2
    s_add_u32 s66, s66, 128
    v_mov_b32 v24, s66
    v_mov_b32 v25, 1
    s_mov_b64 exec, 1
    buffer_atomic_add v25, v24, s[92:95], 0 offen sc1
    s_mov_b64 exec, -1
L_w_nsa:
    s_add_u32 s91, s91, 127
    s_branch L_w_a
L_w_o:
    s_sub_u32 s83, s83, 32
    s_mov_b32 s60, 0x33333334
    s_mul_hi_u32 s42, s83, s60
    s_mul_i32 s61, s42, 5
    s_sub_u32 s40, s83, s61
    s_mov_b32 s41, s82
    s_cmp_lg_u32 s80, 0
    s_cbranch_scc1 L_w_oko
    s_lshl_b32 s66, s82, 2
    s_add_u32 s66, s66, 128
    v_mov_b32 v24, s66
    s_mov_b32 s74, 0
L_w_wto:
    buffer_load_dword v25, v24, s[92:95], 0 offen sc1
    s_waitcnt vmcnt(0)
    v_readfirstlane_b32 s66, v25
    s_add_u32 s74, s74, 1
    s_cmp_ge_u32 s74, 1048576
    s_cbranch_scc1 L_ch_done
    s_cmp_ge_u32 s66, 32
    s_cbranch_scc1 L_w_oko
    s_sleep 32
    s_branch L_w_wto
L_w_oko:
    s_barrier
    s_mov_b32 s6, s78
    s_mov_b32 s7, s79
    s_lshr_b32 s45, s44, 1
    s_and_b32 s46, s44, 1
    s_add_u32 s12, s4, 0x5300000
    s_addc_u32 s13, s5, 0
    s_mov_b32 s14, 0x1800000
    s_mov_b32 s15, 0x20000
    s_mov_b32 s16, s6
    s_mov_b32 s17, s7
    s_mov_b32 s18, 0x780000
    s_mov_b32 s19, 0x20000
    s_mov_b32 s47, s40
    v_lshrrev_b32 v3, 2, v2
    v_and_b32 v4, 3, v2
    v_lshrrev_b32 v5, 3, v3
    v_lshlrev_b32 v5, 1, v5
    v_xor_b32 v4, v4, v5
    s_mul_i32 s48, s41, 128
    s_mul_i32 s49, s44, 32
    s_add_u32 s48, s48, s49
    v_add_u32 v3, s48, v3
    s_mov_b32 s60, 12288
    v_mul_lo_u32 v3, v3, s60
    v_lshl_add_u32 v6, v4, 4, v3
    v_add_u32 v7, 0x30000, v6
    s_mul_i32 s50, s44, 2
    s_lshr_b32 s51, s50, 3
    s_and_b32 s52, s50, 7
    v_lshrrev_b32 v3, 4, v2
    s_add_u32 s53, s52, 0
    s_mul_i32 s53, s53, 4
    v_add_u32 v3, s53, v3
    v_and_b32 v4, 15, v2
    v_and_b32 v5, 3, v3
    v_lshrrev_b32 v30, 3, v3
    v_and_b32 v30, 1, v30
    v_lshl_or_b32 v5, v30, 2, v5
    v_lshlrev_b32 v5, 1, v5
    v_xor_b32 v4, v4, v5
    s_mov_b32 s60, 1280
    v_mul_lo_u32 v3, v3, s60
    v_lshl_add_u32 v3, v4, 4, v3
    s_mul_i32 s53, s47, 256
    v_add_u32 v8, s53, v3
    v_lshrrev_b32 v3, 4, v2
    s_add_u32 s53, s52, 1
    s_mul_i32 s53, s53, 4
    v_add_u32 v3, s53, v3
    v_and_b32 v4, 15, v2
    v_and_b32 v5, 3, v3
    v_lshrrev_b32 v30, 3, v3
    v_and_b32 v30, 1, v30
    v_lshl_or_b32 v5, v30, 2, v5
    v_lshlrev_b32 v5, 1, v5
    v_xor_b32 v4, v4, v5
    s_mov_b32 s60, 1280
    v_mul_lo_u32 v3, v3, s60
    v_lshl_add_u32 v3, v4, 4, v3
    s_mul_i32 s53, s47, 256
    v_add_u32 v9, s53, v3
    v_and_b32 v3, 15, v2
    v_lshrrev_b32 v4, 4, v2
    v_lshrrev_b32 v5, 3, v3
    v_lshlrev_b32 v5, 1, v5
    v_xor_b32 v5, v4, v5
    s_mul_i32 s53, s45, 64
    v_add_u32 v30, s53, v3
    v_lshlrev_b32 v30, 6, v30
    v_lshl_add_u32 v10, v5, 4, v30
    v_lshrrev_b32 v5, 2, v3
    v_and_b32 v30, 3, v2
    v_lshl_add_u32 v31, v4, 3, v5
    v_mul_u32_u24 v31, 256, v31
    v_lshl_add_u32 v31, v30, 3, v31
    v_add_u32 v31, 8192, v31
    v_and_b32 v30, 1, v4
    v_lshl_or_b32 v5, v30, 2, v5
    v_xor_b32 v30, 0, v5
    v_lshl_add_u32 v11, v30, 5, v31
    v_xor_b32 v30, 1, v5
    v_lshl_add_u32 v12, v30, 5, v31
    v_xor_b32 v30, 2, v5
    v_lshl_add_u32 v13, v30, 5, v31
    v_xor_b32 v30, 3, v5
    v_lshl_add_u32 v14, v30, 5, v31
    v_xor_b32 v30, 4, v5
    v_lshl_add_u32 v15, v30, 5, v31
    v_xor_b32 v30, 5, v5
    v_lshl_add_u32 v16, v30, 5, v31
    v_xor_b32 v30, 6, v5
    v_lshl_add_u32 v17, v30, 5, v31
    v_xor_b32 v30, 7, v5
    v_lshl_add_u32 v18, v30, 5, v31
    s_mul_i32 s53, s46, 4
    s_add_u32 s54, s53, 0
    v_xor_b32 v30, s54, v5
    v_lshl_add_u32 v11, v30, 5, v31
    s_add_u32 s54, s53, 1
    v_xor_b32 v30, s54, v5
    v_lshl_add_u32 v12, v30, 5, v31
    s_add_u32 s54, s53, 2
    v_xor_b32 v30, s54, v5
    v_lshl_add_u32 v13, v30, 5, v31
    s_add_u32 s54, s53, 3
    v_xor_b32 v30, s54, v5
    v_lshl_add_u32 v14, v30, 5, v31
    v_mov_b32 v60, 0
    v_mov_b32 v61, 0
    v_mov_b32 v62, 0
    v_mov_b32 v63, 0
    v_mov_b32 v64, 0
    v_mov_b32 v65, 0
    v_mov_b32 v66, 0
    v_mov_b32 v67, 0
    v_mov_b32 v68, 0
    v_mov_b32 v69, 0
    v_mov_b32 v70, 0
    v_mov_b32 v71, 0
    v_mov_b32 v72, 0
    v_mov_b32 v73, 0
    v_mov_b32 v74, 0
    v_mov_b32 v75, 0
    v_mov_b32 v76, 0
    v_mov_b32 v77, 0
    v_mov_b32 v78, 0
    v_mov_b32 v79, 0
    v_mov_b32 v80, 0
    v_mov_b32 v81, 0
    v_mov_b32 v82, 0
    v_mov_b32 v83, 0
    v_mov_b32 v84, 0
    v_mov_b32 v85, 0
    v_mov_b32 v86, 0
    v_mov_b32 v87, 0
    v_mov_b32 v88, 0
    v_mov_b32 v89, 0
    v_mov_b32 v90, 0
    v_mov_b32 v91, 0
    v_mov_b32 v92, 0
    v_mov_b32 v93, 0
    v_mov_b32 v94, 0
    v_mov_b32 v95, 0
    v_mov_b32 v96, 0
    v_mov_b32 v97, 0
    v_mov_b32 v98, 0
    v_mov_b32 v99, 0
    v_mov_b32 v100, 0
    v_mov_b32 v101, 0
    v_mov_b32 v102, 0
    v_mov_b32 v103, 0
    v_mov_b32 v104, 0
    v_mov_b32 v105, 0
    v_mov_b32 v106, 0
    v_mov_b32 v107, 0
    v_mov_b32 v108, 0
    v_mov_b32 v109, 0
    v_mov_b32 v110, 0
    v_mov_b32 v111, 0
    v_mov_b32 v112, 0
    v_mov_b32 v113, 0
    v_mov_b32 v114, 0
    v_mov_b32 v115, 0
    v_mov_b32 v116, 0
    v_mov_b32 v117, 0
    v_mov_b32 v118, 0
    v_mov_b32 v119, 0
    v_mov_b32 v120, 0
    v_mov_b32 v121, 0
    v_mov_b32 v122, 0
    v_mov_b32 v123, 0
    s_mul_i32 s56, s42, 2048
    s_mul_i32 s57, s42, 1310720
    s_mov_b32 s58, 0
    s_mov_b32 s59, 0
    s_mul_i32 s63, s44, 2048
    s_mul_i32 s64, s44, 2048
    s_add_u32 s64, s64, 8192
    s_add_u32 s65, s58, s63
    s_add_u32 m0, s65, 0
    s_nop 0
    buffer_load_dwordx4 v6, s[12:15], s56 offen sc1 lds
    s_add_u32 s65, s58, s63
    s_add_u32 m0, s65, 1024
    s_nop 0
    buffer_load_dwordx4 v7, s[12:15], s56 offen sc1 lds
    s_add_u32 s65, s58, s64
    s_add_u32 m0, s65, 0
    s_nop 0
    buffer_load_dwordx4 v8, s[16:19], s57 offen lds
    s_add_u32 s65, s58, s64
    s_add_u32 m0, s65, 1024
    s_nop 0
    buffer_load_dwordx4 v9, s[16:19], s57 offen lds
    s_add_u32 s56, s56, 64
    s_add_u32 s57, s57, 40960
    s_add_u32 s58, s58, 16384
    s_cmp_ge_u32 s58, 131072
    s_cselect_b32 s58, 0, s58
    s_add_u32 s65, s58, s63
    s_add_u32 m0, s65, 0
    s_nop 0
    buffer_load_dwordx4 v6, s[12:15], s56 offen sc1 lds
    s_add_u32 s65, s58, s63
    s_add_u32 m0, s65, 1024
    s_nop 0
    buffer_load_dwordx4 v7, s[12:15], s56 offen sc1 lds
    s_add_u32 s65, s58, s64
    s_add_u32 m0, s65, 0
    s_nop 0
    buffer_load_dwordx4 v8, s[16:19], s57 offen lds
    s_add_u32 s65, s58, s64
    s_add_u32 m0, s65, 1024
    s_nop 0
    buffer_load_dwordx4 v9, s[16:19], s57 offen lds
    s_add_u32 s56, s56, 64
    s_add_u32 s57, s57, 40960
    s_add_u32 s58, s58, 16384
    s_cmp_ge_u32 s58, 131072
    s_cselect_b32 s58, 0, s58
    s_add_u32 s65, s58, s63
    s_add_u32 m0, s65, 0
    s_nop 0
    buffer_load_dwordx4 v6, s[12:15], s56 offen sc1 lds
    s_add_u32 s65, s58, s63
    s_add_u32 m0, s65, 1024
    s_nop 0
    buffer_load_dwordx4 v7, s[12:15], s56 offen sc1 lds
    s_add_u32 s65, s58, s64
    s_add_u32 m0, s65, 0
    s_nop 0
    buffer_load_dwordx4 v8, s[16:19], s57 offen lds
    s_add_u32 s65, s58, s64
    s_add_u32 m0, s65, 1024
    s_nop 0
    buffer_load_dwordx4 v9, s[16:19], s57 offen lds
    s_add_u32 s56, s56, 64
    s_add_u32 s57, s57, 40960
    s_add_u32 s58, s58, 16384
    s_cmp_ge_u32 s58, 131072
    s_cselect_b32 s58, 0, s58
    s_add_u32 s65, s58, s63
    s_add_u32 m0, s65, 0
    s_nop 0
    buffer_load_dwordx4 v6, s[12:15], s56 offen sc1 lds
    s_add_u32 s65, s58, s63
    s_add_u32 m0, s65, 1024
    s_nop 0
    buffer_load_dwordx4 v7, s[12:15], s56 offen sc1 lds
    s_add_u32 s65, s58, s64
    s_add_u32 m0, s65, 0
    s_nop 0
    buffer_load_dwordx4 v8, s[16:19], s57 offen lds
    s_add_u32 s65, s58, s64
    s_add_u32 m0, s65, 1024
    s_nop 0
    buffer_load_dwordx4 v9, s[16:19], s57 offen lds
    s_add_u32 s56, s56, 64
    s_add_u32 s57, s57, 40960
    s_add_u32 s58, s58, 16384
    s_cmp_ge_u32 s58, 131072
    s_cselect_b32 s58, 0, s58
    s_add_u32 s65, s58, s63
    s_add_u32 m0, s65, 0
    s_nop 0
    buffer_load_dwordx4 v6, s[12:15], s56 offen sc1 lds
    s_add_u32 s65, s58, s63
    s_add_u32 m0, s65, 1024
    s_nop 0
    buffer_load_dwordx4 v7, s[12:15], s56 offen sc1 lds
    s_add_u32 s65, s58, s64
    s_add_u32 m0, s65, 0
    s_nop 0
    buffer_load_dwordx4 v8, s[16:19], s57 offen lds
    s_add_u32 s65, s58, s64
    s_add_u32 m0, s65, 1024
    s_nop 0
    buffer_load_dwordx4 v9, s[16:19], s57 offen lds
    s_add_u32 s56, s56, 64
    s_add_u32 s57, s57, 40960
    s_add_u32 s58, s58, 16384
    s_cmp_ge_u32 s58, 131072
    s_cselect_b32 s58, 0, s58
    s_add_u32 s65, s58, s63
    s_add_u32 m0, s65, 0
    s_nop 0
    buffer_load_dwordx4 v6, s[12:15], s56 offen sc1 lds
    s_add_u32 s65, s58, s63
    s_add_u32 m0, s65, 1024
    s_nop 0
    buffer_load_dwordx4 v7, s[12:15], s56 offen sc1 lds
    s_add_u32 s65, s58, s64
    s_add_u32 m0, s65, 0
    s_nop 0
    buffer_load_dwordx4 v8, s[16:19], s57 offen lds
    s_add_u32 s65, s58, s64
    s_add_u32 m0, s65, 1024
    s_nop 0
    buffer_load_dwordx4 v9, s[16:19], s57 offen lds
    s_add_u32 s56, s56, 64
    s_add_u32 s57, s57, 40960
    s_add_u32 s58, s58, 16384
    s_cmp_ge_u32 s58, 131072
    s_cselect_b32 s58, 0, s58
    s_add_u32 s65, s58, s63
    s_add_u32 m0, s65, 0
    s_nop 0
    buffer_load_dwordx4 v6, s[12:15], s56 offen sc1 lds
    s_add_u32 s65, s58, s63
    s_add_u32 m0, s65, 1024
    s_nop 0
    buffer_load_dwordx4 v7, s[12:15], s56 offen sc1 lds
    s_add_u32 s65, s58, s64
    s_add_u32 m0, s65, 0
    s_nop 0
    buffer_load_dwordx4 v8, s[16:19], s57 offen lds
    s_add_u32 s65, s58, s64
    s_add_u32 m0, s65, 1024
    s_nop 0
    buffer_load_dwordx4 v9, s[16:19], s57 offen lds
    s_add_u32 s56, s56, 64
    s_add_u32 s57, s57, 40960
    s_add_u32 s58, s58, 16384
    s_cmp_ge_u32 s58, 131072
    s_cselect_b32 s58, 0, s58
    s_mov_b32 s62, 25
L_wo_loop:
    s_waitcnt vmcnt(24)
    s_barrier
    s_add_u32 s65, s58, s63
    s_add_u32 m0, s65, 0
    s_nop 0
    buffer_load_dwordx4 v6, s[12:15], s56 offen sc1 lds
    s_add_u32 s65, s58, s63
    s_add_u32 m0, s65, 1024
    s_nop 0
    buffer_load_dwordx4 v7, s[12:15], s56 offen sc1 lds
    s_add_u32 s65, s58, s64
    s_add_u32 m0, s65, 0
    s_nop 0
    buffer_load_dwordx4 v8, s[16:19], s57 offen lds
    s_add_u32 s65, s58, s64
    s_add_u32 m0, s65, 1024
    s_nop 0
    buffer_load_dwordx4 v9, s[16:19], s57 offen lds
    s_add_u32 s56, s56, 64
    s_add_u32 s57, s57, 40960
    s_add_u32 s58, s58, 16384
    s_cmp_ge_u32 s58, 131072
    s_cselect_b32 s58, 0, s58
    v_add_u32 v19, s59, v10
    v_add_u32 v20, s59, v11
    v_add_u32 v21, s59, v12
    v_add_u32 v22, s59, v13
    v_add_u32 v23, s59, v14
    ds_read_b128 v[28:31], v19 offset:0
    ds_read_b64_tr_b16 v[44:45], v20 offset:0
    ds_read_b64_tr_b16 v[46:47], v20 offset:1024
    ds_read_b64_tr_b16 v[48:49], v21 offset:0
    ds_read_b64_tr_b16 v[50:51], v21 offset:1024
    ds_read_b64_tr_b16 v[52:53], v22 offset:0
    ds_read_b64_tr_b16 v[54:55], v22 offset:1024
    ds_read_b64_tr_b16 v[56:57], v23 offset:0
    ds_read_b64_tr_b16 v[58:59], v23 offset:1024
    ds_read_b128 v[32:35], v19 offset:1024
    s_waitcnt lgkmcnt(7)
    v_mfma_f32_16x16x32_bf16 v[60:63], v[44:47], v[28:31], v[60:63]
    ds_read_b128 v[36:39], v19 offset:2048
    ds_read_b128 v[40:43], v19 offset:3072
    s_waitcnt lgkmcnt(7)
    v_mfma_f32_16x16x32_bf16 v[64:67], v[48:51], v[28:31], v[64:67]
    s_waitcnt lgkmcnt(5)
    v_mfma_f32_16x16x32_bf16 v[68:71], v[52:55], v[28:31], v[68:71]
    s_waitcnt lgkmcnt(3)
    v_mfma_f32_16x16x32_bf16 v[72:75], v[56:59], v[28:31], v[72:75]
    s_waitcnt lgkmcnt(2)
    v_mfma_f32_16x16x32_bf16 v[76:79], v[44:47], v[32:35], v[76:79]
    v_mfma_f32_16x16x32_bf16 v[80:83], v[48:51], v[32:35], v[80:83]
    v_mfma_f32_16x16x32_bf16 v[84:87], v[52:55], v[32:35], v[84:87]
    v_mfma_f32_16x16x32_bf16 v[88:91], v[56:59], v[32:35], v[88:91]
    s_waitcnt lgkmcnt(1)
    v_mfma_f32_16x16x32_bf16 v[92:95], v[44:47], v[36:39], v[92:95]
    v_mfma_f32_16x16x32_bf16 v[96:99], v[48:51], v[36:39], v[96:99]
    v_mfma_f32_16x16x32_bf16 v[100:103], v[52:55], v[36:39], v[100:103]
    v_mfma_f32_16x16x32_bf16 v[104:107], v[56:59], v[36:39], v[104:107]
    s_waitcnt lgkmcnt(0)
    v_mfma_f32_16x16x32_bf16 v[108:111], v[44:47], v[40:43], v[108:111]
    v_mfma_f32_16x16x32_bf16 v[112:115], v[48:51], v[40:43], v[112:115]
    v_mfma_f32_16x16x32_bf16 v[116:119], v[52:55], v[40:43], v[116:119]
    v_mfma_f32_16x16x32_bf16 v[120:123], v[56:59], v[40:43], v[120:123]
    s_add_u32 s59, s59, 16384
    s_cmp_ge_u32 s59, 131072
    s_cselect_b32 s59, 0, s59
    s_sub_u32 s62, s62, 1
    s_cmp_lg_u32 s62, 0
    s_cbranch_scc1 L_wo_loop
    s_waitcnt vmcnt(24)
    s_barrier
    v_add_u32 v19, s59, v10
    v_add_u32 v20, s59, v11
    v_add_u32 v21, s59, v12
    v_add_u32 v22, s59, v13
    v_add_u32 v23, s59, v14
    ds_read_b128 v[28:31], v19 offset:0
    ds_read_b64_tr_b16 v[44:45], v20 offset:0
    ds_read_b64_tr_b16 v[46:47], v20 offset:1024
    ds_read_b64_tr_b16 v[48:49], v21 offset:0
    ds_read_b64_tr_b16 v[50:51], v21 offset:1024
    ds_read_b64_tr_b16 v[52:53], v22 offset:0
    ds_read_b64_tr_b16 v[54:55], v22 offset:1024
    ds_read_b64_tr_b16 v[56:57], v23 offset:0
    ds_read_b64_tr_b16 v[58:59], v23 offset:1024
    ds_read_b128 v[32:35], v19 offset:1024
    s_waitcnt lgkmcnt(7)
    v_mfma_f32_16x16x32_bf16 v[60:63], v[44:47], v[28:31], v[60:63]
    ds_read_b128 v[36:39], v19 offset:2048
    ds_read_b128 v[40:43], v19 offset:3072
    s_waitcnt lgkmcnt(7)
    v_mfma_f32_16x16x32_bf16 v[64:67], v[48:51], v[28:31], v[64:67]
    s_waitcnt lgkmcnt(5)
    v_mfma_f32_16x16x32_bf16 v[68:71], v[52:55], v[28:31], v[68:71]
    s_waitcnt lgkmcnt(3)
    v_mfma_f32_16x16x32_bf16 v[72:75], v[56:59], v[28:31], v[72:75]
    s_waitcnt lgkmcnt(2)
    v_mfma_f32_16x16x32_bf16 v[76:79], v[44:47], v[32:35], v[76:79]
    v_mfma_f32_16x16x32_bf16 v[80:83], v[48:51], v[32:35], v[80:83]
    v_mfma_f32_16x16x32_bf16 v[84:87], v[52:55], v[32:35], v[84:87]
    v_mfma_f32_16x16x32_bf16 v[88:91], v[56:59], v[32:35], v[88:91]
    s_waitcnt lgkmcnt(1)
    v_mfma_f32_16x16x32_bf16 v[92:95], v[44:47], v[36:39], v[92:95]
    v_mfma_f32_16x16x32_bf16 v[96:99], v[48:51], v[36:39], v[96:99]
    v_mfma_f32_16x16x32_bf16 v[100:103], v[52:55], v[36:39], v[100:103]
    v_mfma_f32_16x16x32_bf16 v[104:107], v[56:59], v[36:39], v[104:107]
    s_waitcnt lgkmcnt(0)
    v_mfma_f32_16x16x32_bf16 v[108:111], v[44:47], v[40:43], v[108:111]
    v_mfma_f32_16x16x32_bf16 v[112:115], v[48:51], v[40:43], v[112:115]
    v_mfma_f32_16x16x32_bf16 v[116:119], v[52:55], v[40:43], v[116:119]
    v_mfma_f32_16x16x32_bf16 v[120:123], v[56:59], v[40:43], v[120:123]
    s_add_u32 s59, s59, 16384
    s_cmp_ge_u32 s59, 131072
    s_cselect_b32 s59, 0, s59
    s_waitcnt vmcnt(20)
    s_barrier
    v_add_u32 v19, s59, v10
    v_add_u32 v20, s59, v11
    v_add_u32 v21, s59, v12
    v_add_u32 v22, s59, v13
    v_add_u32 v23, s59, v14
    ds_read_b128 v[28:31], v19 offset:0
    ds_read_b64_tr_b16 v[44:45], v20 offset:0
    ds_read_b64_tr_b16 v[46:47], v20 offset:1024
    ds_read_b64_tr_b16 v[48:49], v21 offset:0
    ds_read_b64_tr_b16 v[50:51], v21 offset:1024
    ds_read_b64_tr_b16 v[52:53], v22 offset:0
    ds_read_b64_tr_b16 v[54:55], v22 offset:1024
    ds_read_b64_tr_b16 v[56:57], v23 offset:0
    ds_read_b64_tr_b16 v[58:59], v23 offset:1024
    ds_read_b128 v[32:35], v19 offset:1024
    s_waitcnt lgkmcnt(7)
    v_mfma_f32_16x16x32_bf16 v[60:63], v[44:47], v[28:31], v[60:63]
    ds_read_b128 v[36:39], v19 offset:2048
    ds_read_b128 v[40:43], v19 offset:3072
    s_waitcnt lgkmcnt(7)
    v_mfma_f32_16x16x32_bf16 v[64:67], v[48:51], v[28:31], v[64:67]
    s_waitcnt lgkmcnt(5)
    v_mfma_f32_16x16x32_bf16 v[68:71], v[52:55], v[28:31], v[68:71]
    s_waitcnt lgkmcnt(3)
    v_mfma_f32_16x16x32_bf16 v[72:75], v[56:59], v[28:31], v[72:75]
    s_waitcnt lgkmcnt(2)
    v_mfma_f32_16x16x32_bf16 v[76:79], v[44:47], v[32:35], v[76:79]
    v_mfma_f32_16x16x32_bf16 v[80:83], v[48:51], v[32:35], v[80:83]
    v_mfma_f32_16x16x32_bf16 v[84:87], v[52:55], v[32:35], v[84:87]
    v_mfma_f32_16x16x32_bf16 v[88:91], v[56:59], v[32:35], v[88:91]
    s_waitcnt lgkmcnt(1)
    v_mfma_f32_16x16x32_bf16 v[92:95], v[44:47], v[36:39], v[92:95]
    v_mfma_f32_16x16x32_bf16 v[96:99], v[48:51], v[36:39], v[96:99]
    v_mfma_f32_16x16x32_bf16 v[100:103], v[52:55], v[36:39], v[100:103]
    v_mfma_f32_16x16x32_bf16 v[104:107], v[56:59], v[36:39], v[104:107]
    s_waitcnt lgkmcnt(0)
    v_mfma_f32_16x16x32_bf16 v[108:111], v[44:47], v[40:43], v[108:111]
    v_mfma_f32_16x16x32_bf16 v[112:115], v[48:51], v[40:43], v[112:115]
    v_mfma_f32_16x16x32_bf16 v[116:119], v[52:55], v[40:43], v[116:119]
    v_mfma_f32_16x16x32_bf16 v[120:123], v[56:59], v[40:43], v[120:123]
    s_add_u32 s59, s59, 16384
    s_cmp_ge_u32 s59, 131072
    s_cselect_b32 s59, 0, s59
    s_waitcnt vmcnt(16)
    s_barrier
    v_add_u32 v19, s59, v10
    v_add_u32 v20, s59, v11
    v_add_u32 v21, s59, v12
    v_add_u32 v22, s59, v13
    v_add_u32 v23, s59, v14
    ds_read_b128 v[28:31], v19 offset:0
    ds_read_b64_tr_b16 v[44:45], v20 offset:0
    ds_read_b64_tr_b16 v[46:47], v20 offset:1024
    ds_read_b64_tr_b16 v[48:49], v21 offset:0
    ds_read_b64_tr_b16 v[50:51], v21 offset:1024
    ds_read_b64_tr_b16 v[52:53], v22 offset:0
    ds_read_b64_tr_b16 v[54:55], v22 offset:1024
    ds_read_b64_tr_b16 v[56:57], v23 offset:0
    ds_read_b64_tr_b16 v[58:59], v23 offset:1024
    ds_read_b128 v[32:35], v19 offset:1024
    s_waitcnt lgkmcnt(7)
    v_mfma_f32_16x16x32_bf16 v[60:63], v[44:47], v[28:31], v[60:63]
    ds_read_b128 v[36:39], v19 offset:2048
    ds_read_b128 v[40:43], v19 offset:3072
    s_waitcnt lgkmcnt(7)
    v_mfma_f32_16x16x32_bf16 v[64:67], v[48:51], v[28:31], v[64:67]
    s_waitcnt lgkmcnt(5)
    v_mfma_f32_16x16x32_bf16 v[68:71], v[52:55], v[28:31], v[68:71]
    s_waitcnt lgkmcnt(3)
    v_mfma_f32_16x16x32_bf16 v[72:75], v[56:59], v[28:31], v[72:75]
    s_waitcnt lgkmcnt(2)
    v_mfma_f32_16x16x32_bf16 v[76:79], v[44:47], v[32:35], v[76:79]
    v_mfma_f32_16x16x32_bf16 v[80:83], v[48:51], v[32:35], v[80:83]
    v_mfma_f32_16x16x32_bf16 v[84:87], v[52:55], v[32:35], v[84:87]
    v_mfma_f32_16x16x32_bf16 v[88:91], v[56:59], v[32:35], v[88:91]
    s_waitcnt lgkmcnt(1)
    v_mfma_f32_16x16x32_bf16 v[92:95], v[44:47], v[36:39], v[92:95]
    v_mfma_f32_16x16x32_bf16 v[96:99], v[48:51], v[36:39], v[96:99]
    v_mfma_f32_16x16x32_bf16 v[100:103], v[52:55], v[36:39], v[100:103]
    v_mfma_f32_16x16x32_bf16 v[104:107], v[56:59], v[36:39], v[104:107]
    s_waitcnt lgkmcnt(0)
    v_mfma_f32_16x16x32_bf16 v[108:111], v[44:47], v[40:43], v[108:111]
    v_mfma_f32_16x16x32_bf16 v[112:115], v[48:51], v[40:43], v[112:115]
    v_mfma_f32_16x16x32_bf16 v[116:119], v[52:55], v[40:43], v[116:119]
    v_mfma_f32_16x16x32_bf16 v[120:123], v[56:59], v[40:43], v[120:123]
    s_add_u32 s59, s59, 16384
    s_cmp_ge_u32 s59, 131072
    s_cselect_b32 s59, 0, s59
    s_waitcnt vmcnt(12)
    s_barrier
    v_add_u32 v19, s59, v10
    v_add_u32 v20, s59, v11
    v_add_u32 v21, s59, v12
    v_add_u32 v22, s59, v13
    v_add_u32 v23, s59, v14
    ds_read_b128 v[28:31], v19 offset:0
    ds_read_b64_tr_b16 v[44:45], v20 offset:0
    ds_read_b64_tr_b16 v[46:47], v20 offset:1024
    ds_read_b64_tr_b16 v[48:49], v21 offset:0
    ds_read_b64_tr_b16 v[50:51], v21 offset:1024
    ds_read_b64_tr_b16 v[52:53], v22 offset:0
    ds_read_b64_tr_b16 v[54:55], v22 offset:1024
    ds_read_b64_tr_b16 v[56:57], v23 offset:0
    ds_read_b64_tr_b16 v[58:59], v23 offset:1024
    ds_read_b128 v[32:35], v19 offset:1024
    s_waitcnt lgkmcnt(7)
    v_mfma_f32_16x16x32_bf16 v[60:63], v[44:47], v[28:31], v[60:63]
    ds_read_b128 v[36:39], v19 offset:2048
    ds_read_b128 v[40:43], v19 offset:3072
    s_waitcnt lgkmcnt(7)
    v_mfma_f32_16x16x32_bf16 v[64:67], v[48:51], v[28:31], v[64:67]
    s_waitcnt lgkmcnt(5)
    v_mfma_f32_16x16x32_bf16 v[68:71], v[52:55], v[28:31], v[68:71]
    s_waitcnt lgkmcnt(3)
    v_mfma_f32_16x16x32_bf16 v[72:75], v[56:59], v[28:31], v[72:75]
    s_waitcnt lgkmcnt(2)
    v_mfma_f32_16x16x32_bf16 v[76:79], v[44:47], v[32:35], v[76:79]
    v_mfma_f32_16x16x32_bf16 v[80:83], v[48:51], v[32:35], v[80:83]
    v_mfma_f32_16x16x32_bf16 v[84:87], v[52:55], v[32:35], v[84:87]
    v_mfma_f32_16x16x32_bf16 v[88:91], v[56:59], v[32:35], v[88:91]
    s_waitcnt lgkmcnt(1)
    v_mfma_f32_16x16x32_bf16 v[92:95], v[44:47], v[36:39], v[92:95]
    v_mfma_f32_16x16x32_bf16 v[96:99], v[48:51], v[36:39], v[96:99]
    v_mfma_f32_16x16x32_bf16 v[100:103], v[52:55], v[36:39], v[100:103]
    v_mfma_f32_16x16x32_bf16 v[104:107], v[56:59], v[36:39], v[104:107]
    s_waitcnt lgkmcnt(0)
    v_mfma_f32_16x16x32_bf16 v[108:111], v[44:47], v[40:43], v[108:111]
    v_mfma_f32_16x16x32_bf16 v[112:115], v[48:51], v[40:43], v[112:115]
    v_mfma_f32_16x16x32_bf16 v[116:119], v[52:55], v[40:43], v[116:119]
    v_mfma_f32_16x16x32_bf16 v[120:123], v[56:59], v[40:43], v[120:123]
    s_add_u32 s59, s59, 16384
    s_cmp_ge_u32 s59, 131072
    s_cselect_b32 s59, 0, s59
    s_waitcnt vmcnt(8)
    s_barrier
    v_add_u32 v19, s59, v10
    v_add_u32 v20, s59, v11
    v_add_u32 v21, s59, v12
    v_add_u32 v22, s59, v13
    v_add_u32 v23, s59, v14
    ds_read_b128 v[28:31], v19 offset:0
    ds_read_b64_tr_b16 v[44:45], v20 offset:0
    ds_read_b64_tr_b16 v[46:47], v20 offset:1024
    ds_read_b64_tr_b16 v[48:49], v21 offset:0
    ds_read_b64_tr_b16 v[50:51], v21 offset:1024
    ds_read_b64_tr_b16 v[52:53], v22 offset:0
    ds_read_b64_tr_b16 v[54:55], v22 offset:1024
    ds_read_b64_tr_b16 v[56:57], v23 offset:0
    ds_read_b64_tr_b16 v[58:59], v23 offset:1024
    ds_read_b128 v[32:35], v19 offset:1024
    s_waitcnt lgkmcnt(7)
    v_mfma_f32_16x16x32_bf16 v[60:63], v[44:47], v[28:31], v[60:63]
    ds_read_b128 v[36:39], v19 offset:2048
    ds_read_b128 v[40:43], v19 offset:3072
    s_waitcnt lgkmcnt(7)
    v_mfma_f32_16x16x32_bf16 v[64:67], v[48:51], v[28:31], v[64:67]
    s_waitcnt lgkmcnt(5)
    v_mfma_f32_16x16x32_bf16 v[68:71], v[52:55], v[28:31], v[68:71]
    s_waitcnt lgkmcnt(3)
    v_mfma_f32_16x16x32_bf16 v[72:75], v[56:59], v[28:31], v[72:75]
    s_waitcnt lgkmcnt(2)
    v_mfma_f32_16x16x32_bf16 v[76:79], v[44:47], v[32:35], v[76:79]
    v_mfma_f32_16x16x32_bf16 v[80:83], v[48:51], v[32:35], v[80:83]
    v_mfma_f32_16x16x32_bf16 v[84:87], v[52:55], v[32:35], v[84:87]
    v_mfma_f32_16x16x32_bf16 v[88:91], v[56:59], v[32:35], v[88:91]
    s_waitcnt lgkmcnt(1)
    v_mfma_f32_16x16x32_bf16 v[92:95], v[44:47], v[36:39], v[92:95]
    v_mfma_f32_16x16x32_bf16 v[96:99], v[48:51], v[36:39], v[96:99]
    v_mfma_f32_16x16x32_bf16 v[100:103], v[52:55], v[36:39], v[100:103]
    v_mfma_f32_16x16x32_bf16 v[104:107], v[56:59], v[36:39], v[104:107]
    s_waitcnt lgkmcnt(0)
    v_mfma_f32_16x16x32_bf16 v[108:111], v[44:47], v[40:43], v[108:111]
    v_mfma_f32_16x16x32_bf16 v[112:115], v[48:51], v[40:43], v[112:115]
    v_mfma_f32_16x16x32_bf16 v[116:119], v[52:55], v[40:43], v[116:119]
    v_mfma_f32_16x16x32_bf16 v[120:123], v[56:59], v[40:43], v[120:123]
    s_add_u32 s59, s59, 16384
    s_cmp_ge_u32 s59, 131072
    s_cselect_b32 s59, 0, s59
    s_waitcnt vmcnt(4)
    s_barrier
    v_add_u32 v19, s59, v10
    v_add_u32 v20, s59, v11
    v_add_u32 v21, s59, v12
    v_add_u32 v22, s59, v13
    v_add_u32 v23, s59, v14
    ds_read_b128 v[28:31], v19 offset:0
    ds_read_b64_tr_b16 v[44:45], v20 offset:0
    ds_read_b64_tr_b16 v[46:47], v20 offset:1024
    ds_read_b64_tr_b16 v[48:49], v21 offset:0
    ds_read_b64_tr_b16 v[50:51], v21 offset:1024
    ds_read_b64_tr_b16 v[52:53], v22 offset:0
    ds_read_b64_tr_b16 v[54:55], v22 offset:1024
    ds_read_b64_tr_b16 v[56:57], v23 offset:0
    ds_read_b64_tr_b16 v[58:59], v23 offset:1024
    ds_read_b128 v[32:35], v19 offset:1024
    s_waitcnt lgkmcnt(7)
    v_mfma_f32_16x16x32_bf16 v[60:63], v[44:47], v[28:31], v[60:63]
    ds_read_b128 v[36:39], v19 offset:2048
    ds_read_b128 v[40:43], v19 offset:3072
    s_waitcnt lgkmcnt(7)
    v_mfma_f32_16x16x32_bf16 v[64:67], v[48:51], v[28:31], v[64:67]
    s_waitcnt lgkmcnt(5)
    v_mfma_f32_16x16x32_bf16 v[68:71], v[52:55], v[28:31], v[68:71]
    s_waitcnt lgkmcnt(3)
    v_mfma_f32_16x16x32_bf16 v[72:75], v[56:59], v[28:31], v[72:75]
    s_waitcnt lgkmcnt(2)
    v_mfma_f32_16x16x32_bf16 v[76:79], v[44:47], v[32:35], v[76:79]
    v_mfma_f32_16x16x32_bf16 v[80:83], v[48:51], v[32:35], v[80:83]
    v_mfma_f32_16x16x32_bf16 v[84:87], v[52:55], v[32:35], v[84:87]
    v_mfma_f32_16x16x32_bf16 v[88:91], v[56:59], v[32:35], v[88:91]
    s_waitcnt lgkmcnt(1)
    v_mfma_f32_16x16x32_bf16 v[92:95], v[44:47], v[36:39], v[92:95]
    v_mfma_f32_16x16x32_bf16 v[96:99], v[48:51], v[36:39], v[96:99]
    v_mfma_f32_16x16x32_bf16 v[100:103], v[52:55], v[36:39], v[100:103]
    v_mfma_f32_16x16x32_bf16 v[104:107], v[56:59], v[36:39], v[104:107]
    s_waitcnt lgkmcnt(0)
    v_mfma_f32_16x16x32_bf16 v[108:111], v[44:47], v[40:43], v[108:111]
    v_mfma_f32_16x16x32_bf16 v[112:115], v[48:51], v[40:43], v[112:115]
    v_mfma_f32_16x16x32_bf16 v[116:119], v[52:55], v[40:43], v[116:119]
    v_mfma_f32_16x16x32_bf16 v[120:123], v[56:59], v[40:43], v[120:123]
    s_add_u32 s59, s59, 16384
    s_cmp_ge_u32 s59, 131072
    s_cselect_b32 s59, 0, s59
    s_waitcnt vmcnt(0)
    s_barrier
    v_add_u32 v19, s59, v10
    v_add_u32 v20, s59, v11
    v_add_u32 v21, s59, v12
    v_add_u32 v22, s59, v13
    v_add_u32 v23, s59, v14
    ds_read_b128 v[28:31], v19 offset:0
    ds_read_b64_tr_b16 v[44:45], v20 offset:0
    ds_read_b64_tr_b16 v[46:47], v20 offset:1024
    ds_read_b64_tr_b16 v[48:49], v21 offset:0
    ds_read_b64_tr_b16 v[50:51], v21 offset:1024
    ds_read_b64_tr_b16 v[52:53], v22 offset:0
    ds_read_b64_tr_b16 v[54:55], v22 offset:1024
    ds_read_b64_tr_b16 v[56:57], v23 offset:0
    ds_read_b64_tr_b16 v[58:59], v23 offset:1024
    ds_read_b128 v[32:35], v19 offset:1024
    s_waitcnt lgkmcnt(7)
    v_mfma_f32_16x16x32_bf16 v[60:63], v[44:47], v[28:31], v[60:63]
    ds_read_b128 v[36:39], v19 offset:2048
    ds_read_b128 v[40:43], v19 offset:3072
    s_waitcnt lgkmcnt(7)
    v_mfma_f32_16x16x32_bf16 v[64:67], v[48:51], v[28:31], v[64:67]
    s_waitcnt lgkmcnt(5)
    v_mfma_f32_16x16x32_bf16 v[68:71], v[52:55], v[28:31], v[68:71]
    s_waitcnt lgkmcnt(3)
    v_mfma_f32_16x16x32_bf16 v[72:75], v[56:59], v[28:31], v[72:75]
    s_waitcnt lgkmcnt(2)
    v_mfma_f32_16x16x32_bf16 v[76:79], v[44:47], v[32:35], v[76:79]
    v_mfma_f32_16x16x32_bf16 v[80:83], v[48:51], v[32:35], v[80:83]
    v_mfma_f32_16x16x32_bf16 v[84:87], v[52:55], v[32:35], v[84:87]
    v_mfma_f32_16x16x32_bf16 v[88:91], v[56:59], v[32:35], v[88:91]
    s_waitcnt lgkmcnt(1)
    v_mfma_f32_16x16x32_bf16 v[92:95], v[44:47], v[36:39], v[92:95]
    v_mfma_f32_16x16x32_bf16 v[96:99], v[48:51], v[36:39], v[96:99]
    v_mfma_f32_16x16x32_bf16 v[100:103], v[52:55], v[36:39], v[100:103]
    v_mfma_f32_16x16x32_bf16 v[104:107], v[56:59], v[36:39], v[104:107]
    s_waitcnt lgkmcnt(0)
    v_mfma_f32_16x16x32_bf16 v[108:111], v[44:47], v[40:43], v[108:111]
    v_mfma_f32_16x16x32_bf16 v[112:115], v[48:51], v[40:43], v[112:115]
    v_mfma_f32_16x16x32_bf16 v[116:119], v[52:55], v[40:43], v[116:119]
    v_mfma_f32_16x16x32_bf16 v[120:123], v[56:59], v[40:43], v[120:123]
    s_add_u32 s59, s59, 16384
    s_cmp_ge_u32 s59, 131072
    s_cselect_b32 s59, 0, s59
    s_nop 7
    s_nop 7
    s_mul_i32 s53, s42, 5242880
    s_add_u32 s53, s53, 0x7700000
    s_add_u32 s28, s4, s53
    s_addc_u32 s29, s5, 0
    s_mov_b32 s30, 0x500000
    s_mov_b32 s31, 0x20000
    v_and_b32 v3, 15, v2
    v_lshrrev_b32 v4, 4, v2
    s_mul_i32 s53, s41, 128
    s_mul_i32 s54, s45, 64
    s_add_u32 s53, s53, s54
    v_add_u32 v3, s53, v3
    s_mov_b32 s60, 2560
    v_mul_lo_u32 v3, v3, s60
    s_mul_i32 s53, s47, 128
    s_mul_i32 s54, s46, 64
    s_add_u32 s53, s53, s54
    v_lshl_add_u32 v4, v4, 2, s53
    v_lshl_add_u32 v3, v4, 2, v3
    buffer_store_dwordx4 v[60:63], v3, s[28:31], 0 offen offset:0
    buffer_store_dwordx4 v[64:67], v3, s[28:31], 0 offen offset:64
    buffer_store_dwordx4 v[68:71], v3, s[28:31], 0 offen offset:128
    buffer_store_dwordx4 v[72:75], v3, s[28:31], 0 offen offset:192
    v_add_u32 v3, 0xa000, v3
    buffer_store_dwordx4 v[76:79], v3, s[28:31], 0 offen offset:0
    buffer_store_dwordx4 v[80:83], v3, s[28:31], 0 offen offset:64
    buffer_store_dwordx4 v[84:87], v3, s[28:31], 0 offen offset:128
    buffer_store_dwordx4 v[88:91], v3, s[28:31], 0 offen offset:192
    v_add_u32 v3, 0xa000, v3
    buffer_store_dwordx4 v[92:95], v3, s[28:31], 0 offen offset:0
    buffer_store_dwordx4 v[96:99], v3, s[28:31], 0 offen offset:64
    buffer_store_dwordx4 v[100:103], v3, s[28:31], 0 offen offset:128
    buffer_store_dwordx4 v[104:107], v3, s[28:31], 0 offen offset:192
    v_add_u32 v3, 0xa000, v3
    buffer_store_dwordx4 v[108:111], v3, s[28:31], 0 offen offset:0
    buffer_store_dwordx4 v[112:115], v3, s[28:31], 0 offen offset:64
    buffer_store_dwordx4 v[116:119], v3, s[28:31], 0 offen offset:128
    buffer_store_dwordx4 v[120:123], v3, s[28:31], 0 offen offset:192
    s_barrier
    s_add_u32 s91, s91, 127
    s_branch L_w_a
L_ch_monitor:
    s_cmp_lg_u32 s40, 0
    s_cbranch_scc1 L_ch_done
    v_lshlrev_b32 v6, 4, v2
    v_add_u32 v7, 4096, v6
    v_mov_b32 v24, 120
    s_mov_b32 s62, 1
L_ch_mstep:
    s_sub_u32 s66, s62, 1
    s_and_b32 s66, s66, 3
    s_mul_i32 s67, s66, 655360
    s_mov_b32 s74, 0
L_ch_mpoll:
    s_add_u32 s68, s67, 0
    buffer_load_dwordx4 v[32:35], v6, s[24:27], s68 offen offset:0 sc1
    buffer_load_dwordx4 v[36:39], v6, s[24:27], s68 offen offset:1024 sc1
    buffer_load_dwordx4 v[40:43], v6, s[24:27], s68 offen offset:2048 sc1
    buffer_load_dwordx4 v[44:47], v6, s[24:27], s68 offen offset:3072 sc1
    buffer_load_dwordx4 v[48:51], v7, s[24:27], s68 offen offset:0 sc1
    buffer_load_dwordx4 v[52:55], v7, s[24:27], s68 offen offset:1024 sc1
    buffer_load_dwordx4 v[56:59], v7, s[24:27], s68 offen offset:2048 sc1
    buffer_load_dwordx4 v[60:63], v7, s[24:27], s68 offen offset:3072 sc1
    s_add_u32 s68, s67, 163840
    buffer_load_dwordx4 v[64:67], v6, s[24:27], s68 offen offset:0 sc1
    buffer_load_dwordx4 v[68:71], v6, s[24:27], s68 offen offset:1024 sc1
    buffer_load_dwordx4 v[72:75], v6, s[24:27], s68 offen offset:2048 sc1
    buffer_load_dwordx4 v[76:79], v6, s[24:27], s68 offen offset:3072 sc1
    buffer_load_dwordx4 v[80:83], v7, s[24:27], s68 offen offset:0 sc1
    buffer_load_dwordx4 v[84:87], v7, s[24:27], s68 offen offset:1024 sc1
    buffer_load_dwordx4 v[88:91], v7, s[24:27], s68 offen offset:2048 sc1
    buffer_load_dwordx4 v[92:95], v7, s[24:27], s68 offen offset:3072 sc1
    s_add_u32 s68, s67, 327680
    buffer_load_dwordx4 v[96:99], v6, s[24:27], s68 offen offset:0 sc1
    buffer_load_dwordx4 v[100:103], v6, s[24:27], s68 offen offset:1024 sc1
    buffer_load_dwordx4 v[104:107], v6, s[24:27], s68 offen offset:2048 sc1
    buffer_load_dwordx4 v[108:111], v6, s[24:27], s68 offen offset:3072 sc1
    buffer_load_dwordx4 v[112:115], v7, s[24:27], s68 offen offset:0 sc1
    buffer_load_dwordx4 v[116:119], v7, s[24:27], s68 offen offset:1024 sc1
    buffer_load_dwordx4 v[120:123], v7, s[24:27], s68 offen offset:2048 sc1
    buffer_load_dwordx4 v[124:127], v7, s[24:27], s68 offen offset:3072 sc1
    s_add_u32 s68, s67, 491520
    buffer_load_dwordx4 v[128:131], v6, s[24:27], s68 offen offset:0 sc1
    buffer_load_dwordx4 v[132:135], v6, s[24:27], s68 offen offset:1024 sc1
    buffer_load_dwordx4 v[136:139], v6, s[24:27], s68 offen offset:2048 sc1
    buffer_load_dwordx4 v[140:143], v6, s[24:27], s68 offen offset:3072 sc1
    buffer_load_dwordx4 v[144:147], v7, s[24:27], s68 offen offset:0 sc1
    buffer_load_dwordx4 v[148:151], v7, s[24:27], s68 offen offset:1024 sc1
    buffer_load_dwordx4 v[152:155], v7, s[24:27], s68 offen offset:2048 sc1
    buffer_load_dwordx4 v[156:159], v7, s[24:27], s68 offen offset:3072 sc1
    s_waitcnt vmcnt(0)
    v_max3_u32 v25, v32, v33, v34
    v_max3_u32 v25, v25, v35, v36
    v_max3_u32 v25, v25, v37, v38
    v_max3_u32 v25, v25, v39, v40
    v_max3_u32 v25, v25, v41, v42
    v_max3_u32 v25, v25, v43, v44
    v_max3_u32 v25, v25, v45, v46
    v_max3_u32 v25, v25, v47, v48
    v_max3_u32 v25, v25, v49, v50
    v_max3_u32 v25, v25, v51, v52
    v_max3_u32 v25, v25, v53, v54
    v_max3_u32 v25, v25, v55, v56
    v_max3_u32 v25, v25, v57, v58
    v_max3_u32 v25, v25, v59, v60
    v_max3_u32 v25, v25, v61, v62
    v_max3_u32 v25, v25, v63, v64
    v_max3_u32 v25, v25, v65, v66
    v_max3_u32 v25, v25, v67, v68
    v_max3_u32 v25, v25, v69, v70
    v_max3_u32 v25, v25, v71, v72
    v_max3_u32 v25, v25, v73, v74
    v_max3_u32 v25, v25, v75, v76
    v_max3_u32 v25, v25, v77, v78
    v_max3_u32 v25, v25, v79, v80
    v_max3_u32 v25, v25, v81, v82
    v_max3_u32 v25, v25, v83, v84
    v_max3_u32 v25, v25, v85, v86
    v_max3_u32 v25, v25, v87, v88
    v_max3_u32 v25, v25, v89, v90
    v_max3_u32 v25, v25, v91, v92
    v_max3_u32 v25, v25, v93, v94
    v_max3_u32 v25, v25, v95, v96
    v_max3_u32 v25, v25, v97, v98
    v_max3_u32 v25, v25, v99, v100
    v_max3_u32 v25, v25, v101, v102
    v_max3_u32 v25, v25, v103, v104
    v_max3_u32 v25, v25, v105, v106
    v_max3_u32 v25, v25, v107, v108
    v_max3_u32 v25, v25, v109, v110
    v_max3_u32 v25, v25, v111, v112
    v_max3_u32 v25, v25, v113, v114
    v_max3_u32 v25, v25, v115, v116
    v_max3_u32 v25, v25, v117, v118
    v_max3_u32 v25, v25, v119, v120
    v_max3_u32 v25, v25, v121, v122
    v_max3_u32 v25, v25, v123, v124
    v_max3_u32 v25, v25, v125, v126
    v_max3_u32 v25, v25, v127, v128
    v_max3_u32 v25, v25, v129, v130
    v_max3_u32 v25, v25, v131, v132
    v_max3_u32 v25, v25, v133, v134
    v_max3_u32 v25, v25, v135, v136
    v_max3_u32 v25, v25, v137, v138
    v_max3_u32 v25, v25, v139, v140
    v_max3_u32 v25, v25, v141, v142
    v_max3_u32 v25, v25, v143, v144
    v_max3_u32 v25, v25, v145, v146
    v_max3_u32 v25, v25, v147, v148
    v_max3_u32 v25, v25, v149, v150
    v_max3_u32 v25, v25, v151, v152
    v_max3_u32 v25, v25, v153, v154
    v_max3_u32 v25, v25, v155, v156
    v_max3_u32 v25, v25, v157, v158
    v_max_u32 v25, v25, v159
    v_cmp_eq_u32 vcc, -1, v25
    s_add_u32 s74, s74, 1
    s_cmp_ge_u32 s74, 262144
    s_cbranch_scc1 L_ch_done
    s_cbranch_vccz L_ch_mok
    s_sleep 16
    s_branch L_ch_mpoll
L_ch_mok:
    s_sub_u32 s66, s62, 1
    v_mov_b32 v25, s66
    s_mov_b64 exec, 1
    buffer_store_dword v25, v24, s[92:95], 0 offen sc1
    s_mov_b64 exec, -1
    s_add_u32 s62, s62, 1
    s_cmp_lt_u32 s62, 64
    s_cbranch_scc1 L_ch_mstep
    v_lshlrev_b32 v6, 3, v2
    v_add_u32 v6, 256, v6
    s_mov_b32 s74, 0
L_ch_mlast:
    buffer_load_dwordx2 v[32:33], v6, s[92:95], 0 offen sc1
    s_waitcnt vmcnt(0)
    v_min_u32 v32, v32, v33
    v_cmp_gt_u32 vcc, 64, v32
    s_add_u32 s74, s74, 1
    s_cmp_ge_u32 s74, 262144
    s_cbranch_scc1 L_ch_done
    s_cbranch_vccnz L_ch_mlast
    v_mov_b32 v25, 64
    s_mov_b64 exec, 1
    buffer_store_dword v25, v24, s[92:95], 0 offen sc1
    s_mov_b64 exec, -1
    s_branch L_ch_done
L_ch_done:
    s_endpgm
.globl fin_kernel
.p2align 8
.type fin_kernel,@function
fin_kernel:
    s_cmp_ge_u32 s2, 640
    s_cbranch_scc1 L_fin_done
    s_load_dwordx2 s[4:5], s[0:1], 104
    s_load_dwordx2 s[6:7], s[0:1], 0
    s_load_dwordx2 s[8:9], s[0:1], 88
    s_waitcnt lgkmcnt(0)
    s_mov_b32 s12, s6
    s_mov_b32 s13, s7
    s_mov_b32 s14, 0x280000
    s_mov_b32 s15, 0x20000
    s_add_u32 s16, s4, 0x5080000
    s_addc_u32 s17, s5, 0
    s_mov_b32 s18, 0x280000
    s_mov_b32 s19, 0x20000
    s_add_u32 s20, s4, 0x7700000
    s_addc_u32 s21, s5, 0
    s_mov_b32 s22, 0x1e00000
    s_mov_b32 s23, 0x20000
    s_mov_b32 s24, s8
    s_mov_b32 s25, s9
    s_mov_b32 s26, 0x280000
    s_mov_b32 s27, 0x20000
    s_lshl_b32 s3, s2, 8
    v_add_u32 v1, s3, v0
    v_lshlrev_b32 v2, 4, v1
    v_lshlrev_b32 v3, 5, v1
    buffer_load_dwordx4 v[8:11], v2, s[12:15], 0 offen
    buffer_load_dwordx4 v[12:15], v2, s[16:19], 0 offen
    s_mov_b32 s30, 0x0
    buffer_load_dwordx4 v[48:51], v3, s[20:23], s30 offen
    buffer_load_dwordx4 v[52:55], v3, s[20:23], s30 offen offset:16
    s_mov_b32 s30, 0x500000
    buffer_load_dwordx4 v[56:59], v3, s[20:23], s30 offen
    buffer_load_dwordx4 v[60:63], v3, s[20:23], s30 offen offset:16
    s_mov_b32 s30, 0xa00000
    buffer_load_dwordx4 v[64:67], v3, s[20:23], s30 offen
    buffer_load_dwordx4 v[68:71], v3, s[20:23], s30 offen offset:16
    s_mov_b32 s30, 0xf00000
    buffer_load_dwordx4 v[72:75], v3, s[20:23], s30 offen
    buffer_load_dwordx4 v[76:79], v3, s[20:23], s30 offen offset:16
    s_mov_b32 s30, 0x1400000
    buffer_load_dwordx4 v[80:83], v3, s[20:23], s30 offen
    buffer_load_dwordx4 v[84:87], v3, s[20:23], s30 offen offset:16
    s_mov_b32 s30, 0x1900000
    buffer_load_dwordx4 v[88:91], v3, s[20:23], s30 offen
    buffer_load_dwordx4 v[92:95], v3, s[20:23], s30 offen offset:16
    s_waitcnt vmcnt(0)
    v_add_f32 v16, v48, v56
    v_add_f32 v16, v16, v64
    v_add_f32 v16, v16, v72
    v_add_f32 v16, v16, v80
    v_add_f32 v16, v16, v88
    v_cvt_pk_bf16_f32 v16, v16, v16
    v_lshlrev_b32 v16, 16, v16
    v_lshlrev_b32 v40, 16, v8
    v_lshlrev_b32 v41, 16, v12
    v_add_f32 v16, v40, v16
    v_cvt_pk_bf16_f32 v16, v16, v16
    v_lshlrev_b32 v16, 16, v16
    v_add_f32 v16, v16, v41
    v_add_f32 v17, v49, v57
    v_add_f32 v17, v17, v65
    v_add_f32 v17, v17, v73
    v_add_f32 v17, v17, v81
    v_add_f32 v17, v17, v89
    v_cvt_pk_bf16_f32 v17, v17, v17
    v_lshlrev_b32 v17, 16, v17
    v_and_b32 v40, 0xffff0000, v8
    v_and_b32 v41, 0xffff0000, v12
    v_add_f32 v17, v40, v17
    v_cvt_pk_bf16_f32 v17, v17, v17
    v_lshlrev_b32 v17, 16, v17
    v_add_f32 v17, v17, v41
    v_add_f32 v18, v50, v58
    v_add_f32 v18, v18, v66
    v_add_f32 v18, v18, v74
    v_add_f32 v18, v18, v82
    v_add_f32 v18, v18, v90
    v_cvt_pk_bf16_f32 v18, v18, v18
    v_lshlrev_b32 v18, 16, v18
    v_lshlrev_b32 v40, 16, v9
    v_lshlrev_b32 v41, 16, v13
    v_add_f32 v18, v40, v18
    v_cvt_pk_bf16_f32 v18, v18, v18
    v_lshlrev_b32 v18, 16, v18
    v_add_f32 v18, v18, v41
    v_add_f32 v19, v51, v59
    v_add_f32 v19, v19, v67
    v_add_f32 v19, v19, v75
    v_add_f32 v19, v19, v83
    v_add_f32 v19, v19, v91
    v_cvt_pk_bf16_f32 v19, v19, v19
    v_lshlrev_b32 v19, 16, v19
    v_and_b32 v40, 0xffff0000, v9
    v_and_b32 v41, 0xffff0000, v13
    v_add_f32 v19, v40, v19
    v_cvt_pk_bf16_f32 v19, v19, v19
    v_lshlrev_b32 v19, 16, v19
    v_add_f32 v19, v19, v41
    v_add_f32 v20, v52, v60
    v_add_f32 v20, v20, v68
    v_add_f32 v20, v20, v76
    v_add_f32 v20, v20, v84
    v_add_f32 v20, v20, v92
    v_cvt_pk_bf16_f32 v20, v20, v20
    v_lshlrev_b32 v20, 16, v20
    v_lshlrev_b32 v40, 16, v10
    v_lshlrev_b32 v41, 16, v14
    v_add_f32 v20, v40, v20
    v_cvt_pk_bf16_f32 v20, v20, v20
    v_lshlrev_b32 v20, 16, v20
    v_add_f32 v20, v20, v41
    v_add_f32 v21, v53, v61
    v_add_f32 v21, v21, v69
    v_add_f32 v21, v21, v77
    v_add_f32 v21, v21, v85
    v_add_f32 v21, v21, v93
    v_cvt_pk_bf16_f32 v21, v21, v21
    v_lshlrev_b32 v21, 16, v21
    v_and_b32 v40, 0xffff0000, v10
    v_and_b32 v41, 0xffff0000, v14
    v_add_f32 v21, v40, v21
    v_cvt_pk_bf16_f32 v21, v21, v21
    v_lshlrev_b32 v21, 16, v21
    v_add_f32 v21, v21, v41
    v_add_f32 v22, v54, v62
    v_add_f32 v22, v22, v70
    v_add_f32 v22, v22, v78
    v_add_f32 v22, v22, v86
    v_add_f32 v22, v22, v94
    v_cvt_pk_bf16_f32 v22, v22, v22
    v_lshlrev_b32 v22, 16, v22
    v_lshlrev_b32 v40, 16, v11
    v_lshlrev_b32 v41, 16, v15
    v_add_f32 v22, v40, v22
    v_cvt_pk_bf16_f32 v22, v22, v22
    v_lshlrev_b32 v22, 16, v22
    v_add_f32 v22, v22, v41
    v_add_f32 v23, v55, v63
    v_add_f32 v23, v23, v71
    v_add_f32 v23, v23, v79
    v_add_f32 v23, v23, v87
    v_add_f32 v23, v23, v95
    v_cvt_pk_bf16_f32 v23, v23, v23
    v_lshlrev_b32 v23, 16, v23
    v_and_b32 v40, 0xffff0000, v11
    v_and_b32 v41, 0xffff0000, v15
    v_add_f32 v23, v40, v23
    v_cvt_pk_bf16_f32 v23, v23, v23
    v_lshlrev_b32 v23, 16, v23
    v_add_f32 v23, v23, v41
    v_cvt_pk_bf16_f32 v44, v16, v17
    v_cvt_pk_bf16_f32 v45, v18, v19
    v_cvt_pk_bf16_f32 v46, v20, v21
    v_cvt_pk_bf16_f32 v47, v22, v23
    buffer_store_dwordx4 v[44:47], v2, s[24:27], 0 offen
L_fin_done:
    s_endpgm
.section .rodata,"a"
.p2align 6
.amdhsa_kernel ln_kernel
  .amdhsa_next_free_vgpr 64
  .amdhsa_next_free_sgpr 102
  .amdhsa_accum_offset 64
  .amdhsa_group_segment_fixed_size 0
  .amdhsa_kernarg_size 112
  .amdhsa_user_sgpr_count 2
  .amdhsa_user_sgpr_kernarg_segment_ptr 1
  .amdhsa_system_sgpr_workgroup_id_x 1
.end_amdhsa_kernel
.p2align 6
.amdhsa_kernel chain_kernel
  .amdhsa_next_free_vgpr 512
  .amdhsa_next_free_sgpr 102
  .amdhsa_accum_offset 256
  .amdhsa_group_segment_fixed_size 0
  .amdhsa_kernarg_size 112
  .amdhsa_user_sgpr_count 2
  .amdhsa_user_sgpr_kernarg_segment_ptr 1
  .amdhsa_system_sgpr_workgroup_id_x 1
.end_amdhsa_kernel
.p2align 6
.amdhsa_kernel fin_kernel
  .amdhsa_next_free_vgpr 96
  .amdhsa_next_free_sgpr 102
  .amdhsa_accum_offset 96
  .amdhsa_group_segment_fixed_size 0
  .amdhsa_kernarg_size 112
  .amdhsa_user_sgpr_count 2
  .amdhsa_user_sgpr_kernarg_segment_ptr 1
  .amdhsa_system_sgpr_workgroup_id_x 1
.end_amdhsa_kernel
```
